```python
import torch

def _softmax(x, axis=-1):
    return torch.softmax(x, dim=axis)
def _gelu(x):
    return torch.nn.functional.gelu(x, approximate="tanh")
def _silu(x):
    return torch.nn.functional.silu(x)
def _sigmoid(x):
    return torch.sigmoid(x)
def _layernorm(x, axis=-1, eps=1e-5):
    m = x.mean(dim=axis, keepdim=True)
    v = x.var(dim=axis, keepdim=True, unbiased=False)
    return (x - m) / torch.sqrt(v + eps)
def _scatter_add(tgt, idx, src, axis=0):
    return tgt.clone().index_add_(axis, idx, src)
def _segment_sum(src, seg, n):
    out = torch.zeros((n,) + src.shape[1:], dtype=src.dtype)
    return out.index_add_(0, seg, src)
def _pad(x, pw):
    flat = tuple(v for pair in reversed(pw) for v in pair)
    return torch.nn.functional.pad(x, flat)

kernel_name = 'recurrent_scan__sliding_block_cached__dense_activation_squared_relu__prompt'

def setup_inputs():

    _w = (lambda a: (lambda t: t.to(torch.bfloat16) if t.is_floating_point() else t)(torch.as_tensor(a)))
    def _A_setup():
        B, Sq, D = 1, 2048, 1024
        Hq, Hkv, Sk, Dh = 32, 4, 2048, 128
        assert Hq % Hkv == 0, (Hq, Hkv)
        return {
            "x": _w((lambda *s: torch.randn(*s, dtype=torch.bfloat16) * 0.05)(B, Sq, D)),
            "k_cache": _w((lambda *s: torch.randn(*s, dtype=torch.bfloat16) * 0.8)(B, Hkv, Sk, Dh)),
            "v_cache": _w((lambda *s: torch.randn(*s, dtype=torch.bfloat16) * 0.2)(B, Hkv, Sk, Dh)),
            "wq": _w((lambda *s: torch.randn(*s, dtype=torch.bfloat16) * 0.8)(D, Hq * Dh) * (D ** -0.5)),
            "wo": _w((lambda *s: torch.randn(*s, dtype=torch.bfloat16) * 0.2)(Hq * Dh, D) * ((Hq * Dh) ** -0.5)),
        }
    _A_in = _A_setup()

    def _B_setup():
        B, S, D, F = 1, 2048, 1024, 3584
        return {
            "x": _w((lambda *s: torch.randn(*s, dtype=torch.bfloat16) * 0.05)(B, S, D)),
            "w1": _w((lambda *s: torch.randn(*s, dtype=torch.bfloat16) * 0.1)(D, F)),
            "b1": _w((lambda *s: torch.randn(*s, dtype=torch.bfloat16) * 0.1)(F)),
            "w2": _w((lambda *s: torch.randn(*s, dtype=torch.bfloat16) * 0.1)(F, D)),
            "b2": _w((lambda *s: torch.randn(*s, dtype=torch.bfloat16) * 0.1)(D)),
        }
    _B_in = _B_setup()

    return {
        "A_x": _A_in["x"],
        "A_k_cache": _A_in["k_cache"],
        "A_v_cache": _A_in["v_cache"],
        "A_wq": _A_in["wq"],
        "A_wo": _A_in["wo"],
        "B_x": _B_in["x"],
        "B_w1": _B_in["w1"],
        "B_b1": _B_in["b1"],
        "B_w2": _B_in["w2"],
        "B_b2": _B_in["b2"],
    }

def reference(A_x, A_k_cache, A_v_cache, A_wq, A_wo, B_x, B_w1, B_b1, B_w2, B_b2):
    def _A_ref(x, k_cache, v_cache, wq, wo):
        B, Sq, D = x.shape
        Hq, Dh = 32, 128
        Hkv, Sk = k_cache.shape[1], k_cache.shape[2]
        W = min(4096, max(256, Sk // 4))
        rep = Hq // Hkv
        q = (lambda x, *d: x.permute(*d))((x @ wq).reshape(B, Sq, Hq, Dh), 0, 2, 1, 3)
        k = (lambda x, n, axis: torch.repeat_interleave(x, n, dim=axis))(k_cache[:, :, Sk - W:, :], rep, axis=1)
        v = (lambda x, n, axis: torch.repeat_interleave(x, n, dim=axis))(v_cache[:, :, Sk - W:, :], rep, axis=1)
        scores = torch.einsum("bhqd,bhkd->bhqk", q, k) * (Dh ** -0.5)
        p = _softmax(scores, axis=-1)
        o = torch.einsum("bhqk,bhkd->bhqd", p, v)
        return (lambda x, *d: x.permute(*d))(o, 0, 2, 1, 3).reshape(B, Sq, Hq * Dh) @ wo

    def _B_ref(x, w1, b1, w2, b2):
        h = torch.einsum("bsd,df->bsf", x, w1) + b1
        zero = torch.zeros_like(h)
        r = torch.where(h > zero, h, zero)
        h = r * r
        out = torch.einsum("bsf,fd->bsd", h, w2) + b2
        return out

    x = A_x
    xn = _layernorm(x, axis=-1)
    s = _A_ref(xn, A_k_cache, A_v_cache, A_wq, A_wo)
    g = _silu(_B_ref(xn, B_w1, B_b1, B_w2, B_b2))
    return x + s * g
```

```asm
; @launch grid=(256,1,1) block=(256,1,1) lds=163840
.amdgcn_target "amdgcn-amd-amdhsa--gfx950"
.text
.globl recurrent_scan__sliding_block_cached__dense_activation_squared_relu__prompt_kernel
.p2align 8
.type recurrent_scan__sliding_block_cached__dense_activation_squared_relu__prompt_kernel,@function
recurrent_scan__sliding_block_cached__dense_activation_squared_relu__prompt_kernel:
s_cmp_ge_u32 s2, 256
s_cbranch_scc1 L_end_k
s_load_dwordx16 s[64:79], s[0:1], 0
s_load_dwordx8 s[80:87], s[0:1], 64
s_load_dwordx2 s[88:89], s[0:1], 96
v_lshrrev_b32 v15, 6, v0
s_nop 0
v_readfirstlane_b32 s26, v15
s_and_b32 s34, s2, 7
s_lshr_b32 s35, s2, 3
s_and_b32 s36, s34, 3
s_lshl_b32 s36, s36, 3
s_and_b32 s37, s35, 7
s_add_u32 s27, s36, s37
s_lshr_b32 s36, s34, 2
s_lshl_b32 s36, s36, 2
s_lshr_b32 s37, s35, 3
s_add_u32 s28, s36, s37
v_and_b32 v15, 63, v0
s_lshl_b32 s36, s28, 8
s_lshl_b32 s37, s27, 3
s_add_u32 s36, s36, s37
s_lshl_b32 s37, s26, 1
s_add_u32 s36, s36, s37
v_lshrrev_b32 v16, 5, v15
v_add_u32 v16, s36, v16
v_and_b32 v17, 31, v15
v_lshlrev_b32 v20, 4, v17
v_lshl_add_u32 v20, v16, 11, v20
v_and_b32 v17, 15, v15
v_lshrrev_b32 v18, 4, v15
s_bitcmp1_b32 s26, 0
s_mov_b32 s38, 8192
s_cselect_b32 s36, 7168, s38
s_mov_b32 s38, 0x100
s_cselect_b32 s37, 224, s38
s_cselect_b32 s38, 14, 16
s_lshl_b32 s35, s36, 2
s_mul_i32 s32, s36, 124
s_mov_b32 s33, 0
s_mul_i32 s37, s37, s27
s_lshl_b32 s39, s28, 1
s_lshr_b32 s3, s26, 1
s_add_u32 s39, s39, s3
s_lshl_b32 s3, s39, 3
v_add_u32 v19, s3, v18
v_mul_lo_u32 v19, v19, s36
v_lshl_add_u32 v19, v17, 4, v19
v_add_u32 v19, s37, v19
v_mov_b32 v21, 0x40000000
v_cmp_gt_u32 vcc, s38, v17
s_nop 1
v_cndmask_b32 v22, v21, v19, vcc
s_lshl_b32 s3, s27, 4
s_add_u32 s3, s3, s39
s_lshl_b32 s3, s3, 10
s_and_b32 s36, s26, 1
s_lshl_b32 s36, s36, 9
s_add_u32 s3, s3, s36
s_add_u32 s3, s3, 0
v_lshlrev_b32 v19, 5, v17
v_lshl_add_u32 v19, v18, 4, v19
v_add_u32 v19, s3, v19
v_cmp_gt_u32 vcc, 32, v15
s_nop 1
v_cndmask_b32 v23, v21, v19, vcc
s_lshl_b32 s36, s28, 8
s_lshl_b32 s37, s26, 6
s_add_u32 s36, s36, s37
v_lshrrev_b32 v12, 3, v15
v_bfe_u32 v13, v15, 4, 1
v_bfe_u32 v14, v15, 5, 1
v_lshl_or_b32 v13, v14, 2, v13
v_xor_b32 v13, v13, v15
v_and_b32 v13, 7, v13
v_add_u32 v12, s36, v12
v_lshlrev_b32 v13, 4, v13
v_lshl_add_u32 v3, v12, 11, v13
v_xor_b32 v80, 96, v3
s_lshl_b32 s25, s26, 12
s_lshl_b32 s54, s26, 11
s_lshl_b32 s55, s26, 13
s_waitcnt lgkmcnt(0)
s_mov_b32 s8, s64
s_and_b32 s9, s65, 0xffff
s_mov_b32 s10, 0x400000
s_mov_b32 s11, 0x00020000
s_bitcmp1_b32 s26, 0
s_cselect_b32 s60, s76, s70
s_cselect_b32 s61, s77, s71
s_mov_b32 s36, 7340032
s_mov_b32 s37, 8388608
s_cselect_b32 s62, s36, s37
s_and_b32 s61, s61, 0xffff
s_mov_b32 s63, 0x00020000
buffer_load_dwordx4 v[24:27], v20, s[8:11], 0 offen offset:0
buffer_load_dwordx4 a[96:99], v22, s[60:63], s33 offen
s_add_u32 s33, s33, s35
buffer_load_dwordx4 a[100:103], v22, s[60:63], s33 offen
s_add_u32 s33, s33, s32
s_lshl_b32 s38, s27, 8
s_mul_i32 s39, s27, 224
s_lshl_b32 s29, s26, 8
v_add_u32 v1, s29, v15
v_add_u32 v1, 0, v1
v_mul_u32_u24 v2, 3641, v1
v_lshrrev_b32 v2, 16, v2
v_mul_u32_u24 v12, 18, v2
v_sub_u32 v12, v1, v12
v_bfe_u32 v18, v2, 2, 2
v_lshlrev_b32 v18, 3, v18
v_lshrrev_b32 v19, 4, v2
v_lshl_or_b32 v18, v19, 2, v18
v_and_b32 v2, 3, v2
v_or_b32 v2, v2, v18
v_lshlrev_b32 v13, 13, v2
v_lshl_add_u32 v13, v12, 4, v13
v_add_u32 v13, s38, v13
v_cmp_gt_u32 vcc, 16, v12
v_mov_b32 v14, 0x40000000
s_nop 0
v_cndmask_b32 v13, v14, v13, vcc
v_subrev_u32 v14, 576, v1
v_mul_u32_u24 v2, 4682, v14
v_lshrrev_b32 v2, 16, v2
v_mul_u32_u24 v12, 14, v2
v_sub_u32 v12, v14, v12
v_bfe_u32 v18, v2, 2, 2
v_lshlrev_b32 v18, 3, v18
v_lshrrev_b32 v19, 4, v2
v_lshl_or_b32 v18, v19, 2, v18
v_and_b32 v2, 3, v2
v_or_b32 v2, v2, v18
v_mul_u32_u24 v14, 7168, v2
v_lshl_add_u32 v14, v12, 4, v14
v_add_u32 v14, s39, v14
v_cmp_gt_u32 vcc, 576, v1
s_nop 1
v_cndmask_b32 v4, v14, v13, vcc
v_add_u32 v4, 4096, v4
v_add_u32 v1, s29, v15
v_add_u32 v1, 64, v1
v_mul_u32_u24 v2, 3641, v1
v_lshrrev_b32 v2, 16, v2
v_mul_u32_u24 v12, 18, v2
v_sub_u32 v12, v1, v12
v_bfe_u32 v18, v2, 2, 2
v_lshlrev_b32 v18, 3, v18
v_lshrrev_b32 v19, 4, v2
v_lshl_or_b32 v18, v19, 2, v18
v_and_b32 v2, 3, v2
v_or_b32 v2, v2, v18
v_lshlrev_b32 v13, 13, v2
v_lshl_add_u32 v13, v12, 4, v13
v_add_u32 v13, s38, v13
v_cmp_gt_u32 vcc, 16, v12
v_mov_b32 v14, 0x40000000
s_nop 0
v_cndmask_b32 v13, v14, v13, vcc
v_subrev_u32 v14, 576, v1
v_mul_u32_u24 v2, 4682, v14
v_lshrrev_b32 v2, 16, v2
v_mul_u32_u24 v12, 14, v2
v_sub_u32 v12, v14, v12
v_bfe_u32 v18, v2, 2, 2
v_lshlrev_b32 v18, 3, v18
v_lshrrev_b32 v19, 4, v2
v_lshl_or_b32 v18, v19, 2, v18
v_and_b32 v2, 3, v2
v_or_b32 v2, v2, v18
v_mul_u32_u24 v14, 7168, v2
v_lshl_add_u32 v14, v12, 4, v14
v_add_u32 v14, s39, v14
v_cmp_gt_u32 vcc, 576, v1
s_nop 1
v_cndmask_b32 v5, v14, v13, vcc
v_add_u32 v5, 3072, v5
v_add_u32 v1, s29, v15
v_add_u32 v1, 128, v1
v_mul_u32_u24 v2, 3641, v1
v_lshrrev_b32 v2, 16, v2
v_mul_u32_u24 v12, 18, v2
v_sub_u32 v12, v1, v12
v_bfe_u32 v18, v2, 2, 2
v_lshlrev_b32 v18, 3, v18
v_lshrrev_b32 v19, 4, v2
v_lshl_or_b32 v18, v19, 2, v18
v_and_b32 v2, 3, v2
v_or_b32 v2, v2, v18
v_lshlrev_b32 v13, 13, v2
v_lshl_add_u32 v13, v12, 4, v13
v_add_u32 v13, s38, v13
v_cmp_gt_u32 vcc, 16, v12
v_mov_b32 v14, 0x40000000
s_nop 0
v_cndmask_b32 v13, v14, v13, vcc
v_subrev_u32 v14, 576, v1
v_mul_u32_u24 v2, 4682, v14
v_lshrrev_b32 v2, 16, v2
v_mul_u32_u24 v12, 14, v2
v_sub_u32 v12, v14, v12
v_bfe_u32 v18, v2, 2, 2
v_lshlrev_b32 v18, 3, v18
v_lshrrev_b32 v19, 4, v2
v_lshl_or_b32 v18, v19, 2, v18
v_and_b32 v2, 3, v2
v_or_b32 v2, v2, v18
v_mul_u32_u24 v14, 7168, v2
v_lshl_add_u32 v14, v12, 4, v14
v_add_u32 v14, s39, v14
v_cmp_gt_u32 vcc, 576, v1
s_nop 1
v_cndmask_b32 v6, v14, v13, vcc
v_add_u32 v6, 2048, v6
v_add_u32 v1, s29, v15
v_add_u32 v1, 192, v1
v_mul_u32_u24 v2, 3641, v1
v_lshrrev_b32 v2, 16, v2
v_mul_u32_u24 v12, 18, v2
v_sub_u32 v12, v1, v12
v_bfe_u32 v18, v2, 2, 2
v_lshlrev_b32 v18, 3, v18
v_lshrrev_b32 v19, 4, v2
v_lshl_or_b32 v18, v19, 2, v18
v_and_b32 v2, 3, v2
v_or_b32 v2, v2, v18
v_lshlrev_b32 v13, 13, v2
v_lshl_add_u32 v13, v12, 4, v13
v_add_u32 v13, s38, v13
v_cmp_gt_u32 vcc, 16, v12
v_mov_b32 v14, 0x40000000
s_nop 0
v_cndmask_b32 v13, v14, v13, vcc
v_subrev_u32 v14, 576, v1
v_mul_u32_u24 v2, 4682, v14
v_lshrrev_b32 v2, 16, v2
v_mul_u32_u24 v12, 14, v2
v_sub_u32 v12, v14, v12
v_bfe_u32 v18, v2, 2, 2
v_lshlrev_b32 v18, 3, v18
v_lshrrev_b32 v19, 4, v2
v_lshl_or_b32 v18, v19, 2, v18
v_and_b32 v2, 3, v2
v_or_b32 v2, v2, v18
v_mul_u32_u24 v14, 7168, v2
v_lshl_add_u32 v14, v12, 4, v14
v_add_u32 v14, s39, v14
v_cmp_gt_u32 vcc, 576, v1
s_nop 1
v_cndmask_b32 v7, v14, v13, vcc
v_add_u32 v7, 1024, v7
v_mov_b32 v13, v80
s_sub_u32 s4, s70, 4096
s_subb_u32 s5, s71, 0
s_sub_u32 s6, s76, 4096
s_subb_u32 s7, s77, 0
s_mov_b32 s46, 8392704
s_mov_b32 s47, 7344128
s_mov_b32 s48, 262144
s_mov_b32 s49, 229376
s_cmp_lt_u32 s26, 3
s_cselect_b32 s12, s4, s6
s_cselect_b32 s13, s5, s7
s_cselect_b32 s14, s46, s47
s_cselect_b32 s23, s48, s49
s_and_b32 s13, s13, 0xffff
s_mov_b32 s15, 0x00020000
s_cmp_lt_u32 s26, 2
s_cselect_b32 s16, s4, s6
s_cselect_b32 s17, s5, s7
s_cselect_b32 s18, s46, s47
s_cselect_b32 s24, s48, s49
s_and_b32 s17, s17, 0xffff
s_mov_b32 s19, 0x00020000
s_mov_b32 s20, 0
s_mov_b32 s21, 0
s_mov_b32 s22, 0
s_add_u32 m0, s25, 0
s_nop 0
buffer_load_dwordx4 v4, s[12:15], s21 offen offset:0 lds
buffer_load_dwordx4 v5, s[16:19], s22 offen offset:1024 lds
buffer_load_dwordx4 v6, s[16:19], s22 offen offset:2048 lds
buffer_load_dwordx4 v7, s[16:19], s22 offen offset:3072 lds
s_add_u32 s21, s21, s23
s_add_u32 s22, s22, s24
buffer_load_dwordx4 v[28:31], v20, s[8:11], 0 offen offset:512
buffer_load_dwordx4 v[32:35], v20, s[8:11], 0 offen offset:1024
buffer_load_dwordx4 v[36:39], v20, s[8:11], 0 offen offset:1536
s_add_u32 m0, s55, 65536
s_add_u32 s3, s20, 0
buffer_load_dwordx4 v3, s[8:11], s3 offen offset:0 lds
s_add_u32 s3, s20, 15360
buffer_load_dwordx4 v13, s[8:11], s3 offen offset:1024 lds
s_add_u32 s3, s20, 30720
buffer_load_dwordx4 v3, s[8:11], s3 offen offset:2048 lds
s_add_u32 s3, s20, 46080
buffer_load_dwordx4 v13, s[8:11], s3 offen offset:3072 lds
s_add_u32 m0, s55, 69632
s_add_u32 s3, s20, 65536
buffer_load_dwordx4 v3, s[8:11], s3 offen offset:0 lds
s_add_u32 s3, s20, 80896
buffer_load_dwordx4 v13, s[8:11], s3 offen offset:1024 lds
s_add_u32 s3, s20, 96256
buffer_load_dwordx4 v3, s[8:11], s3 offen offset:2048 lds
s_add_u32 s3, s20, 111616
buffer_load_dwordx4 v13, s[8:11], s3 offen offset:3072 lds
s_add_u32 s20, s20, 128
buffer_load_dwordx4 a[104:107], v22, s[60:63], s33 offen
s_add_u32 s33, s33, s35
buffer_load_dwordx4 a[108:111], v22, s[60:63], s33 offen
s_add_u32 s33, s33, s32
s_getpc_b64 s[36:37]
L_pc0:
s_add_u32 s36, s36, L_gemm_k-L_pc0
s_addc_u32 s37, s37, 0
s_mov_b32 s56, s36
s_and_b32 s57, s37, 0xffff
s_mov_b32 s58, L_end_k-L_gemm_k
s_mov_b32 s59, 0x00020000
s_lshr_b32 s36, s2, 3
s_lshl_b32 s36, s36, 2
s_add_u32 s36, s36, s26
s_lshl_b32 s36, s36, 10
v_and_b32 v13, 63, v0
v_lshlrev_b32 v13, 4, v13
buffer_load_dwordx4 a[232:235], v13, s[56:59], s36 offen
v_mov_b32 v13, v80
s_add_u32 s56, s88, 41943040
s_addc_u32 s57, s89, 0
s_and_b32 s57, s57, 0xffff
s_mov_b32 s58, 0x4000
s_mov_b32 s59, 0x00020000
s_lshl_b32 s38, s28, 8
s_lshl_b32 s36, s27, 2
s_add_u32 s38, s38, s36
v_lshlrev_b32 v17, 11, v0
v_add_u32 v17, s38, v17
v_mov_b32 v18, 0
v_mov_b32 v19, 0x40000000
v_cmp_gt_u32 vcc, 6, v0
s_nop 1
v_cndmask_b32 v17, v19, v17, vcc
buffer_store_dword v18, v17, s[56:59], 0 offen sc0 sc1
s_lshl_b32 s37, s28, 12
s_lshl_b32 s36, s26, 10
s_add_u32 s36, s36, s37
v_lshrrev_b32 v12, 4, v15
v_and_b32 v81, 15, v15
v_lshlrev_b32 v12, 15, v12
v_lshl_add_u32 v12, v81, 4, v12
v_add_u32 v12, s36, v12
v_accvgpr_write_b32 a214, v12
v_accvgpr_write_b32 a213, v0
s_mov_b32 s44, s66
s_and_b32 s45, s67, 0xffff
s_mov_b32 s46, 0x200000
s_mov_b32 s47, 0x00020000
s_mov_b32 s48, s68
s_and_b32 s49, s69, 0xffff
s_mov_b32 s50, 0x200000
s_mov_b32 s51, 0x00020000
s_lshr_b32 s36, s27, 3
s_lshl_b32 s36, s36, 19
s_add_u32 s52, s36, 393216
s_mov_b32 s53, s52
s_lshl_b32 s36, s26, 3
v_lshrrev_b32 v12, 4, v15
v_add_u32 v12, s36, v12
v_add_u32 v12, 0, v12
v_and_b32 v81, 15, v15
v_and_b32 v14, 15, v12
v_xor_b32 v14, v81, v14
v_lshlrev_b32 v14, 4, v14
v_lshl_add_u32 v14, v12, 8, v14
v_subrev_u32 v8, 0, v14
v_and_b32 v14, 7, v12
v_lshlrev_b32 v14, 1, v14
v_xor_b32 v14, v81, v14
v_lshlrev_b32 v14, 4, v14
v_lshl_add_u32 v14, v12, 8, v14
v_subrev_u32 v10, 0, v14
v_lshrrev_b32 v12, 4, v15
v_add_u32 v12, s36, v12
v_add_u32 v12, 4, v12
v_and_b32 v81, 15, v15
v_and_b32 v14, 15, v12
v_xor_b32 v14, v81, v14
v_lshlrev_b32 v14, 4, v14
v_lshl_add_u32 v14, v12, 8, v14
v_subrev_u32 v9, 1024, v14
v_and_b32 v14, 7, v12
v_lshlrev_b32 v14, 1, v14
v_xor_b32 v14, v81, v14
v_lshlrev_b32 v14, 4, v14
v_lshl_add_u32 v14, v12, 8, v14
v_subrev_u32 v11, 1024, v14
v_lshrrev_b32 v12, 4, v15
v_and_b32 v81, 15, v15
v_lshrrev_b32 v81, 2, v81
v_lshl_add_u32 v81, v12, 2, v81
v_and_b32 v14, 3, v15
v_lshlrev_b32 v14, 3, v14
v_mul_u32_u24 v1, 288, v81
v_add_u32 v1, v1, v14
v_mul_u32_u24 v2, 224, v81
v_add_u32 v2, v2, v14
v_add_u32 v2, 9216, v2
s_add_u32 m0, s25, 16384
s_nop 0
buffer_load_dwordx4 v4, s[12:15], s21 offen offset:0 lds
buffer_load_dwordx4 v5, s[16:19], s22 offen offset:1024 lds
buffer_load_dwordx4 v6, s[16:19], s22 offen offset:2048 lds
buffer_load_dwordx4 v7, s[16:19], s22 offen offset:3072 lds
s_add_u32 s21, s21, s23
s_add_u32 s22, s22, s24
buffer_load_dwordx4 a[112:115], v22, s[60:63], s33 offen
s_add_u32 s33, s33, s35
buffer_load_dwordx4 a[116:119], v22, s[60:63], s33 offen
s_add_u32 s33, s33, s32
v_lshrrev_b32 v17, 4, v15
v_and_b32 v18, 15, v15
v_add_u32 v19, 0, v17
v_xor_b32 v19, v19, v18
v_lshlrev_b32 v19, 4, v19
v_lshl_add_u32 v19, v18, 8, v19
v_add_u32 v19, 131072, v19
v_accvgpr_write_b32 a200, v19
v_add_u32 v19, 4, v17
v_xor_b32 v19, v19, v18
v_lshlrev_b32 v19, 4, v19
v_lshl_add_u32 v19, v18, 8, v19
v_add_u32 v19, 131072, v19
v_accvgpr_write_b32 a201, v19
v_add_u32 v19, 8, v17
v_xor_b32 v19, v19, v18
v_lshlrev_b32 v19, 4, v19
v_lshl_add_u32 v19, v18, 8, v19
v_add_u32 v19, 131072, v19
v_accvgpr_write_b32 a202, v19
v_add_u32 v19, 12, v17
v_xor_b32 v19, v19, v18
v_lshlrev_b32 v19, 4, v19
v_lshl_add_u32 v19, v18, 8, v19
v_add_u32 v19, 131072, v19
v_accvgpr_write_b32 a203, v19
v_lshrrev_b32 v18, 2, v18
v_lshl_add_u32 v18, v17, 2, v18
v_and_b32 v17, 7, v18
v_and_b32 v19, 3, v15
v_lshlrev_b32 v19, 3, v19
v_lshl_add_u32 v19, v18, 8, v19
v_add_u32 v19, 98304, v19
v_xor_b32 v21, 0, v17
v_lshl_add_u32 v21, v21, 5, v19
v_accvgpr_write_b32 a204, v21
v_xor_b32 v21, 1, v17
v_lshl_add_u32 v21, v21, 5, v19
v_accvgpr_write_b32 a205, v21
v_xor_b32 v21, 2, v17
v_lshl_add_u32 v21, v21, 5, v19
v_accvgpr_write_b32 a206, v21
v_xor_b32 v21, 3, v17
v_lshl_add_u32 v21, v21, 5, v19
v_accvgpr_write_b32 a207, v21
v_xor_b32 v21, 4, v17
v_lshl_add_u32 v21, v21, 5, v19
v_accvgpr_write_b32 a208, v21
v_xor_b32 v21, 5, v17
v_lshl_add_u32 v21, v21, 5, v19
v_accvgpr_write_b32 a209, v21
v_xor_b32 v21, 6, v17
v_lshl_add_u32 v21, v21, 5, v19
v_accvgpr_write_b32 a210, v21
v_xor_b32 v21, 7, v17
v_lshl_add_u32 v21, v21, 5, v19
v_accvgpr_write_b32 a211, v21
v_mov_b32 v21, 0x3f803f80
v_accvgpr_write_b32 a192, v21
v_accvgpr_write_b32 a193, v21
v_accvgpr_write_b32 a194, v21
v_accvgpr_write_b32 a195, v21
s_lshl_b32 s3, s2, 2
s_add_u32 s3, s3, s26
s_lshl_b32 s3, s3, 10
v_lshlrev_b32 v21, 6, v15
v_add_u32 v21, s3, v21
v_mov_b32 v19, 0x40000000
v_cmp_gt_u32 vcc, 16, v15
s_nop 1
v_cndmask_b32 v21, v19, v21, vcc
v_accvgpr_write_b32 a212, v21
s_and_b32 s31, s2, 1
s_xor_b32 s31, s31, 1
s_bfe_u32 s36, s2, 0x10001
s_lshl_b32 s29, s28, 1
s_add_u32 s29, s29, s36
s_lshr_b32 s36, s2, 3
s_and_b32 s30, s36, 7
s_lshr_b32 s36, s26, 1
s_lshl_b32 s36, s36, 17
s_and_b32 s37, s26, 1
s_lshl_b32 s37, s37, 10
s_add_u32 s36, s36, s37
s_lshl_b32 s37, s29, 11
s_add_u32 s36, s36, s37
v_lshrrev_b32 v17, 4, v15
v_and_b32 v18, 15, v15
v_lshlrev_b32 v17, 15, v17
v_lshl_add_u32 v17, v18, 4, v17
v_add_u32 v17, s36, v17
v_accvgpr_write_b32 a228, v17
s_lshl_b32 s36, s26, 5
s_lshl_b32 s37, s30, 8
s_add_u32 s38, s37, 128
v_lshrrev_b32 v17, 4, v15
v_add_u32 v17, s36, v17
v_add_u32 v17, 0, v17
v_and_b32 v18, 7, v17
v_lshlrev_b32 v18, 1, v18
v_and_b32 v19, 15, v15
v_xor_b32 v18, v18, v19
v_cmp_gt_u32 vcc, 8, v18
v_mov_b32 v19, s38
v_mov_b32 v84, s37
v_cndmask_b32 v19, v19, v84, vcc
v_and_b32 v18, 7, v18
v_lshlrev_b32 v18, 4, v18
v_lshl_add_u32 v18, v17, 11, v18
v_add_u32 v18, v19, v18
v_subrev_u32 v18, 0, v18
v_accvgpr_write_b32 a216, v18
v_lshrrev_b32 v17, 4, v15
v_add_u32 v17, s36, v17
v_add_u32 v17, 4, v17
v_and_b32 v18, 7, v17
v_lshlrev_b32 v18, 1, v18
v_and_b32 v19, 15, v15
v_xor_b32 v18, v18, v19
v_cmp_gt_u32 vcc, 8, v18
v_mov_b32 v19, s38
v_mov_b32 v84, s37
v_cndmask_b32 v19, v19, v84, vcc
v_and_b32 v18, 7, v18
v_lshlrev_b32 v18, 4, v18
v_lshl_add_u32 v18, v17, 11, v18
v_add_u32 v18, v19, v18
v_subrev_u32 v18, 1024, v18
v_accvgpr_write_b32 a217, v18
v_lshrrev_b32 v17, 4, v15
v_add_u32 v17, s36, v17
v_add_u32 v17, 8, v17
v_and_b32 v18, 7, v17
v_lshlrev_b32 v18, 1, v18
v_and_b32 v19, 15, v15
v_xor_b32 v18, v18, v19
v_cmp_gt_u32 vcc, 8, v18
v_mov_b32 v19, s38
v_mov_b32 v84, s37
v_cndmask_b32 v19, v19, v84, vcc
v_and_b32 v18, 7, v18
v_lshlrev_b32 v18, 4, v18
v_lshl_add_u32 v18, v17, 11, v18
v_add_u32 v18, v19, v18
v_subrev_u32 v18, 2048, v18
v_accvgpr_write_b32 a218, v18
v_lshrrev_b32 v17, 4, v15
v_add_u32 v17, s36, v17
v_add_u32 v17, 12, v17
v_and_b32 v18, 7, v17
v_lshlrev_b32 v18, 1, v18
v_and_b32 v19, 15, v15
v_xor_b32 v18, v18, v19
v_cmp_gt_u32 vcc, 8, v18
v_mov_b32 v19, s38
v_mov_b32 v84, s37
v_cndmask_b32 v19, v19, v84, vcc
v_and_b32 v18, 7, v18
v_lshlrev_b32 v18, 4, v18
v_lshl_add_u32 v18, v17, 11, v18
v_add_u32 v18, v19, v18
v_subrev_u32 v18, 3072, v18
v_accvgpr_write_b32 a219, v18
v_lshrrev_b32 v17, 4, v15
v_and_b32 v18, 15, v15
v_lshrrev_b32 v18, 2, v18
v_lshl_add_u32 v18, v17, 2, v18
v_and_b32 v17, 7, v18
v_and_b32 v19, 3, v15
v_lshlrev_b32 v19, 3, v19
v_lshl_add_u32 v19, v18, 8, v19
s_lshr_b32 s36, s26, 1
s_lshl_b32 s36, s36, 13
v_add_u32 v19, s36, v19
v_xor_b32 v18, 0, v17
v_lshl_add_u32 v18, v18, 5, v19
v_accvgpr_write_b32 a220, v18
v_xor_b32 v18, 1, v17
v_lshl_add_u32 v18, v18, 5, v19
v_accvgpr_write_b32 a221, v18
v_xor_b32 v18, 2, v17
v_lshl_add_u32 v18, v18, 5, v19
v_accvgpr_write_b32 a222, v18
v_xor_b32 v18, 3, v17
v_lshl_add_u32 v18, v18, 5, v19
v_accvgpr_write_b32 a223, v18
v_xor_b32 v18, 4, v17
v_lshl_add_u32 v18, v18, 5, v19
v_accvgpr_write_b32 a224, v18
v_xor_b32 v18, 5, v17
v_lshl_add_u32 v18, v18, 5, v19
v_accvgpr_write_b32 a225, v18
v_xor_b32 v18, 6, v17
v_lshl_add_u32 v18, v18, 5, v19
v_accvgpr_write_b32 a226, v18
v_xor_b32 v18, 7, v17
v_lshl_add_u32 v18, v18, 5, v19
v_accvgpr_write_b32 a227, v18
v_and_b32 v17, 15, v15
v_lshrrev_b32 v18, 4, v15
v_mov_b32 v21, 0x40000000
v_and_b32 v19, 7, v15
v_and_b32 v81, 1, v19
v_lshrrev_b32 v19, 1, v19
v_cmp_eq_u32 vcc, 1, v81
v_mov_b32 v81, 0x3f80
v_mov_b32 v82, 0x3f800000
v_cndmask_b32 v81, v81, v82, vcc
v_cmp_eq_u32 vcc, 0, v19
s_nop 1
v_cndmask_b32 v82, 0, v81, vcc
v_accvgpr_write_b32 a160, v82
v_cmp_eq_u32 vcc, 1, v19
s_nop 1
v_cndmask_b32 v82, 0, v81, vcc
v_accvgpr_write_b32 a161, v82
v_cmp_eq_u32 vcc, 2, v19
s_nop 1
v_cndmask_b32 v82, 0, v81, vcc
v_accvgpr_write_b32 a162, v82
v_cmp_eq_u32 vcc, 3, v19
s_nop 1
v_cndmask_b32 v82, 0, v81, vcc
v_accvgpr_write_b32 a163, v82
s_lshl_b32 s3, s27, 14
s_add_u32 s3, s3, 0
v_lshlrev_b32 v19, 2, v0
v_add_u32 v81, s3, v19
v_accvgpr_write_b32 a199, v81
v_lshlrev_b32 v19, 1, v19
v_add_u32 v19, 0, v19
v_accvgpr_write_b32 a92, v19
v_lshlrev_b32 v19, 3, v17
v_add_u32 v19, 0, v19
v_add_u32 v81, 2048, v19
v_cmp_eq_u32 vcc, 0, v18
s_nop 1
v_cndmask_b32 v19, v81, v19, vcc
v_accvgpr_write_b32 a93, v19
s_mul_i32 s3, s27, 112
v_subrev_u32 v19, 128, v0
v_cmp_gt_u32 vcc, 112, v19
v_add_u32 v19, s3, v19
v_lshlrev_b32 v19, 1, v19
v_cndmask_b32 v19, v21, v19, vcc
v_accvgpr_write_b32 a229, v19
s_lshl_b32 s3, s28, 8
s_lshl_b32 s36, s26, 6
s_add_u32 s3, s3, s36
v_add_u32 v19, s3, v17
v_lshlrev_b32 v19, 3, v19
v_add_u32 v19, 1048576, v19
v_accvgpr_write_b32 a231, v19
s_and_b32 s36, s28, 3
s_lshl_b32 s36, s36, 6
s_lshr_b32 s37, s28, 2
s_lshl_b32 s37, s37, 2
s_add_u32 s36, s36, s37
v_and_b32 v19, 7, v15
v_lshlrev_b32 v81, 3, v19
v_add_u32 v81, s36, v81
s_and_b32 s36, s27, 7
s_lshl_b32 s36, s36, 3
v_and_b32 v82, 3, v19
v_lshlrev_b32 v82, 6, v82
v_lshrrev_b32 v19, 2, v19
v_lshl_add_u32 v82, v19, 2, v82
v_add_u32 v82, s36, v82
v_cmp_gt_u32 vcc, 8, v15
s_nop 1
v_cndmask_b32 v81, v82, v81, vcc
v_accvgpr_write_b32 a215, v81
s_lshr_b32 s36, s27, 3
s_lshl_b32 s36, s36, 3
s_lshl_b32 s36, 1, s36
v_mov_b32 v81, s36
v_mov_b32 v82, 0x01010101
v_cndmask_b32 v81, v81, v82, vcc
v_cmp_gt_u32 vcc, 16, v15
s_nop 1
v_cndmask_b32 v81, 0, v81, vcc
v_accvgpr_write_b32 a196, v81
v_lshrrev_b32 v19, 3, v17
v_and_b32 v81, 7, v17
v_bfe_u32 v82, v17, 1, 1
v_lshl_or_b32 v82, v19, 1, v82
v_add_u32 v84, 4, v17
v_bfe_u32 v84, v84, 3, 1
v_lshl_or_b32 v82, v84, 2, v82
v_xor_b32 v82, v82, v18
v_lshlrev_b32 v82, 4, v82
v_lshl_add_u32 v82, v81, 7, v82
v_lshl_add_u32 v82, v19, 10, v82
s_add_u32 s36, s55, 98304
v_add_u32 v0, s36, v82
v_xor_b32 v12, 64, v0
s_waitcnt vmcnt(27)
v_lshlrev_b32 v40, 16, v24
v_and_b32 v41, 0xffff0000, v24
v_mov_b32 v72, v40
v_mov_b32 v73, v41
v_lshlrev_b32 v42, 16, v25
v_and_b32 v43, 0xffff0000, v25
v_mov_b32 v74, v42
v_mov_b32 v75, v43
v_lshlrev_b32 v44, 16, v26
v_and_b32 v45, 0xffff0000, v26
v_pk_add_f32 v[72:73], v[72:73], v[44:45]
v_lshlrev_b32 v46, 16, v27
v_and_b32 v47, 0xffff0000, v27
v_pk_add_f32 v[74:75], v[74:75], v[46:47]
s_waitcnt vmcnt(20)
v_lshlrev_b32 v48, 16, v28
v_and_b32 v49, 0xffff0000, v28
v_pk_add_f32 v[72:73], v[72:73], v[48:49]
v_lshlrev_b32 v50, 16, v29
v_and_b32 v51, 0xffff0000, v29
v_pk_add_f32 v[74:75], v[74:75], v[50:51]
v_lshlrev_b32 v52, 16, v30
v_and_b32 v53, 0xffff0000, v30
v_pk_add_f32 v[72:73], v[72:73], v[52:53]
v_lshlrev_b32 v54, 16, v31
v_and_b32 v55, 0xffff0000, v31
v_pk_add_f32 v[74:75], v[74:75], v[54:55]
s_waitcnt vmcnt(19)
v_lshlrev_b32 v56, 16, v32
v_and_b32 v57, 0xffff0000, v32
v_pk_add_f32 v[72:73], v[72:73], v[56:57]
v_lshlrev_b32 v58, 16, v33
v_and_b32 v59, 0xffff0000, v33
v_pk_add_f32 v[74:75], v[74:75], v[58:59]
v_lshlrev_b32 v60, 16, v34
v_and_b32 v61, 0xffff0000, v34
v_pk_add_f32 v[72:73], v[72:73], v[60:61]
v_lshlrev_b32 v62, 16, v35
v_and_b32 v63, 0xffff0000, v35
v_pk_add_f32 v[74:75], v[74:75], v[62:63]
s_waitcnt vmcnt(18)
v_lshlrev_b32 v64, 16, v36
v_and_b32 v65, 0xffff0000, v36
v_pk_add_f32 v[72:73], v[72:73], v[64:65]
v_lshlrev_b32 v66, 16, v37
v_and_b32 v67, 0xffff0000, v37
v_pk_add_f32 v[74:75], v[74:75], v[66:67]
v_lshlrev_b32 v68, 16, v38
v_and_b32 v69, 0xffff0000, v38
v_pk_add_f32 v[72:73], v[72:73], v[68:69]
v_lshlrev_b32 v70, 16, v39
v_and_b32 v71, 0xffff0000, v39
v_pk_add_f32 v[74:75], v[74:75], v[70:71]
v_pk_add_f32 v[72:73], v[72:73], v[74:75]
v_add_f32 v72, v72, v73
s_nop 1
v_add_f32_dpp v72, v72, v72 row_ror:8 row_mask:0xf bank_mask:0xf
s_nop 1
v_add_f32_dpp v72, v72, v72 row_ror:4 row_mask:0xf bank_mask:0xf
s_nop 1
v_add_f32_dpp v72, v72, v72 row_ror:2 row_mask:0xf bank_mask:0xf
s_nop 1
v_add_f32_dpp v72, v72, v72 row_ror:1 row_mask:0xf bank_mask:0xf
v_mov_b32 v76, v72
s_nop 1
v_permlane16_swap_b32 v72, v76
v_add_f32 v72, v72, v76
v_mul_f32 v72, 0x3a800000, v72
v_cvt_pk_bf16_f32 v78, v72, v72
v_lshlrev_b32 v78, 16, v78
v_sub_f32 v77, v72, v78
v_pk_add_f32 v[40:41], v[40:41], v[78:79] op_sel_hi:[1,0] neg_lo:[0,1] neg_hi:[0,1]
v_pk_mul_f32 v[72:73], v[40:41], v[40:41]
v_pk_add_f32 v[42:43], v[42:43], v[78:79] op_sel_hi:[1,0] neg_lo:[0,1] neg_hi:[0,1]
v_pk_mul_f32 v[74:75], v[42:43], v[42:43]
v_pk_add_f32 v[44:45], v[44:45], v[78:79] op_sel_hi:[1,0] neg_lo:[0,1] neg_hi:[0,1]
v_pk_fma_f32 v[72:73], v[44:45], v[44:45], v[72:73]
v_pk_add_f32 v[46:47], v[46:47], v[78:79] op_sel_hi:[1,0] neg_lo:[0,1] neg_hi:[0,1]
v_pk_fma_f32 v[74:75], v[46:47], v[46:47], v[74:75]
v_pk_add_f32 v[48:49], v[48:49], v[78:79] op_sel_hi:[1,0] neg_lo:[0,1] neg_hi:[0,1]
v_pk_fma_f32 v[72:73], v[48:49], v[48:49], v[72:73]
v_pk_add_f32 v[50:51], v[50:51], v[78:79] op_sel_hi:[1,0] neg_lo:[0,1] neg_hi:[0,1]
v_pk_fma_f32 v[74:75], v[50:51], v[50:51], v[74:75]
v_pk_add_f32 v[52:53], v[52:53], v[78:79] op_sel_hi:[1,0] neg_lo:[0,1] neg_hi:[0,1]
v_pk_fma_f32 v[72:73], v[52:53], v[52:53], v[72:73]
v_pk_add_f32 v[54:55], v[54:55], v[78:79] op_sel_hi:[1,0] neg_lo:[0,1] neg_hi:[0,1]
v_pk_fma_f32 v[74:75], v[54:55], v[54:55], v[74:75]
v_pk_add_f32 v[56:57], v[56:57], v[78:79] op_sel_hi:[1,0] neg_lo:[0,1] neg_hi:[0,1]
v_pk_fma_f32 v[72:73], v[56:57], v[56:57], v[72:73]
v_pk_add_f32 v[58:59], v[58:59], v[78:79] op_sel_hi:[1,0] neg_lo:[0,1] neg_hi:[0,1]
v_pk_fma_f32 v[74:75], v[58:59], v[58:59], v[74:75]
v_pk_add_f32 v[60:61], v[60:61], v[78:79] op_sel_hi:[1,0] neg_lo:[0,1] neg_hi:[0,1]
v_pk_fma_f32 v[72:73], v[60:61], v[60:61], v[72:73]
v_pk_add_f32 v[62:63], v[62:63], v[78:79] op_sel_hi:[1,0] neg_lo:[0,1] neg_hi:[0,1]
v_pk_fma_f32 v[74:75], v[62:63], v[62:63], v[74:75]
v_pk_add_f32 v[64:65], v[64:65], v[78:79] op_sel_hi:[1,0] neg_lo:[0,1] neg_hi:[0,1]
v_pk_fma_f32 v[72:73], v[64:65], v[64:65], v[72:73]
v_pk_add_f32 v[66:67], v[66:67], v[78:79] op_sel_hi:[1,0] neg_lo:[0,1] neg_hi:[0,1]
v_pk_fma_f32 v[74:75], v[66:67], v[66:67], v[74:75]
v_pk_add_f32 v[68:69], v[68:69], v[78:79] op_sel_hi:[1,0] neg_lo:[0,1] neg_hi:[0,1]
v_pk_fma_f32 v[72:73], v[68:69], v[68:69], v[72:73]
v_pk_add_f32 v[70:71], v[70:71], v[78:79] op_sel_hi:[1,0] neg_lo:[0,1] neg_hi:[0,1]
v_pk_fma_f32 v[74:75], v[70:71], v[70:71], v[74:75]
v_pk_add_f32 v[72:73], v[72:73], v[74:75]
v_add_f32 v72, v72, v73
s_nop 1
v_add_f32_dpp v72, v72, v72 row_ror:8 row_mask:0xf bank_mask:0xf
s_nop 1
v_add_f32_dpp v72, v72, v72 row_ror:4 row_mask:0xf bank_mask:0xf
s_nop 1
v_add_f32_dpp v72, v72, v72 row_ror:2 row_mask:0xf bank_mask:0xf
s_nop 1
v_add_f32_dpp v72, v72, v72 row_ror:1 row_mask:0xf bank_mask:0xf
v_mov_b32 v76, v72
s_nop 1
v_permlane16_swap_b32 v72, v76
v_add_f32 v72, v72, v76
v_mul_f32 v72, 0x3a800000, v72
v_fma_f32 v72, -v77, v77, v72
v_max_f32 v72, 0, v72
v_cvt_pk_bf16_f32 v72, v72, v72
v_lshlrev_b32 v72, 16, v72
v_add_f32 v72, 0x3727c5ac, v72
v_cvt_pk_bf16_f32 v72, v72, v72
v_lshlrev_b32 v72, 16, v72
v_sqrt_f32 v72, v72
s_nop 0
v_cvt_pk_bf16_f32 v72, v72, v72
v_lshlrev_b32 v72, 16, v72
v_rcp_f32 v79, v72
s_mov_b32 s40, s88
s_and_b32 s41, s89, 0xffff
s_mov_b32 s42, 0x200000
s_mov_b32 s43, 0x00020000
v_lshlrev_b32 v16, 3, v16
v_add_u32 v16, 1048576, v16
v_and_b32 v17, 31, v15
v_cmp_eq_u32 vcc, 0, v17
s_nop 1
v_cndmask_b32 v16, v21, v16, vcc
buffer_store_dwordx2 v[78:79], v16, s[40:43], 0 offen sc0 sc1
s_add_u32 m0, s25, 32768
s_nop 0
buffer_load_dwordx4 v4, s[12:15], s21 offen offset:0 lds
buffer_load_dwordx4 v5, s[16:19], s22 offen offset:1024 lds
buffer_load_dwordx4 v6, s[16:19], s22 offen offset:2048 lds
buffer_load_dwordx4 v7, s[16:19], s22 offen offset:3072 lds
s_add_u32 s21, s21, s23
s_add_u32 s22, s22, s24
v_accvgpr_write_b32 a94, v22
v_accvgpr_write_b32 a198, v23
s_mov_b32 s56, s86
s_and_b32 s57, s87, 0xffff
s_mov_b32 s58, 0x100
s_mov_b32 s59, 0x00020000
s_barrier
L_gemm_k:
s_waitcnt vmcnt(15)
v_subrev_u32 v15, 32768, v0
ds_read_b128 a[60:63], v15 offset:0
ds_read_b128 a[64:67], v15 offset:2048
ds_read_b128 a[68:71], v15 offset:4096
ds_read_b128 a[72:75], v15 offset:6144
ds_read_b64_tr_b16 a[0:1], v1 offset:0
ds_read_b64_tr_b16 a[2:3], v1 offset:4608
ds_read_b64_tr_b16 a[4:5], v1 offset:32
ds_read_b64_tr_b16 a[6:7], v1 offset:4640
ds_read_b64_tr_b16 a[8:9], v1 offset:64
ds_read_b64_tr_b16 a[10:11], v1 offset:4672
ds_read_b64_tr_b16 a[12:13], v1 offset:96
ds_read_b64_tr_b16 a[14:15], v1 offset:4704
ds_read_b64_tr_b16 a[16:17], v1 offset:128
ds_read_b64_tr_b16 a[18:19], v1 offset:4736
ds_read_b64_tr_b16 a[20:21], v1 offset:160
ds_read_b64_tr_b16 a[22:23], v1 offset:4768
ds_read_b64_tr_b16 a[24:25], v1 offset:192
ds_read_b64_tr_b16 a[26:27], v1 offset:4800
ds_read_b64_tr_b16 a[28:29], v1 offset:224
ds_read_b64_tr_b16 a[30:31], v1 offset:4832
ds_read_b64_tr_b16 a[32:33], v2 offset:0
ds_read_b64_tr_b16 a[34:35], v2 offset:3584
ds_read_b64_tr_b16 a[36:37], v2 offset:32
ds_read_b64_tr_b16 a[38:39], v2 offset:3616
ds_read_b64_tr_b16 a[40:41], v2 offset:64
ds_read_b64_tr_b16 a[42:43], v2 offset:3648
ds_read_b64_tr_b16 a[44:45], v2 offset:96
ds_read_b64_tr_b16 a[46:47], v2 offset:3680
ds_read_b64_tr_b16 a[48:49], v2 offset:128
ds_read_b64_tr_b16 a[50:51], v2 offset:3712
ds_read_b64_tr_b16 a[52:53], v2 offset:160
ds_read_b64_tr_b16 a[54:55], v2 offset:3744
ds_read_b64_tr_b16 a[56:57], v2 offset:192
ds_read_b64_tr_b16 a[58:59], v2 offset:3776
s_waitcnt lgkmcnt(15)
v_mfma_f32_16x16x32_bf16 v[16:19], a[0:3], a[60:63], 0
v_accvgpr_read_b32 v14, a94
v_mfma_f32_16x16x32_bf16 v[20:23], a[0:3], a[64:67], 0
v_subrev_u32 v15, 32768, v12
s_add_u32 m0, s55, 131072
s_add_u32 s3, s20, 0
buffer_load_dwordx4 v3, s[8:11], s3 offen offset:0 lds
v_mfma_f32_16x16x32_bf16 v[24:27], a[0:3], a[68:71], 0
s_add_u32 s3, s20, 15360
buffer_load_dwordx4 v13, s[8:11], s3 offen offset:1024 lds
v_mfma_f32_16x16x32_bf16 v[28:31], a[0:3], a[72:75], 0
ds_read_b128 a[76:79], v15 offset:0
v_mfma_f32_16x16x32_bf16 v[32:35], a[4:7], a[60:63], 0
s_add_u32 s3, s20, 30720
buffer_load_dwordx4 v3, s[8:11], s3 offen offset:2048 lds
v_mfma_f32_16x16x32_bf16 v[36:39], a[4:7], a[64:67], 0
s_add_u32 s3, s20, 46080
buffer_load_dwordx4 v13, s[8:11], s3 offen offset:3072 lds
v_mfma_f32_16x16x32_bf16 v[40:43], a[4:7], a[68:71], 0
ds_read_b128 a[80:83], v15 offset:2048
v_mfma_f32_16x16x32_bf16 v[44:47], a[4:7], a[72:75], 0
s_add_u32 m0, s55, 135168
s_add_u32 s3, s20, 65536
buffer_load_dwordx4 v3, s[8:11], s3 offen offset:0 lds
v_mfma_f32_16x16x32_bf16 v[48:51], a[8:11], a[60:63], 0
s_add_u32 s3, s20, 80896
buffer_load_dwordx4 v13, s[8:11], s3 offen offset:1024 lds
v_mfma_f32_16x16x32_bf16 v[52:55], a[8:11], a[64:67], 0
ds_read_b128 a[84:87], v15 offset:4096
v_mfma_f32_16x16x32_bf16 v[56:59], a[8:11], a[68:71], 0
s_add_u32 s3, s20, 96256
buffer_load_dwordx4 v3, s[8:11], s3 offen offset:2048 lds
v_mfma_f32_16x16x32_bf16 v[60:63], a[8:11], a[72:75], 0
s_add_u32 s3, s20, 111616
buffer_load_dwordx4 v13, s[8:11], s3 offen offset:3072 lds
v_mfma_f32_16x16x32_bf16 v[64:67], a[12:15], a[60:63], 0
ds_read_b128 a[88:91], v15 offset:6144
v_mfma_f32_16x16x32_bf16 v[68:71], a[12:15], a[64:67], 0
v_mfma_f32_16x16x32_bf16 v[72:75], a[12:15], a[68:71], 0
s_add_u32 s20, s20, 128
s_add_u32 m0, s25, 49152
s_nop 0
buffer_load_dwordx4 v4, s[12:15], s21 offen offset:0 lds
v_mfma_f32_16x16x32_bf16 v[76:79], a[12:15], a[72:75], 0
v_mfma_f32_16x16x32_bf16 v[80:83], a[16:19], a[60:63], 0
buffer_load_dwordx4 v5, s[16:19], s22 offen offset:1024 lds
v_mfma_f32_16x16x32_bf16 v[84:87], a[16:19], a[64:67], 0
v_mfma_f32_16x16x32_bf16 v[88:91], a[16:19], a[68:71], 0
buffer_load_dwordx4 a[120:123], v14, s[60:63], s33 offen
s_add_u32 s33, s33, s35
v_mfma_f32_16x16x32_bf16 v[92:95], a[16:19], a[72:75], 0
v_mfma_f32_16x16x32_bf16 v[96:99], a[20:23], a[60:63], 0
buffer_load_dwordx4 v6, s[16:19], s22 offen offset:2048 lds
v_mfma_f32_16x16x32_bf16 v[100:103], a[20:23], a[64:67], 0
v_mfma_f32_16x16x32_bf16 v[104:107], a[20:23], a[68:71], 0
buffer_load_dwordx4 v7, s[16:19], s22 offen offset:3072 lds
v_mfma_f32_16x16x32_bf16 v[108:111], a[20:23], a[72:75], 0
s_waitcnt lgkmcnt(15)
v_mfma_f32_16x16x32_bf16 v[112:115], a[24:27], a[60:63], 0
v_mfma_f32_16x16x32_bf16 v[116:119], a[24:27], a[64:67], 0
s_add_u32 s21, s21, s23
s_add_u32 s22, s22, s24
v_mfma_f32_16x16x32_bf16 v[120:123], a[24:27], a[68:71], 0
v_mfma_f32_16x16x32_bf16 v[124:127], a[24:27], a[72:75], 0
v_mfma_f32_16x16x32_bf16 v[128:131], a[28:31], a[60:63], 0
v_mfma_f32_16x16x32_bf16 v[132:135], a[28:31], a[64:67], 0
v_mfma_f32_16x16x32_bf16 v[136:139], a[28:31], a[68:71], 0
v_mfma_f32_16x16x32_bf16 v[140:143], a[28:31], a[72:75], 0
v_mfma_f32_16x16x32_bf16 v[144:147], a[32:35], a[60:63], 0
v_mfma_f32_16x16x32_bf16 v[148:151], a[32:35], a[64:67], 0
v_mfma_f32_16x16x32_bf16 v[152:155], a[32:35], a[68:71], 0
v_mfma_f32_16x16x32_bf16 v[156:159], a[32:35], a[72:75], 0
s_waitcnt lgkmcnt(10)
v_mfma_f32_16x16x32_bf16 v[160:163], a[36:39], a[60:63], 0
s_waitcnt vmcnt(20) lgkmcnt(0)
s_barrier
v_mfma_f32_16x16x32_bf16 v[164:167], a[36:39], a[64:67], 0
ds_read_b64_tr_b16 a[0:1], v1 offset:16384
v_mfma_f32_16x16x32_bf16 v[168:171], a[36:39], a[68:71], 0
ds_read_b64_tr_b16 a[2:3], v1 offset:20992
v_mfma_f32_16x16x32_bf16 v[172:175], a[36:39], a[72:75], 0
s_add_u32 m0, s25, 0
v_mfma_f32_16x16x32_bf16 v[176:179], a[40:43], a[60:63], 0
ds_read_b64_tr_b16 a[4:5], v1 offset:16416
v_mfma_f32_16x16x32_bf16 v[180:183], a[40:43], a[64:67], 0
ds_read_b64_tr_b16 a[6:7], v1 offset:21024
v_mfma_f32_16x16x32_bf16 v[184:187], a[40:43], a[68:71], 0
buffer_load_dwordx4 v4, s[12:15], s21 offen offset:0 lds
v_mfma_f32_16x16x32_bf16 v[188:191], a[40:43], a[72:75], 0
ds_read_b64_tr_b16 a[8:9], v1 offset:16448
v_mfma_f32_16x16x32_bf16 v[192:195], a[44:47], a[60:63], 0
ds_read_b64_tr_b16 a[10:11], v1 offset:21056
v_mfma_f32_16x16x32_bf16 v[196:199], a[44:47], a[64:67], 0
v_mfma_f32_16x16x32_bf16 v[200:203], a[44:47], a[68:71], 0
ds_read_b64_tr_b16 a[12:13], v1 offset:16480
v_mfma_f32_16x16x32_bf16 v[204:207], a[44:47], a[72:75], 0
ds_read_b64_tr_b16 a[14:15], v1 offset:21088
v_mfma_f32_16x16x32_bf16 v[208:211], a[48:51], a[60:63], 0
buffer_load_dwordx4 v5, s[16:19], s22 offen offset:1024 lds
v_mfma_f32_16x16x32_bf16 v[212:215], a[48:51], a[64:67], 0
ds_read_b64_tr_b16 a[16:17], v1 offset:16512
v_mfma_f32_16x16x32_bf16 v[216:219], a[48:51], a[68:71], 0
ds_read_b64_tr_b16 a[18:19], v1 offset:21120
v_mfma_f32_16x16x32_bf16 v[220:223], a[48:51], a[72:75], 0
v_mfma_f32_16x16x32_bf16 v[224:227], a[52:55], a[60:63], 0
ds_read_b64_tr_b16 a[20:21], v1 offset:16544
v_mfma_f32_16x16x32_bf16 v[228:231], a[52:55], a[64:67], 0
ds_read_b64_tr_b16 a[22:23], v1 offset:21152
v_mfma_f32_16x16x32_bf16 v[232:235], a[52:55], a[68:71], 0
buffer_load_dwordx4 v6, s[16:19], s22 offen offset:2048 lds
v_mfma_f32_16x16x32_bf16 v[236:239], a[52:55], a[72:75], 0
ds_read_b64_tr_b16 a[24:25], v1 offset:16576
v_mfma_f32_16x16x32_bf16 v[240:243], a[56:59], a[60:63], 0
ds_read_b64_tr_b16 a[26:27], v1 offset:21184
v_mfma_f32_16x16x32_bf16 v[244:247], a[56:59], a[64:67], 0
v_mfma_f32_16x16x32_bf16 v[248:251], a[56:59], a[68:71], 0
ds_read_b64_tr_b16 a[28:29], v1 offset:16608
v_mfma_f32_16x16x32_bf16 v[252:255], a[56:59], a[72:75], 0
ds_read_b64_tr_b16 a[30:31], v1 offset:21216
s_waitcnt lgkmcnt(10)
v_mfma_f32_16x16x32_bf16 v[16:19], a[0:3], a[76:79], v[16:19]
buffer_load_dwordx4 v7, s[16:19], s22 offen offset:3072 lds
v_mfma_f32_16x16x32_bf16 v[20:23], a[0:3], a[80:83], v[20:23]
ds_read_b64_tr_b16 a[32:33], v2 offset:16384
v_mfma_f32_16x16x32_bf16 v[24:27], a[0:3], a[84:87], v[24:27]
ds_read_b64_tr_b16 a[34:35], v2 offset:19968
s_waitcnt vmcnt(9)
s_add_u32 m0, s55, 98304
s_add_u32 s3, s20, 0
buffer_load_dwordx4 v3, s[8:11], s3 offen offset:0 lds
v_mfma_f32_16x16x32_bf16 v[28:31], a[0:3], a[88:91], v[28:31]
ds_read_b128 a[60:63], v0 offset:32768
s_add_u32 s3, s20, 15360
buffer_load_dwordx4 v13, s[8:11], s3 offen offset:1024 lds
v_mfma_f32_16x16x32_bf16 v[32:35], a[4:7], a[76:79], v[32:35]
ds_read_b64_tr_b16 a[36:37], v2 offset:16416
v_mfma_f32_16x16x32_bf16 v[36:39], a[4:7], a[80:83], v[36:39]
ds_read_b64_tr_b16 a[38:39], v2 offset:20000
s_add_u32 s3, s20, 30720
buffer_load_dwordx4 v3, s[8:11], s3 offen offset:2048 lds
v_mfma_f32_16x16x32_bf16 v[40:43], a[4:7], a[84:87], v[40:43]
s_add_u32 s21, s21, s23
s_add_u32 s22, s22, s24
ds_read_b128 a[64:67], v0 offset:34816
s_add_u32 s3, s20, 46080
buffer_load_dwordx4 v13, s[8:11], s3 offen offset:3072 lds
v_mfma_f32_16x16x32_bf16 v[44:47], a[4:7], a[88:91], v[44:47]
ds_read_b64_tr_b16 a[40:41], v2 offset:16448
v_mfma_f32_16x16x32_bf16 v[48:51], a[8:11], a[76:79], v[48:51]
ds_read_b64_tr_b16 a[42:43], v2 offset:20032
s_add_u32 m0, s55, 102400
s_add_u32 s3, s20, 65536
buffer_load_dwordx4 v3, s[8:11], s3 offen offset:0 lds
v_mfma_f32_16x16x32_bf16 v[52:55], a[8:11], a[80:83], v[52:55]
ds_read_b128 a[68:71], v0 offset:36864
s_add_u32 s3, s20, 80896
buffer_load_dwordx4 v13, s[8:11], s3 offen offset:1024 lds
v_mfma_f32_16x16x32_bf16 v[56:59], a[8:11], a[84:87], v[56:59]
ds_read_b64_tr_b16 a[44:45], v2 offset:16480
v_mfma_f32_16x16x32_bf16 v[60:63], a[8:11], a[88:91], v[60:63]
ds_read_b64_tr_b16 a[46:47], v2 offset:20064
s_add_u32 s3, s20, 96256
buffer_load_dwordx4 v3, s[8:11], s3 offen offset:2048 lds
s_waitcnt lgkmcnt(15)
v_mfma_f32_16x16x32_bf16 v[64:67], a[12:15], a[76:79], v[64:67]
ds_read_b128 a[72:75], v0 offset:38912
s_add_u32 s3, s20, 111616
buffer_load_dwordx4 v13, s[8:11], s3 offen offset:3072 lds
s_add_u32 s20, s20, 128
v_mfma_f32_16x16x32_bf16 v[68:71], a[12:15], a[80:83], v[68:71]
ds_read_b64_tr_b16 a[48:49], v2 offset:16512
s_add_u32 m0, s55, 65536
v_mfma_f32_16x16x32_bf16 v[72:75], a[12:15], a[84:87], v[72:75]
ds_read_b64_tr_b16 a[50:51], v2 offset:20096
s_add_u32 s3, s20, 0
v_mfma_f32_16x16x32_bf16 v[76:79], a[12:15], a[88:91], v[76:79]
buffer_load_dwordx4 v3, s[8:11], s3 offen offset:0 lds
v_mfma_f32_16x16x32_bf16 v[80:83], a[16:19], a[76:79], v[80:83]
ds_read_b64_tr_b16 a[52:53], v2 offset:16544
v_mfma_f32_16x16x32_bf16 v[84:87], a[16:19], a[80:83], v[84:87]
ds_read_b64_tr_b16 a[54:55], v2 offset:20128
v_mfma_f32_16x16x32_bf16 v[88:91], a[16:19], a[84:87], v[88:91]
buffer_load_dwordx4 a[124:127], v14, s[60:63], s33 offen
s_add_u32 s33, s33, s32
v_mfma_f32_16x16x32_bf16 v[92:95], a[16:19], a[88:91], v[92:95]
ds_read_b64_tr_b16 a[56:57], v2 offset:16576
v_mfma_f32_16x16x32_bf16 v[96:99], a[20:23], a[76:79], v[96:99]
ds_read_b64_tr_b16 a[58:59], v2 offset:20160
s_add_u32 s3, s20, 15360
v_mfma_f32_16x16x32_bf16 v[100:103], a[20:23], a[80:83], v[100:103]
buffer_load_dwordx4 v13, s[8:11], s3 offen offset:1024 lds
v_mfma_f32_16x16x32_bf16 v[104:107], a[20:23], a[84:87], v[104:107]
v_mfma_f32_16x16x32_bf16 v[108:111], a[20:23], a[88:91], v[108:111]
s_waitcnt lgkmcnt(15)
v_mfma_f32_16x16x32_bf16 v[112:115], a[24:27], a[76:79], v[112:115]
v_mfma_f32_16x16x32_bf16 v[116:119], a[24:27], a[80:83], v[116:119]
v_mfma_f32_16x16x32_bf16 v[120:123], a[24:27], a[84:87], v[120:123]
s_add_u32 s3, s20, 30720
v_mfma_f32_16x16x32_bf16 v[124:127], a[24:27], a[88:91], v[124:127]
buffer_load_dwordx4 v3, s[8:11], s3 offen offset:2048 lds
v_mfma_f32_16x16x32_bf16 v[128:131], a[28:31], a[76:79], v[128:131]
v_mfma_f32_16x16x32_bf16 v[132:135], a[28:31], a[80:83], v[132:135]
v_mfma_f32_16x16x32_bf16 v[136:139], a[28:31], a[84:87], v[136:139]
v_mfma_f32_16x16x32_bf16 v[140:143], a[28:31], a[88:91], v[140:143]
v_mfma_f32_16x16x32_bf16 v[144:147], a[32:35], a[76:79], v[144:147]
s_add_u32 s3, s20, 46080
v_mfma_f32_16x16x32_bf16 v[148:151], a[32:35], a[80:83], v[148:151]
buffer_load_dwordx4 v13, s[8:11], s3 offen offset:3072 lds
v_mfma_f32_16x16x32_bf16 v[152:155], a[32:35], a[84:87], v[152:155]
v_mfma_f32_16x16x32_bf16 v[156:159], a[32:35], a[88:91], v[156:159]
s_waitcnt lgkmcnt(7)
v_mfma_f32_16x16x32_bf16 v[160:163], a[36:39], a[76:79], v[160:163]
s_waitcnt lgkmcnt(0)
s_barrier
v_mfma_f32_16x16x32_bf16 v[164:167], a[36:39], a[80:83], v[164:167]
ds_read_b64_tr_b16 a[0:1], v1 offset:32768
v_mfma_f32_16x16x32_bf16 v[168:171], a[36:39], a[84:87], v[168:171]
ds_read_b64_tr_b16 a[2:3], v1 offset:37376
v_mfma_f32_16x16x32_bf16 v[172:175], a[36:39], a[88:91], v[172:175]
s_add_u32 m0, s25, 16384
v_mfma_f32_16x16x32_bf16 v[176:179], a[40:43], a[76:79], v[176:179]
ds_read_b64_tr_b16 a[4:5], v1 offset:32800
v_mfma_f32_16x16x32_bf16 v[180:183], a[40:43], a[80:83], v[180:183]
ds_read_b64_tr_b16 a[6:7], v1 offset:37408
v_mfma_f32_16x16x32_bf16 v[184:187], a[40:43], a[84:87], v[184:187]
buffer_load_dwordx4 v4, s[12:15], s21 offen offset:0 lds
v_mfma_f32_16x16x32_bf16 v[188:191], a[40:43], a[88:91], v[188:191]
ds_read_b64_tr_b16 a[8:9], v1 offset:32832
v_mfma_f32_16x16x32_bf16 v[192:195], a[44:47], a[76:79], v[192:195]
ds_read_b64_tr_b16 a[10:11], v1 offset:37440
v_mfma_f32_16x16x32_bf16 v[196:199], a[44:47], a[80:83], v[196:199]
v_mfma_f32_16x16x32_bf16 v[200:203], a[44:47], a[84:87], v[200:203]
ds_read_b64_tr_b16 a[12:13], v1 offset:32864
v_mfma_f32_16x16x32_bf16 v[204:207], a[44:47], a[88:91], v[204:207]
ds_read_b64_tr_b16 a[14:15], v1 offset:37472
v_mfma_f32_16x16x32_bf16 v[208:211], a[48:51], a[76:79], v[208:211]
buffer_load_dwordx4 v5, s[16:19], s22 offen offset:1024 lds
v_mfma_f32_16x16x32_bf16 v[212:215], a[48:51], a[80:83], v[212:215]
ds_read_b64_tr_b16 a[16:17], v1 offset:32896
v_mfma_f32_16x16x32_bf16 v[216:219], a[48:51], a[84:87], v[216:219]
ds_read_b64_tr_b16 a[18:19], v1 offset:37504
v_mfma_f32_16x16x32_bf16 v[220:223], a[48:51], a[88:91], v[220:223]
v_mfma_f32_16x16x32_bf16 v[224:227], a[52:55], a[76:79], v[224:227]
ds_read_b64_tr_b16 a[20:21], v1 offset:32928
v_mfma_f32_16x16x32_bf16 v[228:231], a[52:55], a[80:83], v[228:231]
ds_read_b64_tr_b16 a[22:23], v1 offset:37536
v_mfma_f32_16x16x32_bf16 v[232:235], a[52:55], a[84:87], v[232:235]
buffer_load_dwordx4 v6, s[16:19], s22 offen offset:2048 lds
v_mfma_f32_16x16x32_bf16 v[236:239], a[52:55], a[88:91], v[236:239]
ds_read_b64_tr_b16 a[24:25], v1 offset:32960
v_mfma_f32_16x16x32_bf16 v[240:243], a[56:59], a[76:79], v[240:243]
ds_read_b64_tr_b16 a[26:27], v1 offset:37568
v_mfma_f32_16x16x32_bf16 v[244:247], a[56:59], a[80:83], v[244:247]
v_mfma_f32_16x16x32_bf16 v[248:251], a[56:59], a[84:87], v[248:251]
ds_read_b64_tr_b16 a[28:29], v1 offset:32992
v_mfma_f32_16x16x32_bf16 v[252:255], a[56:59], a[88:91], v[252:255]
ds_read_b64_tr_b16 a[30:31], v1 offset:37600
s_waitcnt lgkmcnt(10)
v_mfma_f32_16x16x32_bf16 v[16:19], a[0:3], a[60:63], v[16:19]
buffer_load_dwordx4 v7, s[16:19], s22 offen offset:3072 lds
v_mfma_f32_16x16x32_bf16 v[20:23], a[0:3], a[64:67], v[20:23]
ds_read_b64_tr_b16 a[32:33], v2 offset:32768
v_mfma_f32_16x16x32_bf16 v[24:27], a[0:3], a[68:71], v[24:27]
ds_read_b64_tr_b16 a[34:35], v2 offset:36352
v_mfma_f32_16x16x32_bf16 v[28:31], a[0:3], a[72:75], v[28:31]
ds_read_b128 a[76:79], v12 offset:32768
v_mfma_f32_16x16x32_bf16 v[32:35], a[4:7], a[60:63], v[32:35]
ds_read_b64_tr_b16 a[36:37], v2 offset:32800
v_mfma_f32_16x16x32_bf16 v[36:39], a[4:7], a[64:67], v[36:39]
ds_read_b64_tr_b16 a[38:39], v2 offset:36384
v_mfma_f32_16x16x32_bf16 v[40:43], a[4:7], a[68:71], v[40:43]
s_add_u32 s21, s21, s23
s_add_u32 s22, s22, s24
ds_read_b128 a[80:83], v12 offset:34816
v_mfma_f32_16x16x32_bf16 v[44:47], a[4:7], a[72:75], v[44:47]
ds_read_b64_tr_b16 a[40:41], v2 offset:32832
v_mfma_f32_16x16x32_bf16 v[48:51], a[8:11], a[60:63], v[48:51]
ds_read_b64_tr_b16 a[42:43], v2 offset:36416
v_mfma_f32_16x16x32_bf16 v[52:55], a[8:11], a[64:67], v[52:55]
ds_read_b128 a[84:87], v12 offset:36864
v_mfma_f32_16x16x32_bf16 v[56:59], a[8:11], a[68:71], v[56:59]
ds_read_b64_tr_b16 a[44:45], v2 offset:32864
v_mfma_f32_16x16x32_bf16 v[60:63], a[8:11], a[72:75], v[60:63]
ds_read_b64_tr_b16 a[46:47], v2 offset:36448
s_waitcnt lgkmcnt(15)
v_mfma_f32_16x16x32_bf16 v[64:67], a[12:15], a[60:63], v[64:67]
ds_read_b128 a[88:91], v12 offset:38912
v_mfma_f32_16x16x32_bf16 v[68:71], a[12:15], a[64:67], v[68:71]
ds_read_b64_tr_b16 a[48:49], v2 offset:32896
s_add_u32 m0, s55, 69632
v_mfma_f32_16x16x32_bf16 v[72:75], a[12:15], a[68:71], v[72:75]
ds_read_b64_tr_b16 a[50:51], v2 offset:36480
s_add_u32 s3, s20, 65536
v_mfma_f32_16x16x32_bf16 v[76:79], a[12:15], a[72:75], v[76:79]
buffer_load_dwordx4 v3, s[8:11], s3 offen offset:0 lds
v_mfma_f32_16x16x32_bf16 v[80:83], a[16:19], a[60:63], v[80:83]
ds_read_b64_tr_b16 a[52:53], v2 offset:32928
v_mfma_f32_16x16x32_bf16 v[84:87], a[16:19], a[64:67], v[84:87]
ds_read_b64_tr_b16 a[54:55], v2 offset:36512
v_mfma_f32_16x16x32_bf16 v[88:91], a[16:19], a[68:71], v[88:91]
buffer_load_dwordx4 a[128:131], v14, s[60:63], s33 offen
s_add_u32 s33, s33, s35
v_mfma_f32_16x16x32_bf16 v[92:95], a[16:19], a[72:75], v[92:95]
ds_read_b64_tr_b16 a[56:57], v2 offset:32960
v_mfma_f32_16x16x32_bf16 v[96:99], a[20:23], a[60:63], v[96:99]
ds_read_b64_tr_b16 a[58:59], v2 offset:36544
s_add_u32 s3, s20, 80896
v_mfma_f32_16x16x32_bf16 v[100:103], a[20:23], a[64:67], v[100:103]
buffer_load_dwordx4 v13, s[8:11], s3 offen offset:1024 lds
v_mfma_f32_16x16x32_bf16 v[104:107], a[20:23], a[68:71], v[104:107]
v_mfma_f32_16x16x32_bf16 v[108:111], a[20:23], a[72:75], v[108:111]
s_waitcnt lgkmcnt(15)
v_mfma_f32_16x16x32_bf16 v[112:115], a[24:27], a[60:63], v[112:115]
v_mfma_f32_16x16x32_bf16 v[116:119], a[24:27], a[64:67], v[116:119]
v_mfma_f32_16x16x32_bf16 v[120:123], a[24:27], a[68:71], v[120:123]
s_add_u32 s3, s20, 96256
v_mfma_f32_16x16x32_bf16 v[124:127], a[24:27], a[72:75], v[124:127]
buffer_load_dwordx4 v3, s[8:11], s3 offen offset:2048 lds
v_mfma_f32_16x16x32_bf16 v[128:131], a[28:31], a[60:63], v[128:131]
v_mfma_f32_16x16x32_bf16 v[132:135], a[28:31], a[64:67], v[132:135]
v_mfma_f32_16x16x32_bf16 v[136:139], a[28:31], a[68:71], v[136:139]
v_mfma_f32_16x16x32_bf16 v[140:143], a[28:31], a[72:75], v[140:143]
v_mfma_f32_16x16x32_bf16 v[144:147], a[32:35], a[60:63], v[144:147]
s_add_u32 s3, s20, 111616
v_mfma_f32_16x16x32_bf16 v[148:151], a[32:35], a[64:67], v[148:151]
buffer_load_dwordx4 v13, s[8:11], s3 offen offset:3072 lds
s_add_u32 s20, s20, 128
v_mfma_f32_16x16x32_bf16 v[152:155], a[32:35], a[68:71], v[152:155]
v_mfma_f32_16x16x32_bf16 v[156:159], a[32:35], a[72:75], v[156:159]
s_waitcnt lgkmcnt(7)
v_mfma_f32_16x16x32_bf16 v[160:163], a[36:39], a[60:63], v[160:163]
s_waitcnt vmcnt(26) lgkmcnt(0)
s_barrier
v_mfma_f32_16x16x32_bf16 v[164:167], a[36:39], a[64:67], v[164:167]
ds_read_b64_tr_b16 a[0:1], v1 offset:49152
v_mfma_f32_16x16x32_bf16 v[168:171], a[36:39], a[68:71], v[168:171]
ds_read_b64_tr_b16 a[2:3], v1 offset:53760
v_mfma_f32_16x16x32_bf16 v[172:175], a[36:39], a[72:75], v[172:175]
s_add_u32 m0, s25, 32768
v_mfma_f32_16x16x32_bf16 v[176:179], a[40:43], a[60:63], v[176:179]
ds_read_b64_tr_b16 a[4:5], v1 offset:49184
v_mfma_f32_16x16x32_bf16 v[180:183], a[40:43], a[64:67], v[180:183]
ds_read_b64_tr_b16 a[6:7], v1 offset:53792
v_mfma_f32_16x16x32_bf16 v[184:187], a[40:43], a[68:71], v[184:187]
buffer_load_dwordx4 v4, s[12:15], s21 offen offset:0 lds
v_mfma_f32_16x16x32_bf16 v[188:191], a[40:43], a[72:75], v[188:191]
ds_read_b64_tr_b16 a[8:9], v1 offset:49216
v_mfma_f32_16x16x32_bf16 v[192:195], a[44:47], a[60:63], v[192:195]
ds_read_b64_tr_b16 a[10:11], v1 offset:53824
v_mfma_f32_16x16x32_bf16 v[196:199], a[44:47], a[64:67], v[196:199]
v_mfma_f32_16x16x32_bf16 v[200:203], a[44:47], a[68:71], v[200:203]
ds_read_b64_tr_b16 a[12:13], v1 offset:49248
v_mfma_f32_16x16x32_bf16 v[204:207], a[44:47], a[72:75], v[204:207]
ds_read_b64_tr_b16 a[14:15], v1 offset:53856
v_mfma_f32_16x16x32_bf16 v[208:211], a[48:51], a[60:63], v[208:211]
buffer_load_dwordx4 v5, s[16:19], s22 offen offset:1024 lds
v_mfma_f32_16x16x32_bf16 v[212:215], a[48:51], a[64:67], v[212:215]
ds_read_b64_tr_b16 a[16:17], v1 offset:49280
v_mfma_f32_16x16x32_bf16 v[216:219], a[48:51], a[68:71], v[216:219]
ds_read_b64_tr_b16 a[18:19], v1 offset:53888
v_mfma_f32_16x16x32_bf16 v[220:223], a[48:51], a[72:75], v[220:223]
v_mfma_f32_16x16x32_bf16 v[224:227], a[52:55], a[60:63], v[224:227]
ds_read_b64_tr_b16 a[20:21], v1 offset:49312
v_mfma_f32_16x16x32_bf16 v[228:231], a[52:55], a[64:67], v[228:231]
ds_read_b64_tr_b16 a[22:23], v1 offset:53920
v_mfma_f32_16x16x32_bf16 v[232:235], a[52:55], a[68:71], v[232:235]
buffer_load_dwordx4 v6, s[16:19], s22 offen offset:2048 lds
v_mfma_f32_16x16x32_bf16 v[236:239], a[52:55], a[72:75], v[236:239]
ds_read_b64_tr_b16 a[24:25], v1 offset:49344
v_mfma_f32_16x16x32_bf16 v[240:243], a[56:59], a[60:63], v[240:243]
ds_read_b64_tr_b16 a[26:27], v1 offset:53952
v_mfma_f32_16x16x32_bf16 v[244:247], a[56:59], a[64:67], v[244:247]
v_mfma_f32_16x16x32_bf16 v[248:251], a[56:59], a[68:71], v[248:251]
ds_read_b64_tr_b16 a[28:29], v1 offset:49376
v_mfma_f32_16x16x32_bf16 v[252:255], a[56:59], a[72:75], v[252:255]
ds_read_b64_tr_b16 a[30:31], v1 offset:53984
s_waitcnt lgkmcnt(10)
v_mfma_f32_16x16x32_bf16 v[16:19], a[0:3], a[76:79], v[16:19]
buffer_load_dwordx4 v7, s[16:19], s22 offen offset:3072 lds
v_mfma_f32_16x16x32_bf16 v[20:23], a[0:3], a[80:83], v[20:23]
ds_read_b64_tr_b16 a[32:33], v2 offset:49152
v_mfma_f32_16x16x32_bf16 v[24:27], a[0:3], a[84:87], v[24:27]
ds_read_b64_tr_b16 a[34:35], v2 offset:52736
s_waitcnt vmcnt(18)
v_mfma_f32_16x16x32_bf16 v[28:31], a[0:3], a[88:91], v[28:31]
ds_read_b128 a[60:63], v0 offset:0
v_mfma_f32_16x16x32_bf16 v[32:35], a[4:7], a[76:79], v[32:35]
ds_read_b64_tr_b16 a[36:37], v2 offset:49184
v_mfma_f32_16x16x32_bf16 v[36:39], a[4:7], a[80:83], v[36:39]
ds_read_b64_tr_b16 a[38:39], v2 offset:52768
v_mfma_f32_16x16x32_bf16 v[40:43], a[4:7], a[84:87], v[40:43]
s_add_u32 s21, s21, s23
s_add_u32 s22, s22, s24
ds_read_b128 a[64:67], v0 offset:2048
v_mfma_f32_16x16x32_bf16 v[44:47], a[4:7], a[88:91], v[44:47]
ds_read_b64_tr_b16 a[40:41], v2 offset:49216
v_mfma_f32_16x16x32_bf16 v[48:51], a[8:11], a[76:79], v[48:51]
ds_read_b64_tr_b16 a[42:43], v2 offset:52800
v_mfma_f32_16x16x32_bf16 v[52:55], a[8:11], a[80:83], v[52:55]
ds_read_b128 a[68:71], v0 offset:4096
v_mfma_f32_16x16x32_bf16 v[56:59], a[8:11], a[84:87], v[56:59]
ds_read_b64_tr_b16 a[44:45], v2 offset:49248
v_mfma_f32_16x16x32_bf16 v[60:63], a[8:11], a[88:91], v[60:63]
ds_read_b64_tr_b16 a[46:47], v2 offset:52832
s_waitcnt lgkmcnt(15)
v_mfma_f32_16x16x32_bf16 v[64:67], a[12:15], a[76:79], v[64:67]
ds_read_b128 a[72:75], v0 offset:6144
v_mfma_f32_16x16x32_bf16 v[68:71], a[12:15], a[80:83], v[68:71]
ds_read_b64_tr_b16 a[48:49], v2 offset:49280
s_add_u32 m0, s55, 131072
v_mfma_f32_16x16x32_bf16 v[72:75], a[12:15], a[84:87], v[72:75]
ds_read_b64_tr_b16 a[50:51], v2 offset:52864
s_add_u32 s3, s20, 0
v_mfma_f32_16x16x32_bf16 v[76:79], a[12:15], a[88:91], v[76:79]
buffer_load_dwordx4 v3, s[8:11], s3 offen offset:0 lds
v_mfma_f32_16x16x32_bf16 v[80:83], a[16:19], a[76:79], v[80:83]
ds_read_b64_tr_b16 a[52:53], v2 offset:49312
v_mfma_f32_16x16x32_bf16 v[84:87], a[16:19], a[80:83], v[84:87]
ds_read_b64_tr_b16 a[54:55], v2 offset:52896
v_mfma_f32_16x16x32_bf16 v[88:91], a[16:19], a[84:87], v[88:91]
buffer_load_dwordx4 a[132:135], v14, s[60:63], s33 offen
s_add_u32 s33, s33, s32
v_mfma_f32_16x16x32_bf16 v[92:95], a[16:19], a[88:91], v[92:95]
ds_read_b64_tr_b16 a[56:57], v2 offset:49344
v_mfma_f32_16x16x32_bf16 v[96:99], a[20:23], a[76:79], v[96:99]
ds_read_b64_tr_b16 a[58:59], v2 offset:52928
s_add_u32 s3, s20, 15360
v_mfma_f32_16x16x32_bf16 v[100:103], a[20:23], a[80:83], v[100:103]
buffer_load_dwordx4 v13, s[8:11], s3 offen offset:1024 lds
v_mfma_f32_16x16x32_bf16 v[104:107], a[20:23], a[84:87], v[104:107]
v_mfma_f32_16x16x32_bf16 v[108:111], a[20:23], a[88:91], v[108:111]
s_waitcnt lgkmcnt(15)
v_mfma_f32_16x16x32_bf16 v[112:115], a[24:27], a[76:79], v[112:115]
v_mfma_f32_16x16x32_bf16 v[116:119], a[24:27], a[80:83], v[116:119]
v_mfma_f32_16x16x32_bf16 v[120:123], a[24:27], a[84:87], v[120:123]
s_add_u32 s3, s20, 30720
v_mfma_f32_16x16x32_bf16 v[124:127], a[24:27], a[88:91], v[124:127]
buffer_load_dwordx4 v3, s[8:11], s3 offen offset:2048 lds
v_mfma_f32_16x16x32_bf16 v[128:131], a[28:31], a[76:79], v[128:131]
v_mfma_f32_16x16x32_bf16 v[132:135], a[28:31], a[80:83], v[132:135]
v_mfma_f32_16x16x32_bf16 v[136:139], a[28:31], a[84:87], v[136:139]
v_mfma_f32_16x16x32_bf16 v[140:143], a[28:31], a[88:91], v[140:143]
v_mfma_f32_16x16x32_bf16 v[144:147], a[32:35], a[76:79], v[144:147]
s_add_u32 s3, s20, 46080
v_mfma_f32_16x16x32_bf16 v[148:151], a[32:35], a[80:83], v[148:151]
buffer_load_dwordx4 v13, s[8:11], s3 offen offset:3072 lds
v_mfma_f32_16x16x32_bf16 v[152:155], a[32:35], a[84:87], v[152:155]
v_mfma_f32_16x16x32_bf16 v[156:159], a[32:35], a[88:91], v[156:159]
s_waitcnt lgkmcnt(7)
v_mfma_f32_16x16x32_bf16 v[160:163], a[36:39], a[76:79], v[160:163]
s_waitcnt lgkmcnt(0)
s_barrier
v_mfma_f32_16x16x32_bf16 v[164:167], a[36:39], a[80:83], v[164:167]
ds_read_b64_tr_b16 a[0:1], v1 offset:0
v_mfma_f32_16x16x32_bf16 v[168:171], a[36:39], a[84:87], v[168:171]
ds_read_b64_tr_b16 a[2:3], v1 offset:4608
v_mfma_f32_16x16x32_bf16 v[172:175], a[36:39], a[88:91], v[172:175]
s_add_u32 m0, s25, 49152
v_mfma_f32_16x16x32_bf16 v[176:179], a[40:43], a[76:79], v[176:179]
ds_read_b64_tr_b16 a[4:5], v1 offset:32
v_mfma_f32_16x16x32_bf16 v[180:183], a[40:43], a[80:83], v[180:183]
ds_read_b64_tr_b16 a[6:7], v1 offset:4640
v_mfma_f32_16x16x32_bf16 v[184:187], a[40:43], a[84:87], v[184:187]
buffer_load_dwordx4 v4, s[12:15], s21 offen offset:0 lds
v_mfma_f32_16x16x32_bf16 v[188:191], a[40:43], a[88:91], v[188:191]
ds_read_b64_tr_b16 a[8:9], v1 offset:64
v_mfma_f32_16x16x32_bf16 v[192:195], a[44:47], a[76:79], v[192:195]
ds_read_b64_tr_b16 a[10:11], v1 offset:4672
v_mfma_f32_16x16x32_bf16 v[196:199], a[44:47], a[80:83], v[196:199]
v_mfma_f32_16x16x32_bf16 v[200:203], a[44:47], a[84:87], v[200:203]
ds_read_b64_tr_b16 a[12:13], v1 offset:96
v_mfma_f32_16x16x32_bf16 v[204:207], a[44:47], a[88:91], v[204:207]
ds_read_b64_tr_b16 a[14:15], v1 offset:4704
v_mfma_f32_16x16x32_bf16 v[208:211], a[48:51], a[76:79], v[208:211]
buffer_load_dwordx4 v5, s[16:19], s22 offen offset:1024 lds
v_mfma_f32_16x16x32_bf16 v[212:215], a[48:51], a[80:83], v[212:215]
ds_read_b64_tr_b16 a[16:17], v1 offset:128
v_mfma_f32_16x16x32_bf16 v[216:219], a[48:51], a[84:87], v[216:219]
ds_read_b64_tr_b16 a[18:19], v1 offset:4736
v_mfma_f32_16x16x32_bf16 v[220:223], a[48:51], a[88:91], v[220:223]
v_mfma_f32_16x16x32_bf16 v[224:227], a[52:55], a[76:79], v[224:227]
ds_read_b64_tr_b16 a[20:21], v1 offset:160
v_mfma_f32_16x16x32_bf16 v[228:231], a[52:55], a[80:83], v[228:231]
ds_read_b64_tr_b16 a[22:23], v1 offset:4768
v_mfma_f32_16x16x32_bf16 v[232:235], a[52:55], a[84:87], v[232:235]
buffer_load_dwordx4 v6, s[16:19], s22 offen offset:2048 lds
v_mfma_f32_16x16x32_bf16 v[236:239], a[52:55], a[88:91], v[236:239]
ds_read_b64_tr_b16 a[24:25], v1 offset:192
v_mfma_f32_16x16x32_bf16 v[240:243], a[56:59], a[76:79], v[240:243]
ds_read_b64_tr_b16 a[26:27], v1 offset:4800
v_mfma_f32_16x16x32_bf16 v[244:247], a[56:59], a[80:83], v[244:247]
v_mfma_f32_16x16x32_bf16 v[248:251], a[56:59], a[84:87], v[248:251]
ds_read_b64_tr_b16 a[28:29], v1 offset:224
v_mfma_f32_16x16x32_bf16 v[252:255], a[56:59], a[88:91], v[252:255]
ds_read_b64_tr_b16 a[30:31], v1 offset:4832
s_waitcnt lgkmcnt(10)
v_mfma_f32_16x16x32_bf16 v[16:19], a[0:3], a[60:63], v[16:19]
buffer_load_dwordx4 v7, s[16:19], s22 offen offset:3072 lds
v_mfma_f32_16x16x32_bf16 v[20:23], a[0:3], a[64:67], v[20:23]
ds_read_b64_tr_b16 a[32:33], v2 offset:0
v_mfma_f32_16x16x32_bf16 v[24:27], a[0:3], a[68:71], v[24:27]
ds_read_b64_tr_b16 a[34:35], v2 offset:3584
v_mfma_f32_16x16x32_bf16 v[28:31], a[0:3], a[72:75], v[28:31]
ds_read_b128 a[76:79], v12 offset:0
v_mfma_f32_16x16x32_bf16 v[32:35], a[4:7], a[60:63], v[32:35]
ds_read_b64_tr_b16 a[36:37], v2 offset:32
v_mfma_f32_16x16x32_bf16 v[36:39], a[4:7], a[64:67], v[36:39]
ds_read_b64_tr_b16 a[38:39], v2 offset:3616
v_mfma_f32_16x16x32_bf16 v[40:43], a[4:7], a[68:71], v[40:43]
s_add_u32 s21, s21, s23
s_add_u32 s22, s22, s24
ds_read_b128 a[80:83], v12 offset:2048
v_mfma_f32_16x16x32_bf16 v[44:47], a[4:7], a[72:75], v[44:47]
ds_read_b64_tr_b16 a[40:41], v2 offset:64
v_mfma_f32_16x16x32_bf16 v[48:51], a[8:11], a[60:63], v[48:51]
ds_read_b64_tr_b16 a[42:43], v2 offset:3648
v_mfma_f32_16x16x32_bf16 v[52:55], a[8:11], a[64:67], v[52:55]
ds_read_b128 a[84:87], v12 offset:4096
v_mfma_f32_16x16x32_bf16 v[56:59], a[8:11], a[68:71], v[56:59]
ds_read_b64_tr_b16 a[44:45], v2 offset:96
v_mfma_f32_16x16x32_bf16 v[60:63], a[8:11], a[72:75], v[60:63]
ds_read_b64_tr_b16 a[46:47], v2 offset:3680
s_waitcnt lgkmcnt(15)
v_mfma_f32_16x16x32_bf16 v[64:67], a[12:15], a[60:63], v[64:67]
ds_read_b128 a[88:91], v12 offset:6144
v_mfma_f32_16x16x32_bf16 v[68:71], a[12:15], a[64:67], v[68:71]
ds_read_b64_tr_b16 a[48:49], v2 offset:128
s_add_u32 m0, s55, 135168
v_mfma_f32_16x16x32_bf16 v[72:75], a[12:15], a[68:71], v[72:75]
ds_read_b64_tr_b16 a[50:51], v2 offset:3712
s_add_u32 s3, s20, 65536
v_mfma_f32_16x16x32_bf16 v[76:79], a[12:15], a[72:75], v[76:79]
buffer_load_dwordx4 v3, s[8:11], s3 offen offset:0 lds
v_mfma_f32_16x16x32_bf16 v[80:83], a[16:19], a[60:63], v[80:83]
ds_read_b64_tr_b16 a[52:53], v2 offset:160
v_mfma_f32_16x16x32_bf16 v[84:87], a[16:19], a[64:67], v[84:87]
ds_read_b64_tr_b16 a[54:55], v2 offset:3744
v_mfma_f32_16x16x32_bf16 v[88:91], a[16:19], a[68:71], v[88:91]
buffer_load_dwordx4 a[136:139], v14, s[60:63], s33 offen
s_add_u32 s33, s33, s35
v_mfma_f32_16x16x32_bf16 v[92:95], a[16:19], a[72:75], v[92:95]
ds_read_b64_tr_b16 a[56:57], v2 offset:192
v_mfma_f32_16x16x32_bf16 v[96:99], a[20:23], a[60:63], v[96:99]
ds_read_b64_tr_b16 a[58:59], v2 offset:3776
s_add_u32 s3, s20, 80896
v_mfma_f32_16x16x32_bf16 v[100:103], a[20:23], a[64:67], v[100:103]
buffer_load_dwordx4 v13, s[8:11], s3 offen offset:1024 lds
v_mfma_f32_16x16x32_bf16 v[104:107], a[20:23], a[68:71], v[104:107]
v_mfma_f32_16x16x32_bf16 v[108:111], a[20:23], a[72:75], v[108:111]
s_waitcnt lgkmcnt(15)
v_mfma_f32_16x16x32_bf16 v[112:115], a[24:27], a[60:63], v[112:115]
v_mfma_f32_16x16x32_bf16 v[116:119], a[24:27], a[64:67], v[116:119]
v_mfma_f32_16x16x32_bf16 v[120:123], a[24:27], a[68:71], v[120:123]
s_add_u32 s3, s20, 96256
v_mfma_f32_16x16x32_bf16 v[124:127], a[24:27], a[72:75], v[124:127]
buffer_load_dwordx4 v3, s[8:11], s3 offen offset:2048 lds
v_mfma_f32_16x16x32_bf16 v[128:131], a[28:31], a[60:63], v[128:131]
v_mfma_f32_16x16x32_bf16 v[132:135], a[28:31], a[64:67], v[132:135]
v_mfma_f32_16x16x32_bf16 v[136:139], a[28:31], a[68:71], v[136:139]
v_mfma_f32_16x16x32_bf16 v[140:143], a[28:31], a[72:75], v[140:143]
v_mfma_f32_16x16x32_bf16 v[144:147], a[32:35], a[60:63], v[144:147]
s_add_u32 s3, s20, 111616
v_mfma_f32_16x16x32_bf16 v[148:151], a[32:35], a[64:67], v[148:151]
buffer_load_dwordx4 v13, s[8:11], s3 offen offset:3072 lds
s_add_u32 s20, s20, 128
v_mfma_f32_16x16x32_bf16 v[152:155], a[32:35], a[68:71], v[152:155]
v_mfma_f32_16x16x32_bf16 v[156:159], a[32:35], a[72:75], v[156:159]
s_waitcnt lgkmcnt(7)
v_mfma_f32_16x16x32_bf16 v[160:163], a[36:39], a[60:63], v[160:163]
s_waitcnt vmcnt(23) lgkmcnt(0)
s_barrier
v_mfma_f32_16x16x32_bf16 v[164:167], a[36:39], a[64:67], v[164:167]
ds_read_b64_tr_b16 a[0:1], v1 offset:16384
v_mfma_f32_16x16x32_bf16 v[168:171], a[36:39], a[68:71], v[168:171]
ds_read_b64_tr_b16 a[2:3], v1 offset:20992
v_mfma_f32_16x16x32_bf16 v[172:175], a[36:39], a[72:75], v[172:175]
s_add_u32 m0, s25, 0
v_mfma_f32_16x16x32_bf16 v[176:179], a[40:43], a[60:63], v[176:179]
ds_read_b64_tr_b16 a[4:5], v1 offset:16416
v_mfma_f32_16x16x32_bf16 v[180:183], a[40:43], a[64:67], v[180:183]
ds_read_b64_tr_b16 a[6:7], v1 offset:21024
v_mfma_f32_16x16x32_bf16 v[184:187], a[40:43], a[68:71], v[184:187]
buffer_load_dwordx4 v4, s[12:15], s21 offen offset:0 lds
v_mfma_f32_16x16x32_bf16 v[188:191], a[40:43], a[72:75], v[188:191]
ds_read_b64_tr_b16 a[8:9], v1 offset:16448
v_mfma_f32_16x16x32_bf16 v[192:195], a[44:47], a[60:63], v[192:195]
ds_read_b64_tr_b16 a[10:11], v1 offset:21056
v_mfma_f32_16x16x32_bf16 v[196:199], a[44:47], a[64:67], v[196:199]
v_mfma_f32_16x16x32_bf16 v[200:203], a[44:47], a[68:71], v[200:203]
ds_read_b64_tr_b16 a[12:13], v1 offset:16480
v_mfma_f32_16x16x32_bf16 v[204:207], a[44:47], a[72:75], v[204:207]
ds_read_b64_tr_b16 a[14:15], v1 offset:21088
v_mfma_f32_16x16x32_bf16 v[208:211], a[48:51], a[60:63], v[208:211]
buffer_load_dwordx4 v5, s[16:19], s22 offen offset:1024 lds
v_mfma_f32_16x16x32_bf16 v[212:215], a[48:51], a[64:67], v[212:215]
ds_read_b64_tr_b16 a[16:17], v1 offset:16512
v_mfma_f32_16x16x32_bf16 v[216:219], a[48:51], a[68:71], v[216:219]
ds_read_b64_tr_b16 a[18:19], v1 offset:21120
v_mfma_f32_16x16x32_bf16 v[220:223], a[48:51], a[72:75], v[220:223]
v_mfma_f32_16x16x32_bf16 v[224:227], a[52:55], a[60:63], v[224:227]
ds_read_b64_tr_b16 a[20:21], v1 offset:16544
v_mfma_f32_16x16x32_bf16 v[228:231], a[52:55], a[64:67], v[228:231]
ds_read_b64_tr_b16 a[22:23], v1 offset:21152
v_mfma_f32_16x16x32_bf16 v[232:235], a[52:55], a[68:71], v[232:235]
buffer_load_dwordx4 v6, s[16:19], s22 offen offset:2048 lds
v_mfma_f32_16x16x32_bf16 v[236:239], a[52:55], a[72:75], v[236:239]
ds_read_b64_tr_b16 a[24:25], v1 offset:16576
v_mfma_f32_16x16x32_bf16 v[240:243], a[56:59], a[60:63], v[240:243]
ds_read_b64_tr_b16 a[26:27], v1 offset:21184
v_mfma_f32_16x16x32_bf16 v[244:247], a[56:59], a[64:67], v[244:247]
v_mfma_f32_16x16x32_bf16 v[248:251], a[56:59], a[68:71], v[248:251]
ds_read_b64_tr_b16 a[28:29], v1 offset:16608
v_mfma_f32_16x16x32_bf16 v[252:255], a[56:59], a[72:75], v[252:255]
ds_read_b64_tr_b16 a[30:31], v1 offset:21216
s_waitcnt lgkmcnt(10)
v_mfma_f32_16x16x32_bf16 v[16:19], a[0:3], a[76:79], v[16:19]
buffer_load_dwordx4 v7, s[16:19], s22 offen offset:3072 lds
v_mfma_f32_16x16x32_bf16 v[20:23], a[0:3], a[80:83], v[20:23]
ds_read_b64_tr_b16 a[32:33], v2 offset:16384
v_subrev_u32 v15, 32768, v0
v_mfma_f32_16x16x32_bf16 v[24:27], a[0:3], a[84:87], v[24:27]
ds_read_b64_tr_b16 a[34:35], v2 offset:19968
s_waitcnt vmcnt(22)
v_mfma_f32_16x16x32_bf16 v[28:31], a[0:3], a[88:91], v[28:31]
ds_read_b128 a[60:63], v15 offset:0
v_mfma_f32_16x16x32_bf16 v[32:35], a[4:7], a[76:79], v[32:35]
ds_read_b64_tr_b16 a[36:37], v2 offset:16416
v_mfma_f32_16x16x32_bf16 v[36:39], a[4:7], a[80:83], v[36:39]
ds_read_b64_tr_b16 a[38:39], v2 offset:20000
v_mfma_f32_16x16x32_bf16 v[40:43], a[4:7], a[84:87], v[40:43]
s_add_u32 s21, s21, s23
s_add_u32 s22, s22, s24
ds_read_b128 a[64:67], v15 offset:2048
v_mfma_f32_16x16x32_bf16 v[44:47], a[4:7], a[88:91], v[44:47]
ds_read_b64_tr_b16 a[40:41], v2 offset:16448
v_mfma_f32_16x16x32_bf16 v[48:51], a[8:11], a[76:79], v[48:51]
ds_read_b64_tr_b16 a[42:43], v2 offset:20032
v_mfma_f32_16x16x32_bf16 v[52:55], a[8:11], a[80:83], v[52:55]
ds_read_b128 a[68:71], v15 offset:4096
v_mfma_f32_16x16x32_bf16 v[56:59], a[8:11], a[84:87], v[56:59]
ds_read_b64_tr_b16 a[44:45], v2 offset:16480
v_mfma_f32_16x16x32_bf16 v[60:63], a[8:11], a[88:91], v[60:63]
ds_read_b64_tr_b16 a[46:47], v2 offset:20064
s_waitcnt lgkmcnt(15)
v_mfma_f32_16x16x32_bf16 v[64:67], a[12:15], a[76:79], v[64:67]
ds_read_b128 a[72:75], v15 offset:6144
v_mfma_f32_16x16x32_bf16 v[68:71], a[12:15], a[80:83], v[68:71]
ds_read_b64_tr_b16 a[48:49], v2 offset:16512
s_add_u32 m0, s55, 98304
v_mfma_f32_16x16x32_bf16 v[72:75], a[12:15], a[84:87], v[72:75]
ds_read_b64_tr_b16 a[50:51], v2 offset:20096
s_add_u32 s3, s20, 0
v_mfma_f32_16x16x32_bf16 v[76:79], a[12:15], a[88:91], v[76:79]
buffer_load_dwordx4 v3, s[8:11], s3 offen offset:0 lds
v_mfma_f32_16x16x32_bf16 v[80:83], a[16:19], a[76:79], v[80:83]
ds_read_b64_tr_b16 a[52:53], v2 offset:16544
v_mfma_f32_16x16x32_bf16 v[84:87], a[16:19], a[80:83], v[84:87]
ds_read_b64_tr_b16 a[54:55], v2 offset:20128
v_mfma_f32_16x16x32_bf16 v[88:91], a[16:19], a[84:87], v[88:91]
buffer_load_dwordx4 a[140:143], v14, s[60:63], s33 offen
s_add_u32 s33, s33, s32
v_mfma_f32_16x16x32_bf16 v[92:95], a[16:19], a[88:91], v[92:95]
ds_read_b64_tr_b16 a[56:57], v2 offset:16576
v_mfma_f32_16x16x32_bf16 v[96:99], a[20:23], a[76:79], v[96:99]
ds_read_b64_tr_b16 a[58:59], v2 offset:20160
s_add_u32 s3, s20, 15360
v_mfma_f32_16x16x32_bf16 v[100:103], a[20:23], a[80:83], v[100:103]
buffer_load_dwordx4 v13, s[8:11], s3 offen offset:1024 lds
v_mfma_f32_16x16x32_bf16 v[104:107], a[20:23], a[84:87], v[104:107]
v_mfma_f32_16x16x32_bf16 v[108:111], a[20:23], a[88:91], v[108:111]
s_waitcnt lgkmcnt(15)
v_mfma_f32_16x16x32_bf16 v[112:115], a[24:27], a[76:79], v[112:115]
v_mfma_f32_16x16x32_bf16 v[116:119], a[24:27], a[80:83], v[116:119]
v_mfma_f32_16x16x32_bf16 v[120:123], a[24:27], a[84:87], v[120:123]
s_add_u32 s3, s20, 30720
v_mfma_f32_16x16x32_bf16 v[124:127], a[24:27], a[88:91], v[124:127]
buffer_load_dwordx4 v3, s[8:11], s3 offen offset:2048 lds
v_mfma_f32_16x16x32_bf16 v[128:131], a[28:31], a[76:79], v[128:131]
v_mfma_f32_16x16x32_bf16 v[132:135], a[28:31], a[80:83], v[132:135]
v_mfma_f32_16x16x32_bf16 v[136:139], a[28:31], a[84:87], v[136:139]
v_mfma_f32_16x16x32_bf16 v[140:143], a[28:31], a[88:91], v[140:143]
v_mfma_f32_16x16x32_bf16 v[144:147], a[32:35], a[76:79], v[144:147]
s_add_u32 s3, s20, 46080
v_mfma_f32_16x16x32_bf16 v[148:151], a[32:35], a[80:83], v[148:151]
buffer_load_dwordx4 v13, s[8:11], s3 offen offset:3072 lds
v_mfma_f32_16x16x32_bf16 v[152:155], a[32:35], a[84:87], v[152:155]
v_mfma_f32_16x16x32_bf16 v[156:159], a[32:35], a[88:91], v[156:159]
s_waitcnt lgkmcnt(7)
v_mfma_f32_16x16x32_bf16 v[160:163], a[36:39], a[76:79], v[160:163]
s_waitcnt vmcnt(23) lgkmcnt(0)
s_barrier
v_mfma_f32_16x16x32_bf16 v[164:167], a[36:39], a[80:83], v[164:167]
ds_read_b64_tr_b16 a[0:1], v1 offset:32768
v_mfma_f32_16x16x32_bf16 v[168:171], a[36:39], a[84:87], v[168:171]
ds_read_b64_tr_b16 a[2:3], v1 offset:37376
v_mfma_f32_16x16x32_bf16 v[172:175], a[36:39], a[88:91], v[172:175]
s_add_u32 m0, s25, 16384
v_mfma_f32_16x16x32_bf16 v[176:179], a[40:43], a[76:79], v[176:179]
ds_read_b64_tr_b16 a[4:5], v1 offset:32800
v_mfma_f32_16x16x32_bf16 v[180:183], a[40:43], a[80:83], v[180:183]
ds_read_b64_tr_b16 a[6:7], v1 offset:37408
v_mfma_f32_16x16x32_bf16 v[184:187], a[40:43], a[84:87], v[184:187]
buffer_load_dwordx4 v4, s[12:15], s21 offen offset:0 lds
v_mfma_f32_16x16x32_bf16 v[188:191], a[40:43], a[88:91], v[188:191]
ds_read_b64_tr_b16 a[8:9], v1 offset:32832
v_mfma_f32_16x16x32_bf16 v[192:195], a[44:47], a[76:79], v[192:195]
ds_read_b64_tr_b16 a[10:11], v1 offset:37440
v_mfma_f32_16x16x32_bf16 v[196:199], a[44:47], a[80:83], v[196:199]
v_mfma_f32_16x16x32_bf16 v[200:203], a[44:47], a[84:87], v[200:203]
ds_read_b64_tr_b16 a[12:13], v1 offset:32864
v_mfma_f32_16x16x32_bf16 v[204:207], a[44:47], a[88:91], v[204:207]
ds_read_b64_tr_b16 a[14:15], v1 offset:37472
v_mfma_f32_16x16x32_bf16 v[208:211], a[48:51], a[76:79], v[208:211]
buffer_load_dwordx4 v5, s[16:19], s22 offen offset:1024 lds
v_mfma_f32_16x16x32_bf16 v[212:215], a[48:51], a[80:83], v[212:215]
ds_read_b64_tr_b16 a[16:17], v1 offset:32896
v_mfma_f32_16x16x32_bf16 v[216:219], a[48:51], a[84:87], v[216:219]
ds_read_b64_tr_b16 a[18:19], v1 offset:37504
v_mfma_f32_16x16x32_bf16 v[220:223], a[48:51], a[88:91], v[220:223]
v_mfma_f32_16x16x32_bf16 v[224:227], a[52:55], a[76:79], v[224:227]
ds_read_b64_tr_b16 a[20:21], v1 offset:32928
v_mfma_f32_16x16x32_bf16 v[228:231], a[52:55], a[80:83], v[228:231]
ds_read_b64_tr_b16 a[22:23], v1 offset:37536
v_mfma_f32_16x16x32_bf16 v[232:235], a[52:55], a[84:87], v[232:235]
buffer_load_dwordx4 v6, s[16:19], s22 offen offset:2048 lds
v_mfma_f32_16x16x32_bf16 v[236:239], a[52:55], a[88:91], v[236:239]
ds_read_b64_tr_b16 a[24:25], v1 offset:32960
v_mfma_f32_16x16x32_bf16 v[240:243], a[56:59], a[76:79], v[240:243]
ds_read_b64_tr_b16 a[26:27], v1 offset:37568
v_mfma_f32_16x16x32_bf16 v[244:247], a[56:59], a[80:83], v[244:247]
v_mfma_f32_16x16x32_bf16 v[248:251], a[56:59], a[84:87], v[248:251]
ds_read_b64_tr_b16 a[28:29], v1 offset:32992
v_mfma_f32_16x16x32_bf16 v[252:255], a[56:59], a[88:91], v[252:255]
ds_read_b64_tr_b16 a[30:31], v1 offset:37600
s_waitcnt lgkmcnt(10)
v_mfma_f32_16x16x32_bf16 v[16:19], a[0:3], a[60:63], v[16:19]
buffer_load_dwordx4 v7, s[16:19], s22 offen offset:3072 lds
v_mfma_f32_16x16x32_bf16 v[20:23], a[0:3], a[64:67], v[20:23]
ds_read_b64_tr_b16 a[32:33], v2 offset:32768
v_subrev_u32 v15, 32768, v12
v_mfma_f32_16x16x32_bf16 v[24:27], a[0:3], a[68:71], v[24:27]
ds_read_b64_tr_b16 a[34:35], v2 offset:36352
v_mfma_f32_16x16x32_bf16 v[28:31], a[0:3], a[72:75], v[28:31]
ds_read_b128 a[76:79], v15 offset:0
v_mfma_f32_16x16x32_bf16 v[32:35], a[4:7], a[60:63], v[32:35]
ds_read_b64_tr_b16 a[36:37], v2 offset:32800
v_mfma_f32_16x16x32_bf16 v[36:39], a[4:7], a[64:67], v[36:39]
ds_read_b64_tr_b16 a[38:39], v2 offset:36384
v_mfma_f32_16x16x32_bf16 v[40:43], a[4:7], a[68:71], v[40:43]
s_add_u32 s21, s21, s23
s_add_u32 s22, s22, s24
ds_read_b128 a[80:83], v15 offset:2048
v_mfma_f32_16x16x32_bf16 v[44:47], a[4:7], a[72:75], v[44:47]
ds_read_b64_tr_b16 a[40:41], v2 offset:32832
v_mfma_f32_16x16x32_bf16 v[48:51], a[8:11], a[60:63], v[48:51]
ds_read_b64_tr_b16 a[42:43], v2 offset:36416
v_mfma_f32_16x16x32_bf16 v[52:55], a[8:11], a[64:67], v[52:55]
ds_read_b128 a[84:87], v15 offset:4096
v_mfma_f32_16x16x32_bf16 v[56:59], a[8:11], a[68:71], v[56:59]
ds_read_b64_tr_b16 a[44:45], v2 offset:32864
v_mfma_f32_16x16x32_bf16 v[60:63], a[8:11], a[72:75], v[60:63]
ds_read_b64_tr_b16 a[46:47], v2 offset:36448
s_waitcnt lgkmcnt(15)
v_mfma_f32_16x16x32_bf16 v[64:67], a[12:15], a[60:63], v[64:67]
ds_read_b128 a[88:91], v15 offset:6144
v_mfma_f32_16x16x32_bf16 v[68:71], a[12:15], a[64:67], v[68:71]
ds_read_b64_tr_b16 a[48:49], v2 offset:32896
s_add_u32 m0, s55, 102400
v_mfma_f32_16x16x32_bf16 v[72:75], a[12:15], a[68:71], v[72:75]
ds_read_b64_tr_b16 a[50:51], v2 offset:36480
s_add_u32 s3, s20, 65536
v_mfma_f32_16x16x32_bf16 v[76:79], a[12:15], a[72:75], v[76:79]
buffer_load_dwordx4 v3, s[8:11], s3 offen offset:0 lds
v_mfma_f32_16x16x32_bf16 v[80:83], a[16:19], a[60:63], v[80:83]
ds_read_b64_tr_b16 a[52:53], v2 offset:32928
v_mfma_f32_16x16x32_bf16 v[84:87], a[16:19], a[64:67], v[84:87]
ds_read_b64_tr_b16 a[54:55], v2 offset:36512
v_mfma_f32_16x16x32_bf16 v[88:91], a[16:19], a[68:71], v[88:91]
buffer_load_dwordx4 a[144:147], v14, s[60:63], s33 offen
s_add_u32 s33, s33, s35
v_mfma_f32_16x16x32_bf16 v[92:95], a[16:19], a[72:75], v[92:95]
ds_read_b64_tr_b16 a[56:57], v2 offset:32960
v_mfma_f32_16x16x32_bf16 v[96:99], a[20:23], a[60:63], v[96:99]
ds_read_b64_tr_b16 a[58:59], v2 offset:36544
s_add_u32 s3, s20, 80896
v_mfma_f32_16x16x32_bf16 v[100:103], a[20:23], a[64:67], v[100:103]
buffer_load_dwordx4 v13, s[8:11], s3 offen offset:1024 lds
v_mfma_f32_16x16x32_bf16 v[104:107], a[20:23], a[68:71], v[104:107]
v_mfma_f32_16x16x32_bf16 v[108:111], a[20:23], a[72:75], v[108:111]
s_waitcnt lgkmcnt(15)
v_mfma_f32_16x16x32_bf16 v[112:115], a[24:27], a[60:63], v[112:115]
v_mfma_f32_16x16x32_bf16 v[116:119], a[24:27], a[64:67], v[116:119]
v_mfma_f32_16x16x32_bf16 v[120:123], a[24:27], a[68:71], v[120:123]
s_add_u32 s3, s20, 96256
v_mfma_f32_16x16x32_bf16 v[124:127], a[24:27], a[72:75], v[124:127]
buffer_load_dwordx4 v3, s[8:11], s3 offen offset:2048 lds
v_mfma_f32_16x16x32_bf16 v[128:131], a[28:31], a[60:63], v[128:131]
v_mfma_f32_16x16x32_bf16 v[132:135], a[28:31], a[64:67], v[132:135]
v_mfma_f32_16x16x32_bf16 v[136:139], a[28:31], a[68:71], v[136:139]
v_mfma_f32_16x16x32_bf16 v[140:143], a[28:31], a[72:75], v[140:143]
v_mfma_f32_16x16x32_bf16 v[144:147], a[32:35], a[60:63], v[144:147]
s_add_u32 s3, s20, 111616
v_mfma_f32_16x16x32_bf16 v[148:151], a[32:35], a[64:67], v[148:151]
buffer_load_dwordx4 v13, s[8:11], s3 offen offset:3072 lds
s_add_u32 s20, s20, 128
v_mfma_f32_16x16x32_bf16 v[152:155], a[32:35], a[68:71], v[152:155]
v_mfma_f32_16x16x32_bf16 v[156:159], a[32:35], a[72:75], v[156:159]
s_waitcnt lgkmcnt(7)
v_mfma_f32_16x16x32_bf16 v[160:163], a[36:39], a[60:63], v[160:163]
s_waitcnt vmcnt(23) lgkmcnt(0)
s_barrier
v_mfma_f32_16x16x32_bf16 v[164:167], a[36:39], a[64:67], v[164:167]
ds_read_b64_tr_b16 a[0:1], v1 offset:49152
v_mfma_f32_16x16x32_bf16 v[168:171], a[36:39], a[68:71], v[168:171]
ds_read_b64_tr_b16 a[2:3], v1 offset:53760
v_mfma_f32_16x16x32_bf16 v[172:175], a[36:39], a[72:75], v[172:175]
s_add_u32 m0, s25, 32768
v_mfma_f32_16x16x32_bf16 v[176:179], a[40:43], a[60:63], v[176:179]
ds_read_b64_tr_b16 a[4:5], v1 offset:49184
v_mfma_f32_16x16x32_bf16 v[180:183], a[40:43], a[64:67], v[180:183]
ds_read_b64_tr_b16 a[6:7], v1 offset:53792
v_mfma_f32_16x16x32_bf16 v[184:187], a[40:43], a[68:71], v[184:187]
buffer_load_dwordx4 v4, s[12:15], s21 offen offset:0 lds
v_mfma_f32_16x16x32_bf16 v[188:191], a[40:43], a[72:75], v[188:191]
ds_read_b64_tr_b16 a[8:9], v1 offset:49216
v_mfma_f32_16x16x32_bf16 v[192:195], a[44:47], a[60:63], v[192:195]
ds_read_b64_tr_b16 a[10:11], v1 offset:53824
v_mfma_f32_16x16x32_bf16 v[196:199], a[44:47], a[64:67], v[196:199]
v_mfma_f32_16x16x32_bf16 v[200:203], a[44:47], a[68:71], v[200:203]
ds_read_b64_tr_b16 a[12:13], v1 offset:49248
v_mfma_f32_16x16x32_bf16 v[204:207], a[44:47], a[72:75], v[204:207]
ds_read_b64_tr_b16 a[14:15], v1 offset:53856
v_mfma_f32_16x16x32_bf16 v[208:211], a[48:51], a[60:63], v[208:211]
buffer_load_dwordx4 v5, s[16:19], s22 offen offset:1024 lds
v_mfma_f32_16x16x32_bf16 v[212:215], a[48:51], a[64:67], v[212:215]
ds_read_b64_tr_b16 a[16:17], v1 offset:49280
v_mfma_f32_16x16x32_bf16 v[216:219], a[48:51], a[68:71], v[216:219]
ds_read_b64_tr_b16 a[18:19], v1 offset:53888
v_mfma_f32_16x16x32_bf16 v[220:223], a[48:51], a[72:75], v[220:223]
v_mfma_f32_16x16x32_bf16 v[224:227], a[52:55], a[60:63], v[224:227]
ds_read_b64_tr_b16 a[20:21], v1 offset:49312
v_mfma_f32_16x16x32_bf16 v[228:231], a[52:55], a[64:67], v[228:231]
ds_read_b64_tr_b16 a[22:23], v1 offset:53920
v_mfma_f32_16x16x32_bf16 v[232:235], a[52:55], a[68:71], v[232:235]
buffer_load_dwordx4 v6, s[16:19], s22 offen offset:2048 lds
v_mfma_f32_16x16x32_bf16 v[236:239], a[52:55], a[72:75], v[236:239]
ds_read_b64_tr_b16 a[24:25], v1 offset:49344
v_mfma_f32_16x16x32_bf16 v[240:243], a[56:59], a[60:63], v[240:243]
ds_read_b64_tr_b16 a[26:27], v1 offset:53952
v_mfma_f32_16x16x32_bf16 v[244:247], a[56:59], a[64:67], v[244:247]
v_mfma_f32_16x16x32_bf16 v[248:251], a[56:59], a[68:71], v[248:251]
ds_read_b64_tr_b16 a[28:29], v1 offset:49376
v_mfma_f32_16x16x32_bf16 v[252:255], a[56:59], a[72:75], v[252:255]
ds_read_b64_tr_b16 a[30:31], v1 offset:53984
s_waitcnt lgkmcnt(10)
v_mfma_f32_16x16x32_bf16 v[16:19], a[0:3], a[76:79], v[16:19]
buffer_load_dwordx4 v7, s[16:19], s22 offen offset:3072 lds
v_mfma_f32_16x16x32_bf16 v[20:23], a[0:3], a[80:83], v[20:23]
ds_read_b64_tr_b16 a[32:33], v2 offset:49152
v_mfma_f32_16x16x32_bf16 v[24:27], a[0:3], a[84:87], v[24:27]
ds_read_b64_tr_b16 a[34:35], v2 offset:52736
s_waitcnt vmcnt(22)
v_mfma_f32_16x16x32_bf16 v[28:31], a[0:3], a[88:91], v[28:31]
ds_read_b128 a[60:63], v0 offset:32768
v_mfma_f32_16x16x32_bf16 v[32:35], a[4:7], a[76:79], v[32:35]
ds_read_b64_tr_b16 a[36:37], v2 offset:49184
v_mfma_f32_16x16x32_bf16 v[36:39], a[4:7], a[80:83], v[36:39]
ds_read_b64_tr_b16 a[38:39], v2 offset:52768
v_mfma_f32_16x16x32_bf16 v[40:43], a[4:7], a[84:87], v[40:43]
s_add_u32 s21, s21, s23
s_add_u32 s22, s22, s24
ds_read_b128 a[64:67], v0 offset:34816
v_mfma_f32_16x16x32_bf16 v[44:47], a[4:7], a[88:91], v[44:47]
ds_read_b64_tr_b16 a[40:41], v2 offset:49216
v_mfma_f32_16x16x32_bf16 v[48:51], a[8:11], a[76:79], v[48:51]
ds_read_b64_tr_b16 a[42:43], v2 offset:52800
v_mfma_f32_16x16x32_bf16 v[52:55], a[8:11], a[80:83], v[52:55]
ds_read_b128 a[68:71], v0 offset:36864
v_mfma_f32_16x16x32_bf16 v[56:59], a[8:11], a[84:87], v[56:59]
ds_read_b64_tr_b16 a[44:45], v2 offset:49248
v_mfma_f32_16x16x32_bf16 v[60:63], a[8:11], a[88:91], v[60:63]
ds_read_b64_tr_b16 a[46:47], v2 offset:52832
s_waitcnt lgkmcnt(15)
v_mfma_f32_16x16x32_bf16 v[64:67], a[12:15], a[76:79], v[64:67]
ds_read_b128 a[72:75], v0 offset:38912
v_mfma_f32_16x16x32_bf16 v[68:71], a[12:15], a[80:83], v[68:71]
ds_read_b64_tr_b16 a[48:49], v2 offset:49280
s_add_u32 m0, s55, 65536
v_mfma_f32_16x16x32_bf16 v[72:75], a[12:15], a[84:87], v[72:75]
ds_read_b64_tr_b16 a[50:51], v2 offset:52864
s_add_u32 s3, s20, 0
v_mfma_f32_16x16x32_bf16 v[76:79], a[12:15], a[88:91], v[76:79]
buffer_load_dwordx4 v3, s[8:11], s3 offen offset:0 lds
v_mfma_f32_16x16x32_bf16 v[80:83], a[16:19], a[76:79], v[80:83]
ds_read_b64_tr_b16 a[52:53], v2 offset:49312
v_mfma_f32_16x16x32_bf16 v[84:87], a[16:19], a[80:83], v[84:87]
ds_read_b64_tr_b16 a[54:55], v2 offset:52896
v_mfma_f32_16x16x32_bf16 v[88:91], a[16:19], a[84:87], v[88:91]
buffer_load_dwordx4 a[148:151], v14, s[60:63], s33 offen
s_add_u32 s33, s33, s32
v_mfma_f32_16x16x32_bf16 v[92:95], a[16:19], a[88:91], v[92:95]
ds_read_b64_tr_b16 a[56:57], v2 offset:49344
v_mfma_f32_16x16x32_bf16 v[96:99], a[20:23], a[76:79], v[96:99]
ds_read_b64_tr_b16 a[58:59], v2 offset:52928
s_add_u32 s3, s20, 15360
v_mfma_f32_16x16x32_bf16 v[100:103], a[20:23], a[80:83], v[100:103]
buffer_load_dwordx4 v13, s[8:11], s3 offen offset:1024 lds
v_mfma_f32_16x16x32_bf16 v[104:107], a[20:23], a[84:87], v[104:107]
v_mfma_f32_16x16x32_bf16 v[108:111], a[20:23], a[88:91], v[108:111]
s_waitcnt lgkmcnt(15)
v_mfma_f32_16x16x32_bf16 v[112:115], a[24:27], a[76:79], v[112:115]
v_mfma_f32_16x16x32_bf16 v[116:119], a[24:27], a[80:83], v[116:119]
v_mfma_f32_16x16x32_bf16 v[120:123], a[24:27], a[84:87], v[120:123]
s_add_u32 s3, s20, 30720
v_mfma_f32_16x16x32_bf16 v[124:127], a[24:27], a[88:91], v[124:127]
buffer_load_dwordx4 v3, s[8:11], s3 offen offset:2048 lds
v_mfma_f32_16x16x32_bf16 v[128:131], a[28:31], a[76:79], v[128:131]
v_mfma_f32_16x16x32_bf16 v[132:135], a[28:31], a[80:83], v[132:135]
v_mfma_f32_16x16x32_bf16 v[136:139], a[28:31], a[84:87], v[136:139]
v_mfma_f32_16x16x32_bf16 v[140:143], a[28:31], a[88:91], v[140:143]
v_mfma_f32_16x16x32_bf16 v[144:147], a[32:35], a[76:79], v[144:147]
s_add_u32 s3, s20, 46080
v_mfma_f32_16x16x32_bf16 v[148:151], a[32:35], a[80:83], v[148:151]
buffer_load_dwordx4 v13, s[8:11], s3 offen offset:3072 lds
v_mfma_f32_16x16x32_bf16 v[152:155], a[32:35], a[84:87], v[152:155]
v_mfma_f32_16x16x32_bf16 v[156:159], a[32:35], a[88:91], v[156:159]
s_waitcnt lgkmcnt(7)
v_mfma_f32_16x16x32_bf16 v[160:163], a[36:39], a[76:79], v[160:163]
s_waitcnt vmcnt(23) lgkmcnt(0)
s_barrier
v_mfma_f32_16x16x32_bf16 v[164:167], a[36:39], a[80:83], v[164:167]
ds_read_b64_tr_b16 a[0:1], v1 offset:0
v_mfma_f32_16x16x32_bf16 v[168:171], a[36:39], a[84:87], v[168:171]
ds_read_b64_tr_b16 a[2:3], v1 offset:4608
v_mfma_f32_16x16x32_bf16 v[172:175], a[36:39], a[88:91], v[172:175]
s_add_u32 m0, s25, 49152
v_mfma_f32_16x16x32_bf16 v[176:179], a[40:43], a[76:79], v[176:179]
ds_read_b64_tr_b16 a[4:5], v1 offset:32
v_mfma_f32_16x16x32_bf16 v[180:183], a[40:43], a[80:83], v[180:183]
ds_read_b64_tr_b16 a[6:7], v1 offset:4640
v_mfma_f32_16x16x32_bf16 v[184:187], a[40:43], a[84:87], v[184:187]
buffer_load_dwordx4 v4, s[12:15], s21 offen offset:0 lds
v_mfma_f32_16x16x32_bf16 v[188:191], a[40:43], a[88:91], v[188:191]
ds_read_b64_tr_b16 a[8:9], v1 offset:64
v_mfma_f32_16x16x32_bf16 v[192:195], a[44:47], a[76:79], v[192:195]
ds_read_b64_tr_b16 a[10:11], v1 offset:4672
v_mfma_f32_16x16x32_bf16 v[196:199], a[44:47], a[80:83], v[196:199]
v_mfma_f32_16x16x32_bf16 v[200:203], a[44:47], a[84:87], v[200:203]
ds_read_b64_tr_b16 a[12:13], v1 offset:96
v_mfma_f32_16x16x32_bf16 v[204:207], a[44:47], a[88:91], v[204:207]
ds_read_b64_tr_b16 a[14:15], v1 offset:4704
v_mfma_f32_16x16x32_bf16 v[208:211], a[48:51], a[76:79], v[208:211]
buffer_load_dwordx4 v5, s[16:19], s22 offen offset:1024 lds
v_mfma_f32_16x16x32_bf16 v[212:215], a[48:51], a[80:83], v[212:215]
ds_read_b64_tr_b16 a[16:17], v1 offset:128
v_mfma_f32_16x16x32_bf16 v[216:219], a[48:51], a[84:87], v[216:219]
ds_read_b64_tr_b16 a[18:19], v1 offset:4736
v_mfma_f32_16x16x32_bf16 v[220:223], a[48:51], a[88:91], v[220:223]
v_mfma_f32_16x16x32_bf16 v[224:227], a[52:55], a[76:79], v[224:227]
ds_read_b64_tr_b16 a[20:21], v1 offset:160
v_mfma_f32_16x16x32_bf16 v[228:231], a[52:55], a[80:83], v[228:231]
ds_read_b64_tr_b16 a[22:23], v1 offset:4768
v_mfma_f32_16x16x32_bf16 v[232:235], a[52:55], a[84:87], v[232:235]
buffer_load_dwordx4 v6, s[16:19], s22 offen offset:2048 lds
v_mfma_f32_16x16x32_bf16 v[236:239], a[52:55], a[88:91], v[236:239]
ds_read_b64_tr_b16 a[24:25], v1 offset:192
v_mfma_f32_16x16x32_bf16 v[240:243], a[56:59], a[76:79], v[240:243]
ds_read_b64_tr_b16 a[26:27], v1 offset:4800
v_mfma_f32_16x16x32_bf16 v[244:247], a[56:59], a[80:83], v[244:247]
v_mfma_f32_16x16x32_bf16 v[248:251], a[56:59], a[84:87], v[248:251]
ds_read_b64_tr_b16 a[28:29], v1 offset:224
v_mfma_f32_16x16x32_bf16 v[252:255], a[56:59], a[88:91], v[252:255]
ds_read_b64_tr_b16 a[30:31], v1 offset:4832
s_waitcnt lgkmcnt(10)
v_mfma_f32_16x16x32_bf16 v[16:19], a[0:3], a[60:63], v[16:19]
buffer_load_dwordx4 v7, s[16:19], s22 offen offset:3072 lds
v_mfma_f32_16x16x32_bf16 v[20:23], a[0:3], a[64:67], v[20:23]
ds_read_b64_tr_b16 a[32:33], v2 offset:0
v_mfma_f32_16x16x32_bf16 v[24:27], a[0:3], a[68:71], v[24:27]
ds_read_b64_tr_b16 a[34:35], v2 offset:3584
v_mfma_f32_16x16x32_bf16 v[28:31], a[0:3], a[72:75], v[28:31]
ds_read_b128 a[76:79], v12 offset:32768
v_mfma_f32_16x16x32_bf16 v[32:35], a[4:7], a[60:63], v[32:35]
ds_read_b64_tr_b16 a[36:37], v2 offset:32
v_mfma_f32_16x16x32_bf16 v[36:39], a[4:7], a[64:67], v[36:39]
ds_read_b64_tr_b16 a[38:39], v2 offset:3616
v_mfma_f32_16x16x32_bf16 v[40:43], a[4:7], a[68:71], v[40:43]
s_add_u32 s21, s21, s23
s_add_u32 s22, s22, s24
ds_read_b128 a[80:83], v12 offset:34816
v_mfma_f32_16x16x32_bf16 v[44:47], a[4:7], a[72:75], v[44:47]
ds_read_b64_tr_b16 a[40:41], v2 offset:64
v_mfma_f32_16x16x32_bf16 v[48:51], a[8:11], a[60:63], v[48:51]
ds_read_b64_tr_b16 a[42:43], v2 offset:3648
v_mfma_f32_16x16x32_bf16 v[52:55], a[8:11], a[64:67], v[52:55]
ds_read_b128 a[84:87], v12 offset:36864
v_mfma_f32_16x16x32_bf16 v[56:59], a[8:11], a[68:71], v[56:59]
ds_read_b64_tr_b16 a[44:45], v2 offset:96
v_mfma_f32_16x16x32_bf16 v[60:63], a[8:11], a[72:75], v[60:63]
ds_read_b64_tr_b16 a[46:47], v2 offset:3680
s_waitcnt lgkmcnt(15)
v_mfma_f32_16x16x32_bf16 v[64:67], a[12:15], a[60:63], v[64:67]
ds_read_b128 a[88:91], v12 offset:38912
v_mfma_f32_16x16x32_bf16 v[68:71], a[12:15], a[64:67], v[68:71]
ds_read_b64_tr_b16 a[48:49], v2 offset:128
s_add_u32 m0, s55, 69632
v_mfma_f32_16x16x32_bf16 v[72:75], a[12:15], a[68:71], v[72:75]
ds_read_b64_tr_b16 a[50:51], v2 offset:3712
s_add_u32 s3, s20, 65536
s_getpc_b64 s[36:37]
L_pc10:
s_add_u32 s36, s36, L_gs12-L_pc10
s_addc_u32 s37, s37, 0
v_mfma_f32_16x16x32_bf16 v[76:79], a[12:15], a[72:75], v[76:79]
buffer_load_dwordx4 v3, s[8:11], s3 offen offset:0 lds
s_mov_b32 s40, s36
v_mfma_f32_16x16x32_bf16 v[80:83], a[16:19], a[60:63], v[80:83]
ds_read_b64_tr_b16 a[52:53], v2 offset:160
s_and_b32 s41, s37, 0xffff
v_mfma_f32_16x16x32_bf16 v[84:87], a[16:19], a[64:67], v[84:87]
ds_read_b64_tr_b16 a[54:55], v2 offset:3744
s_mov_b32 s42, L_end_k-L_gs12
v_mfma_f32_16x16x32_bf16 v[88:91], a[16:19], a[68:71], v[88:91]
buffer_load_dwordx4 a[152:155], v14, s[60:63], s33 offen
s_add_u32 s33, s33, s35
s_mov_b32 s43, 0x00020000
v_mfma_f32_16x16x32_bf16 v[92:95], a[16:19], a[72:75], v[92:95]
ds_read_b64_tr_b16 a[56:57], v2 offset:192
s_lshr_b32 s36, s2, 3
v_mfma_f32_16x16x32_bf16 v[96:99], a[20:23], a[60:63], v[96:99]
ds_read_b64_tr_b16 a[58:59], v2 offset:3776
s_add_u32 s3, s20, 80896
s_lshl_b32 s36, s36, 2
v_mfma_f32_16x16x32_bf16 v[100:103], a[20:23], a[64:67], v[100:103]
buffer_load_dwordx4 v13, s[8:11], s3 offen offset:1024 lds
s_add_u32 s36, s36, s26
v_mfma_f32_16x16x32_bf16 v[104:107], a[20:23], a[68:71], v[104:107]
s_lshl_b32 s36, s36, 10
v_mfma_f32_16x16x32_bf16 v[108:111], a[20:23], a[72:75], v[108:111]
v_accvgpr_read_b32 v15, a213
s_waitcnt lgkmcnt(15)
v_mfma_f32_16x16x32_bf16 v[112:115], a[24:27], a[60:63], v[112:115]
v_and_b32 v15, 63, v15
v_mfma_f32_16x16x32_bf16 v[116:119], a[24:27], a[64:67], v[116:119]
v_lshlrev_b32 v15, 4, v15
v_mfma_f32_16x16x32_bf16 v[120:123], a[24:27], a[68:71], v[120:123]
s_add_u32 s3, s20, 96256
buffer_load_dwordx4 a[252:255], v15, s[40:43], s36 offen
v_mfma_f32_16x16x32_bf16 v[124:127], a[24:27], a[72:75], v[124:127]
buffer_load_dwordx4 v3, s[8:11], s3 offen offset:2048 lds
v_mfma_f32_16x16x32_bf16 v[128:131], a[28:31], a[60:63], v[128:131]
v_mfma_f32_16x16x32_bf16 v[132:135], a[28:31], a[64:67], v[132:135]
v_mfma_f32_16x16x32_bf16 v[136:139], a[28:31], a[68:71], v[136:139]
v_mfma_f32_16x16x32_bf16 v[140:143], a[28:31], a[72:75], v[140:143]
v_mfma_f32_16x16x32_bf16 v[144:147], a[32:35], a[60:63], v[144:147]
s_add_u32 s3, s20, 111616
v_mfma_f32_16x16x32_bf16 v[148:151], a[32:35], a[64:67], v[148:151]
buffer_load_dwordx4 v13, s[8:11], s3 offen offset:3072 lds
s_add_u32 s20, s20, 128
v_mfma_f32_16x16x32_bf16 v[152:155], a[32:35], a[68:71], v[152:155]
v_mfma_f32_16x16x32_bf16 v[156:159], a[32:35], a[72:75], v[156:159]
s_waitcnt lgkmcnt(7)
v_mfma_f32_16x16x32_bf16 v[160:163], a[36:39], a[60:63], v[160:163]
s_waitcnt vmcnt(24) lgkmcnt(0)
s_barrier
v_mfma_f32_16x16x32_bf16 v[164:167], a[36:39], a[64:67], v[164:167]
ds_read_b64_tr_b16 a[0:1], v1 offset:16384
v_mfma_f32_16x16x32_bf16 v[168:171], a[36:39], a[68:71], v[168:171]
ds_read_b64_tr_b16 a[2:3], v1 offset:20992
v_mfma_f32_16x16x32_bf16 v[172:175], a[36:39], a[72:75], v[172:175]
s_add_u32 m0, s25, 0
v_mfma_f32_16x16x32_bf16 v[176:179], a[40:43], a[60:63], v[176:179]
ds_read_b64_tr_b16 a[4:5], v1 offset:16416
v_mfma_f32_16x16x32_bf16 v[180:183], a[40:43], a[64:67], v[180:183]
ds_read_b64_tr_b16 a[6:7], v1 offset:21024
v_mfma_f32_16x16x32_bf16 v[184:187], a[40:43], a[68:71], v[184:187]
buffer_load_dwordx4 v4, s[12:15], s21 offen offset:0 lds
v_mfma_f32_16x16x32_bf16 v[188:191], a[40:43], a[72:75], v[188:191]
ds_read_b64_tr_b16 a[8:9], v1 offset:16448
v_mfma_f32_16x16x32_bf16 v[192:195], a[44:47], a[60:63], v[192:195]
ds_read_b64_tr_b16 a[10:11], v1 offset:21056
v_mfma_f32_16x16x32_bf16 v[196:199], a[44:47], a[64:67], v[196:199]
v_mfma_f32_16x16x32_bf16 v[200:203], a[44:47], a[68:71], v[200:203]
ds_read_b64_tr_b16 a[12:13], v1 offset:16480
v_mfma_f32_16x16x32_bf16 v[204:207], a[44:47], a[72:75], v[204:207]
ds_read_b64_tr_b16 a[14:15], v1 offset:21088
v_mfma_f32_16x16x32_bf16 v[208:211], a[48:51], a[60:63], v[208:211]
buffer_load_dwordx4 v5, s[16:19], s22 offen offset:1024 lds
v_mfma_f32_16x16x32_bf16 v[212:215], a[48:51], a[64:67], v[212:215]
ds_read_b64_tr_b16 a[16:17], v1 offset:16512
v_mfma_f32_16x16x32_bf16 v[216:219], a[48:51], a[68:71], v[216:219]
ds_read_b64_tr_b16 a[18:19], v1 offset:21120
v_mfma_f32_16x16x32_bf16 v[220:223], a[48:51], a[72:75], v[220:223]
v_mfma_f32_16x16x32_bf16 v[224:227], a[52:55], a[60:63], v[224:227]
ds_read_b64_tr_b16 a[20:21], v1 offset:16544
v_mfma_f32_16x16x32_bf16 v[228:231], a[52:55], a[64:67], v[228:231]
ds_read_b64_tr_b16 a[22:23], v1 offset:21152
v_mfma_f32_16x16x32_bf16 v[232:235], a[52:55], a[68:71], v[232:235]
buffer_load_dwordx4 v6, s[16:19], s22 offen offset:2048 lds
v_mfma_f32_16x16x32_bf16 v[236:239], a[52:55], a[72:75], v[236:239]
ds_read_b64_tr_b16 a[24:25], v1 offset:16576
v_mfma_f32_16x16x32_bf16 v[240:243], a[56:59], a[60:63], v[240:243]
ds_read_b64_tr_b16 a[26:27], v1 offset:21184
v_mfma_f32_16x16x32_bf16 v[244:247], a[56:59], a[64:67], v[244:247]
v_mfma_f32_16x16x32_bf16 v[248:251], a[56:59], a[68:71], v[248:251]
ds_read_b64_tr_b16 a[28:29], v1 offset:16608
v_mfma_f32_16x16x32_bf16 v[252:255], a[56:59], a[72:75], v[252:255]
ds_read_b64_tr_b16 a[30:31], v1 offset:21216
s_waitcnt lgkmcnt(10)
v_mfma_f32_16x16x32_bf16 v[16:19], a[0:3], a[76:79], v[16:19]
buffer_load_dwordx4 v7, s[16:19], s22 offen offset:3072 lds
v_mfma_f32_16x16x32_bf16 v[20:23], a[0:3], a[80:83], v[20:23]
ds_read_b64_tr_b16 a[32:33], v2 offset:16384
v_mfma_f32_16x16x32_bf16 v[24:27], a[0:3], a[84:87], v[24:27]
ds_read_b64_tr_b16 a[34:35], v2 offset:19968
s_waitcnt vmcnt(23)
v_mfma_f32_16x16x32_bf16 v[28:31], a[0:3], a[88:91], v[28:31]
ds_read_b128 a[60:63], v0 offset:0
v_mfma_f32_16x16x32_bf16 v[32:35], a[4:7], a[76:79], v[32:35]
ds_read_b64_tr_b16 a[36:37], v2 offset:16416
v_mfma_f32_16x16x32_bf16 v[36:39], a[4:7], a[80:83], v[36:39]
ds_read_b64_tr_b16 a[38:39], v2 offset:20000
v_mfma_f32_16x16x32_bf16 v[40:43], a[4:7], a[84:87], v[40:43]
s_add_u32 s21, s21, s23
s_add_u32 s22, s22, s24
ds_read_b128 a[64:67], v0 offset:2048
v_mfma_f32_16x16x32_bf16 v[44:47], a[4:7], a[88:91], v[44:47]
ds_read_b64_tr_b16 a[40:41], v2 offset:16448
v_mfma_f32_16x16x32_bf16 v[48:51], a[8:11], a[76:79], v[48:51]
ds_read_b64_tr_b16 a[42:43], v2 offset:20032
v_mfma_f32_16x16x32_bf16 v[52:55], a[8:11], a[80:83], v[52:55]
ds_read_b128 a[68:71], v0 offset:4096
v_mfma_f32_16x16x32_bf16 v[56:59], a[8:11], a[84:87], v[56:59]
ds_read_b64_tr_b16 a[44:45], v2 offset:16480
v_mfma_f32_16x16x32_bf16 v[60:63], a[8:11], a[88:91], v[60:63]
ds_read_b64_tr_b16 a[46:47], v2 offset:20064
s_waitcnt lgkmcnt(15)
v_mfma_f32_16x16x32_bf16 v[64:67], a[12:15], a[76:79], v[64:67]
ds_read_b128 a[72:75], v0 offset:6144
v_mfma_f32_16x16x32_bf16 v[68:71], a[12:15], a[80:83], v[68:71]
ds_read_b64_tr_b16 a[48:49], v2 offset:16512
s_add_u32 m0, s55, 131072
v_mfma_f32_16x16x32_bf16 v[72:75], a[12:15], a[84:87], v[72:75]
ds_read_b64_tr_b16 a[50:51], v2 offset:20096
s_add_u32 s3, s20, 0
v_mfma_f32_16x16x32_bf16 v[76:79], a[12:15], a[88:91], v[76:79]
buffer_load_dwordx4 v3, s[8:11], s3 offen offset:0 lds
v_mfma_f32_16x16x32_bf16 v[80:83], a[16:19], a[76:79], v[80:83]
ds_read_b64_tr_b16 a[52:53], v2 offset:16544
v_mfma_f32_16x16x32_bf16 v[84:87], a[16:19], a[80:83], v[84:87]
ds_read_b64_tr_b16 a[54:55], v2 offset:20128
v_mfma_f32_16x16x32_bf16 v[88:91], a[16:19], a[84:87], v[88:91]
buffer_load_dwordx4 a[156:159], v14, s[60:63], s33 offen
s_add_u32 s33, s33, s32
v_mfma_f32_16x16x32_bf16 v[92:95], a[16:19], a[88:91], v[92:95]
ds_read_b64_tr_b16 a[56:57], v2 offset:16576
v_mfma_f32_16x16x32_bf16 v[96:99], a[20:23], a[76:79], v[96:99]
ds_read_b64_tr_b16 a[58:59], v2 offset:20160
s_add_u32 s3, s20, 15360
v_mfma_f32_16x16x32_bf16 v[100:103], a[20:23], a[80:83], v[100:103]
buffer_load_dwordx4 v13, s[8:11], s3 offen offset:1024 lds
v_mfma_f32_16x16x32_bf16 v[104:107], a[20:23], a[84:87], v[104:107]
v_mfma_f32_16x16x32_bf16 v[108:111], a[20:23], a[88:91], v[108:111]
s_waitcnt lgkmcnt(15)
v_mfma_f32_16x16x32_bf16 v[112:115], a[24:27], a[76:79], v[112:115]
v_mfma_f32_16x16x32_bf16 v[116:119], a[24:27], a[80:83], v[116:119]
v_mfma_f32_16x16x32_bf16 v[120:123], a[24:27], a[84:87], v[120:123]
s_add_u32 s3, s20, 30720
v_mfma_f32_16x16x32_bf16 v[124:127], a[24:27], a[88:91], v[124:127]
buffer_load_dwordx4 v3, s[8:11], s3 offen offset:2048 lds
v_mfma_f32_16x16x32_bf16 v[128:131], a[28:31], a[76:79], v[128:131]
v_mfma_f32_16x16x32_bf16 v[132:135], a[28:31], a[80:83], v[132:135]
v_mfma_f32_16x16x32_bf16 v[136:139], a[28:31], a[84:87], v[136:139]
v_mfma_f32_16x16x32_bf16 v[140:143], a[28:31], a[88:91], v[140:143]
v_mfma_f32_16x16x32_bf16 v[144:147], a[32:35], a[76:79], v[144:147]
s_add_u32 s3, s20, 46080
v_mfma_f32_16x16x32_bf16 v[148:151], a[32:35], a[80:83], v[148:151]
buffer_load_dwordx4 v13, s[8:11], s3 offen offset:3072 lds
v_mfma_f32_16x16x32_bf16 v[152:155], a[32:35], a[84:87], v[152:155]
v_mfma_f32_16x16x32_bf16 v[156:159], a[32:35], a[88:91], v[156:159]
s_waitcnt lgkmcnt(7)
v_mfma_f32_16x16x32_bf16 v[160:163], a[36:39], a[76:79], v[160:163]
s_waitcnt vmcnt(24) lgkmcnt(0)
s_barrier
v_mfma_f32_16x16x32_bf16 v[164:167], a[36:39], a[80:83], v[164:167]
ds_read_b64_tr_b16 a[0:1], v1 offset:32768
v_mfma_f32_16x16x32_bf16 v[168:171], a[36:39], a[84:87], v[168:171]
ds_read_b64_tr_b16 a[2:3], v1 offset:37376
v_mfma_f32_16x16x32_bf16 v[172:175], a[36:39], a[88:91], v[172:175]
s_add_u32 m0, s25, 16384
v_mfma_f32_16x16x32_bf16 v[176:179], a[40:43], a[76:79], v[176:179]
ds_read_b64_tr_b16 a[4:5], v1 offset:32800
v_mfma_f32_16x16x32_bf16 v[180:183], a[40:43], a[80:83], v[180:183]
ds_read_b64_tr_b16 a[6:7], v1 offset:37408
v_mfma_f32_16x16x32_bf16 v[184:187], a[40:43], a[84:87], v[184:187]
buffer_load_dwordx4 v4, s[12:15], s21 offen offset:0 lds
v_mfma_f32_16x16x32_bf16 v[188:191], a[40:43], a[88:91], v[188:191]
ds_read_b64_tr_b16 a[8:9], v1 offset:32832
v_mfma_f32_16x16x32_bf16 v[192:195], a[44:47], a[76:79], v[192:195]
ds_read_b64_tr_b16 a[10:11], v1 offset:37440
v_mfma_f32_16x16x32_bf16 v[196:199], a[44:47], a[80:83], v[196:199]
v_mfma_f32_16x16x32_bf16 v[200:203], a[44:47], a[84:87], v[200:203]
ds_read_b64_tr_b16 a[12:13], v1 offset:32864
v_mfma_f32_16x16x32_bf16 v[204:207], a[44:47], a[88:91], v[204:207]
ds_read_b64_tr_b16 a[14:15], v1 offset:37472
v_mfma_f32_16x16x32_bf16 v[208:211], a[48:51], a[76:79], v[208:211]
buffer_load_dwordx4 v5, s[16:19], s22 offen offset:1024 lds
v_mfma_f32_16x16x32_bf16 v[212:215], a[48:51], a[80:83], v[212:215]
ds_read_b64_tr_b16 a[16:17], v1 offset:32896
v_mfma_f32_16x16x32_bf16 v[216:219], a[48:51], a[84:87], v[216:219]
ds_read_b64_tr_b16 a[18:19], v1 offset:37504
v_mfma_f32_16x16x32_bf16 v[220:223], a[48:51], a[88:91], v[220:223]
v_mfma_f32_16x16x32_bf16 v[224:227], a[52:55], a[76:79], v[224:227]
ds_read_b64_tr_b16 a[20:21], v1 offset:32928
v_mfma_f32_16x16x32_bf16 v[228:231], a[52:55], a[80:83], v[228:231]
ds_read_b64_tr_b16 a[22:23], v1 offset:37536
v_mfma_f32_16x16x32_bf16 v[232:235], a[52:55], a[84:87], v[232:235]
buffer_load_dwordx4 v6, s[16:19], s22 offen offset:2048 lds
v_mfma_f32_16x16x32_bf16 v[236:239], a[52:55], a[88:91], v[236:239]
ds_read_b64_tr_b16 a[24:25], v1 offset:32960
v_mfma_f32_16x16x32_bf16 v[240:243], a[56:59], a[76:79], v[240:243]
ds_read_b64_tr_b16 a[26:27], v1 offset:37568
v_mfma_f32_16x16x32_bf16 v[244:247], a[56:59], a[80:83], v[244:247]
v_mfma_f32_16x16x32_bf16 v[248:251], a[56:59], a[84:87], v[248:251]
ds_read_b64_tr_b16 a[28:29], v1 offset:32992
v_mfma_f32_16x16x32_bf16 v[252:255], a[56:59], a[88:91], v[252:255]
ds_read_b64_tr_b16 a[30:31], v1 offset:37600
s_waitcnt lgkmcnt(10)
v_mfma_f32_16x16x32_bf16 v[16:19], a[0:3], a[60:63], v[16:19]
buffer_load_dwordx4 v7, s[16:19], s22 offen offset:3072 lds
v_mfma_f32_16x16x32_bf16 v[20:23], a[0:3], a[64:67], v[20:23]
ds_read_b64_tr_b16 a[32:33], v2 offset:32768
v_mfma_f32_16x16x32_bf16 v[24:27], a[0:3], a[68:71], v[24:27]
ds_read_b64_tr_b16 a[34:35], v2 offset:36352
v_mfma_f32_16x16x32_bf16 v[28:31], a[0:3], a[72:75], v[28:31]
ds_read_b128 a[76:79], v12 offset:0
v_mfma_f32_16x16x32_bf16 v[32:35], a[4:7], a[60:63], v[32:35]
ds_read_b64_tr_b16 a[36:37], v2 offset:32800
v_mfma_f32_16x16x32_bf16 v[36:39], a[4:7], a[64:67], v[36:39]
ds_read_b64_tr_b16 a[38:39], v2 offset:36384
v_mfma_f32_16x16x32_bf16 v[40:43], a[4:7], a[68:71], v[40:43]
s_add_u32 s21, s21, s23
s_add_u32 s22, s22, s24
ds_read_b128 a[80:83], v12 offset:2048
v_mfma_f32_16x16x32_bf16 v[44:47], a[4:7], a[72:75], v[44:47]
ds_read_b64_tr_b16 a[40:41], v2 offset:32832
v_mfma_f32_16x16x32_bf16 v[48:51], a[8:11], a[60:63], v[48:51]
ds_read_b64_tr_b16 a[42:43], v2 offset:36416
v_mfma_f32_16x16x32_bf16 v[52:55], a[8:11], a[64:67], v[52:55]
ds_read_b128 a[84:87], v12 offset:4096
v_mfma_f32_16x16x32_bf16 v[56:59], a[8:11], a[68:71], v[56:59]
ds_read_b64_tr_b16 a[44:45], v2 offset:32864
v_mfma_f32_16x16x32_bf16 v[60:63], a[8:11], a[72:75], v[60:63]
ds_read_b64_tr_b16 a[46:47], v2 offset:36448
s_waitcnt lgkmcnt(15)
v_mfma_f32_16x16x32_bf16 v[64:67], a[12:15], a[60:63], v[64:67]
ds_read_b128 a[88:91], v12 offset:6144
v_mfma_f32_16x16x32_bf16 v[68:71], a[12:15], a[64:67], v[68:71]
ds_read_b64_tr_b16 a[48:49], v2 offset:32896
s_add_u32 m0, s55, 135168
v_mfma_f32_16x16x32_bf16 v[72:75], a[12:15], a[68:71], v[72:75]
ds_read_b64_tr_b16 a[50:51], v2 offset:36480
s_add_u32 s3, s20, 65536
v_mfma_f32_16x16x32_bf16 v[76:79], a[12:15], a[72:75], v[76:79]
buffer_load_dwordx4 v3, s[8:11], s3 offen offset:0 lds
v_mfma_f32_16x16x32_bf16 v[80:83], a[16:19], a[60:63], v[80:83]
ds_read_b64_tr_b16 a[52:53], v2 offset:32928
v_mfma_f32_16x16x32_bf16 v[84:87], a[16:19], a[64:67], v[84:87]
ds_read_b64_tr_b16 a[54:55], v2 offset:36512
v_mfma_f32_16x16x32_bf16 v[88:91], a[16:19], a[68:71], v[88:91]
v_mfma_f32_16x16x32_bf16 v[92:95], a[16:19], a[72:75], v[92:95]
ds_read_b64_tr_b16 a[56:57], v2 offset:32960
v_mfma_f32_16x16x32_bf16 v[96:99], a[20:23], a[60:63], v[96:99]
ds_read_b64_tr_b16 a[58:59], v2 offset:36544
s_add_u32 s3, s20, 80896
v_mfma_f32_16x16x32_bf16 v[100:103], a[20:23], a[64:67], v[100:103]
buffer_load_dwordx4 v13, s[8:11], s3 offen offset:1024 lds
v_mfma_f32_16x16x32_bf16 v[104:107], a[20:23], a[68:71], v[104:107]
v_mfma_f32_16x16x32_bf16 v[108:111], a[20:23], a[72:75], v[108:111]
s_waitcnt lgkmcnt(15)
v_mfma_f32_16x16x32_bf16 v[112:115], a[24:27], a[60:63], v[112:115]
v_mfma_f32_16x16x32_bf16 v[116:119], a[24:27], a[64:67], v[116:119]
v_mfma_f32_16x16x32_bf16 v[120:123], a[24:27], a[68:71], v[120:123]
s_add_u32 s3, s20, 96256
v_mfma_f32_16x16x32_bf16 v[124:127], a[24:27], a[72:75], v[124:127]
buffer_load_dwordx4 v3, s[8:11], s3 offen offset:2048 lds
v_mfma_f32_16x16x32_bf16 v[128:131], a[28:31], a[60:63], v[128:131]
v_mfma_f32_16x16x32_bf16 v[132:135], a[28:31], a[64:67], v[132:135]
v_mfma_f32_16x16x32_bf16 v[136:139], a[28:31], a[68:71], v[136:139]
v_mfma_f32_16x16x32_bf16 v[140:143], a[28:31], a[72:75], v[140:143]
v_mfma_f32_16x16x32_bf16 v[144:147], a[32:35], a[60:63], v[144:147]
s_add_u32 s3, s20, 111616
v_mfma_f32_16x16x32_bf16 v[148:151], a[32:35], a[64:67], v[148:151]
buffer_load_dwordx4 v13, s[8:11], s3 offen offset:3072 lds
s_add_u32 s20, s20, 128
v_mfma_f32_16x16x32_bf16 v[152:155], a[32:35], a[68:71], v[152:155]
v_mfma_f32_16x16x32_bf16 v[156:159], a[32:35], a[72:75], v[156:159]
s_waitcnt lgkmcnt(7)
v_mfma_f32_16x16x32_bf16 v[160:163], a[36:39], a[60:63], v[160:163]
s_waitcnt vmcnt(23) lgkmcnt(0)
s_barrier
v_mfma_f32_16x16x32_bf16 v[164:167], a[36:39], a[64:67], v[164:167]
ds_read_b64_tr_b16 a[0:1], v1 offset:49152
v_mfma_f32_16x16x32_bf16 v[168:171], a[36:39], a[68:71], v[168:171]
ds_read_b64_tr_b16 a[2:3], v1 offset:53760
v_mfma_f32_16x16x32_bf16 v[172:175], a[36:39], a[72:75], v[172:175]
s_add_u32 m0, s25, 32768
v_mfma_f32_16x16x32_bf16 v[176:179], a[40:43], a[60:63], v[176:179]
ds_read_b64_tr_b16 a[4:5], v1 offset:49184
v_mfma_f32_16x16x32_bf16 v[180:183], a[40:43], a[64:67], v[180:183]
ds_read_b64_tr_b16 a[6:7], v1 offset:53792
v_mfma_f32_16x16x32_bf16 v[184:187], a[40:43], a[68:71], v[184:187]
buffer_load_dwordx4 v4, s[12:15], s21 offen offset:0 lds
v_mfma_f32_16x16x32_bf16 v[188:191], a[40:43], a[72:75], v[188:191]
ds_read_b64_tr_b16 a[8:9], v1 offset:49216
v_mfma_f32_16x16x32_bf16 v[192:195], a[44:47], a[60:63], v[192:195]
ds_read_b64_tr_b16 a[10:11], v1 offset:53824
v_mfma_f32_16x16x32_bf16 v[196:199], a[44:47], a[64:67], v[196:199]
v_mfma_f32_16x16x32_bf16 v[200:203], a[44:47], a[68:71], v[200:203]
ds_read_b64_tr_b16 a[12:13], v1 offset:49248
v_mfma_f32_16x16x32_bf16 v[204:207], a[44:47], a[72:75], v[204:207]
ds_read_b64_tr_b16 a[14:15], v1 offset:53856
v_mfma_f32_16x16x32_bf16 v[208:211], a[48:51], a[60:63], v[208:211]
buffer_load_dwordx4 v5, s[16:19], s22 offen offset:1024 lds
v_mfma_f32_16x16x32_bf16 v[212:215], a[48:51], a[64:67], v[212:215]
ds_read_b64_tr_b16 a[16:17], v1 offset:49280
v_mfma_f32_16x16x32_bf16 v[216:219], a[48:51], a[68:71], v[216:219]
ds_read_b64_tr_b16 a[18:19], v1 offset:53888
v_mfma_f32_16x16x32_bf16 v[220:223], a[48:51], a[72:75], v[220:223]
v_mfma_f32_16x16x32_bf16 v[224:227], a[52:55], a[60:63], v[224:227]
ds_read_b64_tr_b16 a[20:21], v1 offset:49312
v_mfma_f32_16x16x32_bf16 v[228:231], a[52:55], a[64:67], v[228:231]
ds_read_b64_tr_b16 a[22:23], v1 offset:53920
v_mfma_f32_16x16x32_bf16 v[232:235], a[52:55], a[68:71], v[232:235]
buffer_load_dwordx4 v6, s[16:19], s22 offen offset:2048 lds
v_mfma_f32_16x16x32_bf16 v[236:239], a[52:55], a[72:75], v[236:239]
ds_read_b64_tr_b16 a[24:25], v1 offset:49344
v_mfma_f32_16x16x32_bf16 v[240:243], a[56:59], a[60:63], v[240:243]
ds_read_b64_tr_b16 a[26:27], v1 offset:53952
v_mfma_f32_16x16x32_bf16 v[244:247], a[56:59], a[64:67], v[244:247]
v_mfma_f32_16x16x32_bf16 v[248:251], a[56:59], a[68:71], v[248:251]
ds_read_b64_tr_b16 a[28:29], v1 offset:49376
v_mfma_f32_16x16x32_bf16 v[252:255], a[56:59], a[72:75], v[252:255]
ds_read_b64_tr_b16 a[30:31], v1 offset:53984
s_waitcnt lgkmcnt(10)
v_mfma_f32_16x16x32_bf16 v[16:19], a[0:3], a[76:79], v[16:19]
buffer_load_dwordx4 v7, s[16:19], s22 offen offset:3072 lds
v_mfma_f32_16x16x32_bf16 v[20:23], a[0:3], a[80:83], v[20:23]
ds_read_b64_tr_b16 a[32:33], v2 offset:49152
v_subrev_u32 v15, 32768, v0
v_mfma_f32_16x16x32_bf16 v[24:27], a[0:3], a[84:87], v[24:27]
ds_read_b64_tr_b16 a[34:35], v2 offset:52736
s_waitcnt vmcnt(21)
v_mfma_f32_16x16x32_bf16 v[28:31], a[0:3], a[88:91], v[28:31]
ds_read_b128 a[60:63], v15 offset:0
v_mfma_f32_16x16x32_bf16 v[32:35], a[4:7], a[76:79], v[32:35]
ds_read_b64_tr_b16 a[36:37], v2 offset:49184
v_mfma_f32_16x16x32_bf16 v[36:39], a[4:7], a[80:83], v[36:39]
ds_read_b64_tr_b16 a[38:39], v2 offset:52768
v_mfma_f32_16x16x32_bf16 v[40:43], a[4:7], a[84:87], v[40:43]
s_add_u32 s21, s21, s23
s_add_u32 s22, s22, s24
ds_read_b128 a[64:67], v15 offset:2048
v_mfma_f32_16x16x32_bf16 v[44:47], a[4:7], a[88:91], v[44:47]
ds_read_b64_tr_b16 a[40:41], v2 offset:49216
v_mfma_f32_16x16x32_bf16 v[48:51], a[8:11], a[76:79], v[48:51]
ds_read_b64_tr_b16 a[42:43], v2 offset:52800
v_mfma_f32_16x16x32_bf16 v[52:55], a[8:11], a[80:83], v[52:55]
ds_read_b128 a[68:71], v15 offset:4096
v_mfma_f32_16x16x32_bf16 v[56:59], a[8:11], a[84:87], v[56:59]
ds_read_b64_tr_b16 a[44:45], v2 offset:49248
v_mfma_f32_16x16x32_bf16 v[60:63], a[8:11], a[88:91], v[60:63]
ds_read_b64_tr_b16 a[46:47], v2 offset:52832
s_waitcnt lgkmcnt(15)
v_mfma_f32_16x16x32_bf16 v[64:67], a[12:15], a[76:79], v[64:67]
ds_read_b128 a[72:75], v15 offset:6144
v_mfma_f32_16x16x32_bf16 v[68:71], a[12:15], a[80:83], v[68:71]
ds_read_b64_tr_b16 a[48:49], v2 offset:49280
s_add_u32 m0, s55, 98304
v_mfma_f32_16x16x32_bf16 v[72:75], a[12:15], a[84:87], v[72:75]
ds_read_b64_tr_b16 a[50:51], v2 offset:52864
s_add_u32 s3, s20, 0
v_mfma_f32_16x16x32_bf16 v[76:79], a[12:15], a[88:91], v[76:79]
buffer_load_dwordx4 v3, s[8:11], s3 offen offset:0 lds
v_mfma_f32_16x16x32_bf16 v[80:83], a[16:19], a[76:79], v[80:83]
ds_read_b64_tr_b16 a[52:53], v2 offset:49312
v_mfma_f32_16x16x32_bf16 v[84:87], a[16:19], a[80:83], v[84:87]
ds_read_b64_tr_b16 a[54:55], v2 offset:52896
v_mfma_f32_16x16x32_bf16 v[88:91], a[16:19], a[84:87], v[88:91]
v_mfma_f32_16x16x32_bf16 v[92:95], a[16:19], a[88:91], v[92:95]
ds_read_b64_tr_b16 a[56:57], v2 offset:49344
v_mfma_f32_16x16x32_bf16 v[96:99], a[20:23], a[76:79], v[96:99]
ds_read_b64_tr_b16 a[58:59], v2 offset:52928
s_add_u32 s3, s20, 15360
v_mfma_f32_16x16x32_bf16 v[100:103], a[20:23], a[80:83], v[100:103]
buffer_load_dwordx4 v13, s[8:11], s3 offen offset:1024 lds
v_mfma_f32_16x16x32_bf16 v[104:107], a[20:23], a[84:87], v[104:107]
v_mfma_f32_16x16x32_bf16 v[108:111], a[20:23], a[88:91], v[108:111]
s_waitcnt lgkmcnt(15)
v_mfma_f32_16x16x32_bf16 v[112:115], a[24:27], a[76:79], v[112:115]
v_mfma_f32_16x16x32_bf16 v[116:119], a[24:27], a[80:83], v[116:119]
v_mfma_f32_16x16x32_bf16 v[120:123], a[24:27], a[84:87], v[120:123]
s_add_u32 s3, s20, 30720
v_mfma_f32_16x16x32_bf16 v[124:127], a[24:27], a[88:91], v[124:127]
buffer_load_dwordx4 v3, s[8:11], s3 offen offset:2048 lds
v_mfma_f32_16x16x32_bf16 v[128:131], a[28:31], a[76:79], v[128:131]
v_mfma_f32_16x16x32_bf16 v[132:135], a[28:31], a[80:83], v[132:135]
v_mfma_f32_16x16x32_bf16 v[136:139], a[28:31], a[84:87], v[136:139]
v_mfma_f32_16x16x32_bf16 v[140:143], a[28:31], a[88:91], v[140:143]
v_mfma_f32_16x16x32_bf16 v[144:147], a[32:35], a[76:79], v[144:147]
s_add_u32 s3, s20, 46080
v_mfma_f32_16x16x32_bf16 v[148:151], a[32:35], a[80:83], v[148:151]
buffer_load_dwordx4 v13, s[8:11], s3 offen offset:3072 lds
v_mfma_f32_16x16x32_bf16 v[152:155], a[32:35], a[84:87], v[152:155]
v_mfma_f32_16x16x32_bf16 v[156:159], a[32:35], a[88:91], v[156:159]
s_waitcnt lgkmcnt(7)
v_mfma_f32_16x16x32_bf16 v[160:163], a[36:39], a[76:79], v[160:163]
s_waitcnt vmcnt(21) lgkmcnt(0)
s_barrier
v_mfma_f32_16x16x32_bf16 v[164:167], a[36:39], a[80:83], v[164:167]
ds_read_b64_tr_b16 a[0:1], v1 offset:0
v_mfma_f32_16x16x32_bf16 v[168:171], a[36:39], a[84:87], v[168:171]
ds_read_b64_tr_b16 a[2:3], v1 offset:4608
v_mfma_f32_16x16x32_bf16 v[172:175], a[36:39], a[88:91], v[172:175]
s_add_u32 m0, s25, 49152
v_mfma_f32_16x16x32_bf16 v[176:179], a[40:43], a[76:79], v[176:179]
ds_read_b64_tr_b16 a[4:5], v1 offset:32
v_mfma_f32_16x16x32_bf16 v[180:183], a[40:43], a[80:83], v[180:183]
ds_read_b64_tr_b16 a[6:7], v1 offset:4640
v_mfma_f32_16x16x32_bf16 v[184:187], a[40:43], a[84:87], v[184:187]
buffer_load_dwordx4 v4, s[12:15], s21 offen offset:0 lds
v_mfma_f32_16x16x32_bf16 v[188:191], a[40:43], a[88:91], v[188:191]
ds_read_b64_tr_b16 a[8:9], v1 offset:64
v_mfma_f32_16x16x32_bf16 v[192:195], a[44:47], a[76:79], v[192:195]
ds_read_b64_tr_b16 a[10:11], v1 offset:4672
v_mfma_f32_16x16x32_bf16 v[196:199], a[44:47], a[80:83], v[196:199]
v_mfma_f32_16x16x32_bf16 v[200:203], a[44:47], a[84:87], v[200:203]
ds_read_b64_tr_b16 a[12:13], v1 offset:96
v_mfma_f32_16x16x32_bf16 v[204:207], a[44:47], a[88:91], v[204:207]
ds_read_b64_tr_b16 a[14:15], v1 offset:4704
v_mfma_f32_16x16x32_bf16 v[208:211], a[48:51], a[76:79], v[208:211]
buffer_load_dwordx4 v5, s[16:19], s22 offen offset:1024 lds
v_mfma_f32_16x16x32_bf16 v[212:215], a[48:51], a[80:83], v[212:215]
ds_read_b64_tr_b16 a[16:17], v1 offset:128
v_mfma_f32_16x16x32_bf16 v[216:219], a[48:51], a[84:87], v[216:219]
ds_read_b64_tr_b16 a[18:19], v1 offset:4736
v_mfma_f32_16x16x32_bf16 v[220:223], a[48:51], a[88:91], v[220:223]
v_mfma_f32_16x16x32_bf16 v[224:227], a[52:55], a[76:79], v[224:227]
ds_read_b64_tr_b16 a[20:21], v1 offset:160
v_mfma_f32_16x16x32_bf16 v[228:231], a[52:55], a[80:83], v[228:231]
ds_read_b64_tr_b16 a[22:23], v1 offset:4768
v_mfma_f32_16x16x32_bf16 v[232:235], a[52:55], a[84:87], v[232:235]
buffer_load_dwordx4 v6, s[16:19], s22 offen offset:2048 lds
v_mfma_f32_16x16x32_bf16 v[236:239], a[52:55], a[88:91], v[236:239]
ds_read_b64_tr_b16 a[24:25], v1 offset:192
v_mfma_f32_16x16x32_bf16 v[240:243], a[56:59], a[76:79], v[240:243]
ds_read_b64_tr_b16 a[26:27], v1 offset:4800
v_mfma_f32_16x16x32_bf16 v[244:247], a[56:59], a[80:83], v[244:247]
v_mfma_f32_16x16x32_bf16 v[248:251], a[56:59], a[84:87], v[248:251]
ds_read_b64_tr_b16 a[28:29], v1 offset:224
v_mfma_f32_16x16x32_bf16 v[252:255], a[56:59], a[88:91], v[252:255]
ds_read_b64_tr_b16 a[30:31], v1 offset:4832
L_gs12:
s_waitcnt lgkmcnt(10)
v_mfma_f32_16x16x32_bf16 v[16:19], a[0:3], a[60:63], v[16:19]
buffer_load_dwordx4 v7, s[16:19], s22 offen offset:3072 lds
v_mfma_f32_16x16x32_bf16 v[20:23], a[0:3], a[64:67], v[20:23]
ds_read_b64_tr_b16 a[32:33], v2 offset:0
v_subrev_u32 v15, 32768, v12
v_mfma_f32_16x16x32_bf16 v[24:27], a[0:3], a[68:71], v[24:27]
ds_read_b64_tr_b16 a[34:35], v2 offset:3584
v_mfma_f32_16x16x32_bf16 v[28:31], a[0:3], a[72:75], v[28:31]
ds_read_b128 a[76:79], v15 offset:0
v_mfma_f32_16x16x32_bf16 v[32:35], a[4:7], a[60:63], v[32:35]
ds_read_b64_tr_b16 a[36:37], v2 offset:32
v_mfma_f32_16x16x32_bf16 v[36:39], a[4:7], a[64:67], v[36:39]
ds_read_b64_tr_b16 a[38:39], v2 offset:3616
v_mfma_f32_16x16x32_bf16 v[40:43], a[4:7], a[68:71], v[40:43]
s_add_u32 s21, s21, s23
s_add_u32 s22, s22, s24
ds_read_b128 a[80:83], v15 offset:2048
v_mfma_f32_16x16x32_bf16 v[44:47], a[4:7], a[72:75], v[44:47]
ds_read_b64_tr_b16 a[40:41], v2 offset:64
v_mfma_f32_16x16x32_bf16 v[48:51], a[8:11], a[60:63], v[48:51]
ds_read_b64_tr_b16 a[42:43], v2 offset:3648
v_mfma_f32_16x16x32_bf16 v[52:55], a[8:11], a[64:67], v[52:55]
ds_read_b128 a[84:87], v15 offset:4096
v_mfma_f32_16x16x32_bf16 v[56:59], a[8:11], a[68:71], v[56:59]
ds_read_b64_tr_b16 a[44:45], v2 offset:96
v_mfma_f32_16x16x32_bf16 v[60:63], a[8:11], a[72:75], v[60:63]
ds_read_b64_tr_b16 a[46:47], v2 offset:3680
s_waitcnt lgkmcnt(15)
v_mfma_f32_16x16x32_bf16 v[64:67], a[12:15], a[60:63], v[64:67]
ds_read_b128 a[88:91], v15 offset:6144
v_mfma_f32_16x16x32_bf16 v[68:71], a[12:15], a[64:67], v[68:71]
ds_read_b64_tr_b16 a[48:49], v2 offset:128
s_add_u32 m0, s55, 102400
v_mfma_f32_16x16x32_bf16 v[72:75], a[12:15], a[68:71], v[72:75]
ds_read_b64_tr_b16 a[50:51], v2 offset:3712
s_add_u32 s3, s20, 65536
v_mfma_f32_16x16x32_bf16 v[76:79], a[12:15], a[72:75], v[76:79]
buffer_load_dwordx4 v3, s[8:11], s3 offen offset:0 lds
v_mfma_f32_16x16x32_bf16 v[80:83], a[16:19], a[60:63], v[80:83]
ds_read_b64_tr_b16 a[52:53], v2 offset:160
v_mfma_f32_16x16x32_bf16 v[84:87], a[16:19], a[64:67], v[84:87]
ds_read_b64_tr_b16 a[54:55], v2 offset:3744
v_mfma_f32_16x16x32_bf16 v[88:91], a[16:19], a[68:71], v[88:91]
v_mfma_f32_16x16x32_bf16 v[92:95], a[16:19], a[72:75], v[92:95]
ds_read_b64_tr_b16 a[56:57], v2 offset:192
v_mfma_f32_16x16x32_bf16 v[96:99], a[20:23], a[60:63], v[96:99]
ds_read_b64_tr_b16 a[58:59], v2 offset:3776
s_add_u32 s3, s20, 80896
v_mfma_f32_16x16x32_bf16 v[100:103], a[20:23], a[64:67], v[100:103]
buffer_load_dwordx4 v13, s[8:11], s3 offen offset:1024 lds
v_mfma_f32_16x16x32_bf16 v[104:107], a[20:23], a[68:71], v[104:107]
v_mfma_f32_16x16x32_bf16 v[108:111], a[20:23], a[72:75], v[108:111]
s_waitcnt lgkmcnt(15)
v_mfma_f32_16x16x32_bf16 v[112:115], a[24:27], a[60:63], v[112:115]
v_mfma_f32_16x16x32_bf16 a[164:167], a[160:163], a[96:99], 0
v_mfma_f32_16x16x32_bf16 v[116:119], a[24:27], a[64:67], v[116:119]
v_mfma_f32_16x16x32_bf16 a[164:167], a[160:163], a[100:103], a[164:167]
v_mfma_f32_16x16x32_bf16 v[120:123], a[24:27], a[68:71], v[120:123]
s_add_u32 s3, s20, 96256
v_mfma_f32_16x16x32_bf16 a[164:167], a[160:163], a[104:107], a[164:167]
v_mfma_f32_16x16x32_bf16 v[124:127], a[24:27], a[72:75], v[124:127]
buffer_load_dwordx4 v3, s[8:11], s3 offen offset:2048 lds
v_mfma_f32_16x16x32_bf16 a[164:167], a[160:163], a[108:111], a[164:167]
v_mfma_f32_16x16x32_bf16 v[128:131], a[28:31], a[60:63], v[128:131]
v_mfma_f32_16x16x32_bf16 a[164:167], a[160:163], a[112:115], a[164:167]
v_mfma_f32_16x16x32_bf16 v[132:135], a[28:31], a[64:67], v[132:135]
v_mfma_f32_16x16x32_bf16 a[164:167], a[160:163], a[116:119], a[164:167]
v_mfma_f32_16x16x32_bf16 v[136:139], a[28:31], a[68:71], v[136:139]
v_mfma_f32_16x16x32_bf16 a[164:167], a[160:163], a[120:123], a[164:167]
v_mfma_f32_16x16x32_bf16 v[140:143], a[28:31], a[72:75], v[140:143]
v_mfma_f32_16x16x32_bf16 a[164:167], a[160:163], a[124:127], a[164:167]
v_mfma_f32_16x16x32_bf16 v[144:147], a[32:35], a[60:63], v[144:147]
s_add_u32 s3, s20, 111616
v_mfma_f32_16x16x32_bf16 v[148:151], a[32:35], a[64:67], v[148:151]
buffer_load_dwordx4 v13, s[8:11], s3 offen offset:3072 lds
s_add_u32 s20, s20, 128
v_mfma_f32_16x16x32_bf16 v[152:155], a[32:35], a[68:71], v[152:155]
v_mfma_f32_16x16x32_bf16 v[156:159], a[32:35], a[72:75], v[156:159]
s_waitcnt lgkmcnt(7)
v_mfma_f32_16x16x32_bf16 v[160:163], a[36:39], a[60:63], v[160:163]
s_waitcnt vmcnt(20) lgkmcnt(0)
s_barrier
v_mfma_f32_16x16x32_bf16 v[164:167], a[36:39], a[64:67], v[164:167]
ds_read_b64_tr_b16 a[0:1], v1 offset:16384
v_mfma_f32_16x16x32_bf16 v[168:171], a[36:39], a[68:71], v[168:171]
ds_read_b64_tr_b16 a[2:3], v1 offset:20992
v_mfma_f32_16x16x32_bf16 v[172:175], a[36:39], a[72:75], v[172:175]
s_add_u32 m0, s25, 0
v_mfma_f32_16x16x32_bf16 v[176:179], a[40:43], a[60:63], v[176:179]
ds_read_b64_tr_b16 a[4:5], v1 offset:16416
v_mfma_f32_16x16x32_bf16 v[180:183], a[40:43], a[64:67], v[180:183]
ds_read_b64_tr_b16 a[6:7], v1 offset:21024
v_mfma_f32_16x16x32_bf16 v[184:187], a[40:43], a[68:71], v[184:187]
buffer_load_dwordx4 v4, s[12:15], s21 offen offset:0 lds
v_mfma_f32_16x16x32_bf16 v[188:191], a[40:43], a[72:75], v[188:191]
ds_read_b64_tr_b16 a[8:9], v1 offset:16448
v_mfma_f32_16x16x32_bf16 v[192:195], a[44:47], a[60:63], v[192:195]
ds_read_b64_tr_b16 a[10:11], v1 offset:21056
v_mfma_f32_16x16x32_bf16 v[196:199], a[44:47], a[64:67], v[196:199]
v_mfma_f32_16x16x32_bf16 v[200:203], a[44:47], a[68:71], v[200:203]
ds_read_b64_tr_b16 a[12:13], v1 offset:16480
v_mfma_f32_16x16x32_bf16 v[204:207], a[44:47], a[72:75], v[204:207]
ds_read_b64_tr_b16 a[14:15], v1 offset:21088
v_mfma_f32_16x16x32_bf16 v[208:211], a[48:51], a[60:63], v[208:211]
buffer_load_dwordx4 v5, s[16:19], s22 offen offset:1024 lds
v_mfma_f32_16x16x32_bf16 v[212:215], a[48:51], a[64:67], v[212:215]
ds_read_b64_tr_b16 a[16:17], v1 offset:16512
v_mfma_f32_16x16x32_bf16 v[216:219], a[48:51], a[68:71], v[216:219]
ds_read_b64_tr_b16 a[18:19], v1 offset:21120
v_mfma_f32_16x16x32_bf16 v[220:223], a[48:51], a[72:75], v[220:223]
v_mfma_f32_16x16x32_bf16 v[224:227], a[52:55], a[60:63], v[224:227]
ds_read_b64_tr_b16 a[20:21], v1 offset:16544
v_mfma_f32_16x16x32_bf16 v[228:231], a[52:55], a[64:67], v[228:231]
ds_read_b64_tr_b16 a[22:23], v1 offset:21152
v_mfma_f32_16x16x32_bf16 v[232:235], a[52:55], a[68:71], v[232:235]
buffer_load_dwordx4 v6, s[16:19], s22 offen offset:2048 lds
v_mfma_f32_16x16x32_bf16 v[236:239], a[52:55], a[72:75], v[236:239]
ds_read_b64_tr_b16 a[24:25], v1 offset:16576
v_mfma_f32_16x16x32_bf16 v[240:243], a[56:59], a[60:63], v[240:243]
ds_read_b64_tr_b16 a[26:27], v1 offset:21184
v_mfma_f32_16x16x32_bf16 v[244:247], a[56:59], a[64:67], v[244:247]
v_mfma_f32_16x16x32_bf16 v[248:251], a[56:59], a[68:71], v[248:251]
ds_read_b64_tr_b16 a[28:29], v1 offset:16608
v_mfma_f32_16x16x32_bf16 v[252:255], a[56:59], a[72:75], v[252:255]
ds_read_b64_tr_b16 a[30:31], v1 offset:21216
s_waitcnt lgkmcnt(10)
v_mfma_f32_16x16x32_bf16 v[16:19], a[0:3], a[76:79], v[16:19]
buffer_load_dwordx4 v7, s[16:19], s22 offen offset:3072 lds
v_mfma_f32_16x16x32_bf16 v[20:23], a[0:3], a[80:83], v[20:23]
ds_read_b64_tr_b16 a[32:33], v2 offset:16384
v_mfma_f32_16x16x32_bf16 v[24:27], a[0:3], a[84:87], v[24:27]
ds_read_b64_tr_b16 a[34:35], v2 offset:19968
s_waitcnt vmcnt(20)
v_mfma_f32_16x16x32_bf16 v[28:31], a[0:3], a[88:91], v[28:31]
ds_read_b128 a[60:63], v0 offset:32768
v_mfma_f32_16x16x32_bf16 v[32:35], a[4:7], a[76:79], v[32:35]
ds_read_b64_tr_b16 a[36:37], v2 offset:16416
v_mfma_f32_16x16x32_bf16 v[36:39], a[4:7], a[80:83], v[36:39]
ds_read_b64_tr_b16 a[38:39], v2 offset:20000
v_mfma_f32_16x16x32_bf16 v[40:43], a[4:7], a[84:87], v[40:43]
s_add_u32 s21, s21, s23
s_add_u32 s22, s22, s24
ds_read_b128 a[64:67], v0 offset:34816
v_mfma_f32_16x16x32_bf16 v[44:47], a[4:7], a[88:91], v[44:47]
ds_read_b64_tr_b16 a[40:41], v2 offset:16448
v_mfma_f32_16x16x32_bf16 v[48:51], a[8:11], a[76:79], v[48:51]
ds_read_b64_tr_b16 a[42:43], v2 offset:20032
v_mfma_f32_16x16x32_bf16 v[52:55], a[8:11], a[80:83], v[52:55]
ds_read_b128 a[68:71], v0 offset:36864
v_mfma_f32_16x16x32_bf16 v[56:59], a[8:11], a[84:87], v[56:59]
ds_read_b64_tr_b16 a[44:45], v2 offset:16480
s_mov_b32 s60, s88
v_mfma_f32_16x16x32_bf16 v[60:63], a[8:11], a[88:91], v[60:63]
ds_read_b64_tr_b16 a[46:47], v2 offset:20064
s_and_b32 s61, s89, 0xffff
s_waitcnt lgkmcnt(15)
v_mfma_f32_16x16x32_bf16 v[64:67], a[12:15], a[76:79], v[64:67]
ds_read_b128 a[72:75], v0 offset:38912
s_mov_b32 s62, 0x200000
v_mfma_f32_16x16x32_bf16 v[68:71], a[12:15], a[80:83], v[68:71]
ds_read_b64_tr_b16 a[48:49], v2 offset:16512
s_add_u32 m0, s55, 65536
s_mov_b32 s63, 0x00020000
v_mfma_f32_16x16x32_bf16 v[72:75], a[12:15], a[84:87], v[72:75]
ds_read_b64_tr_b16 a[50:51], v2 offset:20096
s_add_u32 s3, s20, 0
v_mfma_f32_16x16x32_bf16 v[76:79], a[12:15], a[88:91], v[76:79]
buffer_load_dwordx4 v3, s[8:11], s3 offen offset:0 lds
v_mfma_f32_16x16x32_bf16 v[80:83], a[16:19], a[76:79], v[80:83]
ds_read_b64_tr_b16 a[52:53], v2 offset:16544
v_mfma_f32_16x16x32_bf16 v[84:87], a[16:19], a[80:83], v[84:87]
ds_read_b64_tr_b16 a[54:55], v2 offset:20128
v_mfma_f32_16x16x32_bf16 v[88:91], a[16:19], a[84:87], v[88:91]
v_mfma_f32_16x16x32_bf16 v[92:95], a[16:19], a[88:91], v[92:95]
ds_read_b64_tr_b16 a[56:57], v2 offset:16576
v_mfma_f32_16x16x32_bf16 v[96:99], a[20:23], a[76:79], v[96:99]
ds_read_b64_tr_b16 a[58:59], v2 offset:20160
s_add_u32 s3, s20, 15360
v_mfma_f32_16x16x32_bf16 v[100:103], a[20:23], a[80:83], v[100:103]
buffer_load_dwordx4 v13, s[8:11], s3 offen offset:1024 lds
v_mfma_f32_16x16x32_bf16 v[104:107], a[20:23], a[84:87], v[104:107]
v_mfma_f32_16x16x32_bf16 v[108:111], a[20:23], a[88:91], v[108:111]
s_waitcnt lgkmcnt(15)
v_mfma_f32_16x16x32_bf16 v[112:115], a[24:27], a[76:79], v[112:115]
v_mfma_f32_16x16x32_bf16 a[164:167], a[160:163], a[128:131], a[164:167]
v_mfma_f32_16x16x32_bf16 v[116:119], a[24:27], a[80:83], v[116:119]
v_mfma_f32_16x16x32_bf16 a[164:167], a[160:163], a[132:135], a[164:167]
v_mfma_f32_16x16x32_bf16 v[120:123], a[24:27], a[84:87], v[120:123]
s_add_u32 s3, s20, 30720
v_mfma_f32_16x16x32_bf16 a[164:167], a[160:163], a[136:139], a[164:167]
v_mfma_f32_16x16x32_bf16 v[124:127], a[24:27], a[88:91], v[124:127]
buffer_load_dwordx4 v3, s[8:11], s3 offen offset:2048 lds
v_mfma_f32_16x16x32_bf16 a[164:167], a[160:163], a[140:143], a[164:167]
v_mfma_f32_16x16x32_bf16 v[128:131], a[28:31], a[76:79], v[128:131]
v_mfma_f32_16x16x32_bf16 a[164:167], a[160:163], a[144:147], a[164:167]
v_mfma_f32_16x16x32_bf16 v[132:135], a[28:31], a[80:83], v[132:135]
v_mfma_f32_16x16x32_bf16 a[164:167], a[160:163], a[148:151], a[164:167]
v_mfma_f32_16x16x32_bf16 v[136:139], a[28:31], a[84:87], v[136:139]
v_mfma_f32_16x16x32_bf16 a[164:167], a[160:163], a[152:155], a[164:167]
v_mfma_f32_16x16x32_bf16 v[140:143], a[28:31], a[88:91], v[140:143]
v_mfma_f32_16x16x32_bf16 a[164:167], a[160:163], a[156:159], a[164:167]
v_mfma_f32_16x16x32_bf16 v[144:147], a[32:35], a[76:79], v[144:147]
s_add_u32 s3, s20, 46080
v_mfma_f32_16x16x32_bf16 v[148:151], a[32:35], a[80:83], v[148:151]
buffer_load_dwordx4 v13, s[8:11], s3 offen offset:3072 lds
v_mfma_f32_16x16x32_bf16 v[152:155], a[32:35], a[84:87], v[152:155]
v_mfma_f32_16x16x32_bf16 v[156:159], a[32:35], a[88:91], v[156:159]
s_waitcnt lgkmcnt(7)
v_mfma_f32_16x16x32_bf16 v[160:163], a[36:39], a[76:79], v[160:163]
s_waitcnt vmcnt(20) lgkmcnt(0)
s_barrier
v_mfma_f32_16x16x32_bf16 v[164:167], a[36:39], a[80:83], v[164:167]
ds_read_b64_tr_b16 a[0:1], v1 offset:32768
v_mfma_f32_16x16x32_bf16 v[168:171], a[36:39], a[84:87], v[168:171]
ds_read_b64_tr_b16 a[2:3], v1 offset:37376
v_mfma_f32_16x16x32_bf16 v[172:175], a[36:39], a[88:91], v[172:175]
s_add_u32 m0, s25, 16384
v_mfma_f32_16x16x32_bf16 v[176:179], a[40:43], a[76:79], v[176:179]
ds_read_b64_tr_b16 a[4:5], v1 offset:32800
v_mfma_f32_16x16x32_bf16 v[180:183], a[40:43], a[80:83], v[180:183]
ds_read_b64_tr_b16 a[6:7], v1 offset:37408
v_mfma_f32_16x16x32_bf16 v[184:187], a[40:43], a[84:87], v[184:187]
buffer_load_dwordx4 v4, s[12:15], s21 offen offset:0 lds
v_mfma_f32_16x16x32_bf16 v[188:191], a[40:43], a[88:91], v[188:191]
ds_read_b64_tr_b16 a[8:9], v1 offset:32832
v_mfma_f32_16x16x32_bf16 v[192:195], a[44:47], a[76:79], v[192:195]
ds_read_b64_tr_b16 a[10:11], v1 offset:37440
v_mfma_f32_16x16x32_bf16 v[196:199], a[44:47], a[80:83], v[196:199]
v_mfma_f32_16x16x32_bf16 v[200:203], a[44:47], a[84:87], v[200:203]
ds_read_b64_tr_b16 a[12:13], v1 offset:32864
v_mfma_f32_16x16x32_bf16 v[204:207], a[44:47], a[88:91], v[204:207]
ds_read_b64_tr_b16 a[14:15], v1 offset:37472
v_mfma_f32_16x16x32_bf16 v[208:211], a[48:51], a[76:79], v[208:211]
buffer_load_dwordx4 v5, s[16:19], s22 offen offset:1024 lds
v_mfma_f32_16x16x32_bf16 v[212:215], a[48:51], a[80:83], v[212:215]
ds_read_b64_tr_b16 a[16:17], v1 offset:32896
v_mfma_f32_16x16x32_bf16 v[216:219], a[48:51], a[84:87], v[216:219]
ds_read_b64_tr_b16 a[18:19], v1 offset:37504
v_mfma_f32_16x16x32_bf16 v[220:223], a[48:51], a[88:91], v[220:223]
v_mfma_f32_16x16x32_bf16 v[224:227], a[52:55], a[76:79], v[224:227]
ds_read_b64_tr_b16 a[20:21], v1 offset:32928
v_mfma_f32_16x16x32_bf16 v[228:231], a[52:55], a[80:83], v[228:231]
ds_read_b64_tr_b16 a[22:23], v1 offset:37536
v_mfma_f32_16x16x32_bf16 v[232:235], a[52:55], a[84:87], v[232:235]
buffer_load_dwordx4 v6, s[16:19], s22 offen offset:2048 lds
v_mfma_f32_16x16x32_bf16 v[236:239], a[52:55], a[88:91], v[236:239]
ds_read_b64_tr_b16 a[24:25], v1 offset:32960
v_mfma_f32_16x16x32_bf16 v[240:243], a[56:59], a[76:79], v[240:243]
ds_read_b64_tr_b16 a[26:27], v1 offset:37568
v_mfma_f32_16x16x32_bf16 v[244:247], a[56:59], a[80:83], v[244:247]
v_mfma_f32_16x16x32_bf16 v[248:251], a[56:59], a[84:87], v[248:251]
ds_read_b64_tr_b16 a[28:29], v1 offset:32992
v_mfma_f32_16x16x32_bf16 v[252:255], a[56:59], a[88:91], v[252:255]
ds_read_b64_tr_b16 a[30:31], v1 offset:37600
s_waitcnt lgkmcnt(10)
v_mfma_f32_16x16x32_bf16 v[16:19], a[0:3], a[60:63], v[16:19]
buffer_load_dwordx4 v7, s[16:19], s22 offen offset:3072 lds
v_mfma_f32_16x16x32_bf16 v[20:23], a[0:3], a[64:67], v[20:23]
ds_read_b64_tr_b16 a[32:33], v2 offset:32768
v_mfma_f32_16x16x32_bf16 v[24:27], a[0:3], a[68:71], v[24:27]
ds_read_b64_tr_b16 a[34:35], v2 offset:36352
v_mfma_f32_16x16x32_bf16 v[28:31], a[0:3], a[72:75], v[28:31]
ds_read_b128 a[76:79], v12 offset:32768
v_mfma_f32_16x16x32_bf16 v[32:35], a[4:7], a[60:63], v[32:35]
ds_read_b64_tr_b16 a[36:37], v2 offset:32800
v_mfma_f32_16x16x32_bf16 v[36:39], a[4:7], a[64:67], v[36:39]
ds_read_b64_tr_b16 a[38:39], v2 offset:36384
v_mfma_f32_16x16x32_bf16 v[40:43], a[4:7], a[68:71], v[40:43]
s_add_u32 s21, s21, s23
s_add_u32 s22, s22, s24
ds_read_b128 a[80:83], v12 offset:34816
v_mfma_f32_16x16x32_bf16 v[44:47], a[4:7], a[72:75], v[44:47]
ds_read_b64_tr_b16 a[40:41], v2 offset:32832
v_mfma_f32_16x16x32_bf16 v[48:51], a[8:11], a[60:63], v[48:51]
ds_read_b64_tr_b16 a[42:43], v2 offset:36416
v_mfma_f32_16x16x32_bf16 v[52:55], a[8:11], a[64:67], v[52:55]
ds_read_b128 a[84:87], v12 offset:36864
v_mfma_f32_16x16x32_bf16 v[56:59], a[8:11], a[68:71], v[56:59]
ds_read_b64_tr_b16 a[44:45], v2 offset:32864
v_mfma_f32_16x16x32_bf16 v[60:63], a[8:11], a[72:75], v[60:63]
ds_read_b64_tr_b16 a[46:47], v2 offset:36448
s_waitcnt lgkmcnt(15)
v_mfma_f32_16x16x32_bf16 v[64:67], a[12:15], a[60:63], v[64:67]
ds_read_b128 a[88:91], v12 offset:38912
v_mfma_f32_16x16x32_bf16 v[68:71], a[12:15], a[64:67], v[68:71]
ds_read_b64_tr_b16 a[48:49], v2 offset:32896
s_add_u32 m0, s55, 69632
v_mfma_f32_16x16x32_bf16 v[72:75], a[12:15], a[68:71], v[72:75]
ds_read_b64_tr_b16 a[50:51], v2 offset:36480
s_add_u32 s3, s20, 65536
v_mfma_f32_16x16x32_bf16 v[76:79], a[12:15], a[72:75], v[76:79]
buffer_load_dwordx4 v3, s[8:11], s3 offen offset:0 lds
v_mfma_f32_16x16x32_bf16 v[80:83], a[16:19], a[60:63], v[80:83]
ds_read_b64_tr_b16 a[52:53], v2 offset:32928
v_mfma_f32_16x16x32_bf16 v[84:87], a[16:19], a[64:67], v[84:87]
ds_read_b64_tr_b16 a[54:55], v2 offset:36512
v_mfma_f32_16x16x32_bf16 v[88:91], a[16:19], a[68:71], v[88:91]
v_mfma_f32_16x16x32_bf16 v[92:95], a[16:19], a[72:75], v[92:95]
ds_read_b64_tr_b16 a[56:57], v2 offset:32960
v_mfma_f32_16x16x32_bf16 v[96:99], a[20:23], a[60:63], v[96:99]
ds_read_b64_tr_b16 a[58:59], v2 offset:36544
s_add_u32 s3, s20, 80896
v_mfma_f32_16x16x32_bf16 v[100:103], a[20:23], a[64:67], v[100:103]
buffer_load_dwordx4 v13, s[8:11], s3 offen offset:1024 lds
v_mfma_f32_16x16x32_bf16 v[104:107], a[20:23], a[68:71], v[104:107]
v_mfma_f32_16x16x32_bf16 v[108:111], a[20:23], a[72:75], v[108:111]
s_waitcnt lgkmcnt(15)
v_mfma_f32_16x16x32_bf16 v[112:115], a[24:27], a[60:63], v[112:115]
v_mfma_f32_16x16x32_bf16 v[116:119], a[24:27], a[64:67], v[116:119]
v_mfma_f32_16x16x32_bf16 v[120:123], a[24:27], a[68:71], v[120:123]
s_add_u32 s3, s20, 96256
v_mfma_f32_16x16x32_bf16 v[124:127], a[24:27], a[72:75], v[124:127]
buffer_load_dwordx4 v3, s[8:11], s3 offen offset:2048 lds
v_mfma_f32_16x16x32_bf16 v[128:131], a[28:31], a[60:63], v[128:131]
v_accvgpr_read_b32 v14, a198
v_mfma_f32_16x16x32_bf16 v[132:135], a[28:31], a[64:67], v[132:135]
v_mfma_f32_16x16x32_bf16 v[136:139], a[28:31], a[68:71], v[136:139]
buffer_store_dwordx4 a[164:167], v14, s[60:63], 0 offen sc0 sc1
v_mfma_f32_16x16x32_bf16 v[140:143], a[28:31], a[72:75], v[140:143]
v_mfma_f32_16x16x32_bf16 v[144:147], a[32:35], a[60:63], v[144:147]
s_add_u32 s3, s20, 111616
v_mfma_f32_16x16x32_bf16 v[148:151], a[32:35], a[64:67], v[148:151]
buffer_load_dwordx4 v13, s[8:11], s3 offen offset:3072 lds
s_add_u32 s20, s20, 128
v_mfma_f32_16x16x32_bf16 v[152:155], a[32:35], a[68:71], v[152:155]
v_mfma_f32_16x16x32_bf16 v[156:159], a[32:35], a[72:75], v[156:159]
s_waitcnt lgkmcnt(7)
v_mfma_f32_16x16x32_bf16 v[160:163], a[36:39], a[60:63], v[160:163]
s_waitcnt vmcnt(21) lgkmcnt(0)
s_barrier
v_mfma_f32_16x16x32_bf16 v[164:167], a[36:39], a[64:67], v[164:167]
ds_read_b64_tr_b16 a[0:1], v1 offset:49152
v_mfma_f32_16x16x32_bf16 v[168:171], a[36:39], a[68:71], v[168:171]
ds_read_b64_tr_b16 a[2:3], v1 offset:53760
v_mfma_f32_16x16x32_bf16 v[172:175], a[36:39], a[72:75], v[172:175]
s_add_u32 m0, s25, 32768
v_mfma_f32_16x16x32_bf16 v[176:179], a[40:43], a[60:63], v[176:179]
ds_read_b64_tr_b16 a[4:5], v1 offset:49184
v_mfma_f32_16x16x32_bf16 v[180:183], a[40:43], a[64:67], v[180:183]
ds_read_b64_tr_b16 a[6:7], v1 offset:53792
v_mfma_f32_16x16x32_bf16 v[184:187], a[40:43], a[68:71], v[184:187]
buffer_load_dwordx4 v4, s[12:15], s21 offen offset:0 lds
v_mfma_f32_16x16x32_bf16 v[188:191], a[40:43], a[72:75], v[188:191]
ds_read_b64_tr_b16 a[8:9], v1 offset:49216
v_mfma_f32_16x16x32_bf16 v[192:195], a[44:47], a[60:63], v[192:195]
ds_read_b64_tr_b16 a[10:11], v1 offset:53824
v_mfma_f32_16x16x32_bf16 v[196:199], a[44:47], a[64:67], v[196:199]
v_mfma_f32_16x16x32_bf16 v[200:203], a[44:47], a[68:71], v[200:203]
ds_read_b64_tr_b16 a[12:13], v1 offset:49248
v_mfma_f32_16x16x32_bf16 v[204:207], a[44:47], a[72:75], v[204:207]
ds_read_b64_tr_b16 a[14:15], v1 offset:53856
v_mfma_f32_16x16x32_bf16 v[208:211], a[48:51], a[60:63], v[208:211]
buffer_load_dwordx4 v5, s[16:19], s22 offen offset:1024 lds
v_mfma_f32_16x16x32_bf16 v[212:215], a[48:51], a[64:67], v[212:215]
ds_read_b64_tr_b16 a[16:17], v1 offset:49280
v_mfma_f32_16x16x32_bf16 v[216:219], a[48:51], a[68:71], v[216:219]
ds_read_b64_tr_b16 a[18:19], v1 offset:53888
v_mfma_f32_16x16x32_bf16 v[220:223], a[48:51], a[72:75], v[220:223]
v_mfma_f32_16x16x32_bf16 v[224:227], a[52:55], a[60:63], v[224:227]
ds_read_b64_tr_b16 a[20:21], v1 offset:49312
v_mfma_f32_16x16x32_bf16 v[228:231], a[52:55], a[64:67], v[228:231]
ds_read_b64_tr_b16 a[22:23], v1 offset:53920
v_mfma_f32_16x16x32_bf16 v[232:235], a[52:55], a[68:71], v[232:235]
buffer_load_dwordx4 v6, s[16:19], s22 offen offset:2048 lds
v_mfma_f32_16x16x32_bf16 v[236:239], a[52:55], a[72:75], v[236:239]
ds_read_b64_tr_b16 a[24:25], v1 offset:49344
v_mfma_f32_16x16x32_bf16 v[240:243], a[56:59], a[60:63], v[240:243]
ds_read_b64_tr_b16 a[26:27], v1 offset:53952
v_mfma_f32_16x16x32_bf16 v[244:247], a[56:59], a[64:67], v[244:247]
v_mfma_f32_16x16x32_bf16 v[248:251], a[56:59], a[68:71], v[248:251]
ds_read_b64_tr_b16 a[28:29], v1 offset:49376
v_mfma_f32_16x16x32_bf16 v[252:255], a[56:59], a[72:75], v[252:255]
ds_read_b64_tr_b16 a[30:31], v1 offset:53984
s_waitcnt lgkmcnt(10)
v_mfma_f32_16x16x32_bf16 v[16:19], a[0:3], a[76:79], v[16:19]
buffer_load_dwordx4 v7, s[16:19], s22 offen offset:3072 lds
v_mfma_f32_16x16x32_bf16 v[20:23], a[0:3], a[80:83], v[20:23]
ds_read_b64_tr_b16 a[32:33], v2 offset:49152
v_mfma_f32_16x16x32_bf16 v[24:27], a[0:3], a[84:87], v[24:27]
ds_read_b64_tr_b16 a[34:35], v2 offset:52736
s_waitcnt vmcnt(21)
v_mfma_f32_16x16x32_bf16 v[28:31], a[0:3], a[88:91], v[28:31]
ds_read_b128 a[60:63], v0 offset:0
v_mfma_f32_16x16x32_bf16 v[32:35], a[4:7], a[76:79], v[32:35]
ds_read_b64_tr_b16 a[36:37], v2 offset:49184
v_mfma_f32_16x16x32_bf16 v[36:39], a[4:7], a[80:83], v[36:39]
ds_read_b64_tr_b16 a[38:39], v2 offset:52768
v_mfma_f32_16x16x32_bf16 v[40:43], a[4:7], a[84:87], v[40:43]
s_add_u32 s21, s21, s23
s_add_u32 s22, s22, s24
ds_read_b128 a[64:67], v0 offset:2048
v_mfma_f32_16x16x32_bf16 v[44:47], a[4:7], a[88:91], v[44:47]
ds_read_b64_tr_b16 a[40:41], v2 offset:49216
v_mfma_f32_16x16x32_bf16 v[48:51], a[8:11], a[76:79], v[48:51]
ds_read_b64_tr_b16 a[42:43], v2 offset:52800
v_mfma_f32_16x16x32_bf16 v[52:55], a[8:11], a[80:83], v[52:55]
ds_read_b128 a[68:71], v0 offset:4096
v_mfma_f32_16x16x32_bf16 v[56:59], a[8:11], a[84:87], v[56:59]
ds_read_b64_tr_b16 a[44:45], v2 offset:49248
v_mfma_f32_16x16x32_bf16 v[60:63], a[8:11], a[88:91], v[60:63]
ds_read_b64_tr_b16 a[46:47], v2 offset:52832
s_waitcnt lgkmcnt(15)
v_mfma_f32_16x16x32_bf16 v[64:67], a[12:15], a[76:79], v[64:67]
ds_read_b128 a[72:75], v0 offset:6144
v_mfma_f32_16x16x32_bf16 v[68:71], a[12:15], a[80:83], v[68:71]
ds_read_b64_tr_b16 a[48:49], v2 offset:49280
s_add_u32 m0, s55, 131072
v_mfma_f32_16x16x32_bf16 v[72:75], a[12:15], a[84:87], v[72:75]
ds_read_b64_tr_b16 a[50:51], v2 offset:52864
s_add_u32 s3, s20, 0
v_mfma_f32_16x16x32_bf16 v[76:79], a[12:15], a[88:91], v[76:79]
buffer_load_dwordx4 v3, s[8:11], s3 offen offset:0 lds
v_mfma_f32_16x16x32_bf16 v[80:83], a[16:19], a[76:79], v[80:83]
ds_read_b64_tr_b16 a[52:53], v2 offset:49312
v_mfma_f32_16x16x32_bf16 v[84:87], a[16:19], a[80:83], v[84:87]
ds_read_b64_tr_b16 a[54:55], v2 offset:52896
v_mfma_f32_16x16x32_bf16 v[88:91], a[16:19], a[84:87], v[88:91]
v_mfma_f32_16x16x32_bf16 v[92:95], a[16:19], a[88:91], v[92:95]
ds_read_b64_tr_b16 a[56:57], v2 offset:49344
v_mfma_f32_16x16x32_bf16 v[96:99], a[20:23], a[76:79], v[96:99]
ds_read_b64_tr_b16 a[58:59], v2 offset:52928
s_add_u32 s3, s20, 15360
v_mfma_f32_16x16x32_bf16 v[100:103], a[20:23], a[80:83], v[100:103]
buffer_load_dwordx4 v13, s[8:11], s3 offen offset:1024 lds
v_mfma_f32_16x16x32_bf16 v[104:107], a[20:23], a[84:87], v[104:107]
v_mfma_f32_16x16x32_bf16 v[108:111], a[20:23], a[88:91], v[108:111]
s_waitcnt lgkmcnt(15)
v_mfma_f32_16x16x32_bf16 v[112:115], a[24:27], a[76:79], v[112:115]
v_mfma_f32_16x16x32_bf16 v[116:119], a[24:27], a[80:83], v[116:119]
v_mfma_f32_16x16x32_bf16 v[120:123], a[24:27], a[84:87], v[120:123]
s_add_u32 s3, s20, 30720
v_mfma_f32_16x16x32_bf16 v[124:127], a[24:27], a[88:91], v[124:127]
buffer_load_dwordx4 v3, s[8:11], s3 offen offset:2048 lds
v_mfma_f32_16x16x32_bf16 v[128:131], a[28:31], a[76:79], v[128:131]
v_mfma_f32_16x16x32_bf16 v[132:135], a[28:31], a[80:83], v[132:135]
v_mfma_f32_16x16x32_bf16 v[136:139], a[28:31], a[84:87], v[136:139]
v_mfma_f32_16x16x32_bf16 v[140:143], a[28:31], a[88:91], v[140:143]
v_mfma_f32_16x16x32_bf16 v[144:147], a[32:35], a[76:79], v[144:147]
s_add_u32 s3, s20, 46080
v_mfma_f32_16x16x32_bf16 v[148:151], a[32:35], a[80:83], v[148:151]
buffer_load_dwordx4 v13, s[8:11], s3 offen offset:3072 lds
v_mfma_f32_16x16x32_bf16 v[152:155], a[32:35], a[84:87], v[152:155]
v_mfma_f32_16x16x32_bf16 v[156:159], a[32:35], a[88:91], v[156:159]
s_waitcnt lgkmcnt(7)
v_mfma_f32_16x16x32_bf16 v[160:163], a[36:39], a[76:79], v[160:163]
s_waitcnt vmcnt(21) lgkmcnt(0)
s_barrier
v_mfma_f32_16x16x32_bf16 v[164:167], a[36:39], a[80:83], v[164:167]
ds_read_b64_tr_b16 a[0:1], v1 offset:0
v_mfma_f32_16x16x32_bf16 v[168:171], a[36:39], a[84:87], v[168:171]
ds_read_b64_tr_b16 a[2:3], v1 offset:4608
v_mfma_f32_16x16x32_bf16 v[172:175], a[36:39], a[88:91], v[172:175]
s_add_u32 m0, s25, 49152
v_mfma_f32_16x16x32_bf16 v[176:179], a[40:43], a[76:79], v[176:179]
ds_read_b64_tr_b16 a[4:5], v1 offset:32
v_mfma_f32_16x16x32_bf16 v[180:183], a[40:43], a[80:83], v[180:183]
ds_read_b64_tr_b16 a[6:7], v1 offset:4640
v_mfma_f32_16x16x32_bf16 v[184:187], a[40:43], a[84:87], v[184:187]
buffer_load_dwordx4 v4, s[12:15], s21 offen offset:0 lds
v_mfma_f32_16x16x32_bf16 v[188:191], a[40:43], a[88:91], v[188:191]
ds_read_b64_tr_b16 a[8:9], v1 offset:64
v_mfma_f32_16x16x32_bf16 v[192:195], a[44:47], a[76:79], v[192:195]
ds_read_b64_tr_b16 a[10:11], v1 offset:4672
v_mfma_f32_16x16x32_bf16 v[196:199], a[44:47], a[80:83], v[196:199]
v_mfma_f32_16x16x32_bf16 v[200:203], a[44:47], a[84:87], v[200:203]
ds_read_b64_tr_b16 a[12:13], v1 offset:96
v_mfma_f32_16x16x32_bf16 v[204:207], a[44:47], a[88:91], v[204:207]
ds_read_b64_tr_b16 a[14:15], v1 offset:4704
v_mfma_f32_16x16x32_bf16 v[208:211], a[48:51], a[76:79], v[208:211]
buffer_load_dwordx4 v5, s[16:19], s22 offen offset:1024 lds
v_mfma_f32_16x16x32_bf16 v[212:215], a[48:51], a[80:83], v[212:215]
ds_read_b64_tr_b16 a[16:17], v1 offset:128
v_mfma_f32_16x16x32_bf16 v[216:219], a[48:51], a[84:87], v[216:219]
ds_read_b64_tr_b16 a[18:19], v1 offset:4736
v_mfma_f32_16x16x32_bf16 v[220:223], a[48:51], a[88:91], v[220:223]
v_mfma_f32_16x16x32_bf16 v[224:227], a[52:55], a[76:79], v[224:227]
ds_read_b64_tr_b16 a[20:21], v1 offset:160
v_mfma_f32_16x16x32_bf16 v[228:231], a[52:55], a[80:83], v[228:231]
ds_read_b64_tr_b16 a[22:23], v1 offset:4768
v_mfma_f32_16x16x32_bf16 v[232:235], a[52:55], a[84:87], v[232:235]
buffer_load_dwordx4 v6, s[16:19], s22 offen offset:2048 lds
v_mfma_f32_16x16x32_bf16 v[236:239], a[52:55], a[88:91], v[236:239]
ds_read_b64_tr_b16 a[24:25], v1 offset:192
v_mfma_f32_16x16x32_bf16 v[240:243], a[56:59], a[76:79], v[240:243]
ds_read_b64_tr_b16 a[26:27], v1 offset:4800
v_mfma_f32_16x16x32_bf16 v[244:247], a[56:59], a[80:83], v[244:247]
v_mfma_f32_16x16x32_bf16 v[248:251], a[56:59], a[84:87], v[248:251]
ds_read_b64_tr_b16 a[28:29], v1 offset:224
v_mfma_f32_16x16x32_bf16 v[252:255], a[56:59], a[88:91], v[252:255]
ds_read_b64_tr_b16 a[30:31], v1 offset:4832
s_waitcnt lgkmcnt(10)
v_mfma_f32_16x16x32_bf16 v[16:19], a[0:3], a[60:63], v[16:19]
buffer_load_dwordx4 v7, s[16:19], s22 offen offset:3072 lds
v_mfma_f32_16x16x32_bf16 v[20:23], a[0:3], a[64:67], v[20:23]
ds_read_b64_tr_b16 a[32:33], v2 offset:0
v_mfma_f32_16x16x32_bf16 v[24:27], a[0:3], a[68:71], v[24:27]
ds_read_b64_tr_b16 a[34:35], v2 offset:3584
v_mfma_f32_16x16x32_bf16 v[28:31], a[0:3], a[72:75], v[28:31]
ds_read_b128 a[76:79], v12 offset:0
v_mfma_f32_16x16x32_bf16 v[32:35], a[4:7], a[60:63], v[32:35]
ds_read_b64_tr_b16 a[36:37], v2 offset:32
v_mfma_f32_16x16x32_bf16 v[36:39], a[4:7], a[64:67], v[36:39]
ds_read_b64_tr_b16 a[38:39], v2 offset:3616
v_mfma_f32_16x16x32_bf16 v[40:43], a[4:7], a[68:71], v[40:43]
s_add_u32 s21, s21, s23
s_add_u32 s22, s22, s24
ds_read_b128 a[80:83], v12 offset:2048
v_mfma_f32_16x16x32_bf16 v[44:47], a[4:7], a[72:75], v[44:47]
ds_read_b64_tr_b16 a[40:41], v2 offset:64
v_mfma_f32_16x16x32_bf16 v[48:51], a[8:11], a[60:63], v[48:51]
ds_read_b64_tr_b16 a[42:43], v2 offset:3648
v_mfma_f32_16x16x32_bf16 v[52:55], a[8:11], a[64:67], v[52:55]
ds_read_b128 a[84:87], v12 offset:4096
v_mfma_f32_16x16x32_bf16 v[56:59], a[8:11], a[68:71], v[56:59]
ds_read_b64_tr_b16 a[44:45], v2 offset:96
v_mfma_f32_16x16x32_bf16 v[60:63], a[8:11], a[72:75], v[60:63]
ds_read_b64_tr_b16 a[46:47], v2 offset:3680
s_waitcnt lgkmcnt(15)
v_mfma_f32_16x16x32_bf16 v[64:67], a[12:15], a[60:63], v[64:67]
ds_read_b128 a[88:91], v12 offset:6144
v_mfma_f32_16x16x32_bf16 v[68:71], a[12:15], a[64:67], v[68:71]
ds_read_b64_tr_b16 a[48:49], v2 offset:128
s_add_u32 m0, s55, 135168
v_mfma_f32_16x16x32_bf16 v[72:75], a[12:15], a[68:71], v[72:75]
ds_read_b64_tr_b16 a[50:51], v2 offset:3712
s_add_u32 s3, s20, 65536
v_mfma_f32_16x16x32_bf16 v[76:79], a[12:15], a[72:75], v[76:79]
buffer_load_dwordx4 v3, s[8:11], s3 offen offset:0 lds
v_mfma_f32_16x16x32_bf16 v[80:83], a[16:19], a[60:63], v[80:83]
ds_read_b64_tr_b16 a[52:53], v2 offset:160
v_mfma_f32_16x16x32_bf16 v[84:87], a[16:19], a[64:67], v[84:87]
ds_read_b64_tr_b16 a[54:55], v2 offset:3744
v_mfma_f32_16x16x32_bf16 v[88:91], a[16:19], a[68:71], v[88:91]
v_mfma_f32_16x16x32_bf16 v[92:95], a[16:19], a[72:75], v[92:95]
ds_read_b64_tr_b16 a[56:57], v2 offset:192
v_mfma_f32_16x16x32_bf16 v[96:99], a[20:23], a[60:63], v[96:99]
ds_read_b64_tr_b16 a[58:59], v2 offset:3776
s_add_u32 s3, s20, 80896
v_mfma_f32_16x16x32_bf16 v[100:103], a[20:23], a[64:67], v[100:103]
buffer_load_dwordx4 v13, s[8:11], s3 offen offset:1024 lds
v_mfma_f32_16x16x32_bf16 v[104:107], a[20:23], a[68:71], v[104:107]
v_mfma_f32_16x16x32_bf16 v[108:111], a[20:23], a[72:75], v[108:111]
s_waitcnt lgkmcnt(15)
v_mfma_f32_16x16x32_bf16 v[112:115], a[24:27], a[60:63], v[112:115]
v_mfma_f32_16x16x32_bf16 v[116:119], a[24:27], a[64:67], v[116:119]
v_mfma_f32_16x16x32_bf16 v[120:123], a[24:27], a[68:71], v[120:123]
s_add_u32 s3, s20, 96256
v_mfma_f32_16x16x32_bf16 v[124:127], a[24:27], a[72:75], v[124:127]
buffer_load_dwordx4 v3, s[8:11], s3 offen offset:2048 lds
v_mfma_f32_16x16x32_bf16 v[128:131], a[28:31], a[60:63], v[128:131]
v_mfma_f32_16x16x32_bf16 v[132:135], a[28:31], a[64:67], v[132:135]
v_mfma_f32_16x16x32_bf16 v[136:139], a[28:31], a[68:71], v[136:139]
v_mfma_f32_16x16x32_bf16 v[140:143], a[28:31], a[72:75], v[140:143]
v_mfma_f32_16x16x32_bf16 v[144:147], a[32:35], a[60:63], v[144:147]
s_add_u32 s3, s20, 111616
v_mfma_f32_16x16x32_bf16 v[148:151], a[32:35], a[64:67], v[148:151]
buffer_load_dwordx4 v13, s[8:11], s3 offen offset:3072 lds
s_add_u32 s20, s20, 128
v_mfma_f32_16x16x32_bf16 v[152:155], a[32:35], a[68:71], v[152:155]
v_mfma_f32_16x16x32_bf16 v[156:159], a[32:35], a[72:75], v[156:159]
s_waitcnt lgkmcnt(7)
v_mfma_f32_16x16x32_bf16 v[160:163], a[36:39], a[60:63], v[160:163]
s_waitcnt vmcnt(21) lgkmcnt(0)
s_barrier
v_mfma_f32_16x16x32_bf16 v[164:167], a[36:39], a[64:67], v[164:167]
ds_read_b64_tr_b16 a[0:1], v1 offset:16384
v_mfma_f32_16x16x32_bf16 v[168:171], a[36:39], a[68:71], v[168:171]
ds_read_b64_tr_b16 a[2:3], v1 offset:20992
v_mfma_f32_16x16x32_bf16 v[172:175], a[36:39], a[72:75], v[172:175]
s_add_u32 m0, s25, 0
v_mfma_f32_16x16x32_bf16 v[176:179], a[40:43], a[60:63], v[176:179]
ds_read_b64_tr_b16 a[4:5], v1 offset:16416
v_mfma_f32_16x16x32_bf16 v[180:183], a[40:43], a[64:67], v[180:183]
ds_read_b64_tr_b16 a[6:7], v1 offset:21024
v_mfma_f32_16x16x32_bf16 v[184:187], a[40:43], a[68:71], v[184:187]
buffer_load_dwordx4 v4, s[12:15], s21 offen offset:0 lds
v_mfma_f32_16x16x32_bf16 v[188:191], a[40:43], a[72:75], v[188:191]
ds_read_b64_tr_b16 a[8:9], v1 offset:16448
v_mfma_f32_16x16x32_bf16 v[192:195], a[44:47], a[60:63], v[192:195]
ds_read_b64_tr_b16 a[10:11], v1 offset:21056
v_mfma_f32_16x16x32_bf16 v[196:199], a[44:47], a[64:67], v[196:199]
v_mfma_f32_16x16x32_bf16 v[200:203], a[44:47], a[68:71], v[200:203]
ds_read_b64_tr_b16 a[12:13], v1 offset:16480
v_mfma_f32_16x16x32_bf16 v[204:207], a[44:47], a[72:75], v[204:207]
ds_read_b64_tr_b16 a[14:15], v1 offset:21088
v_mfma_f32_16x16x32_bf16 v[208:211], a[48:51], a[60:63], v[208:211]
buffer_load_dwordx4 v5, s[16:19], s22 offen offset:1024 lds
v_mfma_f32_16x16x32_bf16 v[212:215], a[48:51], a[64:67], v[212:215]
ds_read_b64_tr_b16 a[16:17], v1 offset:16512
v_mfma_f32_16x16x32_bf16 v[216:219], a[48:51], a[68:71], v[216:219]
ds_read_b64_tr_b16 a[18:19], v1 offset:21120
v_mfma_f32_16x16x32_bf16 v[220:223], a[48:51], a[72:75], v[220:223]
v_mfma_f32_16x16x32_bf16 v[224:227], a[52:55], a[60:63], v[224:227]
ds_read_b64_tr_b16 a[20:21], v1 offset:16544
v_mfma_f32_16x16x32_bf16 v[228:231], a[52:55], a[64:67], v[228:231]
ds_read_b64_tr_b16 a[22:23], v1 offset:21152
v_mfma_f32_16x16x32_bf16 v[232:235], a[52:55], a[68:71], v[232:235]
buffer_load_dwordx4 v6, s[16:19], s22 offen offset:2048 lds
v_mfma_f32_16x16x32_bf16 v[236:239], a[52:55], a[72:75], v[236:239]
ds_read_b64_tr_b16 a[24:25], v1 offset:16576
v_mfma_f32_16x16x32_bf16 v[240:243], a[56:59], a[60:63], v[240:243]
ds_read_b64_tr_b16 a[26:27], v1 offset:21184
v_mfma_f32_16x16x32_bf16 v[244:247], a[56:59], a[64:67], v[244:247]
v_mfma_f32_16x16x32_bf16 v[248:251], a[56:59], a[68:71], v[248:251]
ds_read_b64_tr_b16 a[28:29], v1 offset:16608
v_mfma_f32_16x16x32_bf16 v[252:255], a[56:59], a[72:75], v[252:255]
ds_read_b64_tr_b16 a[30:31], v1 offset:21216
s_waitcnt lgkmcnt(10)
v_mfma_f32_16x16x32_bf16 v[16:19], a[0:3], a[76:79], v[16:19]
buffer_load_dwordx4 v7, s[16:19], s22 offen offset:3072 lds
v_mfma_f32_16x16x32_bf16 v[20:23], a[0:3], a[80:83], v[20:23]
ds_read_b64_tr_b16 a[32:33], v2 offset:16384
v_subrev_u32 v15, 32768, v0
v_mfma_f32_16x16x32_bf16 v[24:27], a[0:3], a[84:87], v[24:27]
ds_read_b64_tr_b16 a[34:35], v2 offset:19968
s_waitcnt vmcnt(20)
v_mfma_f32_16x16x32_bf16 v[28:31], a[0:3], a[88:91], v[28:31]
ds_read_b128 a[60:63], v15 offset:0
v_mfma_f32_16x16x32_bf16 v[32:35], a[4:7], a[76:79], v[32:35]
ds_read_b64_tr_b16 a[36:37], v2 offset:16416
v_mfma_f32_16x16x32_bf16 v[36:39], a[4:7], a[80:83], v[36:39]
ds_read_b64_tr_b16 a[38:39], v2 offset:20000
v_mfma_f32_16x16x32_bf16 v[40:43], a[4:7], a[84:87], v[40:43]
s_add_u32 s21, s21, s23
s_add_u32 s22, s22, s24
ds_read_b128 a[64:67], v15 offset:2048
v_mfma_f32_16x16x32_bf16 v[44:47], a[4:7], a[88:91], v[44:47]
ds_read_b64_tr_b16 a[40:41], v2 offset:16448
v_mfma_f32_16x16x32_bf16 v[48:51], a[8:11], a[76:79], v[48:51]
ds_read_b64_tr_b16 a[42:43], v2 offset:20032
v_mfma_f32_16x16x32_bf16 v[52:55], a[8:11], a[80:83], v[52:55]
ds_read_b128 a[68:71], v15 offset:4096
v_mfma_f32_16x16x32_bf16 v[56:59], a[8:11], a[84:87], v[56:59]
ds_read_b64_tr_b16 a[44:45], v2 offset:16480
v_mfma_f32_16x16x32_bf16 v[60:63], a[8:11], a[88:91], v[60:63]
ds_read_b64_tr_b16 a[46:47], v2 offset:20064
s_waitcnt lgkmcnt(15)
v_mfma_f32_16x16x32_bf16 v[64:67], a[12:15], a[76:79], v[64:67]
ds_read_b128 a[72:75], v15 offset:6144
v_mfma_f32_16x16x32_bf16 v[68:71], a[12:15], a[80:83], v[68:71]
ds_read_b64_tr_b16 a[48:49], v2 offset:16512
s_add_u32 m0, s55, 98304
v_mfma_f32_16x16x32_bf16 v[72:75], a[12:15], a[84:87], v[72:75]
ds_read_b64_tr_b16 a[50:51], v2 offset:20096
s_add_u32 s3, s20, 0
v_mfma_f32_16x16x32_bf16 v[76:79], a[12:15], a[88:91], v[76:79]
buffer_load_dwordx4 v3, s[8:11], s3 offen offset:0 lds
v_mfma_f32_16x16x32_bf16 v[80:83], a[16:19], a[76:79], v[80:83]
ds_read_b64_tr_b16 a[52:53], v2 offset:16544
v_mfma_f32_16x16x32_bf16 v[84:87], a[16:19], a[80:83], v[84:87]
ds_read_b64_tr_b16 a[54:55], v2 offset:20128
v_mfma_f32_16x16x32_bf16 v[88:91], a[16:19], a[84:87], v[88:91]
v_mfma_f32_16x16x32_bf16 v[92:95], a[16:19], a[88:91], v[92:95]
ds_read_b64_tr_b16 a[56:57], v2 offset:16576
v_mfma_f32_16x16x32_bf16 v[96:99], a[20:23], a[76:79], v[96:99]
ds_read_b64_tr_b16 a[58:59], v2 offset:20160
s_add_u32 s3, s20, 15360
v_mfma_f32_16x16x32_bf16 v[100:103], a[20:23], a[80:83], v[100:103]
buffer_load_dwordx4 v13, s[8:11], s3 offen offset:1024 lds
v_mfma_f32_16x16x32_bf16 v[104:107], a[20:23], a[84:87], v[104:107]
v_mfma_f32_16x16x32_bf16 v[108:111], a[20:23], a[88:91], v[108:111]
s_waitcnt lgkmcnt(15)
v_mfma_f32_16x16x32_bf16 v[112:115], a[24:27], a[76:79], v[112:115]
v_mfma_f32_16x16x32_bf16 v[116:119], a[24:27], a[80:83], v[116:119]
v_mfma_f32_16x16x32_bf16 v[120:123], a[24:27], a[84:87], v[120:123]
s_add_u32 s3, s20, 30720
v_mfma_f32_16x16x32_bf16 v[124:127], a[24:27], a[88:91], v[124:127]
buffer_load_dwordx4 v3, s[8:11], s3 offen offset:2048 lds
v_mfma_f32_16x16x32_bf16 v[128:131], a[28:31], a[76:79], v[128:131]
v_mfma_f32_16x16x32_bf16 v[132:135], a[28:31], a[80:83], v[132:135]
v_mfma_f32_16x16x32_bf16 v[136:139], a[28:31], a[84:87], v[136:139]
v_mfma_f32_16x16x32_bf16 v[140:143], a[28:31], a[88:91], v[140:143]
v_mfma_f32_16x16x32_bf16 v[144:147], a[32:35], a[76:79], v[144:147]
s_add_u32 s3, s20, 46080
v_mfma_f32_16x16x32_bf16 v[148:151], a[32:35], a[80:83], v[148:151]
buffer_load_dwordx4 v13, s[8:11], s3 offen offset:3072 lds
v_mfma_f32_16x16x32_bf16 v[152:155], a[32:35], a[84:87], v[152:155]
v_mfma_f32_16x16x32_bf16 v[156:159], a[32:35], a[88:91], v[156:159]
s_waitcnt lgkmcnt(7)
v_mfma_f32_16x16x32_bf16 v[160:163], a[36:39], a[76:79], v[160:163]
s_waitcnt vmcnt(20) lgkmcnt(0)
s_barrier
v_mfma_f32_16x16x32_bf16 v[164:167], a[36:39], a[80:83], v[164:167]
ds_read_b64_tr_b16 a[0:1], v1 offset:32768
v_mfma_f32_16x16x32_bf16 v[168:171], a[36:39], a[84:87], v[168:171]
ds_read_b64_tr_b16 a[2:3], v1 offset:37376
v_mfma_f32_16x16x32_bf16 v[172:175], a[36:39], a[88:91], v[172:175]
s_add_u32 m0, s25, 16384
v_mfma_f32_16x16x32_bf16 v[176:179], a[40:43], a[76:79], v[176:179]
ds_read_b64_tr_b16 a[4:5], v1 offset:32800
s_cmp_eq_u32 s26, 0
s_cbranch_scc0 L_pub_skip
s_and_b32 s38, s2, 3
s_lshl_b32 s38, s38, 3
s_lshl_b32 s38, 1, s38
s_and_b32 s39, s2, 0xfc
s_mov_b64 s[36:37], exec
s_mov_b64 exec, 1
v_mov_b32 v14, s38
v_mov_b32 v15, s39
buffer_atomic_or v14, v15, s[56:59], 0 offen sc1
s_mov_b64 exec, s[36:37]
L_pub_skip:
v_mfma_f32_16x16x32_bf16 v[180:183], a[40:43], a[80:83], v[180:183]
ds_read_b64_tr_b16 a[6:7], v1 offset:37408
v_mfma_f32_16x16x32_bf16 v[184:187], a[40:43], a[84:87], v[184:187]
buffer_load_dwordx4 v4, s[12:15], s21 offen offset:0 lds
v_mfma_f32_16x16x32_bf16 v[188:191], a[40:43], a[88:91], v[188:191]
ds_read_b64_tr_b16 a[8:9], v1 offset:32832
v_mfma_f32_16x16x32_bf16 v[192:195], a[44:47], a[76:79], v[192:195]
ds_read_b64_tr_b16 a[10:11], v1 offset:37440
v_mfma_f32_16x16x32_bf16 v[196:199], a[44:47], a[80:83], v[196:199]
v_mfma_f32_16x16x32_bf16 v[200:203], a[44:47], a[84:87], v[200:203]
ds_read_b64_tr_b16 a[12:13], v1 offset:32864
v_mfma_f32_16x16x32_bf16 v[204:207], a[44:47], a[88:91], v[204:207]
ds_read_b64_tr_b16 a[14:15], v1 offset:37472
v_mfma_f32_16x16x32_bf16 v[208:211], a[48:51], a[76:79], v[208:211]
buffer_load_dwordx4 v5, s[16:19], s22 offen offset:1024 lds
v_mfma_f32_16x16x32_bf16 v[212:215], a[48:51], a[80:83], v[212:215]
ds_read_b64_tr_b16 a[16:17], v1 offset:32896
v_mfma_f32_16x16x32_bf16 v[216:219], a[48:51], a[84:87], v[216:219]
ds_read_b64_tr_b16 a[18:19], v1 offset:37504
v_mfma_f32_16x16x32_bf16 v[220:223], a[48:51], a[88:91], v[220:223]
v_mfma_f32_16x16x32_bf16 v[224:227], a[52:55], a[76:79], v[224:227]
ds_read_b64_tr_b16 a[20:21], v1 offset:32928
v_mfma_f32_16x16x32_bf16 v[228:231], a[52:55], a[80:83], v[228:231]
ds_read_b64_tr_b16 a[22:23], v1 offset:37536
v_mfma_f32_16x16x32_bf16 v[232:235], a[52:55], a[84:87], v[232:235]
buffer_load_dwordx4 v6, s[16:19], s22 offen offset:2048 lds
v_mfma_f32_16x16x32_bf16 v[236:239], a[52:55], a[88:91], v[236:239]
ds_read_b64_tr_b16 a[24:25], v1 offset:32960
v_mfma_f32_16x16x32_bf16 v[240:243], a[56:59], a[76:79], v[240:243]
ds_read_b64_tr_b16 a[26:27], v1 offset:37568
v_mfma_f32_16x16x32_bf16 v[244:247], a[56:59], a[80:83], v[244:247]
v_mfma_f32_16x16x32_bf16 v[248:251], a[56:59], a[84:87], v[248:251]
ds_read_b64_tr_b16 a[28:29], v1 offset:32992
v_mfma_f32_16x16x32_bf16 v[252:255], a[56:59], a[88:91], v[252:255]
ds_read_b64_tr_b16 a[30:31], v1 offset:37600
s_waitcnt lgkmcnt(10)
v_mfma_f32_16x16x32_bf16 v[16:19], a[0:3], a[60:63], v[16:19]
buffer_load_dwordx4 v7, s[16:19], s22 offen offset:3072 lds
v_mfma_f32_16x16x32_bf16 v[20:23], a[0:3], a[64:67], v[20:23]
ds_read_b64_tr_b16 a[32:33], v2 offset:32768
v_subrev_u32 v15, 32768, v12
v_mfma_f32_16x16x32_bf16 v[24:27], a[0:3], a[68:71], v[24:27]
ds_read_b64_tr_b16 a[34:35], v2 offset:36352
v_mfma_f32_16x16x32_bf16 v[28:31], a[0:3], a[72:75], v[28:31]
ds_read_b128 a[76:79], v15 offset:0
v_mfma_f32_16x16x32_bf16 v[32:35], a[4:7], a[60:63], v[32:35]
ds_read_b64_tr_b16 a[36:37], v2 offset:32800
v_mfma_f32_16x16x32_bf16 v[36:39], a[4:7], a[64:67], v[36:39]
ds_read_b64_tr_b16 a[38:39], v2 offset:36384
v_mfma_f32_16x16x32_bf16 v[40:43], a[4:7], a[68:71], v[40:43]
s_add_u32 s21, s21, s23
s_add_u32 s22, s22, s24
ds_read_b128 a[80:83], v15 offset:2048
v_mfma_f32_16x16x32_bf16 v[44:47], a[4:7], a[72:75], v[44:47]
ds_read_b64_tr_b16 a[40:41], v2 offset:32832
v_mfma_f32_16x16x32_bf16 v[48:51], a[8:11], a[60:63], v[48:51]
ds_read_b64_tr_b16 a[42:43], v2 offset:36416
v_mfma_f32_16x16x32_bf16 v[52:55], a[8:11], a[64:67], v[52:55]
ds_read_b128 a[84:87], v15 offset:4096
v_mfma_f32_16x16x32_bf16 v[56:59], a[8:11], a[68:71], v[56:59]
ds_read_b64_tr_b16 a[44:45], v2 offset:32864
v_mfma_f32_16x16x32_bf16 v[60:63], a[8:11], a[72:75], v[60:63]
ds_read_b64_tr_b16 a[46:47], v2 offset:36448
s_waitcnt lgkmcnt(15)
v_mfma_f32_16x16x32_bf16 v[64:67], a[12:15], a[60:63], v[64:67]
ds_read_b128 a[88:91], v15 offset:6144
v_mfma_f32_16x16x32_bf16 v[68:71], a[12:15], a[64:67], v[68:71]
ds_read_b64_tr_b16 a[48:49], v2 offset:32896
s_add_u32 m0, s55, 102400
v_mfma_f32_16x16x32_bf16 v[72:75], a[12:15], a[68:71], v[72:75]
ds_read_b64_tr_b16 a[50:51], v2 offset:36480
s_add_u32 s3, s20, 65536
s_getpc_b64 s[36:37]
L_pc11:
s_add_u32 s36, s36, L_gs22-L_pc11
s_addc_u32 s37, s37, 0
v_mfma_f32_16x16x32_bf16 v[76:79], a[12:15], a[72:75], v[76:79]
buffer_load_dwordx4 v3, s[8:11], s3 offen offset:0 lds
s_mov_b32 s40, s36
v_mfma_f32_16x16x32_bf16 v[80:83], a[16:19], a[60:63], v[80:83]
ds_read_b64_tr_b16 a[52:53], v2 offset:32928
s_and_b32 s41, s37, 0xffff
v_mfma_f32_16x16x32_bf16 v[84:87], a[16:19], a[64:67], v[84:87]
ds_read_b64_tr_b16 a[54:55], v2 offset:36512
s_mov_b32 s42, L_end_k-L_gs22
v_mfma_f32_16x16x32_bf16 v[88:91], a[16:19], a[68:71], v[88:91]
s_mov_b32 s43, 0x00020000
v_mfma_f32_16x16x32_bf16 v[92:95], a[16:19], a[72:75], v[92:95]
ds_read_b64_tr_b16 a[56:57], v2 offset:32960
s_lshr_b32 s36, s2, 3
v_mfma_f32_16x16x32_bf16 v[96:99], a[20:23], a[60:63], v[96:99]
ds_read_b64_tr_b16 a[58:59], v2 offset:36544
s_add_u32 s3, s20, 80896
s_lshl_b32 s36, s36, 2
v_mfma_f32_16x16x32_bf16 v[100:103], a[20:23], a[64:67], v[100:103]
buffer_load_dwordx4 v13, s[8:11], s3 offen offset:1024 lds
s_add_u32 s36, s36, s26
v_mfma_f32_16x16x32_bf16 v[104:107], a[20:23], a[68:71], v[104:107]
s_lshl_b32 s36, s36, 10
v_mfma_f32_16x16x32_bf16 v[108:111], a[20:23], a[72:75], v[108:111]
v_accvgpr_read_b32 v15, a213
s_waitcnt lgkmcnt(15)
v_mfma_f32_16x16x32_bf16 v[112:115], a[24:27], a[60:63], v[112:115]
v_and_b32 v15, 63, v15
v_mfma_f32_16x16x32_bf16 v[116:119], a[24:27], a[64:67], v[116:119]
v_lshlrev_b32 v15, 4, v15
v_mfma_f32_16x16x32_bf16 v[120:123], a[24:27], a[68:71], v[120:123]
s_add_u32 s3, s20, 96256
buffer_load_dwordx4 a[252:255], v15, s[40:43], s36 offen
v_mfma_f32_16x16x32_bf16 v[124:127], a[24:27], a[72:75], v[124:127]
buffer_load_dwordx4 v3, s[8:11], s3 offen offset:2048 lds
v_mfma_f32_16x16x32_bf16 v[128:131], a[28:31], a[60:63], v[128:131]
v_mfma_f32_16x16x32_bf16 v[132:135], a[28:31], a[64:67], v[132:135]
v_mfma_f32_16x16x32_bf16 v[136:139], a[28:31], a[68:71], v[136:139]
v_mfma_f32_16x16x32_bf16 v[140:143], a[28:31], a[72:75], v[140:143]
v_mfma_f32_16x16x32_bf16 v[144:147], a[32:35], a[60:63], v[144:147]
s_add_u32 s3, s20, 111616
v_mfma_f32_16x16x32_bf16 v[148:151], a[32:35], a[64:67], v[148:151]
buffer_load_dwordx4 v13, s[8:11], s3 offen offset:3072 lds
s_add_u32 s20, s20, 128
v_mfma_f32_16x16x32_bf16 v[152:155], a[32:35], a[68:71], v[152:155]
v_mfma_f32_16x16x32_bf16 v[156:159], a[32:35], a[72:75], v[156:159]
s_waitcnt lgkmcnt(7)
v_mfma_f32_16x16x32_bf16 v[160:163], a[36:39], a[60:63], v[160:163]
s_waitcnt vmcnt(21) lgkmcnt(0)
s_barrier
v_mfma_f32_16x16x32_bf16 v[164:167], a[36:39], a[64:67], v[164:167]
ds_read_b64_tr_b16 a[0:1], v1 offset:49152
v_mfma_f32_16x16x32_bf16 v[168:171], a[36:39], a[68:71], v[168:171]
ds_read_b64_tr_b16 a[2:3], v1 offset:53760
v_mfma_f32_16x16x32_bf16 v[172:175], a[36:39], a[72:75], v[172:175]
s_add_u32 m0, s25, 32768
v_mfma_f32_16x16x32_bf16 v[176:179], a[40:43], a[60:63], v[176:179]
ds_read_b64_tr_b16 a[4:5], v1 offset:49184
v_mfma_f32_16x16x32_bf16 v[180:183], a[40:43], a[64:67], v[180:183]
ds_read_b64_tr_b16 a[6:7], v1 offset:53792
v_mfma_f32_16x16x32_bf16 v[184:187], a[40:43], a[68:71], v[184:187]
buffer_load_dwordx4 v4, s[12:15], s21 offen offset:0 lds
v_mfma_f32_16x16x32_bf16 v[188:191], a[40:43], a[72:75], v[188:191]
ds_read_b64_tr_b16 a[8:9], v1 offset:49216
v_mfma_f32_16x16x32_bf16 v[192:195], a[44:47], a[60:63], v[192:195]
ds_read_b64_tr_b16 a[10:11], v1 offset:53824
v_mfma_f32_16x16x32_bf16 v[196:199], a[44:47], a[64:67], v[196:199]
v_mfma_f32_16x16x32_bf16 v[200:203], a[44:47], a[68:71], v[200:203]
ds_read_b64_tr_b16 a[12:13], v1 offset:49248
v_mfma_f32_16x16x32_bf16 v[204:207], a[44:47], a[72:75], v[204:207]
ds_read_b64_tr_b16 a[14:15], v1 offset:53856
v_mfma_f32_16x16x32_bf16 v[208:211], a[48:51], a[60:63], v[208:211]
buffer_load_dwordx4 v5, s[16:19], s22 offen offset:1024 lds
v_mfma_f32_16x16x32_bf16 v[212:215], a[48:51], a[64:67], v[212:215]
ds_read_b64_tr_b16 a[16:17], v1 offset:49280
v_mfma_f32_16x16x32_bf16 v[216:219], a[48:51], a[68:71], v[216:219]
ds_read_b64_tr_b16 a[18:19], v1 offset:53888
v_mfma_f32_16x16x32_bf16 v[220:223], a[48:51], a[72:75], v[220:223]
v_mfma_f32_16x16x32_bf16 v[224:227], a[52:55], a[60:63], v[224:227]
ds_read_b64_tr_b16 a[20:21], v1 offset:49312
v_mfma_f32_16x16x32_bf16 v[228:231], a[52:55], a[64:67], v[228:231]
ds_read_b64_tr_b16 a[22:23], v1 offset:53920
v_mfma_f32_16x16x32_bf16 v[232:235], a[52:55], a[68:71], v[232:235]
buffer_load_dwordx4 v6, s[16:19], s22 offen offset:2048 lds
v_mfma_f32_16x16x32_bf16 v[236:239], a[52:55], a[72:75], v[236:239]
ds_read_b64_tr_b16 a[24:25], v1 offset:49344
v_mfma_f32_16x16x32_bf16 v[240:243], a[56:59], a[60:63], v[240:243]
ds_read_b64_tr_b16 a[26:27], v1 offset:53952
v_mfma_f32_16x16x32_bf16 v[244:247], a[56:59], a[64:67], v[244:247]
v_mfma_f32_16x16x32_bf16 v[248:251], a[56:59], a[68:71], v[248:251]
ds_read_b64_tr_b16 a[28:29], v1 offset:49376
v_mfma_f32_16x16x32_bf16 v[252:255], a[56:59], a[72:75], v[252:255]
ds_read_b64_tr_b16 a[30:31], v1 offset:53984
s_waitcnt lgkmcnt(10)
v_mfma_f32_16x16x32_bf16 v[16:19], a[0:3], a[76:79], v[16:19]
buffer_load_dwordx4 v7, s[16:19], s22 offen offset:3072 lds
v_mfma_f32_16x16x32_bf16 v[20:23], a[0:3], a[80:83], v[20:23]
ds_read_b64_tr_b16 a[32:33], v2 offset:49152
v_mfma_f32_16x16x32_bf16 v[24:27], a[0:3], a[84:87], v[24:27]
ds_read_b64_tr_b16 a[34:35], v2 offset:52736
s_waitcnt vmcnt(21)
v_mfma_f32_16x16x32_bf16 v[28:31], a[0:3], a[88:91], v[28:31]
ds_read_b128 a[60:63], v0 offset:32768
v_mfma_f32_16x16x32_bf16 v[32:35], a[4:7], a[76:79], v[32:35]
ds_read_b64_tr_b16 a[36:37], v2 offset:49184
v_mfma_f32_16x16x32_bf16 v[36:39], a[4:7], a[80:83], v[36:39]
ds_read_b64_tr_b16 a[38:39], v2 offset:52768
v_mfma_f32_16x16x32_bf16 v[40:43], a[4:7], a[84:87], v[40:43]
s_add_u32 s21, s21, s23
s_add_u32 s22, s22, s24
ds_read_b128 a[64:67], v0 offset:34816
v_mfma_f32_16x16x32_bf16 v[44:47], a[4:7], a[88:91], v[44:47]
ds_read_b64_tr_b16 a[40:41], v2 offset:49216
v_mfma_f32_16x16x32_bf16 v[48:51], a[8:11], a[76:79], v[48:51]
ds_read_b64_tr_b16 a[42:43], v2 offset:52800
v_mfma_f32_16x16x32_bf16 v[52:55], a[8:11], a[80:83], v[52:55]
ds_read_b128 a[68:71], v0 offset:36864
v_mfma_f32_16x16x32_bf16 v[56:59], a[8:11], a[84:87], v[56:59]
ds_read_b64_tr_b16 a[44:45], v2 offset:49248
v_mfma_f32_16x16x32_bf16 v[60:63], a[8:11], a[88:91], v[60:63]
ds_read_b64_tr_b16 a[46:47], v2 offset:52832
s_waitcnt lgkmcnt(15)
v_mfma_f32_16x16x32_bf16 v[64:67], a[12:15], a[76:79], v[64:67]
ds_read_b128 a[72:75], v0 offset:38912
v_mfma_f32_16x16x32_bf16 v[68:71], a[12:15], a[80:83], v[68:71]
ds_read_b64_tr_b16 a[48:49], v2 offset:49280
s_add_u32 m0, s55, 65536
v_mfma_f32_16x16x32_bf16 v[72:75], a[12:15], a[84:87], v[72:75]
ds_read_b64_tr_b16 a[50:51], v2 offset:52864
s_add_u32 s3, s20, 0
v_mfma_f32_16x16x32_bf16 v[76:79], a[12:15], a[88:91], v[76:79]
buffer_load_dwordx4 v3, s[8:11], s3 offen offset:0 lds
v_mfma_f32_16x16x32_bf16 v[80:83], a[16:19], a[76:79], v[80:83]
ds_read_b64_tr_b16 a[52:53], v2 offset:49312
v_mfma_f32_16x16x32_bf16 v[84:87], a[16:19], a[80:83], v[84:87]
ds_read_b64_tr_b16 a[54:55], v2 offset:52896
v_mfma_f32_16x16x32_bf16 v[88:91], a[16:19], a[84:87], v[88:91]
v_mfma_f32_16x16x32_bf16 v[92:95], a[16:19], a[88:91], v[92:95]
ds_read_b64_tr_b16 a[56:57], v2 offset:49344
v_mfma_f32_16x16x32_bf16 v[96:99], a[20:23], a[76:79], v[96:99]
ds_read_b64_tr_b16 a[58:59], v2 offset:52928
s_add_u32 s3, s20, 15360
v_mfma_f32_16x16x32_bf16 v[100:103], a[20:23], a[80:83], v[100:103]
buffer_load_dwordx4 v13, s[8:11], s3 offen offset:1024 lds
v_mfma_f32_16x16x32_bf16 v[104:107], a[20:23], a[84:87], v[104:107]
v_mfma_f32_16x16x32_bf16 v[108:111], a[20:23], a[88:91], v[108:111]
s_waitcnt lgkmcnt(15)
v_mfma_f32_16x16x32_bf16 v[112:115], a[24:27], a[76:79], v[112:115]
v_mfma_f32_16x16x32_bf16 v[116:119], a[24:27], a[80:83], v[116:119]
v_mfma_f32_16x16x32_bf16 v[120:123], a[24:27], a[84:87], v[120:123]
s_add_u32 s3, s20, 30720
v_mfma_f32_16x16x32_bf16 v[124:127], a[24:27], a[88:91], v[124:127]
buffer_load_dwordx4 v3, s[8:11], s3 offen offset:2048 lds
v_mfma_f32_16x16x32_bf16 v[128:131], a[28:31], a[76:79], v[128:131]
v_mfma_f32_16x16x32_bf16 v[132:135], a[28:31], a[80:83], v[132:135]
v_mfma_f32_16x16x32_bf16 v[136:139], a[28:31], a[84:87], v[136:139]
v_mfma_f32_16x16x32_bf16 v[140:143], a[28:31], a[88:91], v[140:143]
v_mfma_f32_16x16x32_bf16 v[144:147], a[32:35], a[76:79], v[144:147]
s_add_u32 s3, s20, 46080
v_mfma_f32_16x16x32_bf16 v[148:151], a[32:35], a[80:83], v[148:151]
buffer_load_dwordx4 v13, s[8:11], s3 offen offset:3072 lds
v_mfma_f32_16x16x32_bf16 v[152:155], a[32:35], a[84:87], v[152:155]
v_mfma_f32_16x16x32_bf16 v[156:159], a[32:35], a[88:91], v[156:159]
s_waitcnt lgkmcnt(7)
v_mfma_f32_16x16x32_bf16 v[160:163], a[36:39], a[76:79], v[160:163]
s_waitcnt vmcnt(21) lgkmcnt(0)
s_barrier
v_mfma_f32_16x16x32_bf16 v[164:167], a[36:39], a[80:83], v[164:167]
ds_read_b64_tr_b16 a[0:1], v1 offset:0
v_mfma_f32_16x16x32_bf16 v[168:171], a[36:39], a[84:87], v[168:171]
ds_read_b64_tr_b16 a[2:3], v1 offset:4608
v_mfma_f32_16x16x32_bf16 v[172:175], a[36:39], a[88:91], v[172:175]
s_add_u32 m0, s25, 49152
v_mfma_f32_16x16x32_bf16 v[176:179], a[40:43], a[76:79], v[176:179]
ds_read_b64_tr_b16 a[4:5], v1 offset:32
v_mfma_f32_16x16x32_bf16 v[180:183], a[40:43], a[80:83], v[180:183]
ds_read_b64_tr_b16 a[6:7], v1 offset:4640
v_mfma_f32_16x16x32_bf16 v[184:187], a[40:43], a[84:87], v[184:187]
buffer_load_dwordx4 v4, s[12:15], s21 offen offset:0 lds
v_mfma_f32_16x16x32_bf16 v[188:191], a[40:43], a[88:91], v[188:191]
ds_read_b64_tr_b16 a[8:9], v1 offset:64
v_mfma_f32_16x16x32_bf16 v[192:195], a[44:47], a[76:79], v[192:195]
ds_read_b64_tr_b16 a[10:11], v1 offset:4672
v_mfma_f32_16x16x32_bf16 v[196:199], a[44:47], a[80:83], v[196:199]
v_mfma_f32_16x16x32_bf16 v[200:203], a[44:47], a[84:87], v[200:203]
ds_read_b64_tr_b16 a[12:13], v1 offset:96
v_mfma_f32_16x16x32_bf16 v[204:207], a[44:47], a[88:91], v[204:207]
ds_read_b64_tr_b16 a[14:15], v1 offset:4704
v_mfma_f32_16x16x32_bf16 v[208:211], a[48:51], a[76:79], v[208:211]
buffer_load_dwordx4 v5, s[16:19], s22 offen offset:1024 lds
v_mfma_f32_16x16x32_bf16 v[212:215], a[48:51], a[80:83], v[212:215]
ds_read_b64_tr_b16 a[16:17], v1 offset:128
v_mfma_f32_16x16x32_bf16 v[216:219], a[48:51], a[84:87], v[216:219]
ds_read_b64_tr_b16 a[18:19], v1 offset:4736
v_mfma_f32_16x16x32_bf16 v[220:223], a[48:51], a[88:91], v[220:223]
v_mfma_f32_16x16x32_bf16 v[224:227], a[52:55], a[76:79], v[224:227]
ds_read_b64_tr_b16 a[20:21], v1 offset:160
v_mfma_f32_16x16x32_bf16 v[228:231], a[52:55], a[80:83], v[228:231]
ds_read_b64_tr_b16 a[22:23], v1 offset:4768
v_mfma_f32_16x16x32_bf16 v[232:235], a[52:55], a[84:87], v[232:235]
buffer_load_dwordx4 v6, s[16:19], s22 offen offset:2048 lds
v_mfma_f32_16x16x32_bf16 v[236:239], a[52:55], a[88:91], v[236:239]
ds_read_b64_tr_b16 a[24:25], v1 offset:192
v_mfma_f32_16x16x32_bf16 v[240:243], a[56:59], a[76:79], v[240:243]
ds_read_b64_tr_b16 a[26:27], v1 offset:4800
v_mfma_f32_16x16x32_bf16 v[244:247], a[56:59], a[80:83], v[244:247]
v_mfma_f32_16x16x32_bf16 v[248:251], a[56:59], a[84:87], v[248:251]
ds_read_b64_tr_b16 a[28:29], v1 offset:224
v_mfma_f32_16x16x32_bf16 v[252:255], a[56:59], a[88:91], v[252:255]
ds_read_b64_tr_b16 a[30:31], v1 offset:4832
s_waitcnt lgkmcnt(10)
v_mfma_f32_16x16x32_bf16 v[16:19], a[0:3], a[60:63], v[16:19]
buffer_load_dwordx4 v7, s[16:19], s22 offen offset:3072 lds
v_mfma_f32_16x16x32_bf16 v[20:23], a[0:3], a[64:67], v[20:23]
ds_read_b64_tr_b16 a[32:33], v2 offset:0
v_mfma_f32_16x16x32_bf16 v[24:27], a[0:3], a[68:71], v[24:27]
ds_read_b64_tr_b16 a[34:35], v2 offset:3584
v_mfma_f32_16x16x32_bf16 v[28:31], a[0:3], a[72:75], v[28:31]
ds_read_b128 a[76:79], v12 offset:32768
v_mfma_f32_16x16x32_bf16 v[32:35], a[4:7], a[60:63], v[32:35]
ds_read_b64_tr_b16 a[36:37], v2 offset:32
v_mfma_f32_16x16x32_bf16 v[36:39], a[4:7], a[64:67], v[36:39]
ds_read_b64_tr_b16 a[38:39], v2 offset:3616
v_mfma_f32_16x16x32_bf16 v[40:43], a[4:7], a[68:71], v[40:43]
s_add_u32 s21, s21, s23
s_add_u32 s22, s22, s24
ds_read_b128 a[80:83], v12 offset:34816
v_mfma_f32_16x16x32_bf16 v[44:47], a[4:7], a[72:75], v[44:47]
ds_read_b64_tr_b16 a[40:41], v2 offset:64
v_mfma_f32_16x16x32_bf16 v[48:51], a[8:11], a[60:63], v[48:51]
ds_read_b64_tr_b16 a[42:43], v2 offset:3648
v_mfma_f32_16x16x32_bf16 v[52:55], a[8:11], a[64:67], v[52:55]
ds_read_b128 a[84:87], v12 offset:36864
v_mfma_f32_16x16x32_bf16 v[56:59], a[8:11], a[68:71], v[56:59]
ds_read_b64_tr_b16 a[44:45], v2 offset:96
v_mfma_f32_16x16x32_bf16 v[60:63], a[8:11], a[72:75], v[60:63]
ds_read_b64_tr_b16 a[46:47], v2 offset:3680
s_waitcnt lgkmcnt(15)
v_mfma_f32_16x16x32_bf16 v[64:67], a[12:15], a[60:63], v[64:67]
ds_read_b128 a[88:91], v12 offset:38912
v_mfma_f32_16x16x32_bf16 v[68:71], a[12:15], a[64:67], v[68:71]
ds_read_b64_tr_b16 a[48:49], v2 offset:128
s_add_u32 m0, s55, 69632
v_mfma_f32_16x16x32_bf16 v[72:75], a[12:15], a[68:71], v[72:75]
ds_read_b64_tr_b16 a[50:51], v2 offset:3712
s_add_u32 s3, s20, 65536
v_mfma_f32_16x16x32_bf16 v[76:79], a[12:15], a[72:75], v[76:79]
buffer_load_dwordx4 v3, s[8:11], s3 offen offset:0 lds
v_mfma_f32_16x16x32_bf16 v[80:83], a[16:19], a[60:63], v[80:83]
ds_read_b64_tr_b16 a[52:53], v2 offset:160
v_mfma_f32_16x16x32_bf16 v[84:87], a[16:19], a[64:67], v[84:87]
ds_read_b64_tr_b16 a[54:55], v2 offset:3744
v_mfma_f32_16x16x32_bf16 v[88:91], a[16:19], a[68:71], v[88:91]
v_mfma_f32_16x16x32_bf16 v[92:95], a[16:19], a[72:75], v[92:95]
ds_read_b64_tr_b16 a[56:57], v2 offset:192
v_mfma_f32_16x16x32_bf16 v[96:99], a[20:23], a[60:63], v[96:99]
ds_read_b64_tr_b16 a[58:59], v2 offset:3776
s_add_u32 s3, s20, 80896
v_mfma_f32_16x16x32_bf16 v[100:103], a[20:23], a[64:67], v[100:103]
buffer_load_dwordx4 v13, s[8:11], s3 offen offset:1024 lds
v_mfma_f32_16x16x32_bf16 v[104:107], a[20:23], a[68:71], v[104:107]
v_accvgpr_write_b32 a98, 0
v_mfma_f32_16x16x32_bf16 v[108:111], a[20:23], a[72:75], v[108:111]
v_accvgpr_write_b32 a99, 0
s_waitcnt lgkmcnt(15)
v_mfma_f32_16x16x32_bf16 v[112:115], a[24:27], a[60:63], v[112:115]
v_accvgpr_write_b32 a102, 0
v_mfma_f32_16x16x32_bf16 v[116:119], a[24:27], a[64:67], v[116:119]
v_accvgpr_write_b32 a103, 0
v_mfma_f32_16x16x32_bf16 v[120:123], a[24:27], a[68:71], v[120:123]
s_add_u32 s3, s20, 96256
v_accvgpr_write_b32 a106, 0
v_mfma_f32_16x16x32_bf16 v[124:127], a[24:27], a[72:75], v[124:127]
buffer_load_dwordx4 v3, s[8:11], s3 offen offset:2048 lds
v_accvgpr_write_b32 a107, 0
v_mfma_f32_16x16x32_bf16 v[128:131], a[28:31], a[60:63], v[128:131]
v_accvgpr_read_b32 v14, a215
v_accvgpr_write_b32 a110, 0
v_mfma_f32_16x16x32_bf16 v[132:135], a[28:31], a[64:67], v[132:135]
v_accvgpr_write_b32 a111, 0
v_mfma_f32_16x16x32_bf16 v[136:139], a[28:31], a[68:71], v[136:139]
buffer_load_dword a197, v14, s[56:59], 0 offen
v_mfma_f32_16x16x32_bf16 v[140:143], a[28:31], a[72:75], v[140:143]
v_mfma_f32_16x16x32_bf16 v[144:147], a[32:35], a[60:63], v[144:147]
s_add_u32 s3, s20, 111616
v_mfma_f32_16x16x32_bf16 v[148:151], a[32:35], a[64:67], v[148:151]
buffer_load_dwordx4 v13, s[8:11], s3 offen offset:3072 lds
s_add_u32 s20, s20, 128
v_mfma_f32_16x16x32_bf16 v[152:155], a[32:35], a[68:71], v[152:155]
v_mfma_f32_16x16x32_bf16 v[156:159], a[32:35], a[72:75], v[156:159]
s_waitcnt lgkmcnt(7)
v_mfma_f32_16x16x32_bf16 v[160:163], a[36:39], a[60:63], v[160:163]
s_waitcnt vmcnt(22) lgkmcnt(0)
s_barrier
v_mfma_f32_16x16x32_bf16 v[164:167], a[36:39], a[64:67], v[164:167]
ds_read_b64_tr_b16 a[0:1], v1 offset:16384
v_mfma_f32_16x16x32_bf16 v[168:171], a[36:39], a[68:71], v[168:171]
ds_read_b64_tr_b16 a[2:3], v1 offset:20992
v_mfma_f32_16x16x32_bf16 v[172:175], a[36:39], a[72:75], v[172:175]
s_add_u32 m0, s25, 0
v_mfma_f32_16x16x32_bf16 v[176:179], a[40:43], a[60:63], v[176:179]
ds_read_b64_tr_b16 a[4:5], v1 offset:16416
v_mfma_f32_16x16x32_bf16 v[180:183], a[40:43], a[64:67], v[180:183]
ds_read_b64_tr_b16 a[6:7], v1 offset:21024
v_mfma_f32_16x16x32_bf16 v[184:187], a[40:43], a[68:71], v[184:187]
buffer_load_dwordx4 v4, s[12:15], s21 offen offset:0 lds
v_mfma_f32_16x16x32_bf16 v[188:191], a[40:43], a[72:75], v[188:191]
ds_read_b64_tr_b16 a[8:9], v1 offset:16448
v_mfma_f32_16x16x32_bf16 v[192:195], a[44:47], a[60:63], v[192:195]
ds_read_b64_tr_b16 a[10:11], v1 offset:21056
v_mfma_f32_16x16x32_bf16 v[196:199], a[44:47], a[64:67], v[196:199]
v_mfma_f32_16x16x32_bf16 v[200:203], a[44:47], a[68:71], v[200:203]
ds_read_b64_tr_b16 a[12:13], v1 offset:16480
v_mfma_f32_16x16x32_bf16 v[204:207], a[44:47], a[72:75], v[204:207]
ds_read_b64_tr_b16 a[14:15], v1 offset:21088
v_mfma_f32_16x16x32_bf16 v[208:211], a[48:51], a[60:63], v[208:211]
buffer_load_dwordx4 v5, s[16:19], s22 offen offset:1024 lds
v_mfma_f32_16x16x32_bf16 v[212:215], a[48:51], a[64:67], v[212:215]
ds_read_b64_tr_b16 a[16:17], v1 offset:16512
v_mfma_f32_16x16x32_bf16 v[216:219], a[48:51], a[68:71], v[216:219]
ds_read_b64_tr_b16 a[18:19], v1 offset:21120
v_mfma_f32_16x16x32_bf16 v[220:223], a[48:51], a[72:75], v[220:223]
v_mfma_f32_16x16x32_bf16 v[224:227], a[52:55], a[60:63], v[224:227]
ds_read_b64_tr_b16 a[20:21], v1 offset:16544
v_mfma_f32_16x16x32_bf16 v[228:231], a[52:55], a[64:67], v[228:231]
ds_read_b64_tr_b16 a[22:23], v1 offset:21152
v_mfma_f32_16x16x32_bf16 v[232:235], a[52:55], a[68:71], v[232:235]
buffer_load_dwordx4 v6, s[16:19], s22 offen offset:2048 lds
v_mfma_f32_16x16x32_bf16 v[236:239], a[52:55], a[72:75], v[236:239]
ds_read_b64_tr_b16 a[24:25], v1 offset:16576
v_mfma_f32_16x16x32_bf16 v[240:243], a[56:59], a[60:63], v[240:243]
ds_read_b64_tr_b16 a[26:27], v1 offset:21184
v_mfma_f32_16x16x32_bf16 v[244:247], a[56:59], a[64:67], v[244:247]
v_mfma_f32_16x16x32_bf16 v[248:251], a[56:59], a[68:71], v[248:251]
ds_read_b64_tr_b16 a[28:29], v1 offset:16608
v_mfma_f32_16x16x32_bf16 v[252:255], a[56:59], a[72:75], v[252:255]
ds_read_b64_tr_b16 a[30:31], v1 offset:21216
s_waitcnt lgkmcnt(10)
v_mfma_f32_16x16x32_bf16 v[16:19], a[0:3], a[76:79], v[16:19]
buffer_load_dwordx4 v7, s[16:19], s22 offen offset:3072 lds
v_mfma_f32_16x16x32_bf16 v[20:23], a[0:3], a[80:83], v[20:23]
ds_read_b64_tr_b16 a[32:33], v2 offset:16384
v_mfma_f32_16x16x32_bf16 v[24:27], a[0:3], a[84:87], v[24:27]
ds_read_b64_tr_b16 a[34:35], v2 offset:19968
s_waitcnt vmcnt(21)
v_mfma_f32_16x16x32_bf16 v[28:31], a[0:3], a[88:91], v[28:31]
ds_read_b128 a[60:63], v0 offset:0
v_mfma_f32_16x16x32_bf16 v[32:35], a[4:7], a[76:79], v[32:35]
ds_read_b64_tr_b16 a[36:37], v2 offset:16416
v_mfma_f32_16x16x32_bf16 v[36:39], a[4:7], a[80:83], v[36:39]
ds_read_b64_tr_b16 a[38:39], v2 offset:20000
v_mfma_f32_16x16x32_bf16 v[40:43], a[4:7], a[84:87], v[40:43]
s_add_u32 s21, s21, s23
s_add_u32 s22, s22, s24
ds_read_b128 a[64:67], v0 offset:2048
v_mfma_f32_16x16x32_bf16 v[44:47], a[4:7], a[88:91], v[44:47]
ds_read_b64_tr_b16 a[40:41], v2 offset:16448
v_mfma_f32_16x16x32_bf16 v[48:51], a[8:11], a[76:79], v[48:51]
ds_read_b64_tr_b16 a[42:43], v2 offset:20032
v_mfma_f32_16x16x32_bf16 v[52:55], a[8:11], a[80:83], v[52:55]
ds_read_b128 a[68:71], v0 offset:4096
v_mfma_f32_16x16x32_bf16 v[56:59], a[8:11], a[84:87], v[56:59]
ds_read_b64_tr_b16 a[44:45], v2 offset:16480
v_mfma_f32_16x16x32_bf16 v[60:63], a[8:11], a[88:91], v[60:63]
ds_read_b64_tr_b16 a[46:47], v2 offset:20064
s_waitcnt lgkmcnt(15)
v_mfma_f32_16x16x32_bf16 v[64:67], a[12:15], a[76:79], v[64:67]
ds_read_b128 a[72:75], v0 offset:6144
v_mfma_f32_16x16x32_bf16 v[68:71], a[12:15], a[80:83], v[68:71]
ds_read_b64_tr_b16 a[48:49], v2 offset:16512
s_add_u32 m0, s55, 131072
v_mfma_f32_16x16x32_bf16 v[72:75], a[12:15], a[84:87], v[72:75]
ds_read_b64_tr_b16 a[50:51], v2 offset:20096
s_add_u32 s3, s20, 0
v_mfma_f32_16x16x32_bf16 v[76:79], a[12:15], a[88:91], v[76:79]
buffer_load_dwordx4 v3, s[8:11], s3 offen offset:0 lds
v_mfma_f32_16x16x32_bf16 v[80:83], a[16:19], a[76:79], v[80:83]
ds_read_b64_tr_b16 a[52:53], v2 offset:16544
v_mfma_f32_16x16x32_bf16 v[84:87], a[16:19], a[80:83], v[84:87]
ds_read_b64_tr_b16 a[54:55], v2 offset:20128
v_mfma_f32_16x16x32_bf16 v[88:91], a[16:19], a[84:87], v[88:91]
v_mfma_f32_16x16x32_bf16 v[92:95], a[16:19], a[88:91], v[92:95]
ds_read_b64_tr_b16 a[56:57], v2 offset:16576
v_mfma_f32_16x16x32_bf16 v[96:99], a[20:23], a[76:79], v[96:99]
ds_read_b64_tr_b16 a[58:59], v2 offset:20160
s_add_u32 s3, s20, 15360
v_mfma_f32_16x16x32_bf16 v[100:103], a[20:23], a[80:83], v[100:103]
buffer_load_dwordx4 v13, s[8:11], s3 offen offset:1024 lds
v_mfma_f32_16x16x32_bf16 v[104:107], a[20:23], a[84:87], v[104:107]
v_accvgpr_write_b32 a114, 0
v_mfma_f32_16x16x32_bf16 v[108:111], a[20:23], a[88:91], v[108:111]
v_accvgpr_write_b32 a115, 0
s_waitcnt lgkmcnt(15)
v_mfma_f32_16x16x32_bf16 v[112:115], a[24:27], a[76:79], v[112:115]
v_accvgpr_write_b32 a118, 0
v_mfma_f32_16x16x32_bf16 v[116:119], a[24:27], a[80:83], v[116:119]
v_accvgpr_write_b32 a119, 0
v_mfma_f32_16x16x32_bf16 v[120:123], a[24:27], a[84:87], v[120:123]
s_add_u32 s3, s20, 30720
v_accvgpr_write_b32 a122, 0
v_mfma_f32_16x16x32_bf16 v[124:127], a[24:27], a[88:91], v[124:127]
buffer_load_dwordx4 v3, s[8:11], s3 offen offset:2048 lds
v_accvgpr_write_b32 a123, 0
v_mfma_f32_16x16x32_bf16 v[128:131], a[28:31], a[76:79], v[128:131]
v_accvgpr_write_b32 a126, 0
v_mfma_f32_16x16x32_bf16 v[132:135], a[28:31], a[80:83], v[132:135]
v_accvgpr_write_b32 a127, 0
v_mfma_f32_16x16x32_bf16 v[136:139], a[28:31], a[84:87], v[136:139]
v_mfma_f32_16x16x32_bf16 v[140:143], a[28:31], a[88:91], v[140:143]
v_mfma_f32_16x16x32_bf16 v[144:147], a[32:35], a[76:79], v[144:147]
s_add_u32 s3, s20, 46080
v_mfma_f32_16x16x32_bf16 v[148:151], a[32:35], a[80:83], v[148:151]
buffer_load_dwordx4 v13, s[8:11], s3 offen offset:3072 lds
v_mfma_f32_16x16x32_bf16 v[152:155], a[32:35], a[84:87], v[152:155]
v_mfma_f32_16x16x32_bf16 v[156:159], a[32:35], a[88:91], v[156:159]
s_waitcnt lgkmcnt(7)
v_mfma_f32_16x16x32_bf16 v[160:163], a[36:39], a[76:79], v[160:163]
s_waitcnt vmcnt(21) lgkmcnt(0)
s_barrier
v_mfma_f32_16x16x32_bf16 v[164:167], a[36:39], a[80:83], v[164:167]
ds_read_b64_tr_b16 a[0:1], v1 offset:32768
v_mfma_f32_16x16x32_bf16 v[168:171], a[36:39], a[84:87], v[168:171]
ds_read_b64_tr_b16 a[2:3], v1 offset:37376
v_mfma_f32_16x16x32_bf16 v[172:175], a[36:39], a[88:91], v[172:175]
s_add_u32 m0, s25, 16384
v_mfma_f32_16x16x32_bf16 v[176:179], a[40:43], a[76:79], v[176:179]
ds_read_b64_tr_b16 a[4:5], v1 offset:32800
v_mfma_f32_16x16x32_bf16 v[180:183], a[40:43], a[80:83], v[180:183]
ds_read_b64_tr_b16 a[6:7], v1 offset:37408
v_mfma_f32_16x16x32_bf16 v[184:187], a[40:43], a[84:87], v[184:187]
buffer_load_dwordx4 v4, s[12:15], s21 offen offset:0 lds
v_mfma_f32_16x16x32_bf16 v[188:191], a[40:43], a[88:91], v[188:191]
ds_read_b64_tr_b16 a[8:9], v1 offset:32832
v_mfma_f32_16x16x32_bf16 v[192:195], a[44:47], a[76:79], v[192:195]
ds_read_b64_tr_b16 a[10:11], v1 offset:37440
v_mfma_f32_16x16x32_bf16 v[196:199], a[44:47], a[80:83], v[196:199]
v_mfma_f32_16x16x32_bf16 v[200:203], a[44:47], a[84:87], v[200:203]
ds_read_b64_tr_b16 a[12:13], v1 offset:32864
v_mfma_f32_16x16x32_bf16 v[204:207], a[44:47], a[88:91], v[204:207]
ds_read_b64_tr_b16 a[14:15], v1 offset:37472
v_mfma_f32_16x16x32_bf16 v[208:211], a[48:51], a[76:79], v[208:211]
buffer_load_dwordx4 v5, s[16:19], s22 offen offset:1024 lds
v_mfma_f32_16x16x32_bf16 v[212:215], a[48:51], a[80:83], v[212:215]
ds_read_b64_tr_b16 a[16:17], v1 offset:32896
v_mfma_f32_16x16x32_bf16 v[216:219], a[48:51], a[84:87], v[216:219]
ds_read_b64_tr_b16 a[18:19], v1 offset:37504
v_mfma_f32_16x16x32_bf16 v[220:223], a[48:51], a[88:91], v[220:223]
v_mfma_f32_16x16x32_bf16 v[224:227], a[52:55], a[76:79], v[224:227]
ds_read_b64_tr_b16 a[20:21], v1 offset:32928
v_mfma_f32_16x16x32_bf16 v[228:231], a[52:55], a[80:83], v[228:231]
ds_read_b64_tr_b16 a[22:23], v1 offset:37536
v_mfma_f32_16x16x32_bf16 v[232:235], a[52:55], a[84:87], v[232:235]
buffer_load_dwordx4 v6, s[16:19], s22 offen offset:2048 lds
v_mfma_f32_16x16x32_bf16 v[236:239], a[52:55], a[88:91], v[236:239]
ds_read_b64_tr_b16 a[24:25], v1 offset:32960
v_mfma_f32_16x16x32_bf16 v[240:243], a[56:59], a[76:79], v[240:243]
ds_read_b64_tr_b16 a[26:27], v1 offset:37568
v_mfma_f32_16x16x32_bf16 v[244:247], a[56:59], a[80:83], v[244:247]
v_mfma_f32_16x16x32_bf16 v[248:251], a[56:59], a[84:87], v[248:251]
ds_read_b64_tr_b16 a[28:29], v1 offset:32992
v_mfma_f32_16x16x32_bf16 v[252:255], a[56:59], a[88:91], v[252:255]
ds_read_b64_tr_b16 a[30:31], v1 offset:37600
L_gs22:
s_waitcnt lgkmcnt(10)
v_mfma_f32_16x16x32_bf16 v[16:19], a[0:3], a[60:63], v[16:19]
buffer_load_dwordx4 v7, s[16:19], s22 offen offset:3072 lds
v_mfma_f32_16x16x32_bf16 v[20:23], a[0:3], a[64:67], v[20:23]
ds_read_b64_tr_b16 a[32:33], v2 offset:32768
v_mfma_f32_16x16x32_bf16 v[24:27], a[0:3], a[68:71], v[24:27]
ds_read_b64_tr_b16 a[34:35], v2 offset:36352
v_mfma_f32_16x16x32_bf16 v[28:31], a[0:3], a[72:75], v[28:31]
ds_read_b128 a[76:79], v12 offset:0
v_mfma_f32_16x16x32_bf16 v[32:35], a[4:7], a[60:63], v[32:35]
ds_read_b64_tr_b16 a[36:37], v2 offset:32800
v_mfma_f32_16x16x32_bf16 v[36:39], a[4:7], a[64:67], v[36:39]
ds_read_b64_tr_b16 a[38:39], v2 offset:36384
v_mfma_f32_16x16x32_bf16 v[40:43], a[4:7], a[68:71], v[40:43]
s_add_u32 s21, s21, s23
s_add_u32 s22, s22, s24
ds_read_b128 a[80:83], v12 offset:2048
v_mfma_f32_16x16x32_bf16 v[44:47], a[4:7], a[72:75], v[44:47]
ds_read_b64_tr_b16 a[40:41], v2 offset:32832
v_mfma_f32_16x16x32_bf16 v[48:51], a[8:11], a[60:63], v[48:51]
ds_read_b64_tr_b16 a[42:43], v2 offset:36416
v_mfma_f32_16x16x32_bf16 v[52:55], a[8:11], a[64:67], v[52:55]
ds_read_b128 a[84:87], v12 offset:4096
v_mfma_f32_16x16x32_bf16 v[56:59], a[8:11], a[68:71], v[56:59]
ds_read_b64_tr_b16 a[44:45], v2 offset:32864
v_mfma_f32_16x16x32_bf16 v[60:63], a[8:11], a[72:75], v[60:63]
ds_read_b64_tr_b16 a[46:47], v2 offset:36448
s_waitcnt lgkmcnt(15)
v_mfma_f32_16x16x32_bf16 v[64:67], a[12:15], a[60:63], v[64:67]
ds_read_b128 a[88:91], v12 offset:6144
v_mfma_f32_16x16x32_bf16 v[68:71], a[12:15], a[64:67], v[68:71]
ds_read_b64_tr_b16 a[48:49], v2 offset:32896
s_add_u32 m0, s55, 135168
v_mfma_f32_16x16x32_bf16 v[72:75], a[12:15], a[68:71], v[72:75]
ds_read_b64_tr_b16 a[50:51], v2 offset:36480
s_add_u32 s3, s20, 65536
v_mfma_f32_16x16x32_bf16 v[76:79], a[12:15], a[72:75], v[76:79]
buffer_load_dwordx4 v3, s[8:11], s3 offen offset:0 lds
v_mfma_f32_16x16x32_bf16 v[80:83], a[16:19], a[60:63], v[80:83]
ds_read_b64_tr_b16 a[52:53], v2 offset:32928
v_mfma_f32_16x16x32_bf16 v[84:87], a[16:19], a[64:67], v[84:87]
ds_read_b64_tr_b16 a[54:55], v2 offset:36512
v_mfma_f32_16x16x32_bf16 v[88:91], a[16:19], a[68:71], v[88:91]
v_mfma_f32_16x16x32_bf16 v[92:95], a[16:19], a[72:75], v[92:95]
ds_read_b64_tr_b16 a[56:57], v2 offset:32960
v_mfma_f32_16x16x32_bf16 v[96:99], a[20:23], a[60:63], v[96:99]
ds_read_b64_tr_b16 a[58:59], v2 offset:36544
s_add_u32 s3, s20, 80896
v_mfma_f32_16x16x32_bf16 v[100:103], a[20:23], a[64:67], v[100:103]
buffer_load_dwordx4 v13, s[8:11], s3 offen offset:1024 lds
v_mfma_f32_16x16x32_bf16 v[104:107], a[20:23], a[68:71], v[104:107]
v_accvgpr_write_b32 a130, 0
v_mfma_f32_16x16x32_bf16 v[108:111], a[20:23], a[72:75], v[108:111]
v_accvgpr_write_b32 a131, 0
s_waitcnt lgkmcnt(15)
v_mfma_f32_16x16x32_bf16 v[112:115], a[24:27], a[60:63], v[112:115]
v_accvgpr_write_b32 a134, 0
v_mfma_f32_16x16x32_bf16 v[116:119], a[24:27], a[64:67], v[116:119]
v_accvgpr_write_b32 a135, 0
v_mfma_f32_16x16x32_bf16 v[120:123], a[24:27], a[68:71], v[120:123]
s_add_u32 s3, s20, 96256
v_accvgpr_write_b32 a138, 0
v_mfma_f32_16x16x32_bf16 v[124:127], a[24:27], a[72:75], v[124:127]
buffer_load_dwordx4 v3, s[8:11], s3 offen offset:2048 lds
v_accvgpr_write_b32 a139, 0
v_mfma_f32_16x16x32_bf16 v[128:131], a[28:31], a[60:63], v[128:131]
v_accvgpr_write_b32 a142, 0
v_mfma_f32_16x16x32_bf16 v[132:135], a[28:31], a[64:67], v[132:135]
v_accvgpr_write_b32 a143, 0
v_mfma_f32_16x16x32_bf16 v[136:139], a[28:31], a[68:71], v[136:139]
v_mfma_f32_16x16x32_bf16 v[140:143], a[28:31], a[72:75], v[140:143]
v_mfma_f32_16x16x32_bf16 v[144:147], a[32:35], a[60:63], v[144:147]
s_add_u32 s3, s20, 111616
v_mfma_f32_16x16x32_bf16 v[148:151], a[32:35], a[64:67], v[148:151]
buffer_load_dwordx4 v13, s[8:11], s3 offen offset:3072 lds
s_add_u32 s20, s20, 128
v_mfma_f32_16x16x32_bf16 v[152:155], a[32:35], a[68:71], v[152:155]
v_mfma_f32_16x16x32_bf16 v[156:159], a[32:35], a[72:75], v[156:159]
s_waitcnt lgkmcnt(7)
v_mfma_f32_16x16x32_bf16 v[160:163], a[36:39], a[60:63], v[160:163]
s_waitcnt vmcnt(21) lgkmcnt(0)
s_barrier
v_mfma_f32_16x16x32_bf16 v[164:167], a[36:39], a[64:67], v[164:167]
ds_read_b64_tr_b16 a[0:1], v1 offset:49152
v_mfma_f32_16x16x32_bf16 v[168:171], a[36:39], a[68:71], v[168:171]
ds_read_b64_tr_b16 a[2:3], v1 offset:53760
v_mfma_f32_16x16x32_bf16 v[172:175], a[36:39], a[72:75], v[172:175]
s_add_u32 m0, s25, 32768
v_mfma_f32_16x16x32_bf16 v[176:179], a[40:43], a[60:63], v[176:179]
ds_read_b64_tr_b16 a[4:5], v1 offset:49184
v_mfma_f32_16x16x32_bf16 v[180:183], a[40:43], a[64:67], v[180:183]
ds_read_b64_tr_b16 a[6:7], v1 offset:53792
v_mfma_f32_16x16x32_bf16 v[184:187], a[40:43], a[68:71], v[184:187]
buffer_load_dwordx4 v4, s[12:15], s21 offen offset:0 lds
v_mfma_f32_16x16x32_bf16 v[188:191], a[40:43], a[72:75], v[188:191]
ds_read_b64_tr_b16 a[8:9], v1 offset:49216
v_mfma_f32_16x16x32_bf16 v[192:195], a[44:47], a[60:63], v[192:195]
ds_read_b64_tr_b16 a[10:11], v1 offset:53824
v_mfma_f32_16x16x32_bf16 v[196:199], a[44:47], a[64:67], v[196:199]
v_mfma_f32_16x16x32_bf16 v[200:203], a[44:47], a[68:71], v[200:203]
ds_read_b64_tr_b16 a[12:13], v1 offset:49248
v_mfma_f32_16x16x32_bf16 v[204:207], a[44:47], a[72:75], v[204:207]
ds_read_b64_tr_b16 a[14:15], v1 offset:53856
v_mfma_f32_16x16x32_bf16 v[208:211], a[48:51], a[60:63], v[208:211]
buffer_load_dwordx4 v5, s[16:19], s22 offen offset:1024 lds
v_mfma_f32_16x16x32_bf16 v[212:215], a[48:51], a[64:67], v[212:215]
ds_read_b64_tr_b16 a[16:17], v1 offset:49280
v_mfma_f32_16x16x32_bf16 v[216:219], a[48:51], a[68:71], v[216:219]
ds_read_b64_tr_b16 a[18:19], v1 offset:53888
v_mfma_f32_16x16x32_bf16 v[220:223], a[48:51], a[72:75], v[220:223]
v_mfma_f32_16x16x32_bf16 v[224:227], a[52:55], a[60:63], v[224:227]
ds_read_b64_tr_b16 a[20:21], v1 offset:49312
v_mfma_f32_16x16x32_bf16 v[228:231], a[52:55], a[64:67], v[228:231]
ds_read_b64_tr_b16 a[22:23], v1 offset:53920
v_mfma_f32_16x16x32_bf16 v[232:235], a[52:55], a[68:71], v[232:235]
buffer_load_dwordx4 v6, s[16:19], s22 offen offset:2048 lds
v_mfma_f32_16x16x32_bf16 v[236:239], a[52:55], a[72:75], v[236:239]
ds_read_b64_tr_b16 a[24:25], v1 offset:49344
v_mfma_f32_16x16x32_bf16 v[240:243], a[56:59], a[60:63], v[240:243]
ds_read_b64_tr_b16 a[26:27], v1 offset:53952
v_mfma_f32_16x16x32_bf16 v[244:247], a[56:59], a[64:67], v[244:247]
v_mfma_f32_16x16x32_bf16 v[248:251], a[56:59], a[68:71], v[248:251]
ds_read_b64_tr_b16 a[28:29], v1 offset:49376
v_mfma_f32_16x16x32_bf16 v[252:255], a[56:59], a[72:75], v[252:255]
ds_read_b64_tr_b16 a[30:31], v1 offset:53984
s_waitcnt lgkmcnt(10)
v_mfma_f32_16x16x32_bf16 v[16:19], a[0:3], a[76:79], v[16:19]
buffer_load_dwordx4 v7, s[16:19], s22 offen offset:3072 lds
v_mfma_f32_16x16x32_bf16 v[20:23], a[0:3], a[80:83], v[20:23]
ds_read_b64_tr_b16 a[32:33], v2 offset:49152
v_subrev_u32 v15, 32768, v0
v_mfma_f32_16x16x32_bf16 v[24:27], a[0:3], a[84:87], v[24:27]
ds_read_b64_tr_b16 a[34:35], v2 offset:52736
s_waitcnt vmcnt(20)
v_mfma_f32_16x16x32_bf16 v[28:31], a[0:3], a[88:91], v[28:31]
ds_read_b128 a[60:63], v15 offset:0
v_mfma_f32_16x16x32_bf16 v[32:35], a[4:7], a[76:79], v[32:35]
ds_read_b64_tr_b16 a[36:37], v2 offset:49184
v_mfma_f32_16x16x32_bf16 v[36:39], a[4:7], a[80:83], v[36:39]
ds_read_b64_tr_b16 a[38:39], v2 offset:52768
v_mfma_f32_16x16x32_bf16 v[40:43], a[4:7], a[84:87], v[40:43]
s_add_u32 s21, s21, s23
s_add_u32 s22, s22, s24
ds_read_b128 a[64:67], v15 offset:2048
v_mfma_f32_16x16x32_bf16 v[44:47], a[4:7], a[88:91], v[44:47]
ds_read_b64_tr_b16 a[40:41], v2 offset:49216
v_mfma_f32_16x16x32_bf16 v[48:51], a[8:11], a[76:79], v[48:51]
ds_read_b64_tr_b16 a[42:43], v2 offset:52800
v_mfma_f32_16x16x32_bf16 v[52:55], a[8:11], a[80:83], v[52:55]
ds_read_b128 a[68:71], v15 offset:4096
v_mfma_f32_16x16x32_bf16 v[56:59], a[8:11], a[84:87], v[56:59]
ds_read_b64_tr_b16 a[44:45], v2 offset:49248
v_mfma_f32_16x16x32_bf16 v[60:63], a[8:11], a[88:91], v[60:63]
ds_read_b64_tr_b16 a[46:47], v2 offset:52832
s_waitcnt lgkmcnt(15)
v_mfma_f32_16x16x32_bf16 v[64:67], a[12:15], a[76:79], v[64:67]
ds_read_b128 a[72:75], v15 offset:6144
v_mfma_f32_16x16x32_bf16 v[68:71], a[12:15], a[80:83], v[68:71]
ds_read_b64_tr_b16 a[48:49], v2 offset:49280
s_add_u32 m0, s55, 98304
v_mfma_f32_16x16x32_bf16 v[72:75], a[12:15], a[84:87], v[72:75]
ds_read_b64_tr_b16 a[50:51], v2 offset:52864
s_add_u32 s3, s20, 0
v_mfma_f32_16x16x32_bf16 v[76:79], a[12:15], a[88:91], v[76:79]
buffer_load_dwordx4 v3, s[8:11], s3 offen offset:0 lds
v_mfma_f32_16x16x32_bf16 v[80:83], a[16:19], a[76:79], v[80:83]
ds_read_b64_tr_b16 a[52:53], v2 offset:49312
v_mfma_f32_16x16x32_bf16 v[84:87], a[16:19], a[80:83], v[84:87]
ds_read_b64_tr_b16 a[54:55], v2 offset:52896
v_mfma_f32_16x16x32_bf16 v[88:91], a[16:19], a[84:87], v[88:91]
v_mfma_f32_16x16x32_bf16 v[92:95], a[16:19], a[88:91], v[92:95]
ds_read_b64_tr_b16 a[56:57], v2 offset:49344
v_mfma_f32_16x16x32_bf16 v[96:99], a[20:23], a[76:79], v[96:99]
ds_read_b64_tr_b16 a[58:59], v2 offset:52928
s_add_u32 s3, s20, 15360
v_mfma_f32_16x16x32_bf16 v[100:103], a[20:23], a[80:83], v[100:103]
buffer_load_dwordx4 v13, s[8:11], s3 offen offset:1024 lds
v_mfma_f32_16x16x32_bf16 v[104:107], a[20:23], a[84:87], v[104:107]
v_accvgpr_write_b32 a146, 0
v_mfma_f32_16x16x32_bf16 v[108:111], a[20:23], a[88:91], v[108:111]
v_accvgpr_read_b32 v14, a197
v_accvgpr_write_b32 a147, 0
s_waitcnt lgkmcnt(15)
v_mfma_f32_16x16x32_bf16 v[112:115], a[24:27], a[76:79], v[112:115]
v_accvgpr_read_b32 v15, a196
v_accvgpr_write_b32 a150, 0
v_mfma_f32_16x16x32_bf16 v[116:119], a[24:27], a[80:83], v[116:119]
v_and_b32 v14, v14, v15
v_accvgpr_write_b32 a151, 0
v_mfma_f32_16x16x32_bf16 v[120:123], a[24:27], a[84:87], v[120:123]
s_add_u32 s3, s20, 30720
v_cmp_ne_u32 vcc, v14, v15
v_accvgpr_write_b32 a154, 0
v_mfma_f32_16x16x32_bf16 v[124:127], a[24:27], a[88:91], v[124:127]
buffer_load_dwordx4 v3, s[8:11], s3 offen offset:2048 lds
v_accvgpr_write_b32 a155, 0
v_mfma_f32_16x16x32_bf16 v[128:131], a[28:31], a[76:79], v[128:131]
v_mfma_f32_16x16x32_bf16 v[132:135], a[28:31], a[80:83], v[132:135]
s_cbranch_vccnz L_lnpoll
L_lnpoll_ret:
v_mfma_f32_16x16x32_bf16 v[136:139], a[28:31], a[84:87], v[136:139]
v_mfma_f32_16x16x32_bf16 v[140:143], a[28:31], a[88:91], v[140:143]
v_accvgpr_read_b32 v14, a199
v_mfma_f32_16x16x32_bf16 v[144:147], a[32:35], a[76:79], v[144:147]
s_add_u32 s3, s20, 46080
v_mfma_f32_16x16x32_bf16 v[148:151], a[32:35], a[80:83], v[148:151]
buffer_load_dwordx4 v13, s[8:11], s3 offen offset:3072 lds
v_mfma_f32_16x16x32_bf16 v[152:155], a[32:35], a[84:87], v[152:155]
s_mov_b32 s3, 0
v_mfma_f32_16x16x32_bf16 v[156:159], a[32:35], a[88:91], v[156:159]
buffer_load_dword a168, v14, s[60:63], s3 offen offset:0 sc1
s_waitcnt lgkmcnt(7)
v_mfma_f32_16x16x32_bf16 v[160:163], a[36:39], a[76:79], v[160:163]
s_waitcnt vmcnt(21) lgkmcnt(0)
s_barrier
v_mfma_f32_16x16x32_bf16 v[164:167], a[36:39], a[80:83], v[164:167]
ds_read_b64_tr_b16 a[0:1], v1 offset:0
v_mfma_f32_16x16x32_bf16 v[168:171], a[36:39], a[84:87], v[168:171]
ds_read_b64_tr_b16 a[2:3], v1 offset:4608
s_mov_b32 s3, 0
v_mfma_f32_16x16x32_bf16 v[172:175], a[36:39], a[88:91], v[172:175]
s_add_u32 m0, s25, 49152
buffer_load_dword a169, v14, s[60:63], s3 offen offset:1024 sc1
v_mfma_f32_16x16x32_bf16 v[176:179], a[40:43], a[76:79], v[176:179]
ds_read_b64_tr_b16 a[4:5], v1 offset:32
v_mfma_f32_16x16x32_bf16 v[180:183], a[40:43], a[80:83], v[180:183]
ds_read_b64_tr_b16 a[6:7], v1 offset:4640
v_mfma_f32_16x16x32_bf16 v[184:187], a[40:43], a[84:87], v[184:187]
buffer_load_dwordx4 v4, s[12:15], s21 offen offset:0 lds
v_mfma_f32_16x16x32_bf16 v[188:191], a[40:43], a[88:91], v[188:191]
ds_read_b64_tr_b16 a[8:9], v1 offset:64
v_mfma_f32_16x16x32_bf16 v[192:195], a[44:47], a[76:79], v[192:195]
ds_read_b64_tr_b16 a[10:11], v1 offset:4672
v_mfma_f32_16x16x32_bf16 v[196:199], a[44:47], a[80:83], v[196:199]
v_mfma_f32_16x16x32_bf16 v[200:203], a[44:47], a[84:87], v[200:203]
ds_read_b64_tr_b16 a[12:13], v1 offset:96
v_mfma_f32_16x16x32_bf16 v[204:207], a[44:47], a[88:91], v[204:207]
ds_read_b64_tr_b16 a[14:15], v1 offset:4704
v_mfma_f32_16x16x32_bf16 v[208:211], a[48:51], a[76:79], v[208:211]
buffer_load_dwordx4 v5, s[16:19], s22 offen offset:1024 lds
v_mfma_f32_16x16x32_bf16 v[212:215], a[48:51], a[80:83], v[212:215]
ds_read_b64_tr_b16 a[16:17], v1 offset:128
v_mfma_f32_16x16x32_bf16 v[216:219], a[48:51], a[84:87], v[216:219]
ds_read_b64_tr_b16 a[18:19], v1 offset:4736
v_mfma_f32_16x16x32_bf16 v[220:223], a[48:51], a[88:91], v[220:223]
v_mfma_f32_16x16x32_bf16 v[224:227], a[52:55], a[76:79], v[224:227]
ds_read_b64_tr_b16 a[20:21], v1 offset:160
v_mfma_f32_16x16x32_bf16 v[228:231], a[52:55], a[80:83], v[228:231]
ds_read_b64_tr_b16 a[22:23], v1 offset:4768
v_mfma_f32_16x16x32_bf16 v[232:235], a[52:55], a[84:87], v[232:235]
buffer_load_dwordx4 v6, s[16:19], s22 offen offset:2048 lds
v_mfma_f32_16x16x32_bf16 v[236:239], a[52:55], a[88:91], v[236:239]
ds_read_b64_tr_b16 a[24:25], v1 offset:192
v_mfma_f32_16x16x32_bf16 v[240:243], a[56:59], a[76:79], v[240:243]
ds_read_b64_tr_b16 a[26:27], v1 offset:4800
v_mfma_f32_16x16x32_bf16 v[244:247], a[56:59], a[80:83], v[244:247]
v_mfma_f32_16x16x32_bf16 v[248:251], a[56:59], a[84:87], v[248:251]
ds_read_b64_tr_b16 a[28:29], v1 offset:224
v_mfma_f32_16x16x32_bf16 v[252:255], a[56:59], a[88:91], v[252:255]
ds_read_b64_tr_b16 a[30:31], v1 offset:4832
s_waitcnt lgkmcnt(10)
v_mfma_f32_16x16x32_bf16 v[16:19], a[0:3], a[60:63], v[16:19]
buffer_load_dwordx4 v7, s[16:19], s22 offen offset:3072 lds
v_mfma_f32_16x16x32_bf16 v[20:23], a[0:3], a[64:67], v[20:23]
ds_read_b64_tr_b16 a[32:33], v2 offset:0
v_subrev_u32 v15, 32768, v12
v_mfma_f32_16x16x32_bf16 v[24:27], a[0:3], a[68:71], v[24:27]
ds_read_b64_tr_b16 a[34:35], v2 offset:3584
v_mfma_f32_16x16x32_bf16 v[28:31], a[0:3], a[72:75], v[28:31]
ds_read_b128 a[76:79], v15 offset:0
v_mfma_f32_16x16x32_bf16 v[32:35], a[4:7], a[60:63], v[32:35]
ds_read_b64_tr_b16 a[36:37], v2 offset:32
v_mfma_f32_16x16x32_bf16 v[36:39], a[4:7], a[64:67], v[36:39]
ds_read_b64_tr_b16 a[38:39], v2 offset:3616
v_mfma_f32_16x16x32_bf16 v[40:43], a[4:7], a[68:71], v[40:43]
s_add_u32 s21, s21, s23
s_add_u32 s22, s22, s24
ds_read_b128 a[80:83], v15 offset:2048
v_mfma_f32_16x16x32_bf16 v[44:47], a[4:7], a[72:75], v[44:47]
ds_read_b64_tr_b16 a[40:41], v2 offset:64
v_mfma_f32_16x16x32_bf16 v[48:51], a[8:11], a[60:63], v[48:51]
ds_read_b64_tr_b16 a[42:43], v2 offset:3648
v_mfma_f32_16x16x32_bf16 v[52:55], a[8:11], a[64:67], v[52:55]
ds_read_b128 a[84:87], v15 offset:4096
v_mfma_f32_16x16x32_bf16 v[56:59], a[8:11], a[68:71], v[56:59]
ds_read_b64_tr_b16 a[44:45], v2 offset:96
v_mfma_f32_16x16x32_bf16 v[60:63], a[8:11], a[72:75], v[60:63]
ds_read_b64_tr_b16 a[46:47], v2 offset:3680
s_waitcnt lgkmcnt(15)
v_mfma_f32_16x16x32_bf16 v[64:67], a[12:15], a[60:63], v[64:67]
ds_read_b128 a[88:91], v15 offset:6144
v_mfma_f32_16x16x32_bf16 v[68:71], a[12:15], a[64:67], v[68:71]
ds_read_b64_tr_b16 a[48:49], v2 offset:128
s_add_u32 m0, s55, 102400
v_mfma_f32_16x16x32_bf16 v[72:75], a[12:15], a[68:71], v[72:75]
ds_read_b64_tr_b16 a[50:51], v2 offset:3712
s_add_u32 s3, s20, 65536
v_mfma_f32_16x16x32_bf16 v[76:79], a[12:15], a[72:75], v[76:79]
buffer_load_dwordx4 v3, s[8:11], s3 offen offset:0 lds
v_mfma_f32_16x16x32_bf16 v[80:83], a[16:19], a[60:63], v[80:83]
ds_read_b64_tr_b16 a[52:53], v2 offset:160
v_mfma_f32_16x16x32_bf16 v[84:87], a[16:19], a[64:67], v[84:87]
ds_read_b64_tr_b16 a[54:55], v2 offset:3744
s_mov_b32 s3, 0
v_mfma_f32_16x16x32_bf16 v[88:91], a[16:19], a[68:71], v[88:91]
buffer_load_dword a170, v14, s[60:63], s3 offen offset:2048 sc1
v_mfma_f32_16x16x32_bf16 v[92:95], a[16:19], a[72:75], v[92:95]
ds_read_b64_tr_b16 a[56:57], v2 offset:192
v_mfma_f32_16x16x32_bf16 v[96:99], a[20:23], a[60:63], v[96:99]
ds_read_b64_tr_b16 a[58:59], v2 offset:3776
s_add_u32 s3, s20, 80896
v_mfma_f32_16x16x32_bf16 v[100:103], a[20:23], a[64:67], v[100:103]
buffer_load_dwordx4 v13, s[8:11], s3 offen offset:1024 lds
v_mfma_f32_16x16x32_bf16 v[104:107], a[20:23], a[68:71], v[104:107]
v_mfma_f32_16x16x32_bf16 v[108:111], a[20:23], a[72:75], v[108:111]
s_mov_b32 s3, 0
s_waitcnt lgkmcnt(15)
v_mfma_f32_16x16x32_bf16 v[112:115], a[24:27], a[60:63], v[112:115]
buffer_load_dword a171, v14, s[60:63], s3 offen offset:3072 sc1
v_mfma_f32_16x16x32_bf16 v[116:119], a[24:27], a[64:67], v[116:119]
v_mfma_f32_16x16x32_bf16 v[120:123], a[24:27], a[68:71], v[120:123]
s_add_u32 s3, s20, 96256
v_mfma_f32_16x16x32_bf16 v[124:127], a[24:27], a[72:75], v[124:127]
buffer_load_dwordx4 v3, s[8:11], s3 offen offset:2048 lds
v_mfma_f32_16x16x32_bf16 v[128:131], a[28:31], a[60:63], v[128:131]
v_mfma_f32_16x16x32_bf16 v[132:135], a[28:31], a[64:67], v[132:135]
s_mov_b32 s3, 4096
v_mfma_f32_16x16x32_bf16 v[136:139], a[28:31], a[68:71], v[136:139]
buffer_load_dword a172, v14, s[60:63], s3 offen offset:0 sc1
v_mfma_f32_16x16x32_bf16 v[140:143], a[28:31], a[72:75], v[140:143]
v_mfma_f32_16x16x32_bf16 v[144:147], a[32:35], a[60:63], v[144:147]
s_add_u32 s3, s20, 111616
v_mfma_f32_16x16x32_bf16 v[148:151], a[32:35], a[64:67], v[148:151]
buffer_load_dwordx4 v13, s[8:11], s3 offen offset:3072 lds
s_add_u32 s20, s20, 128
v_mfma_f32_16x16x32_bf16 v[152:155], a[32:35], a[68:71], v[152:155]
v_mfma_f32_16x16x32_bf16 v[156:159], a[32:35], a[72:75], v[156:159]
s_waitcnt lgkmcnt(7)
v_mfma_f32_16x16x32_bf16 v[160:163], a[36:39], a[60:63], v[160:163]
s_waitcnt vmcnt(25) lgkmcnt(0)
s_barrier
v_mfma_f32_16x16x32_bf16 v[164:167], a[36:39], a[64:67], v[164:167]
ds_read_b64_tr_b16 a[0:1], v1 offset:16384
v_mfma_f32_16x16x32_bf16 v[168:171], a[36:39], a[68:71], v[168:171]
ds_read_b64_tr_b16 a[2:3], v1 offset:20992
s_mov_b32 s3, 4096
v_mfma_f32_16x16x32_bf16 v[172:175], a[36:39], a[72:75], v[172:175]
s_add_u32 m0, s25, 0
buffer_load_dword a173, v14, s[60:63], s3 offen offset:1024 sc1
v_mfma_f32_16x16x32_bf16 v[176:179], a[40:43], a[60:63], v[176:179]
ds_read_b64_tr_b16 a[4:5], v1 offset:16416
v_mfma_f32_16x16x32_bf16 v[180:183], a[40:43], a[64:67], v[180:183]
ds_read_b64_tr_b16 a[6:7], v1 offset:21024
v_mfma_f32_16x16x32_bf16 v[184:187], a[40:43], a[68:71], v[184:187]
buffer_load_dwordx4 v4, s[12:15], s21 offen offset:0 lds
v_mfma_f32_16x16x32_bf16 v[188:191], a[40:43], a[72:75], v[188:191]
ds_read_b64_tr_b16 a[8:9], v1 offset:16448
v_mfma_f32_16x16x32_bf16 v[192:195], a[44:47], a[60:63], v[192:195]
ds_read_b64_tr_b16 a[10:11], v1 offset:21056
v_mfma_f32_16x16x32_bf16 v[196:199], a[44:47], a[64:67], v[196:199]
v_mfma_f32_16x16x32_bf16 v[200:203], a[44:47], a[68:71], v[200:203]
ds_read_b64_tr_b16 a[12:13], v1 offset:16480
v_mfma_f32_16x16x32_bf16 v[204:207], a[44:47], a[72:75], v[204:207]
ds_read_b64_tr_b16 a[14:15], v1 offset:21088
v_mfma_f32_16x16x32_bf16 v[208:211], a[48:51], a[60:63], v[208:211]
buffer_load_dwordx4 v5, s[16:19], s22 offen offset:1024 lds
v_mfma_f32_16x16x32_bf16 v[212:215], a[48:51], a[64:67], v[212:215]
ds_read_b64_tr_b16 a[16:17], v1 offset:16512
v_mfma_f32_16x16x32_bf16 v[216:219], a[48:51], a[68:71], v[216:219]
ds_read_b64_tr_b16 a[18:19], v1 offset:21120
v_mfma_f32_16x16x32_bf16 v[220:223], a[48:51], a[72:75], v[220:223]
v_mfma_f32_16x16x32_bf16 v[224:227], a[52:55], a[60:63], v[224:227]
ds_read_b64_tr_b16 a[20:21], v1 offset:16544
v_mfma_f32_16x16x32_bf16 v[228:231], a[52:55], a[64:67], v[228:231]
ds_read_b64_tr_b16 a[22:23], v1 offset:21152
v_mfma_f32_16x16x32_bf16 v[232:235], a[52:55], a[68:71], v[232:235]
buffer_load_dwordx4 v6, s[16:19], s22 offen offset:2048 lds
v_mfma_f32_16x16x32_bf16 v[236:239], a[52:55], a[72:75], v[236:239]
ds_read_b64_tr_b16 a[24:25], v1 offset:16576
v_mfma_f32_16x16x32_bf16 v[240:243], a[56:59], a[60:63], v[240:243]
ds_read_b64_tr_b16 a[26:27], v1 offset:21184
v_mfma_f32_16x16x32_bf16 v[244:247], a[56:59], a[64:67], v[244:247]
v_mfma_f32_16x16x32_bf16 v[248:251], a[56:59], a[68:71], v[248:251]
ds_read_b64_tr_b16 a[28:29], v1 offset:16608
v_mfma_f32_16x16x32_bf16 v[252:255], a[56:59], a[72:75], v[252:255]
ds_read_b64_tr_b16 a[30:31], v1 offset:21216
s_waitcnt lgkmcnt(10)
v_mfma_f32_16x16x32_bf16 v[16:19], a[0:3], a[76:79], v[16:19]
buffer_load_dwordx4 v7, s[16:19], s22 offen offset:3072 lds
v_mfma_f32_16x16x32_bf16 v[20:23], a[0:3], a[80:83], v[20:23]
ds_read_b64_tr_b16 a[32:33], v2 offset:16384
v_mfma_f32_16x16x32_bf16 v[24:27], a[0:3], a[84:87], v[24:27]
ds_read_b64_tr_b16 a[34:35], v2 offset:19968
s_waitcnt vmcnt(26)
v_mfma_f32_16x16x32_bf16 v[28:31], a[0:3], a[88:91], v[28:31]
ds_read_b128 a[60:63], v0 offset:32768
v_mfma_f32_16x16x32_bf16 v[32:35], a[4:7], a[76:79], v[32:35]
ds_read_b64_tr_b16 a[36:37], v2 offset:16416
v_mfma_f32_16x16x32_bf16 v[36:39], a[4:7], a[80:83], v[36:39]
ds_read_b64_tr_b16 a[38:39], v2 offset:20000
v_mfma_f32_16x16x32_bf16 v[40:43], a[4:7], a[84:87], v[40:43]
s_add_u32 s21, s21, s23
s_add_u32 s22, s22, s24
ds_read_b128 a[64:67], v0 offset:34816
v_mfma_f32_16x16x32_bf16 v[44:47], a[4:7], a[88:91], v[44:47]
ds_read_b64_tr_b16 a[40:41], v2 offset:16448
v_mfma_f32_16x16x32_bf16 v[48:51], a[8:11], a[76:79], v[48:51]
ds_read_b64_tr_b16 a[42:43], v2 offset:20032
v_mfma_f32_16x16x32_bf16 v[52:55], a[8:11], a[80:83], v[52:55]
ds_read_b128 a[68:71], v0 offset:36864
v_mfma_f32_16x16x32_bf16 v[56:59], a[8:11], a[84:87], v[56:59]
ds_read_b64_tr_b16 a[44:45], v2 offset:16480
v_mfma_f32_16x16x32_bf16 v[60:63], a[8:11], a[88:91], v[60:63]
ds_read_b64_tr_b16 a[46:47], v2 offset:20064
s_waitcnt lgkmcnt(15)
v_mfma_f32_16x16x32_bf16 v[64:67], a[12:15], a[76:79], v[64:67]
ds_read_b128 a[72:75], v0 offset:38912
v_mfma_f32_16x16x32_bf16 v[68:71], a[12:15], a[80:83], v[68:71]
ds_read_b64_tr_b16 a[48:49], v2 offset:16512
s_add_u32 m0, s55, 65536
v_mfma_f32_16x16x32_bf16 v[72:75], a[12:15], a[84:87], v[72:75]
ds_read_b64_tr_b16 a[50:51], v2 offset:20096
s_add_u32 s3, s20, 0
v_mfma_f32_16x16x32_bf16 v[76:79], a[12:15], a[88:91], v[76:79]
buffer_load_dwordx4 v3, s[8:11], s3 offen offset:0 lds
v_mfma_f32_16x16x32_bf16 v[80:83], a[16:19], a[76:79], v[80:83]
ds_read_b64_tr_b16 a[52:53], v2 offset:16544
v_mfma_f32_16x16x32_bf16 v[84:87], a[16:19], a[80:83], v[84:87]
ds_read_b64_tr_b16 a[54:55], v2 offset:20128
s_mov_b32 s3, 4096
v_mfma_f32_16x16x32_bf16 v[88:91], a[16:19], a[84:87], v[88:91]
buffer_load_dword a174, v14, s[60:63], s3 offen offset:2048 sc1
v_mfma_f32_16x16x32_bf16 v[92:95], a[16:19], a[88:91], v[92:95]
ds_read_b64_tr_b16 a[56:57], v2 offset:16576
v_mfma_f32_16x16x32_bf16 v[96:99], a[20:23], a[76:79], v[96:99]
ds_read_b64_tr_b16 a[58:59], v2 offset:20160
s_add_u32 s3, s20, 15360
v_mfma_f32_16x16x32_bf16 v[100:103], a[20:23], a[80:83], v[100:103]
buffer_load_dwordx4 v13, s[8:11], s3 offen offset:1024 lds
v_mfma_f32_16x16x32_bf16 v[104:107], a[20:23], a[84:87], v[104:107]
v_mfma_f32_16x16x32_bf16 v[108:111], a[20:23], a[88:91], v[108:111]
s_mov_b32 s3, 4096
s_waitcnt lgkmcnt(15)
v_mfma_f32_16x16x32_bf16 v[112:115], a[24:27], a[76:79], v[112:115]
buffer_load_dword a175, v14, s[60:63], s3 offen offset:3072 sc1
v_mfma_f32_16x16x32_bf16 v[116:119], a[24:27], a[80:83], v[116:119]
v_mfma_f32_16x16x32_bf16 v[120:123], a[24:27], a[84:87], v[120:123]
s_add_u32 s3, s20, 30720
v_mfma_f32_16x16x32_bf16 v[124:127], a[24:27], a[88:91], v[124:127]
buffer_load_dwordx4 v3, s[8:11], s3 offen offset:2048 lds
v_mfma_f32_16x16x32_bf16 v[128:131], a[28:31], a[76:79], v[128:131]
v_mfma_f32_16x16x32_bf16 v[132:135], a[28:31], a[80:83], v[132:135]
s_mov_b32 s3, 8192
v_mfma_f32_16x16x32_bf16 v[136:139], a[28:31], a[84:87], v[136:139]
buffer_load_dword a176, v14, s[60:63], s3 offen offset:0 sc1
v_mfma_f32_16x16x32_bf16 v[140:143], a[28:31], a[88:91], v[140:143]
v_mfma_f32_16x16x32_bf16 v[144:147], a[32:35], a[76:79], v[144:147]
s_add_u32 s3, s20, 46080
v_mfma_f32_16x16x32_bf16 v[148:151], a[32:35], a[80:83], v[148:151]
buffer_load_dwordx4 v13, s[8:11], s3 offen offset:3072 lds
v_mfma_f32_16x16x32_bf16 v[152:155], a[32:35], a[84:87], v[152:155]
v_mfma_f32_16x16x32_bf16 v[156:159], a[32:35], a[88:91], v[156:159]
s_waitcnt lgkmcnt(7)
v_mfma_f32_16x16x32_bf16 v[160:163], a[36:39], a[76:79], v[160:163]
s_waitcnt vmcnt(29) lgkmcnt(0)
s_barrier
v_mfma_f32_16x16x32_bf16 v[164:167], a[36:39], a[80:83], v[164:167]
ds_read_b64_tr_b16 a[0:1], v1 offset:32768
v_mfma_f32_16x16x32_bf16 v[168:171], a[36:39], a[84:87], v[168:171]
ds_read_b64_tr_b16 a[2:3], v1 offset:37376
s_mov_b32 s3, 8192
v_mfma_f32_16x16x32_bf16 v[172:175], a[36:39], a[88:91], v[172:175]
s_add_u32 m0, s25, 16384
buffer_load_dword a177, v14, s[60:63], s3 offen offset:1024 sc1
v_mfma_f32_16x16x32_bf16 v[176:179], a[40:43], a[76:79], v[176:179]
ds_read_b64_tr_b16 a[4:5], v1 offset:32800
v_mfma_f32_16x16x32_bf16 v[180:183], a[40:43], a[80:83], v[180:183]
ds_read_b64_tr_b16 a[6:7], v1 offset:37408
v_mfma_f32_16x16x32_bf16 v[184:187], a[40:43], a[84:87], v[184:187]
buffer_load_dwordx4 v4, s[12:15], s21 offen offset:0 lds
v_mfma_f32_16x16x32_bf16 v[188:191], a[40:43], a[88:91], v[188:191]
ds_read_b64_tr_b16 a[8:9], v1 offset:32832
v_mfma_f32_16x16x32_bf16 v[192:195], a[44:47], a[76:79], v[192:195]
ds_read_b64_tr_b16 a[10:11], v1 offset:37440
v_mfma_f32_16x16x32_bf16 v[196:199], a[44:47], a[80:83], v[196:199]
v_mfma_f32_16x16x32_bf16 v[200:203], a[44:47], a[84:87], v[200:203]
ds_read_b64_tr_b16 a[12:13], v1 offset:32864
v_mfma_f32_16x16x32_bf16 v[204:207], a[44:47], a[88:91], v[204:207]
ds_read_b64_tr_b16 a[14:15], v1 offset:37472
v_mfma_f32_16x16x32_bf16 v[208:211], a[48:51], a[76:79], v[208:211]
buffer_load_dwordx4 v5, s[16:19], s22 offen offset:1024 lds
v_mfma_f32_16x16x32_bf16 v[212:215], a[48:51], a[80:83], v[212:215]
ds_read_b64_tr_b16 a[16:17], v1 offset:32896
v_mfma_f32_16x16x32_bf16 v[216:219], a[48:51], a[84:87], v[216:219]
ds_read_b64_tr_b16 a[18:19], v1 offset:37504
v_mfma_f32_16x16x32_bf16 v[220:223], a[48:51], a[88:91], v[220:223]
v_mfma_f32_16x16x32_bf16 v[224:227], a[52:55], a[76:79], v[224:227]
ds_read_b64_tr_b16 a[20:21], v1 offset:32928
v_mfma_f32_16x16x32_bf16 v[228:231], a[52:55], a[80:83], v[228:231]
ds_read_b64_tr_b16 a[22:23], v1 offset:37536
v_mfma_f32_16x16x32_bf16 v[232:235], a[52:55], a[84:87], v[232:235]
buffer_load_dwordx4 v6, s[16:19], s22 offen offset:2048 lds
v_mfma_f32_16x16x32_bf16 v[236:239], a[52:55], a[88:91], v[236:239]
ds_read_b64_tr_b16 a[24:25], v1 offset:32960
v_mfma_f32_16x16x32_bf16 v[240:243], a[56:59], a[76:79], v[240:243]
ds_read_b64_tr_b16 a[26:27], v1 offset:37568
v_mfma_f32_16x16x32_bf16 v[244:247], a[56:59], a[80:83], v[244:247]
v_mfma_f32_16x16x32_bf16 v[248:251], a[56:59], a[84:87], v[248:251]
ds_read_b64_tr_b16 a[28:29], v1 offset:32992
v_mfma_f32_16x16x32_bf16 v[252:255], a[56:59], a[88:91], v[252:255]
ds_read_b64_tr_b16 a[30:31], v1 offset:37600
s_waitcnt lgkmcnt(10)
v_mfma_f32_16x16x32_bf16 v[16:19], a[0:3], a[60:63], v[16:19]
buffer_load_dwordx4 v7, s[16:19], s22 offen offset:3072 lds
v_mfma_f32_16x16x32_bf16 v[20:23], a[0:3], a[64:67], v[20:23]
ds_read_b64_tr_b16 a[32:33], v2 offset:32768
v_mfma_f32_16x16x32_bf16 v[24:27], a[0:3], a[68:71], v[24:27]
ds_read_b64_tr_b16 a[34:35], v2 offset:36352
v_mfma_f32_16x16x32_bf16 v[28:31], a[0:3], a[72:75], v[28:31]
ds_read_b128 a[76:79], v12 offset:32768
v_mfma_f32_16x16x32_bf16 v[32:35], a[4:7], a[60:63], v[32:35]
ds_read_b64_tr_b16 a[36:37], v2 offset:32800
v_mfma_f32_16x16x32_bf16 v[36:39], a[4:7], a[64:67], v[36:39]
ds_read_b64_tr_b16 a[38:39], v2 offset:36384
v_mfma_f32_16x16x32_bf16 v[40:43], a[4:7], a[68:71], v[40:43]
s_add_u32 s21, s21, s23
s_add_u32 s22, s22, s24
ds_read_b128 a[80:83], v12 offset:34816
v_mfma_f32_16x16x32_bf16 v[44:47], a[4:7], a[72:75], v[44:47]
ds_read_b64_tr_b16 a[40:41], v2 offset:32832
v_mfma_f32_16x16x32_bf16 v[48:51], a[8:11], a[60:63], v[48:51]
ds_read_b64_tr_b16 a[42:43], v2 offset:36416
v_mfma_f32_16x16x32_bf16 v[52:55], a[8:11], a[64:67], v[52:55]
ds_read_b128 a[84:87], v12 offset:36864
v_mfma_f32_16x16x32_bf16 v[56:59], a[8:11], a[68:71], v[56:59]
ds_read_b64_tr_b16 a[44:45], v2 offset:32864
s_mov_b32 s56, s78
v_mfma_f32_16x16x32_bf16 v[60:63], a[8:11], a[72:75], v[60:63]
ds_read_b64_tr_b16 a[46:47], v2 offset:36448
s_and_b32 s57, s79, 0xffff
s_waitcnt lgkmcnt(15)
v_mfma_f32_16x16x32_bf16 v[64:67], a[12:15], a[60:63], v[64:67]
ds_read_b128 a[88:91], v12 offset:38912
s_mov_b32 s58, 0x1c00
v_mfma_f32_16x16x32_bf16 v[68:71], a[12:15], a[64:67], v[68:71]
ds_read_b64_tr_b16 a[48:49], v2 offset:32896
s_add_u32 m0, s55, 69632
s_mov_b32 s59, 0x00020000
v_mfma_f32_16x16x32_bf16 v[72:75], a[12:15], a[68:71], v[72:75]
ds_read_b64_tr_b16 a[50:51], v2 offset:36480
s_add_u32 s3, s20, 65536
v_mfma_f32_16x16x32_bf16 v[76:79], a[12:15], a[72:75], v[76:79]
buffer_load_dwordx4 v3, s[8:11], s3 offen offset:0 lds
v_mfma_f32_16x16x32_bf16 v[80:83], a[16:19], a[60:63], v[80:83]
ds_read_b64_tr_b16 a[52:53], v2 offset:32928
v_mfma_f32_16x16x32_bf16 v[84:87], a[16:19], a[64:67], v[84:87]
ds_read_b64_tr_b16 a[54:55], v2 offset:36512
s_mov_b32 s3, 8192
v_mfma_f32_16x16x32_bf16 v[88:91], a[16:19], a[68:71], v[88:91]
buffer_load_dword a178, v14, s[60:63], s3 offen offset:2048 sc1
v_mfma_f32_16x16x32_bf16 v[92:95], a[16:19], a[72:75], v[92:95]
ds_read_b64_tr_b16 a[56:57], v2 offset:32960
v_mfma_f32_16x16x32_bf16 v[96:99], a[20:23], a[60:63], v[96:99]
ds_read_b64_tr_b16 a[58:59], v2 offset:36544
s_add_u32 s3, s20, 80896
v_mfma_f32_16x16x32_bf16 v[100:103], a[20:23], a[64:67], v[100:103]
buffer_load_dwordx4 v13, s[8:11], s3 offen offset:1024 lds
v_mfma_f32_16x16x32_bf16 v[104:107], a[20:23], a[68:71], v[104:107]
v_mfma_f32_16x16x32_bf16 v[108:111], a[20:23], a[72:75], v[108:111]
s_mov_b32 s3, 8192
s_waitcnt lgkmcnt(15)
v_mfma_f32_16x16x32_bf16 v[112:115], a[24:27], a[60:63], v[112:115]
buffer_load_dword a179, v14, s[60:63], s3 offen offset:3072 sc1
v_mfma_f32_16x16x32_bf16 v[116:119], a[24:27], a[64:67], v[116:119]
v_mfma_f32_16x16x32_bf16 v[120:123], a[24:27], a[68:71], v[120:123]
s_add_u32 s3, s20, 96256
v_mfma_f32_16x16x32_bf16 v[124:127], a[24:27], a[72:75], v[124:127]
buffer_load_dwordx4 v3, s[8:11], s3 offen offset:2048 lds
v_mfma_f32_16x16x32_bf16 v[128:131], a[28:31], a[60:63], v[128:131]
v_mfma_f32_16x16x32_bf16 v[132:135], a[28:31], a[64:67], v[132:135]
s_mov_b32 s3, 12288
v_mfma_f32_16x16x32_bf16 v[136:139], a[28:31], a[68:71], v[136:139]
buffer_load_dword a180, v14, s[60:63], s3 offen offset:0 sc1
v_mfma_f32_16x16x32_bf16 v[140:143], a[28:31], a[72:75], v[140:143]
v_mfma_f32_16x16x32_bf16 v[144:147], a[32:35], a[60:63], v[144:147]
s_add_u32 s3, s20, 111616
v_mfma_f32_16x16x32_bf16 v[148:151], a[32:35], a[64:67], v[148:151]
buffer_load_dwordx4 v13, s[8:11], s3 offen offset:3072 lds
s_add_u32 s20, s20, 128
v_mfma_f32_16x16x32_bf16 v[152:155], a[32:35], a[68:71], v[152:155]
v_mfma_f32_16x16x32_bf16 v[156:159], a[32:35], a[72:75], v[156:159]
s_waitcnt lgkmcnt(7)
v_mfma_f32_16x16x32_bf16 v[160:163], a[36:39], a[60:63], v[160:163]
s_waitcnt vmcnt(31) lgkmcnt(0)
s_barrier
v_mfma_f32_16x16x32_bf16 v[164:167], a[36:39], a[64:67], v[164:167]
ds_read_b64_tr_b16 a[0:1], v1 offset:49152
v_mfma_f32_16x16x32_bf16 v[168:171], a[36:39], a[68:71], v[168:171]
ds_read_b64_tr_b16 a[2:3], v1 offset:53760
s_mov_b32 s3, 12288
v_mfma_f32_16x16x32_bf16 v[172:175], a[36:39], a[72:75], v[172:175]
s_add_u32 m0, s25, 32768
buffer_load_dword a181, v14, s[60:63], s3 offen offset:1024 sc1
v_mfma_f32_16x16x32_bf16 v[176:179], a[40:43], a[60:63], v[176:179]
ds_read_b64_tr_b16 a[4:5], v1 offset:49184
v_mfma_f32_16x16x32_bf16 v[180:183], a[40:43], a[64:67], v[180:183]
ds_read_b64_tr_b16 a[6:7], v1 offset:53792
v_mfma_f32_16x16x32_bf16 v[184:187], a[40:43], a[68:71], v[184:187]
buffer_load_dwordx4 v4, s[12:15], s21 offen offset:0 lds
v_mfma_f32_16x16x32_bf16 v[188:191], a[40:43], a[72:75], v[188:191]
ds_read_b64_tr_b16 a[8:9], v1 offset:49216
v_mfma_f32_16x16x32_bf16 v[192:195], a[44:47], a[60:63], v[192:195]
ds_read_b64_tr_b16 a[10:11], v1 offset:53824
v_mfma_f32_16x16x32_bf16 v[196:199], a[44:47], a[64:67], v[196:199]
v_mfma_f32_16x16x32_bf16 v[200:203], a[44:47], a[68:71], v[200:203]
ds_read_b64_tr_b16 a[12:13], v1 offset:49248
v_mfma_f32_16x16x32_bf16 v[204:207], a[44:47], a[72:75], v[204:207]
ds_read_b64_tr_b16 a[14:15], v1 offset:53856
v_mfma_f32_16x16x32_bf16 v[208:211], a[48:51], a[60:63], v[208:211]
buffer_load_dwordx4 v5, s[16:19], s22 offen offset:1024 lds
v_mfma_f32_16x16x32_bf16 v[212:215], a[48:51], a[64:67], v[212:215]
ds_read_b64_tr_b16 a[16:17], v1 offset:49280
v_mfma_f32_16x16x32_bf16 v[216:219], a[48:51], a[68:71], v[216:219]
ds_read_b64_tr_b16 a[18:19], v1 offset:53888
v_mfma_f32_16x16x32_bf16 v[220:223], a[48:51], a[72:75], v[220:223]
v_mfma_f32_16x16x32_bf16 v[224:227], a[52:55], a[60:63], v[224:227]
ds_read_b64_tr_b16 a[20:21], v1 offset:49312
v_mfma_f32_16x16x32_bf16 v[228:231], a[52:55], a[64:67], v[228:231]
ds_read_b64_tr_b16 a[22:23], v1 offset:53920
v_mfma_f32_16x16x32_bf16 v[232:235], a[52:55], a[68:71], v[232:235]
buffer_load_dwordx4 v6, s[16:19], s22 offen offset:2048 lds
v_mfma_f32_16x16x32_bf16 v[236:239], a[52:55], a[72:75], v[236:239]
ds_read_b64_tr_b16 a[24:25], v1 offset:49344
v_mfma_f32_16x16x32_bf16 v[240:243], a[56:59], a[60:63], v[240:243]
ds_read_b64_tr_b16 a[26:27], v1 offset:53952
v_mfma_f32_16x16x32_bf16 v[244:247], a[56:59], a[64:67], v[244:247]
v_mfma_f32_16x16x32_bf16 v[248:251], a[56:59], a[68:71], v[248:251]
ds_read_b64_tr_b16 a[28:29], v1 offset:49376
v_mfma_f32_16x16x32_bf16 v[252:255], a[56:59], a[72:75], v[252:255]
ds_read_b64_tr_b16 a[30:31], v1 offset:53984
s_waitcnt lgkmcnt(10)
v_mfma_f32_16x16x32_bf16 v[16:19], a[0:3], a[76:79], v[16:19]
buffer_load_dwordx4 v7, s[16:19], s22 offen offset:3072 lds
v_mfma_f32_16x16x32_bf16 v[20:23], a[0:3], a[80:83], v[20:23]
ds_read_b64_tr_b16 a[32:33], v2 offset:49152
v_mfma_f32_16x16x32_bf16 v[24:27], a[0:3], a[84:87], v[24:27]
ds_read_b64_tr_b16 a[34:35], v2 offset:52736
s_waitcnt vmcnt(29)
v_mfma_f32_16x16x32_bf16 v[28:31], a[0:3], a[88:91], v[28:31]
ds_read_b128 a[60:63], v0 offset:0
v_mfma_f32_16x16x32_bf16 v[32:35], a[4:7], a[76:79], v[32:35]
ds_read_b64_tr_b16 a[36:37], v2 offset:49184
v_mfma_f32_16x16x32_bf16 v[36:39], a[4:7], a[80:83], v[36:39]
ds_read_b64_tr_b16 a[38:39], v2 offset:52768
v_mfma_f32_16x16x32_bf16 v[40:43], a[4:7], a[84:87], v[40:43]
s_add_u32 s21, s21, s23
s_add_u32 s22, s22, s24
ds_read_b128 a[64:67], v0 offset:2048
v_mfma_f32_16x16x32_bf16 v[44:47], a[4:7], a[88:91], v[44:47]
ds_read_b64_tr_b16 a[40:41], v2 offset:49216
v_mfma_f32_16x16x32_bf16 v[48:51], a[8:11], a[76:79], v[48:51]
ds_read_b64_tr_b16 a[42:43], v2 offset:52800
v_mfma_f32_16x16x32_bf16 v[52:55], a[8:11], a[80:83], v[52:55]
ds_read_b128 a[68:71], v0 offset:4096
v_mfma_f32_16x16x32_bf16 v[56:59], a[8:11], a[84:87], v[56:59]
ds_read_b64_tr_b16 a[44:45], v2 offset:49248
v_mfma_f32_16x16x32_bf16 v[60:63], a[8:11], a[88:91], v[60:63]
ds_read_b64_tr_b16 a[46:47], v2 offset:52832
s_waitcnt lgkmcnt(15)
v_mfma_f32_16x16x32_bf16 v[64:67], a[12:15], a[76:79], v[64:67]
ds_read_b128 a[72:75], v0 offset:6144
v_mfma_f32_16x16x32_bf16 v[68:71], a[12:15], a[80:83], v[68:71]
ds_read_b64_tr_b16 a[48:49], v2 offset:49280
v_mfma_f32_16x16x32_bf16 v[72:75], a[12:15], a[84:87], v[72:75]
ds_read_b64_tr_b16 a[50:51], v2 offset:52864
v_mfma_f32_16x16x32_bf16 v[76:79], a[12:15], a[88:91], v[76:79]
v_mfma_f32_16x16x32_bf16 v[80:83], a[16:19], a[76:79], v[80:83]
ds_read_b64_tr_b16 a[52:53], v2 offset:49312
v_mfma_f32_16x16x32_bf16 v[84:87], a[16:19], a[80:83], v[84:87]
ds_read_b64_tr_b16 a[54:55], v2 offset:52896
s_mov_b32 s3, 12288
v_mfma_f32_16x16x32_bf16 v[88:91], a[16:19], a[84:87], v[88:91]
buffer_load_dword a182, v14, s[60:63], s3 offen offset:2048 sc1
v_mfma_f32_16x16x32_bf16 v[92:95], a[16:19], a[88:91], v[92:95]
ds_read_b64_tr_b16 a[56:57], v2 offset:49344
v_mfma_f32_16x16x32_bf16 v[96:99], a[20:23], a[76:79], v[96:99]
ds_read_b64_tr_b16 a[58:59], v2 offset:52928
v_mfma_f32_16x16x32_bf16 v[100:103], a[20:23], a[80:83], v[100:103]
v_mfma_f32_16x16x32_bf16 v[104:107], a[20:23], a[84:87], v[104:107]
v_mfma_f32_16x16x32_bf16 v[108:111], a[20:23], a[88:91], v[108:111]
s_mov_b32 s3, 12288
s_waitcnt lgkmcnt(15)
v_mfma_f32_16x16x32_bf16 v[112:115], a[24:27], a[76:79], v[112:115]
buffer_load_dword a183, v14, s[60:63], s3 offen offset:3072 sc1
v_mfma_f32_16x16x32_bf16 v[116:119], a[24:27], a[80:83], v[116:119]
v_mfma_f32_16x16x32_bf16 v[120:123], a[24:27], a[84:87], v[120:123]
v_mfma_f32_16x16x32_bf16 v[124:127], a[24:27], a[88:91], v[124:127]
v_mfma_f32_16x16x32_bf16 v[128:131], a[28:31], a[76:79], v[128:131]
v_mfma_f32_16x16x32_bf16 v[132:135], a[28:31], a[80:83], v[132:135]
v_accvgpr_read_b32 v14, a229
v_mfma_f32_16x16x32_bf16 v[136:139], a[28:31], a[84:87], v[136:139]
buffer_load_ushort a230, v14, s[56:59], 0 offen
v_mfma_f32_16x16x32_bf16 v[140:143], a[28:31], a[88:91], v[140:143]
v_mfma_f32_16x16x32_bf16 v[144:147], a[32:35], a[76:79], v[144:147]
v_accvgpr_read_b32 v14, a231
v_mfma_f32_16x16x32_bf16 v[148:151], a[32:35], a[80:83], v[148:151]
v_mfma_f32_16x16x32_bf16 v[152:155], a[32:35], a[84:87], v[152:155]
buffer_load_dwordx2 a[184:185], v14, s[60:63], 0 offen offset:0 sc1
v_mfma_f32_16x16x32_bf16 v[156:159], a[32:35], a[88:91], v[156:159]
s_waitcnt lgkmcnt(7)
v_mfma_f32_16x16x32_bf16 v[160:163], a[36:39], a[76:79], v[160:163]
s_waitcnt vmcnt(28) lgkmcnt(0)
s_barrier
v_mfma_f32_16x16x32_bf16 v[164:167], a[36:39], a[80:83], v[164:167]
ds_read_b64_tr_b16 a[0:1], v1 offset:0
v_mfma_f32_16x16x32_bf16 v[168:171], a[36:39], a[84:87], v[168:171]
ds_read_b64_tr_b16 a[2:3], v1 offset:4608
v_mfma_f32_16x16x32_bf16 v[172:175], a[36:39], a[88:91], v[172:175]
s_add_u32 m0, s25, 49152
v_mfma_f32_16x16x32_bf16 v[176:179], a[40:43], a[76:79], v[176:179]
ds_read_b64_tr_b16 a[4:5], v1 offset:32
v_mfma_f32_16x16x32_bf16 v[180:183], a[40:43], a[80:83], v[180:183]
ds_read_b64_tr_b16 a[6:7], v1 offset:4640
v_mfma_f32_16x16x32_bf16 v[184:187], a[40:43], a[84:87], v[184:187]
buffer_load_dwordx4 v4, s[12:15], s21 offen offset:0 lds
v_mfma_f32_16x16x32_bf16 v[188:191], a[40:43], a[88:91], v[188:191]
ds_read_b64_tr_b16 a[8:9], v1 offset:64
v_mfma_f32_16x16x32_bf16 v[192:195], a[44:47], a[76:79], v[192:195]
ds_read_b64_tr_b16 a[10:11], v1 offset:4672
v_mfma_f32_16x16x32_bf16 v[196:199], a[44:47], a[80:83], v[196:199]
v_mfma_f32_16x16x32_bf16 v[200:203], a[44:47], a[84:87], v[200:203]
ds_read_b64_tr_b16 a[12:13], v1 offset:96
v_mfma_f32_16x16x32_bf16 v[204:207], a[44:47], a[88:91], v[204:207]
ds_read_b64_tr_b16 a[14:15], v1 offset:4704
v_mfma_f32_16x16x32_bf16 v[208:211], a[48:51], a[76:79], v[208:211]
buffer_load_dwordx4 v5, s[16:19], s22 offen offset:1024 lds
v_mfma_f32_16x16x32_bf16 v[212:215], a[48:51], a[80:83], v[212:215]
ds_read_b64_tr_b16 a[16:17], v1 offset:128
v_mfma_f32_16x16x32_bf16 v[216:219], a[48:51], a[84:87], v[216:219]
ds_read_b64_tr_b16 a[18:19], v1 offset:4736
v_mfma_f32_16x16x32_bf16 v[220:223], a[48:51], a[88:91], v[220:223]
v_mfma_f32_16x16x32_bf16 v[224:227], a[52:55], a[76:79], v[224:227]
ds_read_b64_tr_b16 a[20:21], v1 offset:160
v_mfma_f32_16x16x32_bf16 v[228:231], a[52:55], a[80:83], v[228:231]
ds_read_b64_tr_b16 a[22:23], v1 offset:4768
v_mfma_f32_16x16x32_bf16 v[232:235], a[52:55], a[84:87], v[232:235]
buffer_load_dwordx4 v6, s[16:19], s22 offen offset:2048 lds
v_mfma_f32_16x16x32_bf16 v[236:239], a[52:55], a[88:91], v[236:239]
ds_read_b64_tr_b16 a[24:25], v1 offset:192
v_mfma_f32_16x16x32_bf16 v[240:243], a[56:59], a[76:79], v[240:243]
ds_read_b64_tr_b16 a[26:27], v1 offset:4800
v_mfma_f32_16x16x32_bf16 v[244:247], a[56:59], a[80:83], v[244:247]
v_mfma_f32_16x16x32_bf16 v[248:251], a[56:59], a[84:87], v[248:251]
ds_read_b64_tr_b16 a[28:29], v1 offset:224
v_mfma_f32_16x16x32_bf16 v[252:255], a[56:59], a[88:91], v[252:255]
ds_read_b64_tr_b16 a[30:31], v1 offset:4832
s_waitcnt lgkmcnt(10)
v_mfma_f32_16x16x32_bf16 v[16:19], a[0:3], a[60:63], v[16:19]
buffer_load_dwordx4 v7, s[16:19], s22 offen offset:3072 lds
v_mfma_f32_16x16x32_bf16 v[20:23], a[0:3], a[64:67], v[20:23]
ds_read_b64_tr_b16 a[32:33], v2 offset:0
v_mfma_f32_16x16x32_bf16 v[24:27], a[0:3], a[68:71], v[24:27]
ds_read_b64_tr_b16 a[34:35], v2 offset:3584
v_mfma_f32_16x16x32_bf16 v[28:31], a[0:3], a[72:75], v[28:31]
ds_read_b128 a[76:79], v12 offset:0
v_mfma_f32_16x16x32_bf16 v[32:35], a[4:7], a[60:63], v[32:35]
ds_read_b64_tr_b16 a[36:37], v2 offset:32
v_mfma_f32_16x16x32_bf16 v[36:39], a[4:7], a[64:67], v[36:39]
ds_read_b64_tr_b16 a[38:39], v2 offset:3616
v_mfma_f32_16x16x32_bf16 v[40:43], a[4:7], a[68:71], v[40:43]
s_add_u32 s21, s21, s23
s_add_u32 s22, s22, s24
ds_read_b128 a[80:83], v12 offset:2048
v_mfma_f32_16x16x32_bf16 v[44:47], a[4:7], a[72:75], v[44:47]
ds_read_b64_tr_b16 a[40:41], v2 offset:64
v_mfma_f32_16x16x32_bf16 v[48:51], a[8:11], a[60:63], v[48:51]
ds_read_b64_tr_b16 a[42:43], v2 offset:3648
v_mfma_f32_16x16x32_bf16 v[52:55], a[8:11], a[64:67], v[52:55]
ds_read_b128 a[84:87], v12 offset:4096
v_mfma_f32_16x16x32_bf16 v[56:59], a[8:11], a[68:71], v[56:59]
ds_read_b64_tr_b16 a[44:45], v2 offset:96
v_mfma_f32_16x16x32_bf16 v[60:63], a[8:11], a[72:75], v[60:63]
ds_read_b64_tr_b16 a[46:47], v2 offset:3680
s_waitcnt lgkmcnt(15)
v_mfma_f32_16x16x32_bf16 v[64:67], a[12:15], a[60:63], v[64:67]
ds_read_b128 a[88:91], v12 offset:6144
v_mfma_f32_16x16x32_bf16 v[68:71], a[12:15], a[64:67], v[68:71]
ds_read_b64_tr_b16 a[48:49], v2 offset:128
v_mfma_f32_16x16x32_bf16 v[72:75], a[12:15], a[68:71], v[72:75]
ds_read_b64_tr_b16 a[50:51], v2 offset:3712
v_mfma_f32_16x16x32_bf16 v[76:79], a[12:15], a[72:75], v[76:79]
v_mfma_f32_16x16x32_bf16 v[80:83], a[16:19], a[60:63], v[80:83]
ds_read_b64_tr_b16 a[52:53], v2 offset:160
v_mfma_f32_16x16x32_bf16 v[84:87], a[16:19], a[64:67], v[84:87]
ds_read_b64_tr_b16 a[54:55], v2 offset:3744
v_mfma_f32_16x16x32_bf16 v[88:91], a[16:19], a[68:71], v[88:91]
buffer_load_dwordx2 a[186:187], v14, s[60:63], 0 offen offset:128 sc1
v_mfma_f32_16x16x32_bf16 v[92:95], a[16:19], a[72:75], v[92:95]
ds_read_b64_tr_b16 a[56:57], v2 offset:192
v_mfma_f32_16x16x32_bf16 v[96:99], a[20:23], a[60:63], v[96:99]
ds_read_b64_tr_b16 a[58:59], v2 offset:3776
v_mfma_f32_16x16x32_bf16 v[100:103], a[20:23], a[64:67], v[100:103]
v_mfma_f32_16x16x32_bf16 v[104:107], a[20:23], a[68:71], v[104:107]
v_mfma_f32_16x16x32_bf16 v[108:111], a[20:23], a[72:75], v[108:111]
s_waitcnt lgkmcnt(15)
v_mfma_f32_16x16x32_bf16 v[112:115], a[24:27], a[60:63], v[112:115]
buffer_load_dwordx2 a[188:189], v14, s[60:63], 0 offen offset:256 sc1
v_mfma_f32_16x16x32_bf16 v[116:119], a[24:27], a[64:67], v[116:119]
v_mfma_f32_16x16x32_bf16 v[120:123], a[24:27], a[68:71], v[120:123]
v_mfma_f32_16x16x32_bf16 v[124:127], a[24:27], a[72:75], v[124:127]
v_mfma_f32_16x16x32_bf16 v[128:131], a[28:31], a[60:63], v[128:131]
v_mfma_f32_16x16x32_bf16 v[132:135], a[28:31], a[64:67], v[132:135]
v_mfma_f32_16x16x32_bf16 v[136:139], a[28:31], a[68:71], v[136:139]
buffer_load_dwordx2 a[190:191], v14, s[60:63], 0 offen offset:384 sc1
v_mfma_f32_16x16x32_bf16 v[140:143], a[28:31], a[72:75], v[140:143]
v_mfma_f32_16x16x32_bf16 v[144:147], a[32:35], a[60:63], v[144:147]
v_mfma_f32_16x16x32_bf16 v[148:151], a[32:35], a[64:67], v[148:151]
v_mfma_f32_16x16x32_bf16 v[152:155], a[32:35], a[68:71], v[152:155]
v_mfma_f32_16x16x32_bf16 v[156:159], a[32:35], a[72:75], v[156:159]
s_waitcnt lgkmcnt(7)
v_mfma_f32_16x16x32_bf16 v[160:163], a[36:39], a[60:63], v[160:163]
s_waitcnt vmcnt(23) lgkmcnt(0)
s_barrier
v_mfma_f32_16x16x32_bf16 v[164:167], a[36:39], a[64:67], v[164:167]
ds_read_b64_tr_b16 a[0:1], v1 offset:16384
v_mfma_f32_16x16x32_bf16 v[168:171], a[36:39], a[68:71], v[168:171]
ds_read_b64_tr_b16 a[2:3], v1 offset:20992
v_mfma_f32_16x16x32_bf16 v[172:175], a[36:39], a[72:75], v[172:175]
s_add_u32 m0, s54, 131072
s_getpc_b64 s[36:37]
L_pc5:
s_add_u32 s36, s36, L_trans_k-L_pc5
s_addc_u32 s37, s37, 0
v_mfma_f32_16x16x32_bf16 v[176:179], a[40:43], a[60:63], v[176:179]
ds_read_b64_tr_b16 a[4:5], v1 offset:16416
s_mov_b32 s40, s36
v_mfma_f32_16x16x32_bf16 v[180:183], a[40:43], a[64:67], v[180:183]
ds_read_b64_tr_b16 a[6:7], v1 offset:21024
s_and_b32 s41, s37, 0xffff
v_mfma_f32_16x16x32_bf16 v[184:187], a[40:43], a[68:71], v[184:187]
buffer_load_dwordx4 v8, s[44:47], s52 offen offset:0 lds
s_mov_b32 s42, L_end_k-L_trans_k
v_mfma_f32_16x16x32_bf16 v[188:191], a[40:43], a[72:75], v[188:191]
ds_read_b64_tr_b16 a[8:9], v1 offset:16448
s_mov_b32 s43, 0x00020000
v_mfma_f32_16x16x32_bf16 v[192:195], a[44:47], a[60:63], v[192:195]
ds_read_b64_tr_b16 a[10:11], v1 offset:21056
s_lshr_b32 s36, s2, 3
v_mfma_f32_16x16x32_bf16 v[196:199], a[44:47], a[64:67], v[196:199]
s_lshl_b32 s36, s36, 2
v_mfma_f32_16x16x32_bf16 v[200:203], a[44:47], a[68:71], v[200:203]
ds_read_b64_tr_b16 a[12:13], v1 offset:16480
s_add_u32 s36, s36, s26
v_mfma_f32_16x16x32_bf16 v[204:207], a[44:47], a[72:75], v[204:207]
ds_read_b64_tr_b16 a[14:15], v1 offset:21088
s_lshl_b32 s36, s36, 10
v_mfma_f32_16x16x32_bf16 v[208:211], a[48:51], a[60:63], v[208:211]
buffer_load_dwordx4 v9, s[44:47], s52 offen offset:1024 lds
v_accvgpr_read_b32 v5, a213
v_mfma_f32_16x16x32_bf16 v[212:215], a[48:51], a[64:67], v[212:215]
ds_read_b64_tr_b16 a[16:17], v1 offset:16512
v_and_b32 v5, 63, v5
v_mfma_f32_16x16x32_bf16 v[216:219], a[48:51], a[68:71], v[216:219]
ds_read_b64_tr_b16 a[18:19], v1 offset:21120
v_lshlrev_b32 v5, 4, v5
v_mfma_f32_16x16x32_bf16 v[220:223], a[48:51], a[72:75], v[220:223]
s_add_u32 m0, s54, 139264
buffer_load_dwordx4 a[252:255], v5, s[40:43], s36 offen
v_mfma_f32_16x16x32_bf16 v[224:227], a[52:55], a[60:63], v[224:227]
ds_read_b64_tr_b16 a[20:21], v1 offset:16544
v_mfma_f32_16x16x32_bf16 v[228:231], a[52:55], a[64:67], v[228:231]
ds_read_b64_tr_b16 a[22:23], v1 offset:21152
v_mfma_f32_16x16x32_bf16 v[232:235], a[52:55], a[68:71], v[232:235]
s_add_u32 s52, s52, 8192
buffer_load_dwordx4 v8, s[44:47], s52 offen offset:0 lds
v_mfma_f32_16x16x32_bf16 v[236:239], a[52:55], a[72:75], v[236:239]
ds_read_b64_tr_b16 a[24:25], v1 offset:16576
v_mfma_f32_16x16x32_bf16 v[240:243], a[56:59], a[60:63], v[240:243]
ds_read_b64_tr_b16 a[26:27], v1 offset:21184
v_mfma_f32_16x16x32_bf16 v[244:247], a[56:59], a[64:67], v[244:247]
v_mfma_f32_16x16x32_bf16 v[248:251], a[56:59], a[68:71], v[248:251]
ds_read_b64_tr_b16 a[28:29], v1 offset:16608
v_mfma_f32_16x16x32_bf16 v[252:255], a[56:59], a[72:75], v[252:255]
ds_read_b64_tr_b16 a[30:31], v1 offset:21216
s_waitcnt lgkmcnt(10)
v_mfma_f32_16x16x32_bf16 v[16:19], a[0:3], a[76:79], v[16:19]
buffer_load_dwordx4 v9, s[44:47], s52 offen offset:1024 lds
v_mfma_f32_16x16x32_bf16 v[20:23], a[0:3], a[80:83], v[20:23]
ds_read_b64_tr_b16 a[32:33], v2 offset:16384
v_subrev_u32 v15, 32768, v0
v_mfma_f32_16x16x32_bf16 v[24:27], a[0:3], a[84:87], v[24:27]
ds_read_b64_tr_b16 a[34:35], v2 offset:19968
s_waitcnt vmcnt(21)
v_mfma_f32_16x16x32_bf16 v[28:31], a[0:3], a[88:91], v[28:31]
ds_read_b128 a[60:63], v15 offset:0
v_mfma_f32_16x16x32_bf16 v[32:35], a[4:7], a[76:79], v[32:35]
ds_read_b64_tr_b16 a[36:37], v2 offset:16416
v_mfma_f32_16x16x32_bf16 v[36:39], a[4:7], a[80:83], v[36:39]
ds_read_b64_tr_b16 a[38:39], v2 offset:20000
v_mfma_f32_16x16x32_bf16 v[40:43], a[4:7], a[84:87], v[40:43]
s_add_u32 s52, s52, 8192
ds_read_b128 a[64:67], v15 offset:2048
v_mfma_f32_16x16x32_bf16 v[44:47], a[4:7], a[88:91], v[44:47]
ds_read_b64_tr_b16 a[40:41], v2 offset:16448
v_mfma_f32_16x16x32_bf16 v[48:51], a[8:11], a[76:79], v[48:51]
ds_read_b64_tr_b16 a[42:43], v2 offset:20032
v_mfma_f32_16x16x32_bf16 v[52:55], a[8:11], a[80:83], v[52:55]
ds_read_b128 a[68:71], v15 offset:4096
v_mfma_f32_16x16x32_bf16 v[56:59], a[8:11], a[84:87], v[56:59]
ds_read_b64_tr_b16 a[44:45], v2 offset:16480
v_mfma_f32_16x16x32_bf16 v[60:63], a[8:11], a[88:91], v[60:63]
ds_read_b64_tr_b16 a[46:47], v2 offset:20064
s_waitcnt lgkmcnt(15)
v_mfma_f32_16x16x32_bf16 v[64:67], a[12:15], a[76:79], v[64:67]
ds_read_b128 a[72:75], v15 offset:6144
v_mfma_f32_16x16x32_bf16 v[68:71], a[12:15], a[80:83], v[68:71]
ds_read_b64_tr_b16 a[48:49], v2 offset:16512
v_mfma_f32_16x16x32_bf16 v[72:75], a[12:15], a[84:87], v[72:75]
ds_read_b64_tr_b16 a[50:51], v2 offset:20096
v_mfma_f32_16x16x32_bf16 v[76:79], a[12:15], a[88:91], v[76:79]
v_mfma_f32_16x16x32_bf16 v[80:83], a[16:19], a[76:79], v[80:83]
ds_read_b64_tr_b16 a[52:53], v2 offset:16544
v_mfma_f32_16x16x32_bf16 v[84:87], a[16:19], a[80:83], v[84:87]
ds_read_b64_tr_b16 a[54:55], v2 offset:20128
v_mfma_f32_16x16x32_bf16 v[88:91], a[16:19], a[84:87], v[88:91]
v_mfma_f32_16x16x32_bf16 v[92:95], a[16:19], a[88:91], v[92:95]
ds_read_b64_tr_b16 a[56:57], v2 offset:16576
v_mfma_f32_16x16x32_bf16 v[96:99], a[20:23], a[76:79], v[96:99]
ds_read_b64_tr_b16 a[58:59], v2 offset:20160
v_mfma_f32_16x16x32_bf16 v[100:103], a[20:23], a[80:83], v[100:103]
v_mfma_f32_16x16x32_bf16 v[104:107], a[20:23], a[84:87], v[104:107]
v_accvgpr_read_b32 v14, a168
v_mfma_f32_16x16x32_bf16 v[108:111], a[20:23], a[88:91], v[108:111]
v_accvgpr_read_b32 v15, a169
v_add_f32 v14, v14, v15
s_waitcnt lgkmcnt(15)
v_mfma_f32_16x16x32_bf16 v[112:115], a[24:27], a[76:79], v[112:115]
v_accvgpr_read_b32 v15, a170
v_add_f32 v14, v14, v15
v_mfma_f32_16x16x32_bf16 v[116:119], a[24:27], a[80:83], v[116:119]
v_accvgpr_read_b32 v15, a171
v_add_f32 v14, v14, v15
v_mfma_f32_16x16x32_bf16 v[120:123], a[24:27], a[84:87], v[120:123]
v_accvgpr_read_b32 v15, a172
v_add_f32 v14, v14, v15
v_mfma_f32_16x16x32_bf16 v[124:127], a[24:27], a[88:91], v[124:127]
v_accvgpr_read_b32 v15, a173
v_add_f32 v14, v14, v15
v_mfma_f32_16x16x32_bf16 v[128:131], a[28:31], a[76:79], v[128:131]
v_accvgpr_read_b32 v15, a174
v_add_f32 v14, v14, v15
v_mfma_f32_16x16x32_bf16 v[132:135], a[28:31], a[80:83], v[132:135]
v_accvgpr_read_b32 v15, a175
v_add_f32 v14, v14, v15
v_mfma_f32_16x16x32_bf16 v[136:139], a[28:31], a[84:87], v[136:139]
v_accvgpr_read_b32 v15, a176
v_add_f32 v14, v14, v15
v_mfma_f32_16x16x32_bf16 v[140:143], a[28:31], a[88:91], v[140:143]
v_accvgpr_read_b32 v15, a177
v_add_f32 v14, v14, v15
v_mfma_f32_16x16x32_bf16 v[144:147], a[32:35], a[76:79], v[144:147]
v_accvgpr_read_b32 v15, a178
v_add_f32 v14, v14, v15
v_mfma_f32_16x16x32_bf16 v[148:151], a[32:35], a[80:83], v[148:151]
v_accvgpr_read_b32 v15, a179
v_add_f32 v14, v14, v15
v_mfma_f32_16x16x32_bf16 v[152:155], a[32:35], a[84:87], v[152:155]
v_accvgpr_read_b32 v15, a180
v_add_f32 v14, v14, v15
v_mfma_f32_16x16x32_bf16 v[156:159], a[32:35], a[88:91], v[156:159]
s_waitcnt vmcnt(20)
v_accvgpr_read_b32 v15, a181
v_add_f32 v14, v14, v15
s_waitcnt lgkmcnt(7)
v_mfma_f32_16x16x32_bf16 v[160:163], a[36:39], a[76:79], v[160:163]
s_waitcnt vmcnt(16) lgkmcnt(0)
s_barrier
v_mfma_f32_16x16x32_bf16 v[164:167], a[36:39], a[80:83], v[164:167]
ds_read_b64_tr_b16 a[0:1], v1 offset:32768
v_mfma_f32_16x16x32_bf16 v[168:171], a[36:39], a[84:87], v[168:171]
ds_read_b64_tr_b16 a[2:3], v1 offset:37376
v_mfma_f32_16x16x32_bf16 v[172:175], a[36:39], a[88:91], v[172:175]
s_add_u32 m0, s54, 147456
v_mfma_f32_16x16x32_bf16 v[176:179], a[40:43], a[76:79], v[176:179]
ds_read_b64_tr_b16 a[4:5], v1 offset:32800
v_mfma_f32_16x16x32_bf16 v[180:183], a[40:43], a[80:83], v[180:183]
ds_read_b64_tr_b16 a[6:7], v1 offset:37408
v_mfma_f32_16x16x32_bf16 v[184:187], a[40:43], a[84:87], v[184:187]
buffer_load_dwordx4 v8, s[44:47], s52 offen offset:0 lds
v_mfma_f32_16x16x32_bf16 v[188:191], a[40:43], a[88:91], v[188:191]
ds_read_b64_tr_b16 a[8:9], v1 offset:32832
v_mfma_f32_16x16x32_bf16 v[192:195], a[44:47], a[76:79], v[192:195]
ds_read_b64_tr_b16 a[10:11], v1 offset:37440
v_mfma_f32_16x16x32_bf16 v[196:199], a[44:47], a[80:83], v[196:199]
v_mfma_f32_16x16x32_bf16 v[200:203], a[44:47], a[84:87], v[200:203]
ds_read_b64_tr_b16 a[12:13], v1 offset:32864
v_mfma_f32_16x16x32_bf16 v[204:207], a[44:47], a[88:91], v[204:207]
ds_read_b64_tr_b16 a[14:15], v1 offset:37472
v_mfma_f32_16x16x32_bf16 v[208:211], a[48:51], a[76:79], v[208:211]
buffer_load_dwordx4 v9, s[44:47], s52 offen offset:1024 lds
v_mfma_f32_16x16x32_bf16 v[212:215], a[48:51], a[80:83], v[212:215]
ds_read_b64_tr_b16 a[16:17], v1 offset:32896
v_mfma_f32_16x16x32_bf16 v[216:219], a[48:51], a[84:87], v[216:219]
ds_read_b64_tr_b16 a[18:19], v1 offset:37504
v_mfma_f32_16x16x32_bf16 v[220:223], a[48:51], a[88:91], v[220:223]
s_add_u32 m0, s54, 155648
v_mfma_f32_16x16x32_bf16 v[224:227], a[52:55], a[76:79], v[224:227]
ds_read_b64_tr_b16 a[20:21], v1 offset:32928
v_mfma_f32_16x16x32_bf16 v[228:231], a[52:55], a[80:83], v[228:231]
ds_read_b64_tr_b16 a[22:23], v1 offset:37536
v_mfma_f32_16x16x32_bf16 v[232:235], a[52:55], a[84:87], v[232:235]
s_add_u32 s52, s52, 8192
buffer_load_dwordx4 v8, s[44:47], s52 offen offset:0 lds
v_mfma_f32_16x16x32_bf16 v[236:239], a[52:55], a[88:91], v[236:239]
ds_read_b64_tr_b16 a[24:25], v1 offset:32960
v_mfma_f32_16x16x32_bf16 v[240:243], a[56:59], a[76:79], v[240:243]
ds_read_b64_tr_b16 a[26:27], v1 offset:37568
v_mfma_f32_16x16x32_bf16 v[244:247], a[56:59], a[80:83], v[244:247]
v_mfma_f32_16x16x32_bf16 v[248:251], a[56:59], a[84:87], v[248:251]
ds_read_b64_tr_b16 a[28:29], v1 offset:32992
v_mfma_f32_16x16x32_bf16 v[252:255], a[56:59], a[88:91], v[252:255]
ds_read_b64_tr_b16 a[30:31], v1 offset:37600
s_waitcnt lgkmcnt(10)
v_mfma_f32_16x16x32_bf16 v[16:19], a[0:3], a[60:63], v[16:19]
buffer_load_dwordx4 v9, s[44:47], s52 offen offset:1024 lds
v_mfma_f32_16x16x32_bf16 v[20:23], a[0:3], a[64:67], v[20:23]
ds_read_b64_tr_b16 a[32:33], v2 offset:32768
v_subrev_u32 v15, 32768, v12
v_mfma_f32_16x16x32_bf16 v[24:27], a[0:3], a[68:71], v[24:27]
ds_read_b64_tr_b16 a[34:35], v2 offset:36352
v_mfma_f32_16x16x32_bf16 v[28:31], a[0:3], a[72:75], v[28:31]
ds_read_b128 a[76:79], v15 offset:0
v_mfma_f32_16x16x32_bf16 v[32:35], a[4:7], a[60:63], v[32:35]
ds_read_b64_tr_b16 a[36:37], v2 offset:32800
v_mfma_f32_16x16x32_bf16 v[36:39], a[4:7], a[64:67], v[36:39]
ds_read_b64_tr_b16 a[38:39], v2 offset:36384
v_mfma_f32_16x16x32_bf16 v[40:43], a[4:7], a[68:71], v[40:43]
s_add_u32 s52, s52, 8192
ds_read_b128 a[80:83], v15 offset:2048
v_mfma_f32_16x16x32_bf16 v[44:47], a[4:7], a[72:75], v[44:47]
ds_read_b64_tr_b16 a[40:41], v2 offset:32832
v_mfma_f32_16x16x32_bf16 v[48:51], a[8:11], a[60:63], v[48:51]
ds_read_b64_tr_b16 a[42:43], v2 offset:36416
v_mfma_f32_16x16x32_bf16 v[52:55], a[8:11], a[64:67], v[52:55]
ds_read_b128 a[84:87], v15 offset:4096
v_mfma_f32_16x16x32_bf16 v[56:59], a[8:11], a[68:71], v[56:59]
ds_read_b64_tr_b16 a[44:45], v2 offset:32864
v_mfma_f32_16x16x32_bf16 v[60:63], a[8:11], a[72:75], v[60:63]
ds_read_b64_tr_b16 a[46:47], v2 offset:36448
s_waitcnt lgkmcnt(15)
v_mfma_f32_16x16x32_bf16 v[64:67], a[12:15], a[60:63], v[64:67]
ds_read_b128 a[88:91], v15 offset:6144
v_mfma_f32_16x16x32_bf16 v[68:71], a[12:15], a[64:67], v[68:71]
ds_read_b64_tr_b16 a[48:49], v2 offset:32896
v_mfma_f32_16x16x32_bf16 v[72:75], a[12:15], a[68:71], v[72:75]
ds_read_b64_tr_b16 a[50:51], v2 offset:36480
v_mfma_f32_16x16x32_bf16 v[76:79], a[12:15], a[72:75], v[76:79]
v_mfma_f32_16x16x32_bf16 v[80:83], a[16:19], a[60:63], v[80:83]
ds_read_b64_tr_b16 a[52:53], v2 offset:32928
v_mfma_f32_16x16x32_bf16 v[84:87], a[16:19], a[64:67], v[84:87]
ds_read_b64_tr_b16 a[54:55], v2 offset:36512
v_mfma_f32_16x16x32_bf16 v[88:91], a[16:19], a[68:71], v[88:91]
v_mfma_f32_16x16x32_bf16 v[92:95], a[16:19], a[72:75], v[92:95]
ds_read_b64_tr_b16 a[56:57], v2 offset:32960
v_mfma_f32_16x16x32_bf16 v[96:99], a[20:23], a[60:63], v[96:99]
ds_read_b64_tr_b16 a[58:59], v2 offset:36544
v_mfma_f32_16x16x32_bf16 v[100:103], a[20:23], a[64:67], v[100:103]
v_mfma_f32_16x16x32_bf16 v[104:107], a[20:23], a[68:71], v[104:107]
s_waitcnt vmcnt(19)
v_accvgpr_read_b32 v15, a182
v_add_f32 v14, v14, v15
v_mfma_f32_16x16x32_bf16 v[108:111], a[20:23], a[72:75], v[108:111]
s_waitcnt vmcnt(18)
v_accvgpr_read_b32 v15, a183
v_add_f32 v14, v14, v15
s_waitcnt lgkmcnt(15)
v_mfma_f32_16x16x32_bf16 v[112:115], a[24:27], a[60:63], v[112:115]
v_accvgpr_read_b32 v5, a92
v_cvt_pk_bf16_f32 v15, v14, v14
v_mfma_f32_16x16x32_bf16 v[116:119], a[24:27], a[64:67], v[116:119]
ds_write_b16 v5, v15
v_lshlrev_b32 v15, 16, v15
v_mfma_f32_16x16x32_bf16 v[120:123], a[24:27], a[68:71], v[120:123]
v_sub_f32 v14, v14, v15
v_cvt_pk_bf16_f32 v15, v14, v14
v_mfma_f32_16x16x32_bf16 v[124:127], a[24:27], a[72:75], v[124:127]
ds_write_b16 v5, v15 offset:2
v_lshlrev_b32 v15, 16, v15
v_mfma_f32_16x16x32_bf16 v[128:131], a[28:31], a[60:63], v[128:131]
v_sub_f32 v14, v14, v15
s_waitcnt vmcnt(17)
v_accvgpr_read_b32 v15, a230
v_mfma_f32_16x16x32_bf16 v[132:135], a[28:31], a[64:67], v[132:135]
v_lshlrev_b32 v15, 16, v15
v_cvt_pk_bf16_f32 v14, v14, v15
v_mfma_f32_16x16x32_bf16 v[136:139], a[28:31], a[68:71], v[136:139]
ds_write_b32 v5, v14 offset:4
v_mov_b32 v14, 0
v_mfma_f32_16x16x32_bf16 v[140:143], a[28:31], a[72:75], v[140:143]
v_mov_b32 v15, 0
ds_write_b64 v5, v[14:15] offset:2048
v_mfma_f32_16x16x32_bf16 v[144:147], a[32:35], a[60:63], v[144:147]
v_mfma_f32_16x16x32_bf16 v[148:151], a[32:35], a[64:67], v[148:151]
v_mfma_f32_16x16x32_bf16 v[152:155], a[32:35], a[68:71], v[152:155]
v_mfma_f32_16x16x32_bf16 v[156:159], a[32:35], a[72:75], v[156:159]
s_waitcnt lgkmcnt(11)
v_mfma_f32_16x16x32_bf16 v[160:163], a[36:39], a[60:63], v[160:163]
s_waitcnt vmcnt(12) lgkmcnt(0)
s_barrier
v_mfma_f32_16x16x32_bf16 v[164:167], a[36:39], a[64:67], v[164:167]
ds_read_b64_tr_b16 a[0:1], v1 offset:49152
v_mfma_f32_16x16x32_bf16 v[168:171], a[36:39], a[68:71], v[168:171]
ds_read_b64_tr_b16 a[2:3], v1 offset:53760
v_mfma_f32_16x16x32_bf16 v[172:175], a[36:39], a[72:75], v[172:175]
s_add_u32 m0, s54, 98304
v_mfma_f32_16x16x32_bf16 v[176:179], a[40:43], a[60:63], v[176:179]
ds_read_b64_tr_b16 a[4:5], v1 offset:49184
v_mfma_f32_16x16x32_bf16 v[180:183], a[40:43], a[64:67], v[180:183]
ds_read_b64_tr_b16 a[6:7], v1 offset:53792
v_mfma_f32_16x16x32_bf16 v[184:187], a[40:43], a[68:71], v[184:187]
buffer_load_dwordx4 v10, s[48:51], s53 offen offset:0 lds
v_mfma_f32_16x16x32_bf16 v[188:191], a[40:43], a[72:75], v[188:191]
ds_read_b64_tr_b16 a[8:9], v1 offset:49216
v_mfma_f32_16x16x32_bf16 v[192:195], a[44:47], a[60:63], v[192:195]
ds_read_b64_tr_b16 a[10:11], v1 offset:53824
v_mfma_f32_16x16x32_bf16 v[196:199], a[44:47], a[64:67], v[196:199]
v_mfma_f32_16x16x32_bf16 v[200:203], a[44:47], a[68:71], v[200:203]
ds_read_b64_tr_b16 a[12:13], v1 offset:49248
v_mfma_f32_16x16x32_bf16 v[204:207], a[44:47], a[72:75], v[204:207]
ds_read_b64_tr_b16 a[14:15], v1 offset:53856
v_mfma_f32_16x16x32_bf16 v[208:211], a[48:51], a[60:63], v[208:211]
buffer_load_dwordx4 v11, s[48:51], s53 offen offset:1024 lds
v_mfma_f32_16x16x32_bf16 v[212:215], a[48:51], a[64:67], v[212:215]
ds_read_b64_tr_b16 a[16:17], v1 offset:49280
v_mfma_f32_16x16x32_bf16 v[216:219], a[48:51], a[68:71], v[216:219]
ds_read_b64_tr_b16 a[18:19], v1 offset:53888
v_mfma_f32_16x16x32_bf16 v[220:223], a[48:51], a[72:75], v[220:223]
s_add_u32 m0, s54, 106496
v_mfma_f32_16x16x32_bf16 v[224:227], a[52:55], a[60:63], v[224:227]
ds_read_b64_tr_b16 a[20:21], v1 offset:49312
v_mfma_f32_16x16x32_bf16 v[228:231], a[52:55], a[64:67], v[228:231]
ds_read_b64_tr_b16 a[22:23], v1 offset:53920
v_mfma_f32_16x16x32_bf16 v[232:235], a[52:55], a[68:71], v[232:235]
s_add_u32 s53, s53, 8192
buffer_load_dwordx4 v10, s[48:51], s53 offen offset:0 lds
v_mfma_f32_16x16x32_bf16 v[236:239], a[52:55], a[72:75], v[236:239]
ds_read_b64_tr_b16 a[24:25], v1 offset:49344
v_mfma_f32_16x16x32_bf16 v[240:243], a[56:59], a[60:63], v[240:243]
ds_read_b64_tr_b16 a[26:27], v1 offset:53952
v_mfma_f32_16x16x32_bf16 v[244:247], a[56:59], a[64:67], v[244:247]
v_mfma_f32_16x16x32_bf16 v[248:251], a[56:59], a[68:71], v[248:251]
ds_read_b64_tr_b16 a[28:29], v1 offset:49376
v_mfma_f32_16x16x32_bf16 v[252:255], a[56:59], a[72:75], v[252:255]
ds_read_b64_tr_b16 a[30:31], v1 offset:53984
s_waitcnt lgkmcnt(10)
v_mfma_f32_16x16x32_bf16 v[16:19], a[0:3], a[76:79], v[16:19]
buffer_load_dwordx4 v11, s[48:51], s53 offen offset:1024 lds
v_mfma_f32_16x16x32_bf16 v[20:23], a[0:3], a[80:83], v[20:23]
ds_read_b64_tr_b16 a[32:33], v2 offset:49152
v_mfma_f32_16x16x32_bf16 v[24:27], a[0:3], a[84:87], v[24:27]
ds_read_b64_tr_b16 a[34:35], v2 offset:52736
v_mfma_f32_16x16x32_bf16 v[28:31], a[0:3], a[88:91], v[28:31]
v_mfma_f32_16x16x32_bf16 v[32:35], a[4:7], a[76:79], v[32:35]
ds_read_b64_tr_b16 a[36:37], v2 offset:49184
v_mfma_f32_16x16x32_bf16 v[36:39], a[4:7], a[80:83], v[36:39]
ds_read_b64_tr_b16 a[38:39], v2 offset:52768
v_mfma_f32_16x16x32_bf16 v[40:43], a[4:7], a[84:87], v[40:43]
s_add_u32 s53, s53, 8192
v_mfma_f32_16x16x32_bf16 v[44:47], a[4:7], a[88:91], v[44:47]
ds_read_b64_tr_b16 a[40:41], v2 offset:49216
v_mfma_f32_16x16x32_bf16 v[48:51], a[8:11], a[76:79], v[48:51]
ds_read_b64_tr_b16 a[42:43], v2 offset:52800
v_mfma_f32_16x16x32_bf16 v[52:55], a[8:11], a[80:83], v[52:55]
v_mfma_f32_16x16x32_bf16 v[56:59], a[8:11], a[84:87], v[56:59]
ds_read_b64_tr_b16 a[44:45], v2 offset:49248
v_mfma_f32_16x16x32_bf16 v[60:63], a[8:11], a[88:91], v[60:63]
ds_read_b64_tr_b16 a[46:47], v2 offset:52832
s_waitcnt lgkmcnt(12)
v_mfma_f32_16x16x32_bf16 v[64:67], a[12:15], a[76:79], v[64:67]
v_mfma_f32_16x16x32_bf16 v[68:71], a[12:15], a[80:83], v[68:71]
ds_read_b64_tr_b16 a[48:49], v2 offset:49280
v_mfma_f32_16x16x32_bf16 v[72:75], a[12:15], a[84:87], v[72:75]
ds_read_b64_tr_b16 a[50:51], v2 offset:52864
v_mfma_f32_16x16x32_bf16 v[76:79], a[12:15], a[88:91], v[76:79]
v_mfma_f32_16x16x32_bf16 v[80:83], a[16:19], a[76:79], v[80:83]
ds_read_b64_tr_b16 a[52:53], v2 offset:49312
v_mfma_f32_16x16x32_bf16 v[84:87], a[16:19], a[80:83], v[84:87]
ds_read_b64_tr_b16 a[54:55], v2 offset:52896
v_mfma_f32_16x16x32_bf16 v[88:91], a[16:19], a[84:87], v[88:91]
v_mfma_f32_16x16x32_bf16 v[92:95], a[16:19], a[88:91], v[92:95]
ds_read_b64_tr_b16 a[56:57], v2 offset:49344
v_mfma_f32_16x16x32_bf16 v[96:99], a[20:23], a[76:79], v[96:99]
ds_read_b64_tr_b16 a[58:59], v2 offset:52928
v_mfma_f32_16x16x32_bf16 v[100:103], a[20:23], a[80:83], v[100:103]
v_accvgpr_read_b32 v4, a93
v_mfma_f32_16x16x32_bf16 v[104:107], a[20:23], a[84:87], v[104:107]
ds_read_b64 a[96:97], v4 offset:0
v_mfma_f32_16x16x32_bf16 v[108:111], a[20:23], a[88:91], v[108:111]
ds_read_b64 a[100:101], v4 offset:128
s_waitcnt lgkmcnt(14)
v_mfma_f32_16x16x32_bf16 v[112:115], a[24:27], a[76:79], v[112:115]
ds_read_b64 a[104:105], v4 offset:256
v_mfma_f32_16x16x32_bf16 v[116:119], a[24:27], a[80:83], v[116:119]
ds_read_b64 a[108:109], v4 offset:384
v_mfma_f32_16x16x32_bf16 v[120:123], a[24:27], a[84:87], v[120:123]
ds_read_b64 a[112:113], v4 offset:512
v_mfma_f32_16x16x32_bf16 v[124:127], a[24:27], a[88:91], v[124:127]
ds_read_b64 a[116:117], v4 offset:640
v_mfma_f32_16x16x32_bf16 v[128:131], a[28:31], a[76:79], v[128:131]
ds_read_b64 a[120:121], v4 offset:768
v_mfma_f32_16x16x32_bf16 v[132:135], a[28:31], a[80:83], v[132:135]
ds_read_b64 a[124:125], v4 offset:896
v_mfma_f32_16x16x32_bf16 v[136:139], a[28:31], a[84:87], v[136:139]
ds_read_b64 a[128:129], v4 offset:1024
v_mfma_f32_16x16x32_bf16 v[140:143], a[28:31], a[88:91], v[140:143]
ds_read_b64 a[132:133], v4 offset:1152
v_mfma_f32_16x16x32_bf16 v[144:147], a[32:35], a[76:79], v[144:147]
ds_read_b64 a[136:137], v4 offset:1280
v_mfma_f32_16x16x32_bf16 v[148:151], a[32:35], a[80:83], v[148:151]
ds_read_b64 a[140:141], v4 offset:1408
v_mfma_f32_16x16x32_bf16 v[152:155], a[32:35], a[84:87], v[152:155]
ds_read_b64 a[144:145], v4 offset:1536
v_mfma_f32_16x16x32_bf16 v[156:159], a[32:35], a[88:91], v[156:159]
ds_read_b64 a[148:149], v4 offset:1664
s_waitcnt lgkmcnt(15)
v_mfma_f32_16x16x32_bf16 v[160:163], a[36:39], a[76:79], v[160:163]
ds_read_b64 a[152:153], v4 offset:1792
s_mov_b32 s3, 0x3e0293ee
v_mfma_f32_16x16x32_bf16 v[164:167], a[36:39], a[80:83], v[164:167]
v_accvgpr_read_b32 v0, a184
v_accvgpr_read_b32 v1, a185
v_mfma_f32_16x16x32_bf16 v[168:171], a[36:39], a[84:87], v[168:171]
v_rcp_f32 v2, v1
v_cvt_pk_bf16_f32 v3, -v0, -v0
v_mfma_f32_16x16x32_bf16 v[172:175], a[36:39], a[88:91], v[172:175]
s_add_u32 m0, s54, 114688
v_cvt_pk_bf16_f32 v2, -v0, v2
v_accvgpr_write_b32 a156, v3
v_mfma_f32_16x16x32_bf16 v[176:179], a[40:43], a[76:79], v[176:179]
v_accvgpr_write_b32 a157, v2
v_accvgpr_write_b32 a158, 0
v_mfma_f32_16x16x32_bf16 v[180:183], a[40:43], a[80:83], v[180:183]
v_accvgpr_write_b32 a159, 0
v_mul_f32 v12, s3, v1
v_mfma_f32_16x16x32_bf16 v[184:187], a[40:43], a[84:87], v[184:187]
buffer_load_dwordx4 v10, s[48:51], s53 offen offset:0 lds
s_waitcnt vmcnt(16)
v_accvgpr_read_b32 v0, a186
v_accvgpr_read_b32 v1, a187
v_mfma_f32_16x16x32_bf16 v[188:191], a[40:43], a[88:91], v[188:191]
v_rcp_f32 v2, v1
v_cvt_pk_bf16_f32 v3, -v0, -v0
v_mfma_f32_16x16x32_bf16 v[192:195], a[44:47], a[76:79], v[192:195]
v_cvt_pk_bf16_f32 v2, -v0, v2
v_accvgpr_write_b32 a160, v3
v_mfma_f32_16x16x32_bf16 v[196:199], a[44:47], a[80:83], v[196:199]
v_accvgpr_write_b32 a161, v2
v_accvgpr_write_b32 a162, 0
v_mfma_f32_16x16x32_bf16 v[200:203], a[44:47], a[84:87], v[200:203]
v_accvgpr_write_b32 a163, 0
v_mul_f32 v13, s3, v1
v_mfma_f32_16x16x32_bf16 v[204:207], a[44:47], a[88:91], v[204:207]
s_waitcnt vmcnt(15)
v_accvgpr_read_b32 v0, a188
v_accvgpr_read_b32 v1, a189
s_waitcnt lgkmcnt(15)
v_mfma_f32_16x16x32_bf16 v[208:211], a[48:51], a[76:79], v[208:211]
buffer_load_dwordx4 v11, s[48:51], s53 offen offset:1024 lds
v_rcp_f32 v2, v1
v_cvt_pk_bf16_f32 v3, -v0, -v0
v_mfma_f32_16x16x32_bf16 v[212:215], a[48:51], a[80:83], v[212:215]
v_cvt_pk_bf16_f32 v2, -v0, v2
v_accvgpr_write_b32 a164, v3
v_mfma_f32_16x16x32_bf16 v[216:219], a[48:51], a[84:87], v[216:219]
v_accvgpr_write_b32 a165, v2
v_accvgpr_write_b32 a166, 0
v_mfma_f32_16x16x32_bf16 v[220:223], a[48:51], a[88:91], v[220:223]
s_add_u32 m0, s54, 122880
v_accvgpr_write_b32 a167, 0
v_mul_f32 v14, s3, v1
v_mfma_f32_16x16x32_bf16 v[224:227], a[52:55], a[76:79], v[224:227]
s_waitcnt vmcnt(15)
v_accvgpr_read_b32 v0, a190
v_accvgpr_read_b32 v1, a191
v_mfma_f32_16x16x32_bf16 v[228:231], a[52:55], a[80:83], v[228:231]
v_rcp_f32 v2, v1
v_cvt_pk_bf16_f32 v3, -v0, -v0
v_mfma_f32_16x16x32_bf16 v[232:235], a[52:55], a[84:87], v[232:235]
s_add_u32 s53, s53, 8192
buffer_load_dwordx4 v10, s[48:51], s53 offen offset:0 lds
v_cvt_pk_bf16_f32 v2, -v0, v2
v_accvgpr_write_b32 a168, v3
v_mfma_f32_16x16x32_bf16 v[236:239], a[52:55], a[88:91], v[236:239]
v_accvgpr_write_b32 a169, v2
v_accvgpr_write_b32 a170, 0
v_mfma_f32_16x16x32_bf16 v[240:243], a[56:59], a[76:79], v[240:243]
v_accvgpr_write_b32 a171, 0
v_mul_f32 v15, s3, v1
v_mfma_f32_16x16x32_bf16 v[244:247], a[56:59], a[80:83], v[244:247]
v_mfma_f32_16x16x32_bf16 v[248:251], a[56:59], a[84:87], v[248:251]
v_mfma_f32_16x16x32_bf16 v[252:255], a[56:59], a[88:91], v[252:255]
buffer_load_dwordx4 v11, s[48:51], s53 offen offset:1024 lds
s_add_u32 s53, s53, 8192
L_trans_k:
s_add_u32 s40, s88, 4194304
s_addc_u32 s41, s89, 0
s_and_b32 s41, s41, 0xffff
s_mov_b32 s42, 0x4000000
s_mov_b32 s43, 0x00020000
s_mul_i32 s38, s27, 7
s_and_b32 s39, s27, 1
s_add_u32 s33, s38, s39
s_lshl_b32 s33, s33, 16
s_cmp_eq_u32 s39, 0
s_cselect_b32 s39, 6, 0
s_add_u32 s39, s38, s39
s_lshr_b32 s3, s39, 1
s_lshl_b32 s3, s3, 17
s_and_b32 s39, s39, 1
s_lshl_b32 s39, s39, 16
s_add_u32 s32, s39, s3
v_accvgpr_read_b32 v0, a213
v_accvgpr_read_b32 v3, a214
v_accvgpr_read_b32 v4, a185
v_accvgpr_read_b32 v5, a187
v_accvgpr_read_b32 v6, a189
v_accvgpr_read_b32 v7, a191
v_mul_f32 v4, 0x3f99be61, v4
v_mul_f32 v5, 0x3f99be61, v5
v_mul_f32 v6, 0x3f99be61, v6
v_mul_f32 v7, 0x3f99be61, v7
v_bfe_u32 v2, v0, 5, 1
v_bfe_u32 v1, v0, 4, 2
v_sub_u32 v1, v2, v1
v_lshlrev_b32 v1, 15, v1
v_add_u32 v1, v3, v1
v_and_b32 v2, 16, v0
v_cmp_eq_u32 vcc, 0, v2
v_mov_b32 v2, 0x40000000
s_nop 0
v_cndmask_b32 v1, v2, v1, vcc
s_bitcmp1_b32 s27, 0
s_cbranch_scc1 L_hodd_k
s_waitcnt lgkmcnt(14)
v_mfma_f32_16x16x32_bf16 v[16:19], a[96:99], a[156:159], v[16:19]
s_waitcnt lgkmcnt(13)
v_mfma_f32_16x16x32_bf16 v[32:35], a[100:103], a[156:159], v[32:35]
s_waitcnt lgkmcnt(6)
v_mfma_f32_16x16x32_bf16 v[144:147], a[128:131], a[156:159], v[144:147]
s_waitcnt lgkmcnt(5)
v_mfma_f32_16x16x32_bf16 v[160:163], a[132:135], a[156:159], v[160:163]
s_nop 1
v_mul_f32 v16, v16, v12
v_mul_f32 v17, v17, v12
v_mul_f32 v18, v18, v12
v_mul_f32 v19, v19, v12
v_mul_f32 v32, v32, v12
v_mul_f32 v33, v33, v12
v_mul_f32 v34, v34, v12
v_mul_f32 v35, v35, v12
v_cvt_pk_bf16_f32 v16, v16, v17
v_cvt_pk_bf16_f32 v17, v18, v19
v_cvt_pk_bf16_f32 v32, v32, v33
v_cvt_pk_bf16_f32 v33, v34, v35
s_nop 0
v_permlane32_swap_b32 v16, v32
v_permlane32_swap_b32 v17, v33
v_mfma_f32_16x16x32_bf16 v[20:23], a[96:99], a[160:163], v[20:23]
v_permlane16_swap_b32 v16, v32
v_permlane16_swap_b32 v17, v33
v_mfma_f32_16x16x32_bf16 v[36:39], a[100:103], a[160:163], v[36:39]
v_accvgpr_write_b32 a0, v16
v_accvgpr_write_b32 a1, v17
v_accvgpr_write_b32 a2, v32
v_accvgpr_write_b32 a3, v33
v_max_f32 v144, 0, v144
v_max_f32 v145, 0, v145
v_max_f32 v146, 0, v146
v_max_f32 v147, 0, v147
v_mul_f32 v144, v144, v4
v_mul_f32 v145, v145, v4
v_mul_f32 v146, v146, v4
v_mul_f32 v147, v147, v4
v_mul_f32 v144, v144, v144
v_mul_f32 v145, v145, v145
v_mul_f32 v146, v146, v146
v_mul_f32 v147, v147, v147
v_mfma_f32_16x16x32_bf16 v[148:151], a[128:131], a[160:163], v[148:151]
v_max_f32 v160, 0, v160
v_max_f32 v161, 0, v161
v_max_f32 v162, 0, v162
v_max_f32 v163, 0, v163
v_mul_f32 v160, v160, v4
v_mul_f32 v161, v161, v4
v_mul_f32 v162, v162, v4
v_mul_f32 v163, v163, v4
v_mul_f32 v160, v160, v160
v_mul_f32 v161, v161, v161
v_mul_f32 v162, v162, v162
v_mul_f32 v163, v163, v163
v_mfma_f32_16x16x32_bf16 v[164:167], a[132:135], a[160:163], v[164:167]
v_cvt_pk_bf16_f32 v144, v144, v145
v_cvt_pk_bf16_f32 v145, v146, v147
v_cvt_pk_bf16_f32 v146, v160, v161
v_cvt_pk_bf16_f32 v147, v162, v163
s_add_u32 s3, s33, 0
buffer_store_dwordx4 v[144:147], v3, s[40:43], s3 offen offset:0 sc0 sc1
v_mul_f32 v20, v20, v13
v_mul_f32 v21, v21, v13
v_mul_f32 v22, v22, v13
v_mul_f32 v23, v23, v13
v_mul_f32 v36, v36, v13
v_mul_f32 v37, v37, v13
v_mul_f32 v38, v38, v13
v_mul_f32 v39, v39, v13
v_cvt_pk_bf16_f32 v20, v20, v21
v_cvt_pk_bf16_f32 v21, v22, v23
v_cvt_pk_bf16_f32 v36, v36, v37
v_cvt_pk_bf16_f32 v37, v38, v39
s_nop 0
v_permlane32_swap_b32 v20, v36
v_permlane32_swap_b32 v21, v37
v_mfma_f32_16x16x32_bf16 v[24:27], a[96:99], a[164:167], v[24:27]
v_permlane16_swap_b32 v20, v36
v_permlane16_swap_b32 v21, v37
v_mfma_f32_16x16x32_bf16 v[40:43], a[100:103], a[164:167], v[40:43]
v_accvgpr_write_b32 a4, v20
v_accvgpr_write_b32 a5, v21
v_accvgpr_write_b32 a6, v36
v_accvgpr_write_b32 a7, v37
v_max_f32 v148, 0, v148
v_max_f32 v149, 0, v149
v_max_f32 v150, 0, v150
v_max_f32 v151, 0, v151
v_mul_f32 v148, v148, v5
v_mul_f32 v149, v149, v5
v_mul_f32 v150, v150, v5
v_mul_f32 v151, v151, v5
v_mul_f32 v148, v148, v148
v_mul_f32 v149, v149, v149
v_mul_f32 v150, v150, v150
v_mul_f32 v151, v151, v151
v_mfma_f32_16x16x32_bf16 v[152:155], a[128:131], a[164:167], v[152:155]
v_max_f32 v164, 0, v164
v_max_f32 v165, 0, v165
v_max_f32 v166, 0, v166
v_max_f32 v167, 0, v167
v_mul_f32 v164, v164, v5
v_mul_f32 v165, v165, v5
v_mul_f32 v166, v166, v5
v_mul_f32 v167, v167, v5
v_mul_f32 v164, v164, v164
v_mul_f32 v165, v165, v165
v_mul_f32 v166, v166, v166
v_mul_f32 v167, v167, v167
v_mfma_f32_16x16x32_bf16 v[168:171], a[132:135], a[164:167], v[168:171]
v_cvt_pk_bf16_f32 v148, v148, v149
v_cvt_pk_bf16_f32 v149, v150, v151
v_cvt_pk_bf16_f32 v150, v164, v165
v_cvt_pk_bf16_f32 v151, v166, v167
s_add_u32 s3, s33, 0
buffer_store_dwordx4 v[148:151], v3, s[40:43], s3 offen offset:256 sc0 sc1
v_mul_f32 v24, v24, v14
v_mul_f32 v25, v25, v14
v_mul_f32 v26, v26, v14
v_mul_f32 v27, v27, v14
v_mul_f32 v40, v40, v14
v_mul_f32 v41, v41, v14
v_mul_f32 v42, v42, v14
v_mul_f32 v43, v43, v14
v_cvt_pk_bf16_f32 v24, v24, v25
v_cvt_pk_bf16_f32 v25, v26, v27
v_cvt_pk_bf16_f32 v40, v40, v41
v_cvt_pk_bf16_f32 v41, v42, v43
s_nop 0
v_permlane32_swap_b32 v24, v40
v_permlane32_swap_b32 v25, v41
v_mfma_f32_16x16x32_bf16 v[28:31], a[96:99], a[168:171], v[28:31]
v_permlane16_swap_b32 v24, v40
v_permlane16_swap_b32 v25, v41
v_mfma_f32_16x16x32_bf16 v[44:47], a[100:103], a[168:171], v[44:47]
v_accvgpr_write_b32 a8, v24
v_accvgpr_write_b32 a9, v25
v_accvgpr_write_b32 a10, v40
v_accvgpr_write_b32 a11, v41
v_max_f32 v152, 0, v152
v_max_f32 v153, 0, v153
v_max_f32 v154, 0, v154
v_max_f32 v155, 0, v155
v_mul_f32 v152, v152, v6
v_mul_f32 v153, v153, v6
v_mul_f32 v154, v154, v6
v_mul_f32 v155, v155, v6
v_mul_f32 v152, v152, v152
v_mul_f32 v153, v153, v153
v_mul_f32 v154, v154, v154
v_mul_f32 v155, v155, v155
v_mfma_f32_16x16x32_bf16 v[156:159], a[128:131], a[168:171], v[156:159]
v_max_f32 v168, 0, v168
v_max_f32 v169, 0, v169
v_max_f32 v170, 0, v170
v_max_f32 v171, 0, v171
v_mul_f32 v168, v168, v6
v_mul_f32 v169, v169, v6
v_mul_f32 v170, v170, v6
v_mul_f32 v171, v171, v6
v_mul_f32 v168, v168, v168
v_mul_f32 v169, v169, v169
v_mul_f32 v170, v170, v170
v_mul_f32 v171, v171, v171
v_mfma_f32_16x16x32_bf16 v[172:175], a[132:135], a[168:171], v[172:175]
v_cvt_pk_bf16_f32 v152, v152, v153
v_cvt_pk_bf16_f32 v153, v154, v155
v_cvt_pk_bf16_f32 v154, v168, v169
v_cvt_pk_bf16_f32 v155, v170, v171
s_add_u32 s3, s33, 0
buffer_store_dwordx4 v[152:155], v3, s[40:43], s3 offen offset:512 sc0 sc1
v_mul_f32 v28, v28, v15
v_mul_f32 v29, v29, v15
v_mul_f32 v30, v30, v15
v_mul_f32 v31, v31, v15
v_mul_f32 v44, v44, v15
v_mul_f32 v45, v45, v15
v_mul_f32 v46, v46, v15
v_mul_f32 v47, v47, v15
v_cvt_pk_bf16_f32 v28, v28, v29
v_cvt_pk_bf16_f32 v29, v30, v31
v_cvt_pk_bf16_f32 v44, v44, v45
v_cvt_pk_bf16_f32 v45, v46, v47
s_nop 0
v_permlane32_swap_b32 v28, v44
v_permlane32_swap_b32 v29, v45
v_mfma_f32_16x16x32_bf16 v[48:51], a[104:107], a[156:159], v[48:51]
v_permlane16_swap_b32 v28, v44
v_permlane16_swap_b32 v29, v45
v_mfma_f32_16x16x32_bf16 v[64:67], a[108:111], a[156:159], v[64:67]
v_accvgpr_write_b32 a12, v28
v_accvgpr_write_b32 a13, v29
v_accvgpr_write_b32 a14, v44
v_accvgpr_write_b32 a15, v45
v_max_f32 v156, 0, v156
v_max_f32 v157, 0, v157
v_max_f32 v158, 0, v158
v_max_f32 v159, 0, v159
v_mul_f32 v156, v156, v7
v_mul_f32 v157, v157, v7
v_mul_f32 v158, v158, v7
v_mul_f32 v159, v159, v7
v_mul_f32 v156, v156, v156
v_mul_f32 v157, v157, v157
v_mul_f32 v158, v158, v158
v_mul_f32 v159, v159, v159
s_waitcnt lgkmcnt(4)
v_mfma_f32_16x16x32_bf16 v[176:179], a[136:139], a[156:159], v[176:179]
v_max_f32 v172, 0, v172
v_max_f32 v173, 0, v173
v_max_f32 v174, 0, v174
v_max_f32 v175, 0, v175
v_mul_f32 v172, v172, v7
v_mul_f32 v173, v173, v7
v_mul_f32 v174, v174, v7
v_mul_f32 v175, v175, v7
v_mul_f32 v172, v172, v172
v_mul_f32 v173, v173, v173
v_mul_f32 v174, v174, v174
v_mul_f32 v175, v175, v175
s_waitcnt lgkmcnt(3)
v_mfma_f32_16x16x32_bf16 v[192:195], a[140:143], a[156:159], v[192:195]
v_cvt_pk_bf16_f32 v156, v156, v157
v_cvt_pk_bf16_f32 v157, v158, v159
v_cvt_pk_bf16_f32 v158, v172, v173
v_cvt_pk_bf16_f32 v159, v174, v175
s_add_u32 s3, s33, 0
buffer_store_dwordx4 v[156:159], v3, s[40:43], s3 offen offset:768 sc0 sc1
v_mul_f32 v48, v48, v12
v_mul_f32 v49, v49, v12
v_mul_f32 v50, v50, v12
v_mul_f32 v51, v51, v12
v_mul_f32 v64, v64, v12
v_mul_f32 v65, v65, v12
v_mul_f32 v66, v66, v12
v_mul_f32 v67, v67, v12
v_cvt_pk_bf16_f32 v48, v48, v49
v_cvt_pk_bf16_f32 v49, v50, v51
v_cvt_pk_bf16_f32 v64, v64, v65
v_cvt_pk_bf16_f32 v65, v66, v67
s_nop 0
v_permlane32_swap_b32 v48, v64
v_permlane32_swap_b32 v49, v65
v_mfma_f32_16x16x32_bf16 v[52:55], a[104:107], a[160:163], v[52:55]
v_permlane16_swap_b32 v48, v64
v_permlane16_swap_b32 v49, v65
v_mfma_f32_16x16x32_bf16 v[68:71], a[108:111], a[160:163], v[68:71]
v_accvgpr_write_b32 a16, v48
v_accvgpr_write_b32 a17, v49
v_accvgpr_write_b32 a18, v64
v_accvgpr_write_b32 a19, v65
v_max_f32 v176, 0, v176
v_max_f32 v177, 0, v177
v_max_f32 v178, 0, v178
v_max_f32 v179, 0, v179
v_mul_f32 v176, v176, v4
v_mul_f32 v177, v177, v4
v_mul_f32 v178, v178, v4
v_mul_f32 v179, v179, v4
v_mul_f32 v176, v176, v176
v_mul_f32 v177, v177, v177
v_mul_f32 v178, v178, v178
v_mul_f32 v179, v179, v179
v_mfma_f32_16x16x32_bf16 v[180:183], a[136:139], a[160:163], v[180:183]
v_max_f32 v192, 0, v192
v_max_f32 v193, 0, v193
v_max_f32 v194, 0, v194
v_max_f32 v195, 0, v195
v_mul_f32 v192, v192, v4
v_mul_f32 v193, v193, v4
v_mul_f32 v194, v194, v4
v_mul_f32 v195, v195, v4
v_mul_f32 v192, v192, v192
v_mul_f32 v193, v193, v193
v_mul_f32 v194, v194, v194
v_mul_f32 v195, v195, v195
v_mfma_f32_16x16x32_bf16 v[196:199], a[140:143], a[160:163], v[196:199]
v_cvt_pk_bf16_f32 v176, v176, v177
v_cvt_pk_bf16_f32 v177, v178, v179
v_cvt_pk_bf16_f32 v178, v192, v193
v_cvt_pk_bf16_f32 v179, v194, v195
s_add_u32 s3, s33, 131072
buffer_store_dwordx4 v[176:179], v3, s[40:43], s3 offen offset:0 sc0 sc1
v_mul_f32 v52, v52, v13
v_mul_f32 v53, v53, v13
v_mul_f32 v54, v54, v13
v_mul_f32 v55, v55, v13
v_mul_f32 v68, v68, v13
v_mul_f32 v69, v69, v13
v_mul_f32 v70, v70, v13
v_mul_f32 v71, v71, v13
v_cvt_pk_bf16_f32 v52, v52, v53
v_cvt_pk_bf16_f32 v53, v54, v55
v_cvt_pk_bf16_f32 v68, v68, v69
v_cvt_pk_bf16_f32 v69, v70, v71
s_nop 0
v_permlane32_swap_b32 v52, v68
v_permlane32_swap_b32 v53, v69
v_mfma_f32_16x16x32_bf16 v[56:59], a[104:107], a[164:167], v[56:59]
v_permlane16_swap_b32 v52, v68
v_permlane16_swap_b32 v53, v69
v_mfma_f32_16x16x32_bf16 v[72:75], a[108:111], a[164:167], v[72:75]
v_accvgpr_write_b32 a20, v52
v_accvgpr_write_b32 a21, v53
v_accvgpr_write_b32 a22, v68
v_accvgpr_write_b32 a23, v69
v_max_f32 v180, 0, v180
v_max_f32 v181, 0, v181
v_max_f32 v182, 0, v182
v_max_f32 v183, 0, v183
v_mul_f32 v180, v180, v5
v_mul_f32 v181, v181, v5
v_mul_f32 v182, v182, v5
v_mul_f32 v183, v183, v5
v_mul_f32 v180, v180, v180
v_mul_f32 v181, v181, v181
v_mul_f32 v182, v182, v182
v_mul_f32 v183, v183, v183
v_mfma_f32_16x16x32_bf16 v[184:187], a[136:139], a[164:167], v[184:187]
v_max_f32 v196, 0, v196
v_max_f32 v197, 0, v197
v_max_f32 v198, 0, v198
v_max_f32 v199, 0, v199
v_mul_f32 v196, v196, v5
v_mul_f32 v197, v197, v5
v_mul_f32 v198, v198, v5
v_mul_f32 v199, v199, v5
v_mul_f32 v196, v196, v196
v_mul_f32 v197, v197, v197
v_mul_f32 v198, v198, v198
v_mul_f32 v199, v199, v199
v_mfma_f32_16x16x32_bf16 v[200:203], a[140:143], a[164:167], v[200:203]
v_cvt_pk_bf16_f32 v180, v180, v181
v_cvt_pk_bf16_f32 v181, v182, v183
v_cvt_pk_bf16_f32 v182, v196, v197
v_cvt_pk_bf16_f32 v183, v198, v199
s_add_u32 s3, s33, 131072
buffer_store_dwordx4 v[180:183], v3, s[40:43], s3 offen offset:256 sc0 sc1
v_mul_f32 v56, v56, v14
v_mul_f32 v57, v57, v14
v_mul_f32 v58, v58, v14
v_mul_f32 v59, v59, v14
v_mul_f32 v72, v72, v14
v_mul_f32 v73, v73, v14
v_mul_f32 v74, v74, v14
v_mul_f32 v75, v75, v14
v_cvt_pk_bf16_f32 v56, v56, v57
v_cvt_pk_bf16_f32 v57, v58, v59
v_cvt_pk_bf16_f32 v72, v72, v73
v_cvt_pk_bf16_f32 v73, v74, v75
s_nop 0
v_permlane32_swap_b32 v56, v72
v_permlane32_swap_b32 v57, v73
v_mfma_f32_16x16x32_bf16 v[60:63], a[104:107], a[168:171], v[60:63]
v_permlane16_swap_b32 v56, v72
v_permlane16_swap_b32 v57, v73
v_mfma_f32_16x16x32_bf16 v[76:79], a[108:111], a[168:171], v[76:79]
v_accvgpr_write_b32 a24, v56
v_accvgpr_write_b32 a25, v57
v_accvgpr_write_b32 a26, v72
v_accvgpr_write_b32 a27, v73
v_max_f32 v184, 0, v184
v_max_f32 v185, 0, v185
v_max_f32 v186, 0, v186
v_max_f32 v187, 0, v187
v_mul_f32 v184, v184, v6
v_mul_f32 v185, v185, v6
v_mul_f32 v186, v186, v6
v_mul_f32 v187, v187, v6
v_mul_f32 v184, v184, v184
v_mul_f32 v185, v185, v185
v_mul_f32 v186, v186, v186
v_mul_f32 v187, v187, v187
v_mfma_f32_16x16x32_bf16 v[188:191], a[136:139], a[168:171], v[188:191]
v_max_f32 v200, 0, v200
v_max_f32 v201, 0, v201
v_max_f32 v202, 0, v202
v_max_f32 v203, 0, v203
v_mul_f32 v200, v200, v6
v_mul_f32 v201, v201, v6
v_mul_f32 v202, v202, v6
v_mul_f32 v203, v203, v6
v_mul_f32 v200, v200, v200
v_mul_f32 v201, v201, v201
v_mul_f32 v202, v202, v202
v_mul_f32 v203, v203, v203
v_mfma_f32_16x16x32_bf16 v[204:207], a[140:143], a[168:171], v[204:207]
v_cvt_pk_bf16_f32 v184, v184, v185
v_cvt_pk_bf16_f32 v185, v186, v187
v_cvt_pk_bf16_f32 v186, v200, v201
v_cvt_pk_bf16_f32 v187, v202, v203
s_add_u32 s3, s33, 131072
buffer_store_dwordx4 v[184:187], v3, s[40:43], s3 offen offset:512 sc0 sc1
v_mul_f32 v60, v60, v15
v_mul_f32 v61, v61, v15
v_mul_f32 v62, v62, v15
v_mul_f32 v63, v63, v15
v_mul_f32 v76, v76, v15
v_mul_f32 v77, v77, v15
v_mul_f32 v78, v78, v15
v_mul_f32 v79, v79, v15
v_cvt_pk_bf16_f32 v60, v60, v61
v_cvt_pk_bf16_f32 v61, v62, v63
v_cvt_pk_bf16_f32 v76, v76, v77
v_cvt_pk_bf16_f32 v77, v78, v79
s_nop 0
v_permlane32_swap_b32 v60, v76
v_permlane32_swap_b32 v61, v77
v_mfma_f32_16x16x32_bf16 v[80:83], a[112:115], a[156:159], v[80:83]
v_permlane16_swap_b32 v60, v76
v_permlane16_swap_b32 v61, v77
v_mfma_f32_16x16x32_bf16 v[96:99], a[116:119], a[156:159], v[96:99]
v_accvgpr_write_b32 a28, v60
v_accvgpr_write_b32 a29, v61
v_accvgpr_write_b32 a30, v76
v_accvgpr_write_b32 a31, v77
v_max_f32 v188, 0, v188
v_max_f32 v189, 0, v189
v_max_f32 v190, 0, v190
v_max_f32 v191, 0, v191
v_mul_f32 v188, v188, v7
v_mul_f32 v189, v189, v7
v_mul_f32 v190, v190, v7
v_mul_f32 v191, v191, v7
v_mul_f32 v188, v188, v188
v_mul_f32 v189, v189, v189
v_mul_f32 v190, v190, v190
v_mul_f32 v191, v191, v191
s_waitcnt lgkmcnt(2)
v_mfma_f32_16x16x32_bf16 v[208:211], a[144:147], a[156:159], v[208:211]
v_max_f32 v204, 0, v204
v_max_f32 v205, 0, v205
v_max_f32 v206, 0, v206
v_max_f32 v207, 0, v207
v_mul_f32 v204, v204, v7
v_mul_f32 v205, v205, v7
v_mul_f32 v206, v206, v7
v_mul_f32 v207, v207, v7
v_mul_f32 v204, v204, v204
v_mul_f32 v205, v205, v205
v_mul_f32 v206, v206, v206
v_mul_f32 v207, v207, v207
s_waitcnt lgkmcnt(1)
v_mfma_f32_16x16x32_bf16 v[224:227], a[148:151], a[156:159], v[224:227]
v_cvt_pk_bf16_f32 v188, v188, v189
v_cvt_pk_bf16_f32 v189, v190, v191
v_cvt_pk_bf16_f32 v190, v204, v205
v_cvt_pk_bf16_f32 v191, v206, v207
s_add_u32 s3, s33, 131072
buffer_store_dwordx4 v[188:191], v3, s[40:43], s3 offen offset:768 sc0 sc1
v_mul_f32 v80, v80, v12
v_mul_f32 v81, v81, v12
v_mul_f32 v82, v82, v12
v_mul_f32 v83, v83, v12
v_mul_f32 v96, v96, v12
v_mul_f32 v97, v97, v12
v_mul_f32 v98, v98, v12
v_mul_f32 v99, v99, v12
v_cvt_pk_bf16_f32 v80, v80, v81
v_cvt_pk_bf16_f32 v81, v82, v83
v_cvt_pk_bf16_f32 v96, v96, v97
v_cvt_pk_bf16_f32 v97, v98, v99
s_nop 0
v_permlane32_swap_b32 v80, v96
v_permlane32_swap_b32 v81, v97
v_mfma_f32_16x16x32_bf16 v[84:87], a[112:115], a[160:163], v[84:87]
v_permlane16_swap_b32 v80, v96
v_permlane16_swap_b32 v81, v97
v_mfma_f32_16x16x32_bf16 v[100:103], a[116:119], a[160:163], v[100:103]
v_accvgpr_write_b32 a32, v80
v_accvgpr_write_b32 a33, v81
v_accvgpr_write_b32 a34, v96
v_accvgpr_write_b32 a35, v97
v_max_f32 v208, 0, v208
v_max_f32 v209, 0, v209
v_max_f32 v210, 0, v210
v_max_f32 v211, 0, v211
v_mul_f32 v208, v208, v4
v_mul_f32 v209, v209, v4
v_mul_f32 v210, v210, v4
v_mul_f32 v211, v211, v4
v_mul_f32 v208, v208, v208
v_mul_f32 v209, v209, v209
v_mul_f32 v210, v210, v210
v_mul_f32 v211, v211, v211
v_mfma_f32_16x16x32_bf16 v[212:215], a[144:147], a[160:163], v[212:215]
v_max_f32 v224, 0, v224
v_max_f32 v225, 0, v225
v_max_f32 v226, 0, v226
v_max_f32 v227, 0, v227
v_mul_f32 v224, v224, v4
v_mul_f32 v225, v225, v4
v_mul_f32 v226, v226, v4
v_mul_f32 v227, v227, v4
v_mul_f32 v224, v224, v224
v_mul_f32 v225, v225, v225
v_mul_f32 v226, v226, v226
v_mul_f32 v227, v227, v227
v_mfma_f32_16x16x32_bf16 v[228:231], a[148:151], a[160:163], v[228:231]
v_cvt_pk_bf16_f32 v208, v208, v209
v_cvt_pk_bf16_f32 v209, v210, v211
v_cvt_pk_bf16_f32 v210, v224, v225
v_cvt_pk_bf16_f32 v211, v226, v227
s_add_u32 s3, s33, 262144
buffer_store_dwordx4 v[208:211], v3, s[40:43], s3 offen offset:0 sc0 sc1
v_mul_f32 v84, v84, v13
v_mul_f32 v85, v85, v13
v_mul_f32 v86, v86, v13
v_mul_f32 v87, v87, v13
v_mul_f32 v100, v100, v13
v_mul_f32 v101, v101, v13
v_mul_f32 v102, v102, v13
v_mul_f32 v103, v103, v13
v_cvt_pk_bf16_f32 v84, v84, v85
v_cvt_pk_bf16_f32 v85, v86, v87
v_cvt_pk_bf16_f32 v100, v100, v101
v_cvt_pk_bf16_f32 v101, v102, v103
s_nop 0
v_permlane32_swap_b32 v84, v100
v_permlane32_swap_b32 v85, v101
v_mfma_f32_16x16x32_bf16 v[88:91], a[112:115], a[164:167], v[88:91]
v_permlane16_swap_b32 v84, v100
v_permlane16_swap_b32 v85, v101
v_mfma_f32_16x16x32_bf16 v[104:107], a[116:119], a[164:167], v[104:107]
v_accvgpr_write_b32 a36, v84
v_accvgpr_write_b32 a37, v85
v_accvgpr_write_b32 a38, v100
v_accvgpr_write_b32 a39, v101
v_max_f32 v212, 0, v212
v_max_f32 v213, 0, v213
v_max_f32 v214, 0, v214
v_max_f32 v215, 0, v215
v_mul_f32 v212, v212, v5
v_mul_f32 v213, v213, v5
v_mul_f32 v214, v214, v5
v_mul_f32 v215, v215, v5
v_mul_f32 v212, v212, v212
v_mul_f32 v213, v213, v213
v_mul_f32 v214, v214, v214
v_mul_f32 v215, v215, v215
v_mfma_f32_16x16x32_bf16 v[216:219], a[144:147], a[164:167], v[216:219]
v_max_f32 v228, 0, v228
v_max_f32 v229, 0, v229
v_max_f32 v230, 0, v230
v_max_f32 v231, 0, v231
v_mul_f32 v228, v228, v5
v_mul_f32 v229, v229, v5
v_mul_f32 v230, v230, v5
v_mul_f32 v231, v231, v5
v_mul_f32 v228, v228, v228
v_mul_f32 v229, v229, v229
v_mul_f32 v230, v230, v230
v_mul_f32 v231, v231, v231
v_mfma_f32_16x16x32_bf16 v[232:235], a[148:151], a[164:167], v[232:235]
v_cvt_pk_bf16_f32 v212, v212, v213
v_cvt_pk_bf16_f32 v213, v214, v215
v_cvt_pk_bf16_f32 v214, v228, v229
v_cvt_pk_bf16_f32 v215, v230, v231
s_add_u32 s3, s33, 262144
buffer_store_dwordx4 v[212:215], v3, s[40:43], s3 offen offset:256 sc0 sc1
v_mul_f32 v88, v88, v14
v_mul_f32 v89, v89, v14
v_mul_f32 v90, v90, v14
v_mul_f32 v91, v91, v14
v_mul_f32 v104, v104, v14
v_mul_f32 v105, v105, v14
v_mul_f32 v106, v106, v14
v_mul_f32 v107, v107, v14
v_cvt_pk_bf16_f32 v88, v88, v89
v_cvt_pk_bf16_f32 v89, v90, v91
v_cvt_pk_bf16_f32 v104, v104, v105
v_cvt_pk_bf16_f32 v105, v106, v107
s_nop 0
v_permlane32_swap_b32 v88, v104
v_permlane32_swap_b32 v89, v105
v_mfma_f32_16x16x32_bf16 v[92:95], a[112:115], a[168:171], v[92:95]
v_permlane16_swap_b32 v88, v104
v_permlane16_swap_b32 v89, v105
v_mfma_f32_16x16x32_bf16 v[108:111], a[116:119], a[168:171], v[108:111]
v_accvgpr_write_b32 a40, v88
v_accvgpr_write_b32 a41, v89
v_accvgpr_write_b32 a42, v104
v_accvgpr_write_b32 a43, v105
v_max_f32 v216, 0, v216
v_max_f32 v217, 0, v217
v_max_f32 v218, 0, v218
v_max_f32 v219, 0, v219
v_mul_f32 v216, v216, v6
v_mul_f32 v217, v217, v6
v_mul_f32 v218, v218, v6
v_mul_f32 v219, v219, v6
v_mul_f32 v216, v216, v216
v_mul_f32 v217, v217, v217
v_mul_f32 v218, v218, v218
v_mul_f32 v219, v219, v219
v_mfma_f32_16x16x32_bf16 v[220:223], a[144:147], a[168:171], v[220:223]
v_max_f32 v232, 0, v232
v_max_f32 v233, 0, v233
v_max_f32 v234, 0, v234
v_max_f32 v235, 0, v235
v_mul_f32 v232, v232, v6
v_mul_f32 v233, v233, v6
v_mul_f32 v234, v234, v6
v_mul_f32 v235, v235, v6
v_mul_f32 v232, v232, v232
v_mul_f32 v233, v233, v233
v_mul_f32 v234, v234, v234
v_mul_f32 v235, v235, v235
v_mfma_f32_16x16x32_bf16 v[236:239], a[148:151], a[168:171], v[236:239]
v_cvt_pk_bf16_f32 v216, v216, v217
v_cvt_pk_bf16_f32 v217, v218, v219
v_cvt_pk_bf16_f32 v218, v232, v233
v_cvt_pk_bf16_f32 v219, v234, v235
s_add_u32 s3, s33, 262144
buffer_store_dwordx4 v[216:219], v3, s[40:43], s3 offen offset:512 sc0 sc1
v_mul_f32 v92, v92, v15
v_mul_f32 v93, v93, v15
v_mul_f32 v94, v94, v15
v_mul_f32 v95, v95, v15
v_mul_f32 v108, v108, v15
v_mul_f32 v109, v109, v15
v_mul_f32 v110, v110, v15
v_mul_f32 v111, v111, v15
v_cvt_pk_bf16_f32 v92, v92, v93
v_cvt_pk_bf16_f32 v93, v94, v95
v_cvt_pk_bf16_f32 v108, v108, v109
v_cvt_pk_bf16_f32 v109, v110, v111
s_nop 0
v_permlane32_swap_b32 v92, v108
v_permlane32_swap_b32 v93, v109
v_mfma_f32_16x16x32_bf16 v[112:115], a[120:123], a[156:159], v[112:115]
v_permlane16_swap_b32 v92, v108
v_permlane16_swap_b32 v93, v109
v_mfma_f32_16x16x32_bf16 v[128:131], a[124:127], a[156:159], v[128:131]
v_accvgpr_write_b32 a44, v92
v_accvgpr_write_b32 a45, v93
v_accvgpr_write_b32 a46, v108
v_accvgpr_write_b32 a47, v109
v_max_f32 v220, 0, v220
v_max_f32 v221, 0, v221
v_max_f32 v222, 0, v222
v_max_f32 v223, 0, v223
v_mul_f32 v220, v220, v7
v_mul_f32 v221, v221, v7
v_mul_f32 v222, v222, v7
v_mul_f32 v223, v223, v7
v_mul_f32 v220, v220, v220
v_mul_f32 v221, v221, v221
v_mul_f32 v222, v222, v222
v_mul_f32 v223, v223, v223
s_waitcnt lgkmcnt(0)
v_mfma_f32_16x16x32_bf16 v[240:243], a[152:155], a[156:159], v[240:243]
v_max_f32 v236, 0, v236
v_max_f32 v237, 0, v237
v_max_f32 v238, 0, v238
v_max_f32 v239, 0, v239
v_mul_f32 v236, v236, v7
v_mul_f32 v237, v237, v7
v_mul_f32 v238, v238, v7
v_mul_f32 v239, v239, v7
v_mul_f32 v236, v236, v236
v_mul_f32 v237, v237, v237
v_mul_f32 v238, v238, v238
v_mul_f32 v239, v239, v239
v_mfma_f32_16x16x32_bf16 v[116:119], a[120:123], a[160:163], v[116:119]
v_cvt_pk_bf16_f32 v220, v220, v221
v_cvt_pk_bf16_f32 v221, v222, v223
v_cvt_pk_bf16_f32 v222, v236, v237
v_cvt_pk_bf16_f32 v223, v238, v239
s_add_u32 s3, s33, 262144
buffer_store_dwordx4 v[220:223], v3, s[40:43], s3 offen offset:768 sc0 sc1
v_mul_f32 v112, v112, v12
v_mul_f32 v113, v113, v12
v_mul_f32 v114, v114, v12
v_mul_f32 v115, v115, v12
v_mul_f32 v128, v128, v12
v_mul_f32 v129, v129, v12
v_mul_f32 v130, v130, v12
v_mul_f32 v131, v131, v12
v_cvt_pk_bf16_f32 v112, v112, v113
v_cvt_pk_bf16_f32 v113, v114, v115
v_cvt_pk_bf16_f32 v128, v128, v129
v_cvt_pk_bf16_f32 v129, v130, v131
s_nop 0
v_permlane32_swap_b32 v112, v128
v_permlane32_swap_b32 v113, v129
v_mfma_f32_16x16x32_bf16 v[132:135], a[124:127], a[160:163], v[132:135]
v_permlane16_swap_b32 v112, v128
v_permlane16_swap_b32 v113, v129
v_mfma_f32_16x16x32_bf16 v[244:247], a[152:155], a[160:163], v[244:247]
v_accvgpr_write_b32 a48, v112
v_accvgpr_write_b32 a49, v113
v_accvgpr_write_b32 a50, v128
v_accvgpr_write_b32 a51, v129
v_max_f32 v240, 0, v240
v_max_f32 v241, 0, v241
v_max_f32 v242, 0, v242
v_max_f32 v243, 0, v243
v_mul_f32 v240, v240, v4
v_mul_f32 v241, v241, v4
v_mul_f32 v242, v242, v4
v_mul_f32 v243, v243, v4
v_mul_f32 v240, v240, v240
v_mul_f32 v241, v241, v241
v_mul_f32 v242, v242, v242
v_mul_f32 v243, v243, v243
v_mfma_f32_16x16x32_bf16 v[120:123], a[120:123], a[164:167], v[120:123]
v_cvt_pk_bf16_f32 v240, v240, v241
v_cvt_pk_bf16_f32 v241, v242, v243
v_mov_b32 v242, v240
v_mov_b32 v243, v241
s_nop 0
v_permlane16_swap_b32 v240, v242
v_permlane16_swap_b32 v241, v243
buffer_store_dwordx4 v[240:243], v1, s[40:43], s32 offen offset:0 sc0 sc1
v_mul_f32 v116, v116, v13
v_mul_f32 v117, v117, v13
v_mul_f32 v118, v118, v13
v_mul_f32 v119, v119, v13
v_mul_f32 v132, v132, v13
v_mul_f32 v133, v133, v13
v_mul_f32 v134, v134, v13
v_mul_f32 v135, v135, v13
v_cvt_pk_bf16_f32 v116, v116, v117
v_cvt_pk_bf16_f32 v117, v118, v119
v_cvt_pk_bf16_f32 v132, v132, v133
v_cvt_pk_bf16_f32 v133, v134, v135
s_nop 0
v_permlane32_swap_b32 v116, v132
v_permlane32_swap_b32 v117, v133
v_mfma_f32_16x16x32_bf16 v[136:139], a[124:127], a[164:167], v[136:139]
v_permlane16_swap_b32 v116, v132
v_permlane16_swap_b32 v117, v133
v_mfma_f32_16x16x32_bf16 v[248:251], a[152:155], a[164:167], v[248:251]
v_accvgpr_write_b32 a52, v116
v_accvgpr_write_b32 a53, v117
v_accvgpr_write_b32 a54, v132
v_accvgpr_write_b32 a55, v133
v_max_f32 v244, 0, v244
v_max_f32 v245, 0, v245
v_max_f32 v246, 0, v246
v_max_f32 v247, 0, v247
v_mul_f32 v244, v244, v5
v_mul_f32 v245, v245, v5
v_mul_f32 v246, v246, v5
v_mul_f32 v247, v247, v5
v_mul_f32 v244, v244, v244
v_mul_f32 v245, v245, v245
v_mul_f32 v246, v246, v246
v_mul_f32 v247, v247, v247
v_mfma_f32_16x16x32_bf16 v[124:127], a[120:123], a[168:171], v[124:127]
v_cvt_pk_bf16_f32 v244, v244, v245
v_cvt_pk_bf16_f32 v245, v246, v247
v_mov_b32 v246, v244
v_mov_b32 v247, v245
s_nop 0
v_permlane16_swap_b32 v244, v246
v_permlane16_swap_b32 v245, v247
buffer_store_dwordx4 v[244:247], v1, s[40:43], s32 offen offset:256 sc0 sc1
v_mul_f32 v120, v120, v14
v_mul_f32 v121, v121, v14
v_mul_f32 v122, v122, v14
v_mul_f32 v123, v123, v14
v_mul_f32 v136, v136, v14
v_mul_f32 v137, v137, v14
v_mul_f32 v138, v138, v14
v_mul_f32 v139, v139, v14
v_cvt_pk_bf16_f32 v120, v120, v121
v_cvt_pk_bf16_f32 v121, v122, v123
v_cvt_pk_bf16_f32 v136, v136, v137
v_cvt_pk_bf16_f32 v137, v138, v139
s_nop 0
v_permlane32_swap_b32 v120, v136
v_permlane32_swap_b32 v121, v137
v_mfma_f32_16x16x32_bf16 v[140:143], a[124:127], a[168:171], v[140:143]
v_permlane16_swap_b32 v120, v136
v_permlane16_swap_b32 v121, v137
v_mfma_f32_16x16x32_bf16 v[252:255], a[152:155], a[168:171], v[252:255]
v_accvgpr_write_b32 a56, v120
v_accvgpr_write_b32 a57, v121
v_accvgpr_write_b32 a58, v136
v_accvgpr_write_b32 a59, v137
v_max_f32 v248, 0, v248
v_max_f32 v249, 0, v249
v_max_f32 v250, 0, v250
v_max_f32 v251, 0, v251
v_mul_f32 v248, v248, v6
v_mul_f32 v249, v249, v6
v_mul_f32 v250, v250, v6
v_mul_f32 v251, v251, v6
v_mul_f32 v248, v248, v248
v_mul_f32 v249, v249, v249
v_mul_f32 v250, v250, v250
v_mul_f32 v251, v251, v251
v_cvt_pk_bf16_f32 v248, v248, v249
v_cvt_pk_bf16_f32 v249, v250, v251
v_mov_b32 v250, v248
v_mov_b32 v251, v249
s_nop 0
v_permlane16_swap_b32 v248, v250
v_permlane16_swap_b32 v249, v251
buffer_store_dwordx4 v[248:251], v1, s[40:43], s32 offen offset:512 sc0 sc1
v_mul_f32 v124, v124, v15
v_mul_f32 v125, v125, v15
v_mul_f32 v126, v126, v15
v_mul_f32 v127, v127, v15
v_mul_f32 v140, v140, v15
v_mul_f32 v141, v141, v15
v_mul_f32 v142, v142, v15
v_mul_f32 v143, v143, v15
v_cvt_pk_bf16_f32 v124, v124, v125
v_cvt_pk_bf16_f32 v125, v126, v127
v_cvt_pk_bf16_f32 v140, v140, v141
v_cvt_pk_bf16_f32 v141, v142, v143
s_nop 0
v_permlane32_swap_b32 v124, v140
v_permlane32_swap_b32 v125, v141
s_nop 0
v_permlane16_swap_b32 v124, v140
v_permlane16_swap_b32 v125, v141
v_accvgpr_write_b32 a60, v124
v_accvgpr_write_b32 a61, v125
v_accvgpr_write_b32 a62, v140
v_accvgpr_write_b32 a63, v141
v_max_f32 v252, 0, v252
v_max_f32 v253, 0, v253
v_max_f32 v254, 0, v254
v_max_f32 v255, 0, v255
v_mul_f32 v252, v252, v7
v_mul_f32 v253, v253, v7
v_mul_f32 v254, v254, v7
v_mul_f32 v255, v255, v7
v_mul_f32 v252, v252, v252
v_mul_f32 v253, v253, v253
v_mul_f32 v254, v254, v254
v_mul_f32 v255, v255, v255
v_cvt_pk_bf16_f32 v252, v252, v253
v_cvt_pk_bf16_f32 v253, v254, v255
v_mov_b32 v254, v252
v_mov_b32 v255, v253
s_nop 0
v_permlane16_swap_b32 v252, v254
v_permlane16_swap_b32 v253, v255
buffer_store_dwordx4 v[252:255], v1, s[40:43], s32 offen offset:768 sc0 sc1
s_branch L_hjoin_k
L_hodd_k:
s_waitcnt lgkmcnt(14)
v_mfma_f32_16x16x32_bf16 v[16:19], a[96:99], a[156:159], v[16:19]
s_waitcnt lgkmcnt(13)
v_mfma_f32_16x16x32_bf16 v[32:35], a[100:103], a[156:159], v[32:35]
s_waitcnt lgkmcnt(5)
v_mfma_f32_16x16x32_bf16 v[160:163], a[132:135], a[156:159], v[160:163]
s_waitcnt lgkmcnt(4)
v_mfma_f32_16x16x32_bf16 v[176:179], a[136:139], a[156:159], v[176:179]
s_nop 1
v_mul_f32 v16, v16, v12
v_mul_f32 v17, v17, v12
v_mul_f32 v18, v18, v12
v_mul_f32 v19, v19, v12
v_mul_f32 v32, v32, v12
v_mul_f32 v33, v33, v12
v_mul_f32 v34, v34, v12
v_mul_f32 v35, v35, v12
v_cvt_pk_bf16_f32 v16, v16, v17
v_cvt_pk_bf16_f32 v17, v18, v19
v_cvt_pk_bf16_f32 v32, v32, v33
v_cvt_pk_bf16_f32 v33, v34, v35
s_nop 0
v_permlane32_swap_b32 v16, v32
v_permlane32_swap_b32 v17, v33
v_mfma_f32_16x16x32_bf16 v[20:23], a[96:99], a[160:163], v[20:23]
v_permlane16_swap_b32 v16, v32
v_permlane16_swap_b32 v17, v33
v_mfma_f32_16x16x32_bf16 v[36:39], a[100:103], a[160:163], v[36:39]
v_accvgpr_write_b32 a0, v16
v_accvgpr_write_b32 a1, v17
v_accvgpr_write_b32 a2, v32
v_accvgpr_write_b32 a3, v33
v_max_f32 v160, 0, v160
v_max_f32 v161, 0, v161
v_max_f32 v162, 0, v162
v_max_f32 v163, 0, v163
v_mul_f32 v160, v160, v4
v_mul_f32 v161, v161, v4
v_mul_f32 v162, v162, v4
v_mul_f32 v163, v163, v4
v_mul_f32 v160, v160, v160
v_mul_f32 v161, v161, v161
v_mul_f32 v162, v162, v162
v_mul_f32 v163, v163, v163
v_mfma_f32_16x16x32_bf16 v[164:167], a[132:135], a[160:163], v[164:167]
v_max_f32 v176, 0, v176
v_max_f32 v177, 0, v177
v_max_f32 v178, 0, v178
v_max_f32 v179, 0, v179
v_mul_f32 v176, v176, v4
v_mul_f32 v177, v177, v4
v_mul_f32 v178, v178, v4
v_mul_f32 v179, v179, v4
v_mul_f32 v176, v176, v176
v_mul_f32 v177, v177, v177
v_mul_f32 v178, v178, v178
v_mul_f32 v179, v179, v179
v_mfma_f32_16x16x32_bf16 v[180:183], a[136:139], a[160:163], v[180:183]
v_cvt_pk_bf16_f32 v160, v160, v161
v_cvt_pk_bf16_f32 v161, v162, v163
v_cvt_pk_bf16_f32 v162, v176, v177
v_cvt_pk_bf16_f32 v163, v178, v179
s_add_u32 s3, s33, 0
buffer_store_dwordx4 v[160:163], v3, s[40:43], s3 offen offset:0 sc0 sc1
v_mul_f32 v20, v20, v13
v_mul_f32 v21, v21, v13
v_mul_f32 v22, v22, v13
v_mul_f32 v23, v23, v13
v_mul_f32 v36, v36, v13
v_mul_f32 v37, v37, v13
v_mul_f32 v38, v38, v13
v_mul_f32 v39, v39, v13
v_cvt_pk_bf16_f32 v20, v20, v21
v_cvt_pk_bf16_f32 v21, v22, v23
v_cvt_pk_bf16_f32 v36, v36, v37
v_cvt_pk_bf16_f32 v37, v38, v39
s_nop 0
v_permlane32_swap_b32 v20, v36
v_permlane32_swap_b32 v21, v37
v_mfma_f32_16x16x32_bf16 v[24:27], a[96:99], a[164:167], v[24:27]
v_permlane16_swap_b32 v20, v36
v_permlane16_swap_b32 v21, v37
v_mfma_f32_16x16x32_bf16 v[40:43], a[100:103], a[164:167], v[40:43]
v_accvgpr_write_b32 a4, v20
v_accvgpr_write_b32 a5, v21
v_accvgpr_write_b32 a6, v36
v_accvgpr_write_b32 a7, v37
v_max_f32 v164, 0, v164
v_max_f32 v165, 0, v165
v_max_f32 v166, 0, v166
v_max_f32 v167, 0, v167
v_mul_f32 v164, v164, v5
v_mul_f32 v165, v165, v5
v_mul_f32 v166, v166, v5
v_mul_f32 v167, v167, v5
v_mul_f32 v164, v164, v164
v_mul_f32 v165, v165, v165
v_mul_f32 v166, v166, v166
v_mul_f32 v167, v167, v167
v_mfma_f32_16x16x32_bf16 v[168:171], a[132:135], a[164:167], v[168:171]
v_max_f32 v180, 0, v180
v_max_f32 v181, 0, v181
v_max_f32 v182, 0, v182
v_max_f32 v183, 0, v183
v_mul_f32 v180, v180, v5
v_mul_f32 v181, v181, v5
v_mul_f32 v182, v182, v5
v_mul_f32 v183, v183, v5
v_mul_f32 v180, v180, v180
v_mul_f32 v181, v181, v181
v_mul_f32 v182, v182, v182
v_mul_f32 v183, v183, v183
v_mfma_f32_16x16x32_bf16 v[184:187], a[136:139], a[164:167], v[184:187]
v_cvt_pk_bf16_f32 v164, v164, v165
v_cvt_pk_bf16_f32 v165, v166, v167
v_cvt_pk_bf16_f32 v166, v180, v181
v_cvt_pk_bf16_f32 v167, v182, v183
s_add_u32 s3, s33, 0
buffer_store_dwordx4 v[164:167], v3, s[40:43], s3 offen offset:256 sc0 sc1
v_mul_f32 v24, v24, v14
v_mul_f32 v25, v25, v14
v_mul_f32 v26, v26, v14
v_mul_f32 v27, v27, v14
v_mul_f32 v40, v40, v14
v_mul_f32 v41, v41, v14
v_mul_f32 v42, v42, v14
v_mul_f32 v43, v43, v14
v_cvt_pk_bf16_f32 v24, v24, v25
v_cvt_pk_bf16_f32 v25, v26, v27
v_cvt_pk_bf16_f32 v40, v40, v41
v_cvt_pk_bf16_f32 v41, v42, v43
s_nop 0
v_permlane32_swap_b32 v24, v40
v_permlane32_swap_b32 v25, v41
v_mfma_f32_16x16x32_bf16 v[28:31], a[96:99], a[168:171], v[28:31]
v_permlane16_swap_b32 v24, v40
v_permlane16_swap_b32 v25, v41
v_mfma_f32_16x16x32_bf16 v[44:47], a[100:103], a[168:171], v[44:47]
v_accvgpr_write_b32 a8, v24
v_accvgpr_write_b32 a9, v25
v_accvgpr_write_b32 a10, v40
v_accvgpr_write_b32 a11, v41
v_max_f32 v168, 0, v168
v_max_f32 v169, 0, v169
v_max_f32 v170, 0, v170
v_max_f32 v171, 0, v171
v_mul_f32 v168, v168, v6
v_mul_f32 v169, v169, v6
v_mul_f32 v170, v170, v6
v_mul_f32 v171, v171, v6
v_mul_f32 v168, v168, v168
v_mul_f32 v169, v169, v169
v_mul_f32 v170, v170, v170
v_mul_f32 v171, v171, v171
v_mfma_f32_16x16x32_bf16 v[172:175], a[132:135], a[168:171], v[172:175]
v_max_f32 v184, 0, v184
v_max_f32 v185, 0, v185
v_max_f32 v186, 0, v186
v_max_f32 v187, 0, v187
v_mul_f32 v184, v184, v6
v_mul_f32 v185, v185, v6
v_mul_f32 v186, v186, v6
v_mul_f32 v187, v187, v6
v_mul_f32 v184, v184, v184
v_mul_f32 v185, v185, v185
v_mul_f32 v186, v186, v186
v_mul_f32 v187, v187, v187
v_mfma_f32_16x16x32_bf16 v[188:191], a[136:139], a[168:171], v[188:191]
v_cvt_pk_bf16_f32 v168, v168, v169
v_cvt_pk_bf16_f32 v169, v170, v171
v_cvt_pk_bf16_f32 v170, v184, v185
v_cvt_pk_bf16_f32 v171, v186, v187
s_add_u32 s3, s33, 0
buffer_store_dwordx4 v[168:171], v3, s[40:43], s3 offen offset:512 sc0 sc1
v_mul_f32 v28, v28, v15
v_mul_f32 v29, v29, v15
v_mul_f32 v30, v30, v15
v_mul_f32 v31, v31, v15
v_mul_f32 v44, v44, v15
v_mul_f32 v45, v45, v15
v_mul_f32 v46, v46, v15
v_mul_f32 v47, v47, v15
v_cvt_pk_bf16_f32 v28, v28, v29
v_cvt_pk_bf16_f32 v29, v30, v31
v_cvt_pk_bf16_f32 v44, v44, v45
v_cvt_pk_bf16_f32 v45, v46, v47
s_nop 0
v_permlane32_swap_b32 v28, v44
v_permlane32_swap_b32 v29, v45
v_mfma_f32_16x16x32_bf16 v[48:51], a[104:107], a[156:159], v[48:51]
v_permlane16_swap_b32 v28, v44
v_permlane16_swap_b32 v29, v45
v_mfma_f32_16x16x32_bf16 v[64:67], a[108:111], a[156:159], v[64:67]
v_accvgpr_write_b32 a12, v28
v_accvgpr_write_b32 a13, v29
v_accvgpr_write_b32 a14, v44
v_accvgpr_write_b32 a15, v45
v_max_f32 v172, 0, v172
v_max_f32 v173, 0, v173
v_max_f32 v174, 0, v174
v_max_f32 v175, 0, v175
v_mul_f32 v172, v172, v7
v_mul_f32 v173, v173, v7
v_mul_f32 v174, v174, v7
v_mul_f32 v175, v175, v7
v_mul_f32 v172, v172, v172
v_mul_f32 v173, v173, v173
v_mul_f32 v174, v174, v174
v_mul_f32 v175, v175, v175
s_waitcnt lgkmcnt(3)
v_mfma_f32_16x16x32_bf16 v[192:195], a[140:143], a[156:159], v[192:195]
v_max_f32 v188, 0, v188
v_max_f32 v189, 0, v189
v_max_f32 v190, 0, v190
v_max_f32 v191, 0, v191
v_mul_f32 v188, v188, v7
v_mul_f32 v189, v189, v7
v_mul_f32 v190, v190, v7
v_mul_f32 v191, v191, v7
v_mul_f32 v188, v188, v188
v_mul_f32 v189, v189, v189
v_mul_f32 v190, v190, v190
v_mul_f32 v191, v191, v191
s_waitcnt lgkmcnt(2)
v_mfma_f32_16x16x32_bf16 v[208:211], a[144:147], a[156:159], v[208:211]
v_cvt_pk_bf16_f32 v172, v172, v173
v_cvt_pk_bf16_f32 v173, v174, v175
v_cvt_pk_bf16_f32 v174, v188, v189
v_cvt_pk_bf16_f32 v175, v190, v191
s_add_u32 s3, s33, 0
buffer_store_dwordx4 v[172:175], v3, s[40:43], s3 offen offset:768 sc0 sc1
v_mul_f32 v48, v48, v12
v_mul_f32 v49, v49, v12
v_mul_f32 v50, v50, v12
v_mul_f32 v51, v51, v12
v_mul_f32 v64, v64, v12
v_mul_f32 v65, v65, v12
v_mul_f32 v66, v66, v12
v_mul_f32 v67, v67, v12
v_cvt_pk_bf16_f32 v48, v48, v49
v_cvt_pk_bf16_f32 v49, v50, v51
v_cvt_pk_bf16_f32 v64, v64, v65
v_cvt_pk_bf16_f32 v65, v66, v67
s_nop 0
v_permlane32_swap_b32 v48, v64
v_permlane32_swap_b32 v49, v65
v_mfma_f32_16x16x32_bf16 v[52:55], a[104:107], a[160:163], v[52:55]
v_permlane16_swap_b32 v48, v64
v_permlane16_swap_b32 v49, v65
v_mfma_f32_16x16x32_bf16 v[68:71], a[108:111], a[160:163], v[68:71]
v_accvgpr_write_b32 a16, v48
v_accvgpr_write_b32 a17, v49
v_accvgpr_write_b32 a18, v64
v_accvgpr_write_b32 a19, v65
v_max_f32 v192, 0, v192
v_max_f32 v193, 0, v193
v_max_f32 v194, 0, v194
v_max_f32 v195, 0, v195
v_mul_f32 v192, v192, v4
v_mul_f32 v193, v193, v4
v_mul_f32 v194, v194, v4
v_mul_f32 v195, v195, v4
v_mul_f32 v192, v192, v192
v_mul_f32 v193, v193, v193
v_mul_f32 v194, v194, v194
v_mul_f32 v195, v195, v195
v_mfma_f32_16x16x32_bf16 v[196:199], a[140:143], a[160:163], v[196:199]
v_max_f32 v208, 0, v208
v_max_f32 v209, 0, v209
v_max_f32 v210, 0, v210
v_max_f32 v211, 0, v211
v_mul_f32 v208, v208, v4
v_mul_f32 v209, v209, v4
v_mul_f32 v210, v210, v4
v_mul_f32 v211, v211, v4
v_mul_f32 v208, v208, v208
v_mul_f32 v209, v209, v209
v_mul_f32 v210, v210, v210
v_mul_f32 v211, v211, v211
v_mfma_f32_16x16x32_bf16 v[212:215], a[144:147], a[160:163], v[212:215]
v_cvt_pk_bf16_f32 v192, v192, v193
v_cvt_pk_bf16_f32 v193, v194, v195
v_cvt_pk_bf16_f32 v194, v208, v209
v_cvt_pk_bf16_f32 v195, v210, v211
s_add_u32 s3, s33, 131072
buffer_store_dwordx4 v[192:195], v3, s[40:43], s3 offen offset:0 sc0 sc1
v_mul_f32 v52, v52, v13
v_mul_f32 v53, v53, v13
v_mul_f32 v54, v54, v13
v_mul_f32 v55, v55, v13
v_mul_f32 v68, v68, v13
v_mul_f32 v69, v69, v13
v_mul_f32 v70, v70, v13
v_mul_f32 v71, v71, v13
v_cvt_pk_bf16_f32 v52, v52, v53
v_cvt_pk_bf16_f32 v53, v54, v55
v_cvt_pk_bf16_f32 v68, v68, v69
v_cvt_pk_bf16_f32 v69, v70, v71
s_nop 0
v_permlane32_swap_b32 v52, v68
v_permlane32_swap_b32 v53, v69
v_mfma_f32_16x16x32_bf16 v[56:59], a[104:107], a[164:167], v[56:59]
v_permlane16_swap_b32 v52, v68
v_permlane16_swap_b32 v53, v69
v_mfma_f32_16x16x32_bf16 v[72:75], a[108:111], a[164:167], v[72:75]
v_accvgpr_write_b32 a20, v52
v_accvgpr_write_b32 a21, v53
v_accvgpr_write_b32 a22, v68
v_accvgpr_write_b32 a23, v69
v_max_f32 v196, 0, v196
v_max_f32 v197, 0, v197
v_max_f32 v198, 0, v198
v_max_f32 v199, 0, v199
v_mul_f32 v196, v196, v5
v_mul_f32 v197, v197, v5
v_mul_f32 v198, v198, v5
v_mul_f32 v199, v199, v5
v_mul_f32 v196, v196, v196
v_mul_f32 v197, v197, v197
v_mul_f32 v198, v198, v198
v_mul_f32 v199, v199, v199
v_mfma_f32_16x16x32_bf16 v[200:203], a[140:143], a[164:167], v[200:203]
v_max_f32 v212, 0, v212
v_max_f32 v213, 0, v213
v_max_f32 v214, 0, v214
v_max_f32 v215, 0, v215
v_mul_f32 v212, v212, v5
v_mul_f32 v213, v213, v5
v_mul_f32 v214, v214, v5
v_mul_f32 v215, v215, v5
v_mul_f32 v212, v212, v212
v_mul_f32 v213, v213, v213
v_mul_f32 v214, v214, v214
v_mul_f32 v215, v215, v215
v_mfma_f32_16x16x32_bf16 v[216:219], a[144:147], a[164:167], v[216:219]
v_cvt_pk_bf16_f32 v196, v196, v197
v_cvt_pk_bf16_f32 v197, v198, v199
v_cvt_pk_bf16_f32 v198, v212, v213
v_cvt_pk_bf16_f32 v199, v214, v215
s_add_u32 s3, s33, 131072
buffer_store_dwordx4 v[196:199], v3, s[40:43], s3 offen offset:256 sc0 sc1
v_mul_f32 v56, v56, v14
v_mul_f32 v57, v57, v14
v_mul_f32 v58, v58, v14
v_mul_f32 v59, v59, v14
v_mul_f32 v72, v72, v14
v_mul_f32 v73, v73, v14
v_mul_f32 v74, v74, v14
v_mul_f32 v75, v75, v14
v_cvt_pk_bf16_f32 v56, v56, v57
v_cvt_pk_bf16_f32 v57, v58, v59
v_cvt_pk_bf16_f32 v72, v72, v73
v_cvt_pk_bf16_f32 v73, v74, v75
s_nop 0
v_permlane32_swap_b32 v56, v72
v_permlane32_swap_b32 v57, v73
v_mfma_f32_16x16x32_bf16 v[60:63], a[104:107], a[168:171], v[60:63]
v_permlane16_swap_b32 v56, v72
v_permlane16_swap_b32 v57, v73
v_mfma_f32_16x16x32_bf16 v[76:79], a[108:111], a[168:171], v[76:79]
v_accvgpr_write_b32 a24, v56
v_accvgpr_write_b32 a25, v57
v_accvgpr_write_b32 a26, v72
v_accvgpr_write_b32 a27, v73
v_max_f32 v200, 0, v200
v_max_f32 v201, 0, v201
v_max_f32 v202, 0, v202
v_max_f32 v203, 0, v203
v_mul_f32 v200, v200, v6
v_mul_f32 v201, v201, v6
v_mul_f32 v202, v202, v6
v_mul_f32 v203, v203, v6
v_mul_f32 v200, v200, v200
v_mul_f32 v201, v201, v201
v_mul_f32 v202, v202, v202
v_mul_f32 v203, v203, v203
v_mfma_f32_16x16x32_bf16 v[204:207], a[140:143], a[168:171], v[204:207]
v_max_f32 v216, 0, v216
v_max_f32 v217, 0, v217
v_max_f32 v218, 0, v218
v_max_f32 v219, 0, v219
v_mul_f32 v216, v216, v6
v_mul_f32 v217, v217, v6
v_mul_f32 v218, v218, v6
v_mul_f32 v219, v219, v6
v_mul_f32 v216, v216, v216
v_mul_f32 v217, v217, v217
v_mul_f32 v218, v218, v218
v_mul_f32 v219, v219, v219
v_mfma_f32_16x16x32_bf16 v[220:223], a[144:147], a[168:171], v[220:223]
v_cvt_pk_bf16_f32 v200, v200, v201
v_cvt_pk_bf16_f32 v201, v202, v203
v_cvt_pk_bf16_f32 v202, v216, v217
v_cvt_pk_bf16_f32 v203, v218, v219
s_add_u32 s3, s33, 131072
buffer_store_dwordx4 v[200:203], v3, s[40:43], s3 offen offset:512 sc0 sc1
v_mul_f32 v60, v60, v15
v_mul_f32 v61, v61, v15
v_mul_f32 v62, v62, v15
v_mul_f32 v63, v63, v15
v_mul_f32 v76, v76, v15
v_mul_f32 v77, v77, v15
v_mul_f32 v78, v78, v15
v_mul_f32 v79, v79, v15
v_cvt_pk_bf16_f32 v60, v60, v61
v_cvt_pk_bf16_f32 v61, v62, v63
v_cvt_pk_bf16_f32 v76, v76, v77
v_cvt_pk_bf16_f32 v77, v78, v79
s_nop 0
v_permlane32_swap_b32 v60, v76
v_permlane32_swap_b32 v61, v77
v_mfma_f32_16x16x32_bf16 v[80:83], a[112:115], a[156:159], v[80:83]
v_permlane16_swap_b32 v60, v76
v_permlane16_swap_b32 v61, v77
v_mfma_f32_16x16x32_bf16 v[96:99], a[116:119], a[156:159], v[96:99]
v_accvgpr_write_b32 a28, v60
v_accvgpr_write_b32 a29, v61
v_accvgpr_write_b32 a30, v76
v_accvgpr_write_b32 a31, v77
v_max_f32 v204, 0, v204
v_max_f32 v205, 0, v205
v_max_f32 v206, 0, v206
v_max_f32 v207, 0, v207
v_mul_f32 v204, v204, v7
v_mul_f32 v205, v205, v7
v_mul_f32 v206, v206, v7
v_mul_f32 v207, v207, v7
v_mul_f32 v204, v204, v204
v_mul_f32 v205, v205, v205
v_mul_f32 v206, v206, v206
v_mul_f32 v207, v207, v207
s_waitcnt lgkmcnt(1)
v_mfma_f32_16x16x32_bf16 v[224:227], a[148:151], a[156:159], v[224:227]
v_max_f32 v220, 0, v220
v_max_f32 v221, 0, v221
v_max_f32 v222, 0, v222
v_max_f32 v223, 0, v223
v_mul_f32 v220, v220, v7
v_mul_f32 v221, v221, v7
v_mul_f32 v222, v222, v7
v_mul_f32 v223, v223, v7
v_mul_f32 v220, v220, v220
v_mul_f32 v221, v221, v221
v_mul_f32 v222, v222, v222
v_mul_f32 v223, v223, v223
s_waitcnt lgkmcnt(0)
v_mfma_f32_16x16x32_bf16 v[240:243], a[152:155], a[156:159], v[240:243]
v_cvt_pk_bf16_f32 v204, v204, v205
v_cvt_pk_bf16_f32 v205, v206, v207
v_cvt_pk_bf16_f32 v206, v220, v221
v_cvt_pk_bf16_f32 v207, v222, v223
s_add_u32 s3, s33, 131072
buffer_store_dwordx4 v[204:207], v3, s[40:43], s3 offen offset:768 sc0 sc1
v_mul_f32 v80, v80, v12
v_mul_f32 v81, v81, v12
v_mul_f32 v82, v82, v12
v_mul_f32 v83, v83, v12
v_mul_f32 v96, v96, v12
v_mul_f32 v97, v97, v12
v_mul_f32 v98, v98, v12
v_mul_f32 v99, v99, v12
v_cvt_pk_bf16_f32 v80, v80, v81
v_cvt_pk_bf16_f32 v81, v82, v83
v_cvt_pk_bf16_f32 v96, v96, v97
v_cvt_pk_bf16_f32 v97, v98, v99
s_nop 0
v_permlane32_swap_b32 v80, v96
v_permlane32_swap_b32 v81, v97
v_mfma_f32_16x16x32_bf16 v[84:87], a[112:115], a[160:163], v[84:87]
v_permlane16_swap_b32 v80, v96
v_permlane16_swap_b32 v81, v97
v_mfma_f32_16x16x32_bf16 v[100:103], a[116:119], a[160:163], v[100:103]
v_accvgpr_write_b32 a32, v80
v_accvgpr_write_b32 a33, v81
v_accvgpr_write_b32 a34, v96
v_accvgpr_write_b32 a35, v97
v_max_f32 v224, 0, v224
v_max_f32 v225, 0, v225
v_max_f32 v226, 0, v226
v_max_f32 v227, 0, v227
v_mul_f32 v224, v224, v4
v_mul_f32 v225, v225, v4
v_mul_f32 v226, v226, v4
v_mul_f32 v227, v227, v4
v_mul_f32 v224, v224, v224
v_mul_f32 v225, v225, v225
v_mul_f32 v226, v226, v226
v_mul_f32 v227, v227, v227
v_mfma_f32_16x16x32_bf16 v[228:231], a[148:151], a[160:163], v[228:231]
v_max_f32 v240, 0, v240
v_max_f32 v241, 0, v241
v_max_f32 v242, 0, v242
v_max_f32 v243, 0, v243
v_mul_f32 v240, v240, v4
v_mul_f32 v241, v241, v4
v_mul_f32 v242, v242, v4
v_mul_f32 v243, v243, v4
v_mul_f32 v240, v240, v240
v_mul_f32 v241, v241, v241
v_mul_f32 v242, v242, v242
v_mul_f32 v243, v243, v243
v_mfma_f32_16x16x32_bf16 v[244:247], a[152:155], a[160:163], v[244:247]
v_cvt_pk_bf16_f32 v224, v224, v225
v_cvt_pk_bf16_f32 v225, v226, v227
v_cvt_pk_bf16_f32 v226, v240, v241
v_cvt_pk_bf16_f32 v227, v242, v243
s_add_u32 s3, s33, 262144
buffer_store_dwordx4 v[224:227], v3, s[40:43], s3 offen offset:0 sc0 sc1
v_mul_f32 v84, v84, v13
v_mul_f32 v85, v85, v13
v_mul_f32 v86, v86, v13
v_mul_f32 v87, v87, v13
v_mul_f32 v100, v100, v13
v_mul_f32 v101, v101, v13
v_mul_f32 v102, v102, v13
v_mul_f32 v103, v103, v13
v_cvt_pk_bf16_f32 v84, v84, v85
v_cvt_pk_bf16_f32 v85, v86, v87
v_cvt_pk_bf16_f32 v100, v100, v101
v_cvt_pk_bf16_f32 v101, v102, v103
s_nop 0
v_permlane32_swap_b32 v84, v100
v_permlane32_swap_b32 v85, v101
v_mfma_f32_16x16x32_bf16 v[88:91], a[112:115], a[164:167], v[88:91]
v_permlane16_swap_b32 v84, v100
v_permlane16_swap_b32 v85, v101
v_mfma_f32_16x16x32_bf16 v[104:107], a[116:119], a[164:167], v[104:107]
v_accvgpr_write_b32 a36, v84
v_accvgpr_write_b32 a37, v85
v_accvgpr_write_b32 a38, v100
v_accvgpr_write_b32 a39, v101
v_max_f32 v228, 0, v228
v_max_f32 v229, 0, v229
v_max_f32 v230, 0, v230
v_max_f32 v231, 0, v231
v_mul_f32 v228, v228, v5
v_mul_f32 v229, v229, v5
v_mul_f32 v230, v230, v5
v_mul_f32 v231, v231, v5
v_mul_f32 v228, v228, v228
v_mul_f32 v229, v229, v229
v_mul_f32 v230, v230, v230
v_mul_f32 v231, v231, v231
v_mfma_f32_16x16x32_bf16 v[232:235], a[148:151], a[164:167], v[232:235]
v_max_f32 v244, 0, v244
v_max_f32 v245, 0, v245
v_max_f32 v246, 0, v246
v_max_f32 v247, 0, v247
v_mul_f32 v244, v244, v5
v_mul_f32 v245, v245, v5
v_mul_f32 v246, v246, v5
v_mul_f32 v247, v247, v5
v_mul_f32 v244, v244, v244
v_mul_f32 v245, v245, v245
v_mul_f32 v246, v246, v246
v_mul_f32 v247, v247, v247
v_mfma_f32_16x16x32_bf16 v[248:251], a[152:155], a[164:167], v[248:251]
v_cvt_pk_bf16_f32 v228, v228, v229
v_cvt_pk_bf16_f32 v229, v230, v231
v_cvt_pk_bf16_f32 v230, v244, v245
v_cvt_pk_bf16_f32 v231, v246, v247
s_add_u32 s3, s33, 262144
buffer_store_dwordx4 v[228:231], v3, s[40:43], s3 offen offset:256 sc0 sc1
v_mul_f32 v88, v88, v14
v_mul_f32 v89, v89, v14
v_mul_f32 v90, v90, v14
v_mul_f32 v91, v91, v14
v_mul_f32 v104, v104, v14
v_mul_f32 v105, v105, v14
v_mul_f32 v106, v106, v14
v_mul_f32 v107, v107, v14
v_cvt_pk_bf16_f32 v88, v88, v89
v_cvt_pk_bf16_f32 v89, v90, v91
v_cvt_pk_bf16_f32 v104, v104, v105
v_cvt_pk_bf16_f32 v105, v106, v107
s_nop 0
v_permlane32_swap_b32 v88, v104
v_permlane32_swap_b32 v89, v105
v_mfma_f32_16x16x32_bf16 v[92:95], a[112:115], a[168:171], v[92:95]
v_permlane16_swap_b32 v88, v104
v_permlane16_swap_b32 v89, v105
v_mfma_f32_16x16x32_bf16 v[108:111], a[116:119], a[168:171], v[108:111]
v_accvgpr_write_b32 a40, v88
v_accvgpr_write_b32 a41, v89
v_accvgpr_write_b32 a42, v104
v_accvgpr_write_b32 a43, v105
v_max_f32 v232, 0, v232
v_max_f32 v233, 0, v233
v_max_f32 v234, 0, v234
v_max_f32 v235, 0, v235
v_mul_f32 v232, v232, v6
v_mul_f32 v233, v233, v6
v_mul_f32 v234, v234, v6
v_mul_f32 v235, v235, v6
v_mul_f32 v232, v232, v232
v_mul_f32 v233, v233, v233
v_mul_f32 v234, v234, v234
v_mul_f32 v235, v235, v235
v_mfma_f32_16x16x32_bf16 v[236:239], a[148:151], a[168:171], v[236:239]
v_max_f32 v248, 0, v248
v_max_f32 v249, 0, v249
v_max_f32 v250, 0, v250
v_max_f32 v251, 0, v251
v_mul_f32 v248, v248, v6
v_mul_f32 v249, v249, v6
v_mul_f32 v250, v250, v6
v_mul_f32 v251, v251, v6
v_mul_f32 v248, v248, v248
v_mul_f32 v249, v249, v249
v_mul_f32 v250, v250, v250
v_mul_f32 v251, v251, v251
v_mfma_f32_16x16x32_bf16 v[252:255], a[152:155], a[168:171], v[252:255]
v_cvt_pk_bf16_f32 v232, v232, v233
v_cvt_pk_bf16_f32 v233, v234, v235
v_cvt_pk_bf16_f32 v234, v248, v249
v_cvt_pk_bf16_f32 v235, v250, v251
s_add_u32 s3, s33, 262144
buffer_store_dwordx4 v[232:235], v3, s[40:43], s3 offen offset:512 sc0 sc1
v_mul_f32 v92, v92, v15
v_mul_f32 v93, v93, v15
v_mul_f32 v94, v94, v15
v_mul_f32 v95, v95, v15
v_mul_f32 v108, v108, v15
v_mul_f32 v109, v109, v15
v_mul_f32 v110, v110, v15
v_mul_f32 v111, v111, v15
v_cvt_pk_bf16_f32 v92, v92, v93
v_cvt_pk_bf16_f32 v93, v94, v95
v_cvt_pk_bf16_f32 v108, v108, v109
v_cvt_pk_bf16_f32 v109, v110, v111
s_nop 0
v_permlane32_swap_b32 v92, v108
v_permlane32_swap_b32 v93, v109
v_mfma_f32_16x16x32_bf16 v[112:115], a[120:123], a[156:159], v[112:115]
v_permlane16_swap_b32 v92, v108
v_permlane16_swap_b32 v93, v109
v_mfma_f32_16x16x32_bf16 v[128:131], a[124:127], a[156:159], v[128:131]
v_accvgpr_write_b32 a44, v92
v_accvgpr_write_b32 a45, v93
v_accvgpr_write_b32 a46, v108
v_accvgpr_write_b32 a47, v109
v_max_f32 v236, 0, v236
v_max_f32 v237, 0, v237
v_max_f32 v238, 0, v238
v_max_f32 v239, 0, v239
v_mul_f32 v236, v236, v7
v_mul_f32 v237, v237, v7
v_mul_f32 v238, v238, v7
v_mul_f32 v239, v239, v7
v_mul_f32 v236, v236, v236
v_mul_f32 v237, v237, v237
v_mul_f32 v238, v238, v238
v_mul_f32 v239, v239, v239
v_mfma_f32_16x16x32_bf16 v[144:147], a[128:131], a[156:159], v[144:147]
v_max_f32 v252, 0, v252
v_max_f32 v253, 0, v253
v_max_f32 v254, 0, v254
v_max_f32 v255, 0, v255
v_mul_f32 v252, v252, v7
v_mul_f32 v253, v253, v7
v_mul_f32 v254, v254, v7
v_mul_f32 v255, v255, v7
v_mul_f32 v252, v252, v252
v_mul_f32 v253, v253, v253
v_mul_f32 v254, v254, v254
v_mul_f32 v255, v255, v255
v_mfma_f32_16x16x32_bf16 v[116:119], a[120:123], a[160:163], v[116:119]
v_cvt_pk_bf16_f32 v236, v236, v237
v_cvt_pk_bf16_f32 v237, v238, v239
v_cvt_pk_bf16_f32 v238, v252, v253
v_cvt_pk_bf16_f32 v239, v254, v255
s_add_u32 s3, s33, 262144
buffer_store_dwordx4 v[236:239], v3, s[40:43], s3 offen offset:768 sc0 sc1
v_mul_f32 v112, v112, v12
v_mul_f32 v113, v113, v12
v_mul_f32 v114, v114, v12
v_mul_f32 v115, v115, v12
v_mul_f32 v128, v128, v12
v_mul_f32 v129, v129, v12
v_mul_f32 v130, v130, v12
v_mul_f32 v131, v131, v12
v_cvt_pk_bf16_f32 v112, v112, v113
v_cvt_pk_bf16_f32 v113, v114, v115
v_cvt_pk_bf16_f32 v128, v128, v129
v_cvt_pk_bf16_f32 v129, v130, v131
s_nop 0
v_permlane32_swap_b32 v112, v128
v_permlane32_swap_b32 v113, v129
v_mfma_f32_16x16x32_bf16 v[132:135], a[124:127], a[160:163], v[132:135]
v_permlane16_swap_b32 v112, v128
v_permlane16_swap_b32 v113, v129
v_mfma_f32_16x16x32_bf16 v[148:151], a[128:131], a[160:163], v[148:151]
v_accvgpr_write_b32 a48, v112
v_accvgpr_write_b32 a49, v113
v_accvgpr_write_b32 a50, v128
v_accvgpr_write_b32 a51, v129
v_max_f32 v144, 0, v144
v_max_f32 v145, 0, v145
v_max_f32 v146, 0, v146
v_max_f32 v147, 0, v147
v_mul_f32 v144, v144, v4
v_mul_f32 v145, v145, v4
v_mul_f32 v146, v146, v4
v_mul_f32 v147, v147, v4
v_mul_f32 v144, v144, v144
v_mul_f32 v145, v145, v145
v_mul_f32 v146, v146, v146
v_mul_f32 v147, v147, v147
v_mfma_f32_16x16x32_bf16 v[120:123], a[120:123], a[164:167], v[120:123]
v_cvt_pk_bf16_f32 v144, v144, v145
v_cvt_pk_bf16_f32 v145, v146, v147
v_mov_b32 v146, v144
v_mov_b32 v147, v145
s_nop 0
v_permlane16_swap_b32 v144, v146
v_permlane16_swap_b32 v145, v147
buffer_store_dwordx4 v[144:147], v1, s[40:43], s32 offen offset:0 sc0 sc1
v_mul_f32 v116, v116, v13
v_mul_f32 v117, v117, v13
v_mul_f32 v118, v118, v13
v_mul_f32 v119, v119, v13
v_mul_f32 v132, v132, v13
v_mul_f32 v133, v133, v13
v_mul_f32 v134, v134, v13
v_mul_f32 v135, v135, v13
v_cvt_pk_bf16_f32 v116, v116, v117
v_cvt_pk_bf16_f32 v117, v118, v119
v_cvt_pk_bf16_f32 v132, v132, v133
v_cvt_pk_bf16_f32 v133, v134, v135
s_nop 0
v_permlane32_swap_b32 v116, v132
v_permlane32_swap_b32 v117, v133
v_mfma_f32_16x16x32_bf16 v[136:139], a[124:127], a[164:167], v[136:139]
v_permlane16_swap_b32 v116, v132
v_permlane16_swap_b32 v117, v133
v_mfma_f32_16x16x32_bf16 v[152:155], a[128:131], a[164:167], v[152:155]
v_accvgpr_write_b32 a52, v116
v_accvgpr_write_b32 a53, v117
v_accvgpr_write_b32 a54, v132
v_accvgpr_write_b32 a55, v133
v_max_f32 v148, 0, v148
v_max_f32 v149, 0, v149
v_max_f32 v150, 0, v150
v_max_f32 v151, 0, v151
v_mul_f32 v148, v148, v5
v_mul_f32 v149, v149, v5
v_mul_f32 v150, v150, v5
v_mul_f32 v151, v151, v5
v_mul_f32 v148, v148, v148
v_mul_f32 v149, v149, v149
v_mul_f32 v150, v150, v150
v_mul_f32 v151, v151, v151
v_mfma_f32_16x16x32_bf16 v[124:127], a[120:123], a[168:171], v[124:127]
v_cvt_pk_bf16_f32 v148, v148, v149
v_cvt_pk_bf16_f32 v149, v150, v151
v_mov_b32 v150, v148
v_mov_b32 v151, v149
s_nop 0
v_permlane16_swap_b32 v148, v150
v_permlane16_swap_b32 v149, v151
buffer_store_dwordx4 v[148:151], v1, s[40:43], s32 offen offset:256 sc0 sc1
v_mul_f32 v120, v120, v14
v_mul_f32 v121, v121, v14
v_mul_f32 v122, v122, v14
v_mul_f32 v123, v123, v14
v_mul_f32 v136, v136, v14
v_mul_f32 v137, v137, v14
v_mul_f32 v138, v138, v14
v_mul_f32 v139, v139, v14
v_cvt_pk_bf16_f32 v120, v120, v121
v_cvt_pk_bf16_f32 v121, v122, v123
v_cvt_pk_bf16_f32 v136, v136, v137
v_cvt_pk_bf16_f32 v137, v138, v139
s_nop 0
v_permlane32_swap_b32 v120, v136
v_permlane32_swap_b32 v121, v137
v_mfma_f32_16x16x32_bf16 v[140:143], a[124:127], a[168:171], v[140:143]
v_permlane16_swap_b32 v120, v136
v_permlane16_swap_b32 v121, v137
v_mfma_f32_16x16x32_bf16 v[156:159], a[128:131], a[168:171], v[156:159]
v_accvgpr_write_b32 a56, v120
v_accvgpr_write_b32 a57, v121
v_accvgpr_write_b32 a58, v136
v_accvgpr_write_b32 a59, v137
v_max_f32 v152, 0, v152
v_max_f32 v153, 0, v153
v_max_f32 v154, 0, v154
v_max_f32 v155, 0, v155
v_mul_f32 v152, v152, v6
v_mul_f32 v153, v153, v6
v_mul_f32 v154, v154, v6
v_mul_f32 v155, v155, v6
v_mul_f32 v152, v152, v152
v_mul_f32 v153, v153, v153
v_mul_f32 v154, v154, v154
v_mul_f32 v155, v155, v155
v_cvt_pk_bf16_f32 v152, v152, v153
v_cvt_pk_bf16_f32 v153, v154, v155
v_mov_b32 v154, v152
v_mov_b32 v155, v153
s_nop 0
v_permlane16_swap_b32 v152, v154
v_permlane16_swap_b32 v153, v155
buffer_store_dwordx4 v[152:155], v1, s[40:43], s32 offen offset:512 sc0 sc1
v_mul_f32 v124, v124, v15
v_mul_f32 v125, v125, v15
v_mul_f32 v126, v126, v15
v_mul_f32 v127, v127, v15
v_mul_f32 v140, v140, v15
v_mul_f32 v141, v141, v15
v_mul_f32 v142, v142, v15
v_mul_f32 v143, v143, v15
v_cvt_pk_bf16_f32 v124, v124, v125
v_cvt_pk_bf16_f32 v125, v126, v127
v_cvt_pk_bf16_f32 v140, v140, v141
v_cvt_pk_bf16_f32 v141, v142, v143
s_nop 0
v_permlane32_swap_b32 v124, v140
v_permlane32_swap_b32 v125, v141
s_nop 0
v_permlane16_swap_b32 v124, v140
v_permlane16_swap_b32 v125, v141
v_accvgpr_write_b32 a60, v124
v_accvgpr_write_b32 a61, v125
v_accvgpr_write_b32 a62, v140
v_accvgpr_write_b32 a63, v141
v_max_f32 v156, 0, v156
v_max_f32 v157, 0, v157
v_max_f32 v158, 0, v158
v_max_f32 v159, 0, v159
v_mul_f32 v156, v156, v7
v_mul_f32 v157, v157, v7
v_mul_f32 v158, v158, v7
v_mul_f32 v159, v159, v7
v_mul_f32 v156, v156, v156
v_mul_f32 v157, v157, v157
v_mul_f32 v158, v158, v158
v_mul_f32 v159, v159, v159
v_cvt_pk_bf16_f32 v156, v156, v157
v_cvt_pk_bf16_f32 v157, v158, v159
v_mov_b32 v158, v156
v_mov_b32 v159, v157
s_nop 0
v_permlane16_swap_b32 v156, v158
v_permlane16_swap_b32 v157, v159
buffer_store_dwordx4 v[156:159], v1, s[40:43], s32 offen offset:768 sc0 sc1
L_hjoin_k:
v_accvgpr_read_b32 v240, a200
v_accvgpr_read_b32 v241, a201
v_accvgpr_read_b32 v242, a202
v_accvgpr_read_b32 v243, a203
v_accvgpr_read_b32 v244, a204
v_accvgpr_read_b32 v245, a205
v_accvgpr_read_b32 v246, a206
v_accvgpr_read_b32 v247, a207
v_accvgpr_read_b32 v248, a208
v_accvgpr_read_b32 v249, a209
v_accvgpr_read_b32 v250, a210
v_accvgpr_read_b32 v251, a211
v_mov_b32 v224, 0
v_mov_b32 v225, 0
v_mov_b32 v226, 0
v_mov_b32 v227, 0
v_mov_b32 v228, 0
v_mov_b32 v229, 0
v_mov_b32 v230, 0
v_mov_b32 v231, 0
v_mov_b32 v232, 0
v_mov_b32 v233, 0
v_mov_b32 v234, 0
v_mov_b32 v235, 0
v_mov_b32 v236, 0
v_mov_b32 v237, 0
v_mov_b32 v238, 0
v_mov_b32 v239, 0
v_and_b32 v1, 63, v0
v_lshlrev_b32 v1, 2, v1
v_add_u32 v1, 131072, v1
v_mov_b32 v2, 0
s_mov_b32 s55, 0
v_accvgpr_read_b32 v12, a212
s_mov_b32 s4, s72
s_and_b32 s5, s73, 0xffff
s_mov_b32 s6, 0x800000
s_mov_b32 s7, 0x00020000
s_mov_b32 s16, s80
s_and_b32 s17, s81, 0xffff
s_mov_b32 s18, 0x700000
s_mov_b32 s19, 0x00020000
s_getpc_b64 s[36:37]
L_pc1:
s_add_u32 s36, s36, L_attn_k-L_pc1
s_addc_u32 s37, s37, 0
s_mov_b32 s56, s36
s_and_b32 s57, s37, 0xffff
s_mov_b32 s58, L_end_k-L_attn_k
s_mov_b32 s59, 0x00020000
s_lshr_b32 s36, s2, 3
s_lshl_b32 s36, s36, 2
s_add_u32 s36, s36, s26
s_lshl_b32 s36, s36, 10
v_and_b32 v13, 63, v0
v_lshlrev_b32 v13, 4, v13
buffer_load_dwordx4 a[196:199], v13, s[56:59], s36 offen
L_attn_k:
s_waitcnt vmcnt(23)
s_barrier
ds_read_b128 a[64:67], v240 offset:0
ds_read_b128 a[68:71], v241 offset:0
ds_read_b128 a[72:75], v242 offset:0
ds_read_b128 a[76:79], v243 offset:0
ds_read_b128 a[80:83], v240 offset:4096
ds_read_b128 a[84:87], v241 offset:4096
ds_read_b128 a[88:91], v242 offset:4096
ds_read_b128 a[92:95], v243 offset:4096
ds_read_b64_tr_b16 a[96:97], v244 offset:0
ds_read_b64_tr_b16 a[98:99], v244 offset:4096
ds_read_b64_tr_b16 a[100:101], v245 offset:0
ds_read_b64_tr_b16 a[102:103], v245 offset:4096
ds_read_b64_tr_b16 a[104:105], v246 offset:0
ds_read_b64_tr_b16 a[106:107], v246 offset:4096
ds_read_b64_tr_b16 a[108:109], v247 offset:0
ds_read_b64_tr_b16 a[110:111], v247 offset:4096
ds_read_b64_tr_b16 a[112:113], v248 offset:0
ds_read_b64_tr_b16 a[114:115], v248 offset:4096
ds_read_b64_tr_b16 a[116:117], v249 offset:0
ds_read_b64_tr_b16 a[118:119], v249 offset:4096
ds_read_b64_tr_b16 a[120:121], v250 offset:0
ds_read_b64_tr_b16 a[122:123], v250 offset:4096
ds_read_b64_tr_b16 a[124:125], v251 offset:0
ds_read_b64_tr_b16 a[126:127], v251 offset:4096
s_waitcnt lgkmcnt(15)
v_mfma_f32_16x16x32_bf16 v[144:147], a[64:67], a[0:3], v[224:227]
v_mfma_f32_16x16x32_bf16 v[148:151], a[64:67], a[4:7], v[228:231]
v_mfma_f32_16x16x32_bf16 v[152:155], a[64:67], a[8:11], v[232:235]
v_mfma_f32_16x16x32_bf16 v[156:159], a[64:67], a[12:15], v[236:239]
ds_read_b128 a[64:67], v240 offset:8192
v_mfma_f32_16x16x32_bf16 v[144:147], a[68:71], a[16:19], v[144:147]
v_mfma_f32_16x16x32_bf16 v[148:151], a[68:71], a[20:23], v[148:151]
v_mfma_f32_16x16x32_bf16 v[152:155], a[68:71], a[24:27], v[152:155]
v_mfma_f32_16x16x32_bf16 v[156:159], a[68:71], a[28:31], v[156:159]
ds_read_b128 a[68:71], v241 offset:8192
v_mfma_f32_16x16x32_bf16 v[144:147], a[72:75], a[32:35], v[144:147]
v_mfma_f32_16x16x32_bf16 v[148:151], a[72:75], a[36:39], v[148:151]
v_mfma_f32_16x16x32_bf16 v[152:155], a[72:75], a[40:43], v[152:155]
v_mfma_f32_16x16x32_bf16 v[156:159], a[72:75], a[44:47], v[156:159]
ds_read_b128 a[72:75], v242 offset:8192
v_mfma_f32_16x16x32_bf16 v[144:147], a[76:79], a[48:51], v[144:147]
v_mfma_f32_16x16x32_bf16 v[148:151], a[76:79], a[52:55], v[148:151]
v_mfma_f32_16x16x32_bf16 v[152:155], a[76:79], a[56:59], v[152:155]
v_mfma_f32_16x16x32_bf16 v[156:159], a[76:79], a[60:63], v[156:159]
ds_read_b128 a[76:79], v243 offset:8192
v_mfma_f32_16x16x32_bf16 v[160:163], a[80:83], a[0:3], v[224:227]
v_mfma_f32_16x16x32_bf16 v[164:167], a[80:83], a[4:7], v[228:231]
v_mfma_f32_16x16x32_bf16 v[168:171], a[80:83], a[8:11], v[232:235]
s_nop 0
v_exp_f32 v144, v144
v_mfma_f32_16x16x32_bf16 v[172:175], a[80:83], a[12:15], v[236:239]
ds_read_b128 a[80:83], v240 offset:12288
v_mfma_f32_16x16x32_bf16 v[160:163], a[84:87], a[16:19], v[160:163]
v_exp_f32 v145, v145
v_mfma_f32_16x16x32_bf16 v[164:167], a[84:87], a[20:23], v[164:167]
v_exp_f32 v146, v146
v_mfma_f32_16x16x32_bf16 v[168:171], a[84:87], a[24:27], v[168:171]
v_exp_f32 v147, v147
v_mfma_f32_16x16x32_bf16 v[172:175], a[84:87], a[28:31], v[172:175]
ds_read_b128 a[84:87], v241 offset:12288
v_mfma_f32_16x16x32_bf16 v[160:163], a[88:91], a[32:35], v[160:163]
v_exp_f32 v148, v148
v_mfma_f32_16x16x32_bf16 v[164:167], a[88:91], a[36:39], v[164:167]
v_exp_f32 v149, v149
v_mfma_f32_16x16x32_bf16 v[168:171], a[88:91], a[40:43], v[168:171]
v_exp_f32 v150, v150
v_mfma_f32_16x16x32_bf16 v[172:175], a[88:91], a[44:47], v[172:175]
ds_read_b128 a[88:91], v242 offset:12288
v_mfma_f32_16x16x32_bf16 v[160:163], a[92:95], a[48:51], v[160:163]
v_exp_f32 v151, v151
v_mfma_f32_16x16x32_bf16 v[164:167], a[92:95], a[52:55], v[164:167]
v_exp_f32 v152, v152
v_mfma_f32_16x16x32_bf16 v[168:171], a[92:95], a[56:59], v[168:171]
v_exp_f32 v153, v153
v_mfma_f32_16x16x32_bf16 v[172:175], a[92:95], a[60:63], v[172:175]
ds_read_b128 a[92:95], v243 offset:12288
v_exp_f32 v154, v154
v_exp_f32 v155, v155
v_exp_f32 v156, v156
v_exp_f32 v157, v157
v_exp_f32 v158, v158
v_exp_f32 v159, v159
v_exp_f32 v160, v160
v_exp_f32 v161, v161
v_exp_f32 v162, v162
v_exp_f32 v163, v163
v_exp_f32 v164, v164
v_exp_f32 v165, v165
v_exp_f32 v166, v166
v_exp_f32 v167, v167
v_exp_f32 v168, v168
v_exp_f32 v169, v169
v_exp_f32 v170, v170
v_exp_f32 v171, v171
v_exp_f32 v172, v172
v_exp_f32 v173, v173
v_exp_f32 v174, v174
v_exp_f32 v175, v175
s_waitcnt lgkmcnt(7)
v_mfma_f32_16x16x32_bf16 v[176:179], a[64:67], a[0:3], v[224:227]
v_cvt_pk_bf16_f32 v208, v144, v145
v_cvt_pk_bf16_f32 v209, v146, v147
v_mfma_f32_16x16x32_bf16 v[180:183], a[64:67], a[4:7], v[228:231]
v_cvt_pk_bf16_f32 v210, v160, v161
v_cvt_pk_bf16_f32 v211, v162, v163
v_mfma_f32_16x16x32_bf16 v[184:187], a[64:67], a[8:11], v[232:235]
v_cvt_pk_bf16_f32 v212, v148, v149
v_cvt_pk_bf16_f32 v213, v150, v151
v_mfma_f32_16x16x32_bf16 v[188:191], a[64:67], a[12:15], v[236:239]
v_cvt_pk_bf16_f32 v214, v164, v165
v_cvt_pk_bf16_f32 v215, v166, v167
s_waitcnt lgkmcnt(6)
v_mfma_f32_16x16x32_bf16 v[176:179], a[68:71], a[16:19], v[176:179]
v_cvt_pk_bf16_f32 v216, v152, v153
v_cvt_pk_bf16_f32 v217, v154, v155
v_mfma_f32_16x16x32_bf16 v[180:183], a[68:71], a[20:23], v[180:183]
v_cvt_pk_bf16_f32 v218, v168, v169
v_cvt_pk_bf16_f32 v219, v170, v171
v_mfma_f32_16x16x32_bf16 v[184:187], a[68:71], a[24:27], v[184:187]
v_cvt_pk_bf16_f32 v220, v156, v157
v_cvt_pk_bf16_f32 v221, v158, v159
v_mfma_f32_16x16x32_bf16 v[188:191], a[68:71], a[28:31], v[188:191]
v_cvt_pk_bf16_f32 v222, v172, v173
v_cvt_pk_bf16_f32 v223, v174, v175
s_waitcnt lgkmcnt(5)
v_mfma_f32_16x16x32_bf16 v[176:179], a[72:75], a[32:35], v[176:179]
s_waitcnt vmcnt(21) lgkmcnt(0)
s_barrier
v_mfma_f32_16x16x32_bf16 v[180:183], a[72:75], a[36:39], v[180:183]
ds_read_b128 a[64:67], v240 offset:16384
v_mfma_f32_16x16x32_bf16 v[184:187], a[72:75], a[40:43], v[184:187]
ds_read_b128 a[68:71], v241 offset:16384
s_add_u32 m0, s54, 131072
v_mfma_f32_16x16x32_bf16 v[188:191], a[72:75], a[44:47], v[188:191]
buffer_load_dwordx4 v8, s[44:47], s52 offen offset:0 lds
v_mfma_f32_16x16x32_bf16 v[176:179], a[76:79], a[48:51], v[176:179]
ds_read_b128 a[72:75], v242 offset:16384
v_mfma_f32_16x16x32_bf16 v[180:183], a[76:79], a[52:55], v[180:183]
buffer_load_dwordx4 v9, s[44:47], s52 offen offset:1024 lds
v_mfma_f32_16x16x32_bf16 v[184:187], a[76:79], a[56:59], v[184:187]
s_add_u32 m0, s54, 139264
v_mfma_f32_16x16x32_bf16 v[188:191], a[76:79], a[60:63], v[188:191]
s_add_u32 s52, s52, 8192
buffer_load_dwordx4 v8, s[44:47], s52 offen offset:0 lds
v_mfma_f32_16x16x32_bf16 v[192:195], a[80:83], a[0:3], v[224:227]
ds_read_b128 a[76:79], v243 offset:16384
v_mfma_f32_16x16x32_bf16 v[196:199], a[80:83], a[4:7], v[228:231]
buffer_load_dwordx4 v9, s[44:47], s52 offen offset:1024 lds
v_mfma_f32_16x16x32_bf16 v[200:203], a[80:83], a[8:11], v[232:235]
s_add_u32 m0, s54, 98304
v_exp_f32 v176, v176
v_mfma_f32_16x16x32_bf16 v[204:207], a[80:83], a[12:15], v[236:239]
s_add_u32 s52, s52, 8192
buffer_load_dwordx4 v10, s[48:51], s53 offen offset:0 lds
v_mfma_f32_16x16x32_bf16 v[192:195], a[84:87], a[16:19], v[192:195]
ds_read_b128 a[80:83], v240 offset:20480
s_mov_b32 s3, 0
v_mfma_f32_16x16x32_bf16 v[196:199], a[84:87], a[20:23], v[196:199]
buffer_load_dword a240, v12, s[4:7], s3 offen
buffer_load_dwordx4 v11, s[48:51], s53 offen offset:1024 lds
v_mfma_f32_16x16x32_bf16 v[200:203], a[84:87], a[24:27], v[200:203]
v_exp_f32 v177, v177
v_mfma_f32_16x16x32_bf16 v[204:207], a[84:87], a[28:31], v[204:207]
s_add_u32 s53, s53, 8192
v_exp_f32 v178, v178
v_mfma_f32_16x16x32_bf16 v[192:195], a[88:91], a[32:35], v[192:195]
ds_read_b128 a[84:87], v241 offset:20480
v_mfma_f32_16x16x32_bf16 v[196:199], a[88:91], a[36:39], v[196:199]
v_exp_f32 v179, v179
v_mfma_f32_16x16x32_bf16 v[200:203], a[88:91], a[40:43], v[200:203]
v_exp_f32 v180, v180
v_mfma_f32_16x16x32_bf16 v[204:207], a[88:91], a[44:47], v[204:207]
v_exp_f32 v181, v181
v_mfma_f32_16x16x32_bf16 v[192:195], a[92:95], a[48:51], v[192:195]
ds_read_b128 a[88:91], v242 offset:20480
v_mfma_f32_16x16x32_bf16 v[196:199], a[92:95], a[52:55], v[196:199]
v_exp_f32 v182, v182
v_mfma_f32_16x16x32_bf16 v[200:203], a[92:95], a[56:59], v[200:203]
v_exp_f32 v183, v183
v_mfma_f32_16x16x32_bf16 v[204:207], a[92:95], a[60:63], v[204:207]
v_exp_f32 v184, v184
v_mfma_f32_16x16x32_bf16 v[16:19], a[96:99], v[208:211], 0
ds_read_b128 a[92:95], v243 offset:20480
v_mfma_f32_16x16x32_bf16 v[20:23], a[96:99], v[212:215], 0
v_exp_f32 v185, v185
v_mfma_f32_16x16x32_bf16 v[24:27], a[96:99], v[216:219], 0
v_exp_f32 v186, v186
v_mfma_f32_16x16x32_bf16 v[28:31], a[96:99], v[220:223], 0
v_exp_f32 v187, v187
v_mfma_f32_16x16x32_bf16 v[32:35], a[100:103], v[208:211], 0
ds_read_b64_tr_b16 a[96:97], v244 offset:8192
ds_read_b64_tr_b16 a[98:99], v244 offset:12288
v_mfma_f32_16x16x32_bf16 v[36:39], a[100:103], v[212:215], 0
v_exp_f32 v188, v188
v_mfma_f32_16x16x32_bf16 v[40:43], a[100:103], v[216:219], 0
v_exp_f32 v189, v189
v_mfma_f32_16x16x32_bf16 v[44:47], a[100:103], v[220:223], 0
v_exp_f32 v190, v190
v_mfma_f32_16x16x32_bf16 v[48:51], a[104:107], v[208:211], 0
ds_read_b64_tr_b16 a[100:101], v245 offset:8192
ds_read_b64_tr_b16 a[102:103], v245 offset:12288
v_mfma_f32_16x16x32_bf16 v[52:55], a[104:107], v[212:215], 0
v_exp_f32 v191, v191
v_mfma_f32_16x16x32_bf16 v[56:59], a[104:107], v[216:219], 0
v_exp_f32 v192, v192
v_mfma_f32_16x16x32_bf16 v[60:63], a[104:107], v[220:223], 0
v_exp_f32 v193, v193
v_mfma_f32_16x16x32_bf16 v[64:67], a[108:111], v[208:211], 0
ds_read_b64_tr_b16 a[104:105], v246 offset:8192
ds_read_b64_tr_b16 a[106:107], v246 offset:12288
v_mfma_f32_16x16x32_bf16 v[68:71], a[108:111], v[212:215], 0
v_exp_f32 v194, v194
v_mfma_f32_16x16x32_bf16 v[72:75], a[108:111], v[216:219], 0
v_exp_f32 v195, v195
v_mfma_f32_16x16x32_bf16 v[76:79], a[108:111], v[220:223], 0
v_exp_f32 v196, v196
v_mfma_f32_16x16x32_bf16 v[80:83], a[112:115], v[208:211], 0
ds_read_b64_tr_b16 a[108:109], v247 offset:8192
ds_read_b64_tr_b16 a[110:111], v247 offset:12288
v_mfma_f32_16x16x32_bf16 v[84:87], a[112:115], v[212:215], 0
v_exp_f32 v197, v197
v_mfma_f32_16x16x32_bf16 v[88:91], a[112:115], v[216:219], 0
v_exp_f32 v198, v198
v_mfma_f32_16x16x32_bf16 v[92:95], a[112:115], v[220:223], 0
v_exp_f32 v199, v199
v_mfma_f32_16x16x32_bf16 v[96:99], a[116:119], v[208:211], 0
ds_read_b64_tr_b16 a[112:113], v248 offset:8192
ds_read_b64_tr_b16 a[114:115], v248 offset:12288
v_mfma_f32_16x16x32_bf16 v[100:103], a[116:119], v[212:215], 0
v_exp_f32 v200, v200
v_mfma_f32_16x16x32_bf16 v[104:107], a[116:119], v[216:219], 0
v_exp_f32 v201, v201
v_mfma_f32_16x16x32_bf16 v[108:111], a[116:119], v[220:223], 0
v_exp_f32 v202, v202
v_mfma_f32_16x16x32_bf16 v[112:115], a[120:123], v[208:211], 0
ds_read_b64_tr_b16 a[116:117], v249 offset:8192
ds_read_b64_tr_b16 a[118:119], v249 offset:12288
v_mfma_f32_16x16x32_bf16 v[116:119], a[120:123], v[212:215], 0
v_exp_f32 v203, v203
v_mfma_f32_16x16x32_bf16 v[120:123], a[120:123], v[216:219], 0
v_exp_f32 v204, v204
v_mfma_f32_16x16x32_bf16 v[124:127], a[120:123], v[220:223], 0
v_exp_f32 v205, v205
v_mfma_f32_16x16x32_bf16 v[128:131], a[124:127], v[208:211], 0
ds_read_b64_tr_b16 a[120:121], v250 offset:8192
ds_read_b64_tr_b16 a[122:123], v250 offset:12288
v_mfma_f32_16x16x32_bf16 v[132:135], a[124:127], v[212:215], 0
v_exp_f32 v206, v206
v_mfma_f32_16x16x32_bf16 v[136:139], a[124:127], v[216:219], 0
v_exp_f32 v207, v207
v_mfma_f32_16x16x32_bf16 v[140:143], a[124:127], v[220:223], 0
v_mfma_f32_16x16x32_bf16 a[176:179], a[192:195], v[208:211], 0
ds_read_b64_tr_b16 a[124:125], v251 offset:8192
ds_read_b64_tr_b16 a[126:127], v251 offset:12288
v_mfma_f32_16x16x32_bf16 a[180:183], a[192:195], v[212:215], 0
v_mfma_f32_16x16x32_bf16 a[184:187], a[192:195], v[216:219], 0
v_mfma_f32_16x16x32_bf16 a[188:191], a[192:195], v[220:223], 0
s_waitcnt lgkmcnt(15)
v_mfma_f32_16x16x32_bf16 v[144:147], a[64:67], a[0:3], v[224:227]
v_cvt_pk_bf16_f32 v208, v176, v177
v_cvt_pk_bf16_f32 v209, v178, v179
v_mfma_f32_16x16x32_bf16 v[148:151], a[64:67], a[4:7], v[228:231]
v_cvt_pk_bf16_f32 v210, v192, v193
v_cvt_pk_bf16_f32 v211, v194, v195
v_mfma_f32_16x16x32_bf16 v[152:155], a[64:67], a[8:11], v[232:235]
v_cvt_pk_bf16_f32 v212, v180, v181
v_cvt_pk_bf16_f32 v213, v182, v183
v_mfma_f32_16x16x32_bf16 v[156:159], a[64:67], a[12:15], v[236:239]
v_cvt_pk_bf16_f32 v214, v196, v197
v_cvt_pk_bf16_f32 v215, v198, v199
v_mfma_f32_16x16x32_bf16 v[144:147], a[68:71], a[16:19], v[144:147]
v_cvt_pk_bf16_f32 v216, v184, v185
v_cvt_pk_bf16_f32 v217, v186, v187
v_mfma_f32_16x16x32_bf16 v[148:151], a[68:71], a[20:23], v[148:151]
v_cvt_pk_bf16_f32 v218, v200, v201
v_cvt_pk_bf16_f32 v219, v202, v203
v_mfma_f32_16x16x32_bf16 v[152:155], a[68:71], a[24:27], v[152:155]
v_cvt_pk_bf16_f32 v220, v188, v189
v_cvt_pk_bf16_f32 v221, v190, v191
v_mfma_f32_16x16x32_bf16 v[156:159], a[68:71], a[28:31], v[156:159]
v_cvt_pk_bf16_f32 v222, v204, v205
v_cvt_pk_bf16_f32 v223, v206, v207
v_mfma_f32_16x16x32_bf16 v[144:147], a[72:75], a[32:35], v[144:147]
s_waitcnt vmcnt(26) lgkmcnt(0)
s_barrier
v_mfma_f32_16x16x32_bf16 v[148:151], a[72:75], a[36:39], v[148:151]
ds_read_b128 a[64:67], v240 offset:24576
v_mfma_f32_16x16x32_bf16 v[152:155], a[72:75], a[40:43], v[152:155]
ds_read_b128 a[68:71], v241 offset:24576
s_add_u32 m0, s54, 147456
v_mfma_f32_16x16x32_bf16 v[156:159], a[72:75], a[44:47], v[156:159]
buffer_load_dwordx4 v8, s[44:47], s52 offen offset:0 lds
v_mfma_f32_16x16x32_bf16 v[144:147], a[76:79], a[48:51], v[144:147]
ds_read_b128 a[72:75], v242 offset:24576
v_mfma_f32_16x16x32_bf16 v[148:151], a[76:79], a[52:55], v[148:151]
buffer_load_dwordx4 v9, s[44:47], s52 offen offset:1024 lds
v_mfma_f32_16x16x32_bf16 v[152:155], a[76:79], a[56:59], v[152:155]
s_add_u32 m0, s54, 106496
v_mfma_f32_16x16x32_bf16 v[156:159], a[76:79], a[60:63], v[156:159]
s_add_u32 s52, s52, 8192
buffer_load_dwordx4 v10, s[48:51], s53 offen offset:0 lds
v_mfma_f32_16x16x32_bf16 v[160:163], a[80:83], a[0:3], v[224:227]
ds_read_b128 a[76:79], v243 offset:24576
v_mfma_f32_16x16x32_bf16 v[164:167], a[80:83], a[4:7], v[228:231]
buffer_load_dwordx4 v11, s[48:51], s53 offen offset:1024 lds
v_mfma_f32_16x16x32_bf16 v[168:171], a[80:83], a[8:11], v[232:235]
v_exp_f32 v144, v144
v_mfma_f32_16x16x32_bf16 v[172:175], a[80:83], a[12:15], v[236:239]
s_add_u32 s53, s53, 8192
v_exp_f32 v145, v145
v_mfma_f32_16x16x32_bf16 v[160:163], a[84:87], a[16:19], v[160:163]
ds_read_b128 a[80:83], v240 offset:28672
s_mov_b32 s3, 0
v_mfma_f32_16x16x32_bf16 v[164:167], a[84:87], a[20:23], v[164:167]
buffer_load_dword a241, v12, s[16:19], s3 offen
v_mfma_f32_16x16x32_bf16 v[168:171], a[84:87], a[24:27], v[168:171]
v_exp_f32 v146, v146
v_mfma_f32_16x16x32_bf16 v[172:175], a[84:87], a[28:31], v[172:175]
v_exp_f32 v147, v147
v_mfma_f32_16x16x32_bf16 v[160:163], a[88:91], a[32:35], v[160:163]
ds_read_b128 a[84:87], v241 offset:28672
v_mfma_f32_16x16x32_bf16 v[164:167], a[88:91], a[36:39], v[164:167]
v_exp_f32 v148, v148
v_mfma_f32_16x16x32_bf16 v[168:171], a[88:91], a[40:43], v[168:171]
v_exp_f32 v149, v149
v_mfma_f32_16x16x32_bf16 v[172:175], a[88:91], a[44:47], v[172:175]
v_exp_f32 v150, v150
v_mfma_f32_16x16x32_bf16 v[160:163], a[92:95], a[48:51], v[160:163]
ds_read_b128 a[88:91], v242 offset:28672
v_mfma_f32_16x16x32_bf16 v[164:167], a[92:95], a[52:55], v[164:167]
v_exp_f32 v151, v151
v_mfma_f32_16x16x32_bf16 v[168:171], a[92:95], a[56:59], v[168:171]
v_exp_f32 v152, v152
v_mfma_f32_16x16x32_bf16 v[172:175], a[92:95], a[60:63], v[172:175]
v_exp_f32 v153, v153
v_mfma_f32_16x16x32_bf16 v[16:19], a[96:99], v[208:211], v[16:19]
ds_read_b128 a[92:95], v243 offset:28672
v_mfma_f32_16x16x32_bf16 v[20:23], a[96:99], v[212:215], v[20:23]
v_exp_f32 v154, v154
v_mfma_f32_16x16x32_bf16 v[24:27], a[96:99], v[216:219], v[24:27]
v_exp_f32 v155, v155
v_mfma_f32_16x16x32_bf16 v[28:31], a[96:99], v[220:223], v[28:31]
v_exp_f32 v156, v156
v_mfma_f32_16x16x32_bf16 v[32:35], a[100:103], v[208:211], v[32:35]
ds_read_b64_tr_b16 a[96:97], v244 offset:16384
ds_read_b64_tr_b16 a[98:99], v244 offset:20480
v_mfma_f32_16x16x32_bf16 v[36:39], a[100:103], v[212:215], v[36:39]
v_exp_f32 v157, v157
v_mfma_f32_16x16x32_bf16 v[40:43], a[100:103], v[216:219], v[40:43]
v_exp_f32 v158, v158
v_mfma_f32_16x16x32_bf16 v[44:47], a[100:103], v[220:223], v[44:47]
v_exp_f32 v159, v159
v_mfma_f32_16x16x32_bf16 v[48:51], a[104:107], v[208:211], v[48:51]
ds_read_b64_tr_b16 a[100:101], v245 offset:16384
ds_read_b64_tr_b16 a[102:103], v245 offset:20480
v_mfma_f32_16x16x32_bf16 v[52:55], a[104:107], v[212:215], v[52:55]
v_exp_f32 v160, v160
v_mfma_f32_16x16x32_bf16 v[56:59], a[104:107], v[216:219], v[56:59]
v_exp_f32 v161, v161
v_mfma_f32_16x16x32_bf16 v[60:63], a[104:107], v[220:223], v[60:63]
v_exp_f32 v162, v162
v_mfma_f32_16x16x32_bf16 v[64:67], a[108:111], v[208:211], v[64:67]
ds_read_b64_tr_b16 a[104:105], v246 offset:16384
ds_read_b64_tr_b16 a[106:107], v246 offset:20480
v_mfma_f32_16x16x32_bf16 v[68:71], a[108:111], v[212:215], v[68:71]
v_exp_f32 v163, v163
v_mfma_f32_16x16x32_bf16 v[72:75], a[108:111], v[216:219], v[72:75]
v_exp_f32 v164, v164
v_mfma_f32_16x16x32_bf16 v[76:79], a[108:111], v[220:223], v[76:79]
v_exp_f32 v165, v165
v_mfma_f32_16x16x32_bf16 v[80:83], a[112:115], v[208:211], v[80:83]
ds_read_b64_tr_b16 a[108:109], v247 offset:16384
ds_read_b64_tr_b16 a[110:111], v247 offset:20480
v_mfma_f32_16x16x32_bf16 v[84:87], a[112:115], v[212:215], v[84:87]
v_exp_f32 v166, v166
v_mfma_f32_16x16x32_bf16 v[88:91], a[112:115], v[216:219], v[88:91]
v_exp_f32 v167, v167
v_mfma_f32_16x16x32_bf16 v[92:95], a[112:115], v[220:223], v[92:95]
v_exp_f32 v168, v168
v_mfma_f32_16x16x32_bf16 v[96:99], a[116:119], v[208:211], v[96:99]
ds_read_b64_tr_b16 a[112:113], v248 offset:16384
ds_read_b64_tr_b16 a[114:115], v248 offset:20480
v_mfma_f32_16x16x32_bf16 v[100:103], a[116:119], v[212:215], v[100:103]
v_exp_f32 v169, v169
v_mfma_f32_16x16x32_bf16 v[104:107], a[116:119], v[216:219], v[104:107]
v_exp_f32 v170, v170
v_mfma_f32_16x16x32_bf16 v[108:111], a[116:119], v[220:223], v[108:111]
v_exp_f32 v171, v171
v_mfma_f32_16x16x32_bf16 v[112:115], a[120:123], v[208:211], v[112:115]
ds_read_b64_tr_b16 a[116:117], v249 offset:16384
ds_read_b64_tr_b16 a[118:119], v249 offset:20480
v_mfma_f32_16x16x32_bf16 v[116:119], a[120:123], v[212:215], v[116:119]
v_exp_f32 v172, v172
v_mfma_f32_16x16x32_bf16 v[120:123], a[120:123], v[216:219], v[120:123]
v_exp_f32 v173, v173
v_mfma_f32_16x16x32_bf16 v[124:127], a[120:123], v[220:223], v[124:127]
v_exp_f32 v174, v174
v_mfma_f32_16x16x32_bf16 v[128:131], a[124:127], v[208:211], v[128:131]
ds_read_b64_tr_b16 a[120:121], v250 offset:16384
ds_read_b64_tr_b16 a[122:123], v250 offset:20480
v_mfma_f32_16x16x32_bf16 v[132:135], a[124:127], v[212:215], v[132:135]
v_exp_f32 v175, v175
v_mfma_f32_16x16x32_bf16 v[136:139], a[124:127], v[216:219], v[136:139]
v_mfma_f32_16x16x32_bf16 v[140:143], a[124:127], v[220:223], v[140:143]
v_mfma_f32_16x16x32_bf16 a[176:179], a[192:195], v[208:211], a[176:179]
ds_read_b64_tr_b16 a[124:125], v251 offset:16384
ds_read_b64_tr_b16 a[126:127], v251 offset:20480
v_mfma_f32_16x16x32_bf16 a[180:183], a[192:195], v[212:215], a[180:183]
v_mfma_f32_16x16x32_bf16 a[184:187], a[192:195], v[216:219], a[184:187]
v_mfma_f32_16x16x32_bf16 a[188:191], a[192:195], v[220:223], a[188:191]
s_waitcnt lgkmcnt(15)
v_mfma_f32_16x16x32_bf16 v[176:179], a[64:67], a[0:3], v[224:227]
v_cvt_pk_bf16_f32 v208, v144, v145
v_cvt_pk_bf16_f32 v209, v146, v147
v_mfma_f32_16x16x32_bf16 v[180:183], a[64:67], a[4:7], v[228:231]
v_cvt_pk_bf16_f32 v210, v160, v161
v_cvt_pk_bf16_f32 v211, v162, v163
v_mfma_f32_16x16x32_bf16 v[184:187], a[64:67], a[8:11], v[232:235]
v_cvt_pk_bf16_f32 v212, v148, v149
v_cvt_pk_bf16_f32 v213, v150, v151
v_mfma_f32_16x16x32_bf16 v[188:191], a[64:67], a[12:15], v[236:239]
v_cvt_pk_bf16_f32 v214, v164, v165
v_cvt_pk_bf16_f32 v215, v166, v167
v_mfma_f32_16x16x32_bf16 v[176:179], a[68:71], a[16:19], v[176:179]
v_cvt_pk_bf16_f32 v216, v152, v153
v_cvt_pk_bf16_f32 v217, v154, v155
v_mfma_f32_16x16x32_bf16 v[180:183], a[68:71], a[20:23], v[180:183]
v_cvt_pk_bf16_f32 v218, v168, v169
v_cvt_pk_bf16_f32 v219, v170, v171
v_mfma_f32_16x16x32_bf16 v[184:187], a[68:71], a[24:27], v[184:187]
v_cvt_pk_bf16_f32 v220, v156, v157
v_cvt_pk_bf16_f32 v221, v158, v159
v_mfma_f32_16x16x32_bf16 v[188:191], a[68:71], a[28:31], v[188:191]
v_cvt_pk_bf16_f32 v222, v172, v173
v_cvt_pk_bf16_f32 v223, v174, v175
v_mfma_f32_16x16x32_bf16 v[176:179], a[72:75], a[32:35], v[176:179]
s_waitcnt vmcnt(10) lgkmcnt(0)
s_barrier
v_mfma_f32_16x16x32_bf16 v[180:183], a[72:75], a[36:39], v[180:183]
ds_read_b128 a[64:67], v240 offset:0
s_cmp_eq_u32 s26, 0
s_cbranch_scc0 L_f2_k
s_add_u32 s56, s88, 41943040
s_addc_u32 s57, s89, 0
s_and_b32 s57, s57, 0xffff
s_mov_b32 s58, 0x4000
s_mov_b32 s59, 0x00020000
s_lshl_b32 s38, s28, 8
s_lshl_b32 s39, s27, 2
s_add_u32 s38, s38, s39
s_add_u32 s38, s38, 0
v_mov_b32 v14, 1
v_mov_b32 v15, s38
v_and_b32 v13, 63, v0
v_cmp_eq_u32 vcc, 0, v13
s_nop 0
s_and_saveexec_b64 s[36:37], vcc
buffer_store_dword v14, v15, s[56:59], 0 offen sc0 sc1
s_mov_b64 exec, s[36:37]
L_f2_k:
v_mfma_f32_16x16x32_bf16 v[184:187], a[72:75], a[40:43], v[184:187]
ds_read_b128 a[68:71], v241 offset:0
s_add_u32 m0, s54, 155648
v_mfma_f32_16x16x32_bf16 v[188:191], a[72:75], a[44:47], v[188:191]
buffer_load_dwordx4 v8, s[44:47], s52 offen offset:0 lds
v_mfma_f32_16x16x32_bf16 v[176:179], a[76:79], a[48:51], v[176:179]
ds_read_b128 a[72:75], v242 offset:0
v_mfma_f32_16x16x32_bf16 v[180:183], a[76:79], a[52:55], v[180:183]
buffer_load_dwordx4 v9, s[44:47], s52 offen offset:1024 lds
v_mfma_f32_16x16x32_bf16 v[184:187], a[76:79], a[56:59], v[184:187]
s_add_u32 m0, s54, 114688
v_mfma_f32_16x16x32_bf16 v[188:191], a[76:79], a[60:63], v[188:191]
s_add_u32 s52, s52, 8192
buffer_load_dwordx4 v10, s[48:51], s53 offen offset:0 lds
v_mfma_f32_16x16x32_bf16 v[192:195], a[80:83], a[0:3], v[224:227]
ds_read_b128 a[76:79], v243 offset:0
v_mfma_f32_16x16x32_bf16 v[196:199], a[80:83], a[4:7], v[228:231]
buffer_load_dwordx4 v11, s[48:51], s53 offen offset:1024 lds
v_mfma_f32_16x16x32_bf16 v[200:203], a[80:83], a[8:11], v[232:235]
v_exp_f32 v176, v176
v_mfma_f32_16x16x32_bf16 v[204:207], a[80:83], a[12:15], v[236:239]
s_add_u32 s53, s53, 8192
v_exp_f32 v177, v177
v_mfma_f32_16x16x32_bf16 v[192:195], a[84:87], a[16:19], v[192:195]
ds_read_b128 a[80:83], v240 offset:4096
s_mov_b32 s3, 1048576
v_mfma_f32_16x16x32_bf16 v[196:199], a[84:87], a[20:23], v[196:199]
buffer_load_dword a242, v12, s[4:7], s3 offen
v_mfma_f32_16x16x32_bf16 v[200:203], a[84:87], a[24:27], v[200:203]
v_exp_f32 v178, v178
v_mfma_f32_16x16x32_bf16 v[204:207], a[84:87], a[28:31], v[204:207]
v_exp_f32 v179, v179
v_mfma_f32_16x16x32_bf16 v[192:195], a[88:91], a[32:35], v[192:195]
ds_read_b128 a[84:87], v241 offset:4096
v_mfma_f32_16x16x32_bf16 v[196:199], a[88:91], a[36:39], v[196:199]
v_exp_f32 v180, v180
v_mfma_f32_16x16x32_bf16 v[200:203], a[88:91], a[40:43], v[200:203]
v_exp_f32 v181, v181
v_mfma_f32_16x16x32_bf16 v[204:207], a[88:91], a[44:47], v[204:207]
v_exp_f32 v182, v182
v_mfma_f32_16x16x32_bf16 v[192:195], a[92:95], a[48:51], v[192:195]
ds_read_b128 a[88:91], v242 offset:4096
v_mfma_f32_16x16x32_bf16 v[196:199], a[92:95], a[52:55], v[196:199]
v_exp_f32 v183, v183
v_mfma_f32_16x16x32_bf16 v[200:203], a[92:95], a[56:59], v[200:203]
v_exp_f32 v184, v184
v_mfma_f32_16x16x32_bf16 v[204:207], a[92:95], a[60:63], v[204:207]
v_exp_f32 v185, v185
v_mfma_f32_16x16x32_bf16 v[16:19], a[96:99], v[208:211], v[16:19]
ds_read_b128 a[92:95], v243 offset:4096
v_mfma_f32_16x16x32_bf16 v[20:23], a[96:99], v[212:215], v[20:23]
v_exp_f32 v186, v186
v_mfma_f32_16x16x32_bf16 v[24:27], a[96:99], v[216:219], v[24:27]
v_exp_f32 v187, v187
v_mfma_f32_16x16x32_bf16 v[28:31], a[96:99], v[220:223], v[28:31]
v_exp_f32 v188, v188
v_mfma_f32_16x16x32_bf16 v[32:35], a[100:103], v[208:211], v[32:35]
ds_read_b64_tr_b16 a[96:97], v244 offset:24576
ds_read_b64_tr_b16 a[98:99], v244 offset:28672
v_mfma_f32_16x16x32_bf16 v[36:39], a[100:103], v[212:215], v[36:39]
v_exp_f32 v189, v189
v_mfma_f32_16x16x32_bf16 v[40:43], a[100:103], v[216:219], v[40:43]
v_exp_f32 v190, v190
v_mfma_f32_16x16x32_bf16 v[44:47], a[100:103], v[220:223], v[44:47]
v_exp_f32 v191, v191
v_mfma_f32_16x16x32_bf16 v[48:51], a[104:107], v[208:211], v[48:51]
ds_read_b64_tr_b16 a[100:101], v245 offset:24576
ds_read_b64_tr_b16 a[102:103], v245 offset:28672
v_mfma_f32_16x16x32_bf16 v[52:55], a[104:107], v[212:215], v[52:55]
v_exp_f32 v192, v192
v_mfma_f32_16x16x32_bf16 v[56:59], a[104:107], v[216:219], v[56:59]
v_exp_f32 v193, v193
v_mfma_f32_16x16x32_bf16 v[60:63], a[104:107], v[220:223], v[60:63]
v_exp_f32 v194, v194
v_mfma_f32_16x16x32_bf16 v[64:67], a[108:111], v[208:211], v[64:67]
ds_read_b64_tr_b16 a[104:105], v246 offset:24576
ds_read_b64_tr_b16 a[106:107], v246 offset:28672
v_mfma_f32_16x16x32_bf16 v[68:71], a[108:111], v[212:215], v[68:71]
v_exp_f32 v195, v195
v_mfma_f32_16x16x32_bf16 v[72:75], a[108:111], v[216:219], v[72:75]
v_exp_f32 v196, v196
v_mfma_f32_16x16x32_bf16 v[76:79], a[108:111], v[220:223], v[76:79]
v_exp_f32 v197, v197
v_mfma_f32_16x16x32_bf16 v[80:83], a[112:115], v[208:211], v[80:83]
ds_read_b64_tr_b16 a[108:109], v247 offset:24576
ds_read_b64_tr_b16 a[110:111], v247 offset:28672
v_mfma_f32_16x16x32_bf16 v[84:87], a[112:115], v[212:215], v[84:87]
v_exp_f32 v198, v198
v_mfma_f32_16x16x32_bf16 v[88:91], a[112:115], v[216:219], v[88:91]
v_exp_f32 v199, v199
v_mfma_f32_16x16x32_bf16 v[92:95], a[112:115], v[220:223], v[92:95]
v_exp_f32 v200, v200
v_mfma_f32_16x16x32_bf16 v[96:99], a[116:119], v[208:211], v[96:99]
ds_read_b64_tr_b16 a[112:113], v248 offset:24576
ds_read_b64_tr_b16 a[114:115], v248 offset:28672
v_mfma_f32_16x16x32_bf16 v[100:103], a[116:119], v[212:215], v[100:103]
v_exp_f32 v201, v201
v_mfma_f32_16x16x32_bf16 v[104:107], a[116:119], v[216:219], v[104:107]
v_exp_f32 v202, v202
v_mfma_f32_16x16x32_bf16 v[108:111], a[116:119], v[220:223], v[108:111]
v_exp_f32 v203, v203
v_mfma_f32_16x16x32_bf16 v[112:115], a[120:123], v[208:211], v[112:115]
ds_read_b64_tr_b16 a[116:117], v249 offset:24576
ds_read_b64_tr_b16 a[118:119], v249 offset:28672
v_mfma_f32_16x16x32_bf16 v[116:119], a[120:123], v[212:215], v[116:119]
v_exp_f32 v204, v204
v_mfma_f32_16x16x32_bf16 v[120:123], a[120:123], v[216:219], v[120:123]
v_exp_f32 v205, v205
v_mfma_f32_16x16x32_bf16 v[124:127], a[120:123], v[220:223], v[124:127]
v_exp_f32 v206, v206
v_mfma_f32_16x16x32_bf16 v[128:131], a[124:127], v[208:211], v[128:131]
ds_read_b64_tr_b16 a[120:121], v250 offset:24576
ds_read_b64_tr_b16 a[122:123], v250 offset:28672
v_mfma_f32_16x16x32_bf16 v[132:135], a[124:127], v[212:215], v[132:135]
v_exp_f32 v207, v207
v_mfma_f32_16x16x32_bf16 v[136:139], a[124:127], v[216:219], v[136:139]
v_mfma_f32_16x16x32_bf16 v[140:143], a[124:127], v[220:223], v[140:143]
v_mfma_f32_16x16x32_bf16 a[176:179], a[192:195], v[208:211], a[176:179]
ds_read_b64_tr_b16 a[124:125], v251 offset:24576
ds_read_b64_tr_b16 a[126:127], v251 offset:28672
v_mfma_f32_16x16x32_bf16 a[180:183], a[192:195], v[212:215], a[180:183]
v_mfma_f32_16x16x32_bf16 a[184:187], a[192:195], v[216:219], a[184:187]
v_mfma_f32_16x16x32_bf16 a[188:191], a[192:195], v[220:223], a[188:191]
s_waitcnt lgkmcnt(15)
v_mfma_f32_16x16x32_bf16 v[144:147], a[64:67], a[0:3], v[224:227]
v_cvt_pk_bf16_f32 v208, v176, v177
v_cvt_pk_bf16_f32 v209, v178, v179
v_mfma_f32_16x16x32_bf16 v[148:151], a[64:67], a[4:7], v[228:231]
v_cvt_pk_bf16_f32 v210, v192, v193
v_cvt_pk_bf16_f32 v211, v194, v195
v_mfma_f32_16x16x32_bf16 v[152:155], a[64:67], a[8:11], v[232:235]
v_cvt_pk_bf16_f32 v212, v180, v181
v_cvt_pk_bf16_f32 v213, v182, v183
v_mfma_f32_16x16x32_bf16 v[156:159], a[64:67], a[12:15], v[236:239]
v_cvt_pk_bf16_f32 v214, v196, v197
v_cvt_pk_bf16_f32 v215, v198, v199
v_mfma_f32_16x16x32_bf16 v[144:147], a[68:71], a[16:19], v[144:147]
v_cvt_pk_bf16_f32 v216, v184, v185
v_cvt_pk_bf16_f32 v217, v186, v187
v_mfma_f32_16x16x32_bf16 v[148:151], a[68:71], a[20:23], v[148:151]
v_cvt_pk_bf16_f32 v218, v200, v201
v_cvt_pk_bf16_f32 v219, v202, v203
v_mfma_f32_16x16x32_bf16 v[152:155], a[68:71], a[24:27], v[152:155]
v_cvt_pk_bf16_f32 v220, v188, v189
v_cvt_pk_bf16_f32 v221, v190, v191
v_mfma_f32_16x16x32_bf16 v[156:159], a[68:71], a[28:31], v[156:159]
v_cvt_pk_bf16_f32 v222, v204, v205
v_cvt_pk_bf16_f32 v223, v206, v207
v_mfma_f32_16x16x32_bf16 v[144:147], a[72:75], a[32:35], v[144:147]
s_waitcnt vmcnt(10) lgkmcnt(0)
s_barrier
v_mfma_f32_16x16x32_bf16 v[148:151], a[72:75], a[36:39], v[148:151]
ds_read_b128 a[64:67], v240 offset:8192
v_mfma_f32_16x16x32_bf16 v[152:155], a[72:75], a[40:43], v[152:155]
ds_read_b128 a[68:71], v241 offset:8192
s_add_u32 m0, s54, 131072
v_mfma_f32_16x16x32_bf16 v[156:159], a[72:75], a[44:47], v[156:159]
buffer_load_dwordx4 v8, s[44:47], s52 offen offset:0 lds
v_mfma_f32_16x16x32_bf16 v[144:147], a[76:79], a[48:51], v[144:147]
ds_read_b128 a[72:75], v242 offset:8192
v_mfma_f32_16x16x32_bf16 v[148:151], a[76:79], a[52:55], v[148:151]
buffer_load_dwordx4 v9, s[44:47], s52 offen offset:1024 lds
v_mfma_f32_16x16x32_bf16 v[152:155], a[76:79], a[56:59], v[152:155]
s_add_u32 m0, s54, 122880
v_mfma_f32_16x16x32_bf16 v[156:159], a[76:79], a[60:63], v[156:159]
s_add_u32 s52, s52, 8192
buffer_load_dwordx4 v10, s[48:51], s53 offen offset:0 lds
v_mfma_f32_16x16x32_bf16 v[160:163], a[80:83], a[0:3], v[224:227]
ds_read_b128 a[76:79], v243 offset:8192
v_mfma_f32_16x16x32_bf16 v[164:167], a[80:83], a[4:7], v[228:231]
buffer_load_dwordx4 v11, s[48:51], s53 offen offset:1024 lds
v_mfma_f32_16x16x32_bf16 v[168:171], a[80:83], a[8:11], v[232:235]
v_exp_f32 v144, v144
v_mfma_f32_16x16x32_bf16 v[172:175], a[80:83], a[12:15], v[236:239]
s_add_u32 s53, s53, 8192
v_exp_f32 v145, v145
v_mfma_f32_16x16x32_bf16 v[160:163], a[84:87], a[16:19], v[160:163]
ds_read_b128 a[80:83], v240 offset:12288
s_mov_b32 s3, 1048576
v_mfma_f32_16x16x32_bf16 v[164:167], a[84:87], a[20:23], v[164:167]
buffer_load_dword a243, v12, s[16:19], s3 offen
v_mfma_f32_16x16x32_bf16 v[168:171], a[84:87], a[24:27], v[168:171]
v_exp_f32 v146, v146
v_mfma_f32_16x16x32_bf16 v[172:175], a[84:87], a[28:31], v[172:175]
v_exp_f32 v147, v147
v_mfma_f32_16x16x32_bf16 v[160:163], a[88:91], a[32:35], v[160:163]
ds_read_b128 a[84:87], v241 offset:12288
v_mfma_f32_16x16x32_bf16 v[164:167], a[88:91], a[36:39], v[164:167]
v_exp_f32 v148, v148
v_mfma_f32_16x16x32_bf16 v[168:171], a[88:91], a[40:43], v[168:171]
v_exp_f32 v149, v149
v_mfma_f32_16x16x32_bf16 v[172:175], a[88:91], a[44:47], v[172:175]
v_exp_f32 v150, v150
v_mfma_f32_16x16x32_bf16 v[160:163], a[92:95], a[48:51], v[160:163]
ds_read_b128 a[88:91], v242 offset:12288
v_mfma_f32_16x16x32_bf16 v[164:167], a[92:95], a[52:55], v[164:167]
v_exp_f32 v151, v151
v_mfma_f32_16x16x32_bf16 v[168:171], a[92:95], a[56:59], v[168:171]
v_exp_f32 v152, v152
v_mfma_f32_16x16x32_bf16 v[172:175], a[92:95], a[60:63], v[172:175]
v_exp_f32 v153, v153
v_mfma_f32_16x16x32_bf16 v[16:19], a[96:99], v[208:211], v[16:19]
ds_read_b128 a[92:95], v243 offset:12288
v_mfma_f32_16x16x32_bf16 v[20:23], a[96:99], v[212:215], v[20:23]
v_exp_f32 v154, v154
v_mfma_f32_16x16x32_bf16 v[24:27], a[96:99], v[216:219], v[24:27]
v_exp_f32 v155, v155
v_mfma_f32_16x16x32_bf16 v[28:31], a[96:99], v[220:223], v[28:31]
v_exp_f32 v156, v156
v_mfma_f32_16x16x32_bf16 v[32:35], a[100:103], v[208:211], v[32:35]
ds_read_b64_tr_b16 a[96:97], v244 offset:0
ds_read_b64_tr_b16 a[98:99], v244 offset:4096
v_mfma_f32_16x16x32_bf16 v[36:39], a[100:103], v[212:215], v[36:39]
v_exp_f32 v157, v157
v_mfma_f32_16x16x32_bf16 v[40:43], a[100:103], v[216:219], v[40:43]
v_exp_f32 v158, v158
v_mfma_f32_16x16x32_bf16 v[44:47], a[100:103], v[220:223], v[44:47]
v_exp_f32 v159, v159
v_mfma_f32_16x16x32_bf16 v[48:51], a[104:107], v[208:211], v[48:51]
ds_read_b64_tr_b16 a[100:101], v245 offset:0
ds_read_b64_tr_b16 a[102:103], v245 offset:4096
v_mfma_f32_16x16x32_bf16 v[52:55], a[104:107], v[212:215], v[52:55]
v_exp_f32 v160, v160
v_mfma_f32_16x16x32_bf16 v[56:59], a[104:107], v[216:219], v[56:59]
v_exp_f32 v161, v161
v_mfma_f32_16x16x32_bf16 v[60:63], a[104:107], v[220:223], v[60:63]
v_exp_f32 v162, v162
v_mfma_f32_16x16x32_bf16 v[64:67], a[108:111], v[208:211], v[64:67]
ds_read_b64_tr_b16 a[104:105], v246 offset:0
ds_read_b64_tr_b16 a[106:107], v246 offset:4096
v_mfma_f32_16x16x32_bf16 v[68:71], a[108:111], v[212:215], v[68:71]
v_exp_f32 v163, v163
v_mfma_f32_16x16x32_bf16 v[72:75], a[108:111], v[216:219], v[72:75]
v_exp_f32 v164, v164
v_mfma_f32_16x16x32_bf16 v[76:79], a[108:111], v[220:223], v[76:79]
v_exp_f32 v165, v165
v_mfma_f32_16x16x32_bf16 v[80:83], a[112:115], v[208:211], v[80:83]
ds_read_b64_tr_b16 a[108:109], v247 offset:0
ds_read_b64_tr_b16 a[110:111], v247 offset:4096
v_mfma_f32_16x16x32_bf16 v[84:87], a[112:115], v[212:215], v[84:87]
v_exp_f32 v166, v166
v_mfma_f32_16x16x32_bf16 v[88:91], a[112:115], v[216:219], v[88:91]
v_exp_f32 v167, v167
v_mfma_f32_16x16x32_bf16 v[92:95], a[112:115], v[220:223], v[92:95]
v_exp_f32 v168, v168
v_mfma_f32_16x16x32_bf16 v[96:99], a[116:119], v[208:211], v[96:99]
ds_read_b64_tr_b16 a[112:113], v248 offset:0
ds_read_b64_tr_b16 a[114:115], v248 offset:4096
v_mfma_f32_16x16x32_bf16 v[100:103], a[116:119], v[212:215], v[100:103]
v_exp_f32 v169, v169
v_mfma_f32_16x16x32_bf16 v[104:107], a[116:119], v[216:219], v[104:107]
v_exp_f32 v170, v170
v_mfma_f32_16x16x32_bf16 v[108:111], a[116:119], v[220:223], v[108:111]
v_exp_f32 v171, v171
v_mfma_f32_16x16x32_bf16 v[112:115], a[120:123], v[208:211], v[112:115]
ds_read_b64_tr_b16 a[116:117], v249 offset:0
ds_read_b64_tr_b16 a[118:119], v249 offset:4096
v_mfma_f32_16x16x32_bf16 v[116:119], a[120:123], v[212:215], v[116:119]
v_exp_f32 v172, v172
v_mfma_f32_16x16x32_bf16 v[120:123], a[120:123], v[216:219], v[120:123]
v_exp_f32 v173, v173
v_mfma_f32_16x16x32_bf16 v[124:127], a[120:123], v[220:223], v[124:127]
v_exp_f32 v174, v174
v_mfma_f32_16x16x32_bf16 v[128:131], a[124:127], v[208:211], v[128:131]
ds_read_b64_tr_b16 a[120:121], v250 offset:0
ds_read_b64_tr_b16 a[122:123], v250 offset:4096
v_mfma_f32_16x16x32_bf16 v[132:135], a[124:127], v[212:215], v[132:135]
v_exp_f32 v175, v175
v_mfma_f32_16x16x32_bf16 v[136:139], a[124:127], v[216:219], v[136:139]
v_mfma_f32_16x16x32_bf16 v[140:143], a[124:127], v[220:223], v[140:143]
v_mfma_f32_16x16x32_bf16 a[176:179], a[192:195], v[208:211], a[176:179]
ds_read_b64_tr_b16 a[124:125], v251 offset:0
ds_read_b64_tr_b16 a[126:127], v251 offset:4096
v_mfma_f32_16x16x32_bf16 a[180:183], a[192:195], v[212:215], a[180:183]
v_mfma_f32_16x16x32_bf16 a[184:187], a[192:195], v[216:219], a[184:187]
v_mfma_f32_16x16x32_bf16 a[188:191], a[192:195], v[220:223], a[188:191]
s_waitcnt lgkmcnt(15)
v_mfma_f32_16x16x32_bf16 v[176:179], a[64:67], a[0:3], v[224:227]
v_cvt_pk_bf16_f32 v208, v144, v145
v_cvt_pk_bf16_f32 v209, v146, v147
v_mfma_f32_16x16x32_bf16 v[180:183], a[64:67], a[4:7], v[228:231]
v_cvt_pk_bf16_f32 v210, v160, v161
v_cvt_pk_bf16_f32 v211, v162, v163
v_mfma_f32_16x16x32_bf16 v[184:187], a[64:67], a[8:11], v[232:235]
v_cvt_pk_bf16_f32 v212, v148, v149
v_cvt_pk_bf16_f32 v213, v150, v151
v_mfma_f32_16x16x32_bf16 v[188:191], a[64:67], a[12:15], v[236:239]
v_cvt_pk_bf16_f32 v214, v164, v165
v_cvt_pk_bf16_f32 v215, v166, v167
v_mfma_f32_16x16x32_bf16 v[176:179], a[68:71], a[16:19], v[176:179]
v_cvt_pk_bf16_f32 v216, v152, v153
v_cvt_pk_bf16_f32 v217, v154, v155
v_mfma_f32_16x16x32_bf16 v[180:183], a[68:71], a[20:23], v[180:183]
v_cvt_pk_bf16_f32 v218, v168, v169
v_cvt_pk_bf16_f32 v219, v170, v171
v_mfma_f32_16x16x32_bf16 v[184:187], a[68:71], a[24:27], v[184:187]
v_cvt_pk_bf16_f32 v220, v156, v157
v_cvt_pk_bf16_f32 v221, v158, v159
v_mfma_f32_16x16x32_bf16 v[188:191], a[68:71], a[28:31], v[188:191]
v_cvt_pk_bf16_f32 v222, v172, v173
v_cvt_pk_bf16_f32 v223, v174, v175
v_mfma_f32_16x16x32_bf16 v[176:179], a[72:75], a[32:35], v[176:179]
s_waitcnt vmcnt(11) lgkmcnt(0)
s_barrier
v_mfma_f32_16x16x32_bf16 v[180:183], a[72:75], a[36:39], v[180:183]
ds_read_b128 a[64:67], v240 offset:16384
v_mfma_f32_16x16x32_bf16 v[184:187], a[72:75], a[40:43], v[184:187]
ds_read_b128 a[68:71], v241 offset:16384
s_add_u32 m0, s54, 139264
v_mfma_f32_16x16x32_bf16 v[188:191], a[72:75], a[44:47], v[188:191]
buffer_load_dwordx4 v8, s[44:47], s52 offen offset:0 lds
v_mfma_f32_16x16x32_bf16 v[176:179], a[76:79], a[48:51], v[176:179]
ds_read_b128 a[72:75], v242 offset:16384
v_mfma_f32_16x16x32_bf16 v[180:183], a[76:79], a[52:55], v[180:183]
buffer_load_dwordx4 v9, s[44:47], s52 offen offset:1024 lds
v_mfma_f32_16x16x32_bf16 v[184:187], a[76:79], a[56:59], v[184:187]
s_add_u32 m0, s54, 98304
v_mfma_f32_16x16x32_bf16 v[188:191], a[76:79], a[60:63], v[188:191]
s_add_u32 s52, s52, 8192
buffer_load_dwordx4 v10, s[48:51], s53 offen offset:0 lds
v_mfma_f32_16x16x32_bf16 v[192:195], a[80:83], a[0:3], v[224:227]
ds_read_b128 a[76:79], v243 offset:16384
v_mfma_f32_16x16x32_bf16 v[196:199], a[80:83], a[4:7], v[228:231]
buffer_load_dwordx4 v11, s[48:51], s53 offen offset:1024 lds
v_mfma_f32_16x16x32_bf16 v[200:203], a[80:83], a[8:11], v[232:235]
v_exp_f32 v176, v176
v_mfma_f32_16x16x32_bf16 v[204:207], a[80:83], a[12:15], v[236:239]
s_add_u32 s53, s53, 8192
v_exp_f32 v177, v177
v_mfma_f32_16x16x32_bf16 v[192:195], a[84:87], a[16:19], v[192:195]
ds_read_b128 a[80:83], v240 offset:20480
s_mov_b32 s3, 2097152
v_mfma_f32_16x16x32_bf16 v[196:199], a[84:87], a[20:23], v[196:199]
buffer_load_dword a244, v12, s[4:7], s3 offen
v_mfma_f32_16x16x32_bf16 v[200:203], a[84:87], a[24:27], v[200:203]
v_exp_f32 v178, v178
v_mfma_f32_16x16x32_bf16 v[204:207], a[84:87], a[28:31], v[204:207]
v_exp_f32 v179, v179
v_mfma_f32_16x16x32_bf16 v[192:195], a[88:91], a[32:35], v[192:195]
ds_read_b128 a[84:87], v241 offset:20480
v_mfma_f32_16x16x32_bf16 v[196:199], a[88:91], a[36:39], v[196:199]
v_exp_f32 v180, v180
v_mfma_f32_16x16x32_bf16 v[200:203], a[88:91], a[40:43], v[200:203]
v_exp_f32 v181, v181
v_mfma_f32_16x16x32_bf16 v[204:207], a[88:91], a[44:47], v[204:207]
v_exp_f32 v182, v182
v_mfma_f32_16x16x32_bf16 v[192:195], a[92:95], a[48:51], v[192:195]
ds_read_b128 a[88:91], v242 offset:20480
v_mfma_f32_16x16x32_bf16 v[196:199], a[92:95], a[52:55], v[196:199]
v_exp_f32 v183, v183
v_mfma_f32_16x16x32_bf16 v[200:203], a[92:95], a[56:59], v[200:203]
v_exp_f32 v184, v184
v_mfma_f32_16x16x32_bf16 v[204:207], a[92:95], a[60:63], v[204:207]
v_exp_f32 v185, v185
v_mfma_f32_16x16x32_bf16 v[16:19], a[96:99], v[208:211], v[16:19]
ds_read_b128 a[92:95], v243 offset:20480
v_mfma_f32_16x16x32_bf16 v[20:23], a[96:99], v[212:215], v[20:23]
v_exp_f32 v186, v186
v_mfma_f32_16x16x32_bf16 v[24:27], a[96:99], v[216:219], v[24:27]
v_exp_f32 v187, v187
v_mfma_f32_16x16x32_bf16 v[28:31], a[96:99], v[220:223], v[28:31]
v_exp_f32 v188, v188
v_mfma_f32_16x16x32_bf16 v[32:35], a[100:103], v[208:211], v[32:35]
ds_read_b64_tr_b16 a[96:97], v244 offset:8192
ds_read_b64_tr_b16 a[98:99], v244 offset:12288
v_mfma_f32_16x16x32_bf16 v[36:39], a[100:103], v[212:215], v[36:39]
v_exp_f32 v189, v189
v_mfma_f32_16x16x32_bf16 v[40:43], a[100:103], v[216:219], v[40:43]
v_exp_f32 v190, v190
v_mfma_f32_16x16x32_bf16 v[44:47], a[100:103], v[220:223], v[44:47]
v_exp_f32 v191, v191
v_mfma_f32_16x16x32_bf16 v[48:51], a[104:107], v[208:211], v[48:51]
ds_read_b64_tr_b16 a[100:101], v245 offset:8192
ds_read_b64_tr_b16 a[102:103], v245 offset:12288
v_mfma_f32_16x16x32_bf16 v[52:55], a[104:107], v[212:215], v[52:55]
v_exp_f32 v192, v192
v_mfma_f32_16x16x32_bf16 v[56:59], a[104:107], v[216:219], v[56:59]
v_exp_f32 v193, v193
v_mfma_f32_16x16x32_bf16 v[60:63], a[104:107], v[220:223], v[60:63]
v_exp_f32 v194, v194
v_mfma_f32_16x16x32_bf16 v[64:67], a[108:111], v[208:211], v[64:67]
ds_read_b64_tr_b16 a[104:105], v246 offset:8192
ds_read_b64_tr_b16 a[106:107], v246 offset:12288
v_mfma_f32_16x16x32_bf16 v[68:71], a[108:111], v[212:215], v[68:71]
v_exp_f32 v195, v195
v_mfma_f32_16x16x32_bf16 v[72:75], a[108:111], v[216:219], v[72:75]
v_exp_f32 v196, v196
v_mfma_f32_16x16x32_bf16 v[76:79], a[108:111], v[220:223], v[76:79]
v_exp_f32 v197, v197
v_mfma_f32_16x16x32_bf16 v[80:83], a[112:115], v[208:211], v[80:83]
ds_read_b64_tr_b16 a[108:109], v247 offset:8192
ds_read_b64_tr_b16 a[110:111], v247 offset:12288
v_mfma_f32_16x16x32_bf16 v[84:87], a[112:115], v[212:215], v[84:87]
v_exp_f32 v198, v198
v_mfma_f32_16x16x32_bf16 v[88:91], a[112:115], v[216:219], v[88:91]
v_exp_f32 v199, v199
v_mfma_f32_16x16x32_bf16 v[92:95], a[112:115], v[220:223], v[92:95]
v_exp_f32 v200, v200
v_mfma_f32_16x16x32_bf16 v[96:99], a[116:119], v[208:211], v[96:99]
ds_read_b64_tr_b16 a[112:113], v248 offset:8192
ds_read_b64_tr_b16 a[114:115], v248 offset:12288
v_mfma_f32_16x16x32_bf16 v[100:103], a[116:119], v[212:215], v[100:103]
v_exp_f32 v201, v201
v_mfma_f32_16x16x32_bf16 v[104:107], a[116:119], v[216:219], v[104:107]
v_exp_f32 v202, v202
v_mfma_f32_16x16x32_bf16 v[108:111], a[116:119], v[220:223], v[108:111]
v_exp_f32 v203, v203
v_mfma_f32_16x16x32_bf16 v[112:115], a[120:123], v[208:211], v[112:115]
ds_read_b64_tr_b16 a[116:117], v249 offset:8192
ds_read_b64_tr_b16 a[118:119], v249 offset:12288
v_mfma_f32_16x16x32_bf16 v[116:119], a[120:123], v[212:215], v[116:119]
v_exp_f32 v204, v204
v_mfma_f32_16x16x32_bf16 v[120:123], a[120:123], v[216:219], v[120:123]
v_exp_f32 v205, v205
v_mfma_f32_16x16x32_bf16 v[124:127], a[120:123], v[220:223], v[124:127]
v_exp_f32 v206, v206
v_mfma_f32_16x16x32_bf16 v[128:131], a[124:127], v[208:211], v[128:131]
ds_read_b64_tr_b16 a[120:121], v250 offset:8192
ds_read_b64_tr_b16 a[122:123], v250 offset:12288
v_mfma_f32_16x16x32_bf16 v[132:135], a[124:127], v[212:215], v[132:135]
v_exp_f32 v207, v207
v_mfma_f32_16x16x32_bf16 v[136:139], a[124:127], v[216:219], v[136:139]
v_mfma_f32_16x16x32_bf16 v[140:143], a[124:127], v[220:223], v[140:143]
v_mfma_f32_16x16x32_bf16 a[176:179], a[192:195], v[208:211], a[176:179]
ds_read_b64_tr_b16 a[124:125], v251 offset:8192
ds_read_b64_tr_b16 a[126:127], v251 offset:12288
v_mfma_f32_16x16x32_bf16 a[180:183], a[192:195], v[212:215], a[180:183]
v_mfma_f32_16x16x32_bf16 a[184:187], a[192:195], v[216:219], a[184:187]
v_mfma_f32_16x16x32_bf16 a[188:191], a[192:195], v[220:223], a[188:191]
s_waitcnt lgkmcnt(15)
v_mfma_f32_16x16x32_bf16 v[144:147], a[64:67], a[0:3], v[224:227]
v_cvt_pk_bf16_f32 v208, v176, v177
v_cvt_pk_bf16_f32 v209, v178, v179
v_mfma_f32_16x16x32_bf16 v[148:151], a[64:67], a[4:7], v[228:231]
v_cvt_pk_bf16_f32 v210, v192, v193
v_cvt_pk_bf16_f32 v211, v194, v195
v_mfma_f32_16x16x32_bf16 v[152:155], a[64:67], a[8:11], v[232:235]
v_cvt_pk_bf16_f32 v212, v180, v181
v_cvt_pk_bf16_f32 v213, v182, v183
v_mfma_f32_16x16x32_bf16 v[156:159], a[64:67], a[12:15], v[236:239]
v_cvt_pk_bf16_f32 v214, v196, v197
v_cvt_pk_bf16_f32 v215, v198, v199
v_mfma_f32_16x16x32_bf16 v[144:147], a[68:71], a[16:19], v[144:147]
v_cvt_pk_bf16_f32 v216, v184, v185
v_cvt_pk_bf16_f32 v217, v186, v187
v_mfma_f32_16x16x32_bf16 v[148:151], a[68:71], a[20:23], v[148:151]
v_cvt_pk_bf16_f32 v218, v200, v201
v_cvt_pk_bf16_f32 v219, v202, v203
v_mfma_f32_16x16x32_bf16 v[152:155], a[68:71], a[24:27], v[152:155]
v_cvt_pk_bf16_f32 v220, v188, v189
v_cvt_pk_bf16_f32 v221, v190, v191
v_mfma_f32_16x16x32_bf16 v[156:159], a[68:71], a[28:31], v[156:159]
v_cvt_pk_bf16_f32 v222, v204, v205
v_cvt_pk_bf16_f32 v223, v206, v207
v_mfma_f32_16x16x32_bf16 v[144:147], a[72:75], a[32:35], v[144:147]
s_waitcnt vmcnt(11) lgkmcnt(0)
s_barrier
v_mfma_f32_16x16x32_bf16 v[148:151], a[72:75], a[36:39], v[148:151]
ds_read_b128 a[64:67], v240 offset:24576
v_mfma_f32_16x16x32_bf16 v[152:155], a[72:75], a[40:43], v[152:155]
ds_read_b128 a[68:71], v241 offset:24576
s_add_u32 m0, s54, 147456
v_mfma_f32_16x16x32_bf16 v[156:159], a[72:75], a[44:47], v[156:159]
buffer_load_dwordx4 v8, s[44:47], s52 offen offset:0 lds
v_mfma_f32_16x16x32_bf16 v[144:147], a[76:79], a[48:51], v[144:147]
ds_read_b128 a[72:75], v242 offset:24576
v_mfma_f32_16x16x32_bf16 v[148:151], a[76:79], a[52:55], v[148:151]
buffer_load_dwordx4 v9, s[44:47], s52 offen offset:1024 lds
v_mfma_f32_16x16x32_bf16 v[152:155], a[76:79], a[56:59], v[152:155]
s_add_u32 m0, s54, 106496
v_mfma_f32_16x16x32_bf16 v[156:159], a[76:79], a[60:63], v[156:159]
s_add_u32 s52, s52, 8192
buffer_load_dwordx4 v10, s[48:51], s53 offen offset:0 lds
v_mfma_f32_16x16x32_bf16 v[160:163], a[80:83], a[0:3], v[224:227]
ds_read_b128 a[76:79], v243 offset:24576
v_mfma_f32_16x16x32_bf16 v[164:167], a[80:83], a[4:7], v[228:231]
buffer_load_dwordx4 v11, s[48:51], s53 offen offset:1024 lds
v_mfma_f32_16x16x32_bf16 v[168:171], a[80:83], a[8:11], v[232:235]
v_exp_f32 v144, v144
v_mfma_f32_16x16x32_bf16 v[172:175], a[80:83], a[12:15], v[236:239]
s_add_u32 s53, s53, 8192
v_exp_f32 v145, v145
v_mfma_f32_16x16x32_bf16 v[160:163], a[84:87], a[16:19], v[160:163]
ds_read_b128 a[80:83], v240 offset:28672
s_mov_b32 s3, 2097152
v_mfma_f32_16x16x32_bf16 v[164:167], a[84:87], a[20:23], v[164:167]
buffer_load_dword a245, v12, s[16:19], s3 offen
v_mfma_f32_16x16x32_bf16 v[168:171], a[84:87], a[24:27], v[168:171]
v_exp_f32 v146, v146
v_mfma_f32_16x16x32_bf16 v[172:175], a[84:87], a[28:31], v[172:175]
v_exp_f32 v147, v147
v_mfma_f32_16x16x32_bf16 v[160:163], a[88:91], a[32:35], v[160:163]
ds_read_b128 a[84:87], v241 offset:28672
s_mov_b32 s56, s82
v_mfma_f32_16x16x32_bf16 v[164:167], a[88:91], a[36:39], v[164:167]
s_and_b32 s57, s83, 0xffff
v_exp_f32 v148, v148
v_mfma_f32_16x16x32_bf16 v[168:171], a[88:91], a[40:43], v[168:171]
s_mov_b32 s58, 0x800
v_exp_f32 v149, v149
v_mfma_f32_16x16x32_bf16 v[172:175], a[88:91], a[44:47], v[172:175]
s_mov_b32 s59, 0x00020000
v_exp_f32 v150, v150
v_mfma_f32_16x16x32_bf16 v[160:163], a[92:95], a[48:51], v[160:163]
ds_read_b128 a[88:91], v242 offset:28672
v_mfma_f32_16x16x32_bf16 v[164:167], a[92:95], a[52:55], v[164:167]
v_exp_f32 v151, v151
v_mfma_f32_16x16x32_bf16 v[168:171], a[92:95], a[56:59], v[168:171]
v_and_b32 v13, 31, v0
v_exp_f32 v152, v152
v_mfma_f32_16x16x32_bf16 v[172:175], a[92:95], a[60:63], v[172:175]
v_lshlrev_b32 v13, 6, v13
v_exp_f32 v153, v153
v_mfma_f32_16x16x32_bf16 v[16:19], a[96:99], v[208:211], v[16:19]
ds_read_b128 a[92:95], v243 offset:28672
v_mfma_f32_16x16x32_bf16 v[20:23], a[96:99], v[212:215], v[20:23]
v_exp_f32 v154, v154
v_mfma_f32_16x16x32_bf16 v[24:27], a[96:99], v[216:219], v[24:27]
buffer_load_dword a255, v13, s[56:59], 0 offen
v_mfma_f32_16x16x32_bf16 v[28:31], a[96:99], v[220:223], v[28:31]
v_exp_f32 v155, v155
v_mfma_f32_16x16x32_bf16 v[32:35], a[100:103], v[208:211], v[32:35]
ds_read_b64_tr_b16 a[96:97], v244 offset:16384
ds_read_b64_tr_b16 a[98:99], v244 offset:20480
v_mfma_f32_16x16x32_bf16 v[36:39], a[100:103], v[212:215], v[36:39]
v_exp_f32 v156, v156
v_mfma_f32_16x16x32_bf16 v[40:43], a[100:103], v[216:219], v[40:43]
v_exp_f32 v157, v157
v_mfma_f32_16x16x32_bf16 v[44:47], a[100:103], v[220:223], v[44:47]
v_exp_f32 v158, v158
v_mfma_f32_16x16x32_bf16 v[48:51], a[104:107], v[208:211], v[48:51]
ds_read_b64_tr_b16 a[100:101], v245 offset:16384
ds_read_b64_tr_b16 a[102:103], v245 offset:20480
v_mfma_f32_16x16x32_bf16 v[52:55], a[104:107], v[212:215], v[52:55]
v_exp_f32 v159, v159
v_mfma_f32_16x16x32_bf16 v[56:59], a[104:107], v[216:219], v[56:59]
v_exp_f32 v160, v160
v_mfma_f32_16x16x32_bf16 v[60:63], a[104:107], v[220:223], v[60:63]
v_exp_f32 v161, v161
v_mfma_f32_16x16x32_bf16 v[64:67], a[108:111], v[208:211], v[64:67]
ds_read_b64_tr_b16 a[104:105], v246 offset:16384
ds_read_b64_tr_b16 a[106:107], v246 offset:20480
v_mfma_f32_16x16x32_bf16 v[68:71], a[108:111], v[212:215], v[68:71]
v_exp_f32 v162, v162
v_mfma_f32_16x16x32_bf16 v[72:75], a[108:111], v[216:219], v[72:75]
v_exp_f32 v163, v163
v_mfma_f32_16x16x32_bf16 v[76:79], a[108:111], v[220:223], v[76:79]
v_exp_f32 v164, v164
v_mfma_f32_16x16x32_bf16 v[80:83], a[112:115], v[208:211], v[80:83]
ds_read_b64_tr_b16 a[108:109], v247 offset:16384
ds_read_b64_tr_b16 a[110:111], v247 offset:20480
v_mfma_f32_16x16x32_bf16 v[84:87], a[112:115], v[212:215], v[84:87]
v_exp_f32 v165, v165
v_mfma_f32_16x16x32_bf16 v[88:91], a[112:115], v[216:219], v[88:91]
v_exp_f32 v166, v166
v_mfma_f32_16x16x32_bf16 v[92:95], a[112:115], v[220:223], v[92:95]
v_exp_f32 v167, v167
v_mfma_f32_16x16x32_bf16 v[96:99], a[116:119], v[208:211], v[96:99]
ds_read_b64_tr_b16 a[112:113], v248 offset:16384
ds_read_b64_tr_b16 a[114:115], v248 offset:20480
v_mfma_f32_16x16x32_bf16 v[100:103], a[116:119], v[212:215], v[100:103]
v_exp_f32 v168, v168
v_mfma_f32_16x16x32_bf16 v[104:107], a[116:119], v[216:219], v[104:107]
v_exp_f32 v169, v169
v_mfma_f32_16x16x32_bf16 v[108:111], a[116:119], v[220:223], v[108:111]
v_exp_f32 v170, v170
v_mfma_f32_16x16x32_bf16 v[112:115], a[120:123], v[208:211], v[112:115]
ds_read_b64_tr_b16 a[116:117], v249 offset:16384
ds_read_b64_tr_b16 a[118:119], v249 offset:20480
v_mfma_f32_16x16x32_bf16 v[116:119], a[120:123], v[212:215], v[116:119]
v_exp_f32 v171, v171
v_mfma_f32_16x16x32_bf16 v[120:123], a[120:123], v[216:219], v[120:123]
v_exp_f32 v172, v172
v_mfma_f32_16x16x32_bf16 v[124:127], a[120:123], v[220:223], v[124:127]
v_exp_f32 v173, v173
v_mfma_f32_16x16x32_bf16 v[128:131], a[124:127], v[208:211], v[128:131]
ds_read_b64_tr_b16 a[120:121], v250 offset:16384
ds_read_b64_tr_b16 a[122:123], v250 offset:20480
v_mfma_f32_16x16x32_bf16 v[132:135], a[124:127], v[212:215], v[132:135]
v_exp_f32 v174, v174
v_mfma_f32_16x16x32_bf16 v[136:139], a[124:127], v[216:219], v[136:139]
v_exp_f32 v175, v175
v_mfma_f32_16x16x32_bf16 v[140:143], a[124:127], v[220:223], v[140:143]
v_mfma_f32_16x16x32_bf16 a[176:179], a[192:195], v[208:211], a[176:179]
ds_read_b64_tr_b16 a[124:125], v251 offset:16384
ds_read_b64_tr_b16 a[126:127], v251 offset:20480
v_mfma_f32_16x16x32_bf16 a[180:183], a[192:195], v[212:215], a[180:183]
v_mfma_f32_16x16x32_bf16 a[184:187], a[192:195], v[216:219], a[184:187]
v_mfma_f32_16x16x32_bf16 a[188:191], a[192:195], v[220:223], a[188:191]
s_waitcnt lgkmcnt(15)
v_mfma_f32_16x16x32_bf16 v[176:179], a[64:67], a[0:3], v[224:227]
v_cvt_pk_bf16_f32 v208, v144, v145
v_cvt_pk_bf16_f32 v209, v146, v147
v_mfma_f32_16x16x32_bf16 v[180:183], a[64:67], a[4:7], v[228:231]
v_cvt_pk_bf16_f32 v210, v160, v161
v_cvt_pk_bf16_f32 v211, v162, v163
v_mfma_f32_16x16x32_bf16 v[184:187], a[64:67], a[8:11], v[232:235]
v_cvt_pk_bf16_f32 v212, v148, v149
v_cvt_pk_bf16_f32 v213, v150, v151
v_mfma_f32_16x16x32_bf16 v[188:191], a[64:67], a[12:15], v[236:239]
v_cvt_pk_bf16_f32 v214, v164, v165
v_cvt_pk_bf16_f32 v215, v166, v167
v_mfma_f32_16x16x32_bf16 v[176:179], a[68:71], a[16:19], v[176:179]
v_cvt_pk_bf16_f32 v216, v152, v153
v_cvt_pk_bf16_f32 v217, v154, v155
v_mfma_f32_16x16x32_bf16 v[180:183], a[68:71], a[20:23], v[180:183]
v_cvt_pk_bf16_f32 v218, v168, v169
v_cvt_pk_bf16_f32 v219, v170, v171
v_mfma_f32_16x16x32_bf16 v[184:187], a[68:71], a[24:27], v[184:187]
v_cvt_pk_bf16_f32 v220, v156, v157
v_cvt_pk_bf16_f32 v221, v158, v159
v_mfma_f32_16x16x32_bf16 v[188:191], a[68:71], a[28:31], v[188:191]
v_cvt_pk_bf16_f32 v222, v172, v173
v_cvt_pk_bf16_f32 v223, v174, v175
v_mfma_f32_16x16x32_bf16 v[176:179], a[72:75], a[32:35], v[176:179]
s_waitcnt vmcnt(12) lgkmcnt(0)
s_barrier
v_mfma_f32_16x16x32_bf16 v[180:183], a[72:75], a[36:39], v[180:183]
ds_read_b128 a[64:67], v240 offset:0
v_mfma_f32_16x16x32_bf16 v[184:187], a[72:75], a[40:43], v[184:187]
ds_read_b128 a[68:71], v241 offset:0
s_add_u32 m0, s54, 155648
v_mfma_f32_16x16x32_bf16 v[188:191], a[72:75], a[44:47], v[188:191]
buffer_load_dwordx4 v8, s[44:47], s52 offen offset:0 lds
v_mfma_f32_16x16x32_bf16 v[176:179], a[76:79], a[48:51], v[176:179]
ds_read_b128 a[72:75], v242 offset:0
v_mfma_f32_16x16x32_bf16 v[180:183], a[76:79], a[52:55], v[180:183]
buffer_load_dwordx4 v9, s[44:47], s52 offen offset:1024 lds
v_mfma_f32_16x16x32_bf16 v[184:187], a[76:79], a[56:59], v[184:187]
s_add_u32 m0, s54, 114688
v_mfma_f32_16x16x32_bf16 v[188:191], a[76:79], a[60:63], v[188:191]
s_add_u32 s52, s52, 8192
buffer_load_dwordx4 v10, s[48:51], s53 offen offset:0 lds
v_mfma_f32_16x16x32_bf16 v[192:195], a[80:83], a[0:3], v[224:227]
ds_read_b128 a[76:79], v243 offset:0
v_mfma_f32_16x16x32_bf16 v[196:199], a[80:83], a[4:7], v[228:231]
buffer_load_dwordx4 v11, s[48:51], s53 offen offset:1024 lds
v_mfma_f32_16x16x32_bf16 v[200:203], a[80:83], a[8:11], v[232:235]
v_exp_f32 v176, v176
v_mfma_f32_16x16x32_bf16 v[204:207], a[80:83], a[12:15], v[236:239]
s_add_u32 s53, s53, 8192
v_exp_f32 v177, v177
v_mfma_f32_16x16x32_bf16 v[192:195], a[84:87], a[16:19], v[192:195]
ds_read_b128 a[80:83], v240 offset:4096
s_mov_b32 s3, 3145728
v_mfma_f32_16x16x32_bf16 v[196:199], a[84:87], a[20:23], v[196:199]
buffer_load_dword a246, v12, s[4:7], s3 offen
v_mfma_f32_16x16x32_bf16 v[200:203], a[84:87], a[24:27], v[200:203]
v_exp_f32 v178, v178
v_mfma_f32_16x16x32_bf16 v[204:207], a[84:87], a[28:31], v[204:207]
v_exp_f32 v179, v179
v_mfma_f32_16x16x32_bf16 v[192:195], a[88:91], a[32:35], v[192:195]
ds_read_b128 a[84:87], v241 offset:4096
v_mfma_f32_16x16x32_bf16 v[196:199], a[88:91], a[36:39], v[196:199]
v_exp_f32 v180, v180
v_mfma_f32_16x16x32_bf16 v[200:203], a[88:91], a[40:43], v[200:203]
v_exp_f32 v181, v181
v_mfma_f32_16x16x32_bf16 v[204:207], a[88:91], a[44:47], v[204:207]
v_exp_f32 v182, v182
v_mfma_f32_16x16x32_bf16 v[192:195], a[92:95], a[48:51], v[192:195]
ds_read_b128 a[88:91], v242 offset:4096
v_mfma_f32_16x16x32_bf16 v[196:199], a[92:95], a[52:55], v[196:199]
v_exp_f32 v183, v183
v_mfma_f32_16x16x32_bf16 v[200:203], a[92:95], a[56:59], v[200:203]
v_exp_f32 v184, v184
v_mfma_f32_16x16x32_bf16 v[204:207], a[92:95], a[60:63], v[204:207]
v_exp_f32 v185, v185
v_mfma_f32_16x16x32_bf16 v[16:19], a[96:99], v[208:211], v[16:19]
ds_read_b128 a[92:95], v243 offset:4096
v_mfma_f32_16x16x32_bf16 v[20:23], a[96:99], v[212:215], v[20:23]
v_exp_f32 v186, v186
v_mfma_f32_16x16x32_bf16 v[24:27], a[96:99], v[216:219], v[24:27]
v_exp_f32 v187, v187
v_mfma_f32_16x16x32_bf16 v[28:31], a[96:99], v[220:223], v[28:31]
v_exp_f32 v188, v188
v_mfma_f32_16x16x32_bf16 v[32:35], a[100:103], v[208:211], v[32:35]
ds_read_b64_tr_b16 a[96:97], v244 offset:24576
ds_read_b64_tr_b16 a[98:99], v244 offset:28672
v_mfma_f32_16x16x32_bf16 v[36:39], a[100:103], v[212:215], v[36:39]
v_exp_f32 v189, v189
v_mfma_f32_16x16x32_bf16 v[40:43], a[100:103], v[216:219], v[40:43]
v_exp_f32 v190, v190
v_mfma_f32_16x16x32_bf16 v[44:47], a[100:103], v[220:223], v[44:47]
v_exp_f32 v191, v191
v_mfma_f32_16x16x32_bf16 v[48:51], a[104:107], v[208:211], v[48:51]
ds_read_b64_tr_b16 a[100:101], v245 offset:24576
ds_read_b64_tr_b16 a[102:103], v245 offset:28672
v_mfma_f32_16x16x32_bf16 v[52:55], a[104:107], v[212:215], v[52:55]
v_exp_f32 v192, v192
v_mfma_f32_16x16x32_bf16 v[56:59], a[104:107], v[216:219], v[56:59]
v_exp_f32 v193, v193
v_mfma_f32_16x16x32_bf16 v[60:63], a[104:107], v[220:223], v[60:63]
v_exp_f32 v194, v194
v_mfma_f32_16x16x32_bf16 v[64:67], a[108:111], v[208:211], v[64:67]
ds_read_b64_tr_b16 a[104:105], v246 offset:24576
ds_read_b64_tr_b16 a[106:107], v246 offset:28672
v_mfma_f32_16x16x32_bf16 v[68:71], a[108:111], v[212:215], v[68:71]
v_exp_f32 v195, v195
v_mfma_f32_16x16x32_bf16 v[72:75], a[108:111], v[216:219], v[72:75]
v_exp_f32 v196, v196
v_mfma_f32_16x16x32_bf16 v[76:79], a[108:111], v[220:223], v[76:79]
v_exp_f32 v197, v197
v_mfma_f32_16x16x32_bf16 v[80:83], a[112:115], v[208:211], v[80:83]
ds_read_b64_tr_b16 a[108:109], v247 offset:24576
ds_read_b64_tr_b16 a[110:111], v247 offset:28672
v_mfma_f32_16x16x32_bf16 v[84:87], a[112:115], v[212:215], v[84:87]
v_exp_f32 v198, v198
v_mfma_f32_16x16x32_bf16 v[88:91], a[112:115], v[216:219], v[88:91]
v_exp_f32 v199, v199
v_mfma_f32_16x16x32_bf16 v[92:95], a[112:115], v[220:223], v[92:95]
v_exp_f32 v200, v200
v_mfma_f32_16x16x32_bf16 v[96:99], a[116:119], v[208:211], v[96:99]
ds_read_b64_tr_b16 a[112:113], v248 offset:24576
ds_read_b64_tr_b16 a[114:115], v248 offset:28672
v_mfma_f32_16x16x32_bf16 v[100:103], a[116:119], v[212:215], v[100:103]
v_exp_f32 v201, v201
v_mfma_f32_16x16x32_bf16 v[104:107], a[116:119], v[216:219], v[104:107]
v_exp_f32 v202, v202
v_mfma_f32_16x16x32_bf16 v[108:111], a[116:119], v[220:223], v[108:111]
v_exp_f32 v203, v203
v_mfma_f32_16x16x32_bf16 v[112:115], a[120:123], v[208:211], v[112:115]
ds_read_b64_tr_b16 a[116:117], v249 offset:24576
ds_read_b64_tr_b16 a[118:119], v249 offset:28672
v_mfma_f32_16x16x32_bf16 v[116:119], a[120:123], v[212:215], v[116:119]
v_exp_f32 v204, v204
v_mfma_f32_16x16x32_bf16 v[120:123], a[120:123], v[216:219], v[120:123]
v_exp_f32 v205, v205
v_mfma_f32_16x16x32_bf16 v[124:127], a[120:123], v[220:223], v[124:127]
v_exp_f32 v206, v206
v_mfma_f32_16x16x32_bf16 v[128:131], a[124:127], v[208:211], v[128:131]
ds_read_b64_tr_b16 a[120:121], v250 offset:24576
ds_read_b64_tr_b16 a[122:123], v250 offset:28672
v_mfma_f32_16x16x32_bf16 v[132:135], a[124:127], v[212:215], v[132:135]
v_exp_f32 v207, v207
v_mfma_f32_16x16x32_bf16 v[136:139], a[124:127], v[216:219], v[136:139]
v_mfma_f32_16x16x32_bf16 v[140:143], a[124:127], v[220:223], v[140:143]
v_mfma_f32_16x16x32_bf16 a[176:179], a[192:195], v[208:211], a[176:179]
ds_read_b64_tr_b16 a[124:125], v251 offset:24576
ds_read_b64_tr_b16 a[126:127], v251 offset:28672
v_mfma_f32_16x16x32_bf16 a[180:183], a[192:195], v[212:215], a[180:183]
v_mfma_f32_16x16x32_bf16 a[184:187], a[192:195], v[216:219], a[184:187]
v_mfma_f32_16x16x32_bf16 a[188:191], a[192:195], v[220:223], a[188:191]
s_waitcnt lgkmcnt(15)
v_mfma_f32_16x16x32_bf16 v[144:147], a[64:67], a[0:3], v[224:227]
v_cvt_pk_bf16_f32 v208, v176, v177
v_cvt_pk_bf16_f32 v209, v178, v179
v_mfma_f32_16x16x32_bf16 v[148:151], a[64:67], a[4:7], v[228:231]
v_cvt_pk_bf16_f32 v210, v192, v193
v_cvt_pk_bf16_f32 v211, v194, v195
v_mfma_f32_16x16x32_bf16 v[152:155], a[64:67], a[8:11], v[232:235]
v_cvt_pk_bf16_f32 v212, v180, v181
v_cvt_pk_bf16_f32 v213, v182, v183
v_mfma_f32_16x16x32_bf16 v[156:159], a[64:67], a[12:15], v[236:239]
v_cvt_pk_bf16_f32 v214, v196, v197
v_cvt_pk_bf16_f32 v215, v198, v199
v_mfma_f32_16x16x32_bf16 v[144:147], a[68:71], a[16:19], v[144:147]
v_cvt_pk_bf16_f32 v216, v184, v185
v_cvt_pk_bf16_f32 v217, v186, v187
v_mfma_f32_16x16x32_bf16 v[148:151], a[68:71], a[20:23], v[148:151]
v_cvt_pk_bf16_f32 v218, v200, v201
v_cvt_pk_bf16_f32 v219, v202, v203
v_mfma_f32_16x16x32_bf16 v[152:155], a[68:71], a[24:27], v[152:155]
v_cvt_pk_bf16_f32 v220, v188, v189
v_cvt_pk_bf16_f32 v221, v190, v191
v_mfma_f32_16x16x32_bf16 v[156:159], a[68:71], a[28:31], v[156:159]
v_cvt_pk_bf16_f32 v222, v204, v205
v_cvt_pk_bf16_f32 v223, v206, v207
v_mfma_f32_16x16x32_bf16 v[144:147], a[72:75], a[32:35], v[144:147]
s_waitcnt vmcnt(12) lgkmcnt(0)
s_barrier
v_mfma_f32_16x16x32_bf16 v[148:151], a[72:75], a[36:39], v[148:151]
ds_read_b128 a[64:67], v240 offset:8192
v_mfma_f32_16x16x32_bf16 v[152:155], a[72:75], a[40:43], v[152:155]
ds_read_b128 a[68:71], v241 offset:8192
s_add_u32 m0, s54, 131072
v_mfma_f32_16x16x32_bf16 v[156:159], a[72:75], a[44:47], v[156:159]
buffer_load_dwordx4 v8, s[44:47], s52 offen offset:0 lds
v_mfma_f32_16x16x32_bf16 v[144:147], a[76:79], a[48:51], v[144:147]
ds_read_b128 a[72:75], v242 offset:8192
v_mfma_f32_16x16x32_bf16 v[148:151], a[76:79], a[52:55], v[148:151]
buffer_load_dwordx4 v9, s[44:47], s52 offen offset:1024 lds
v_mfma_f32_16x16x32_bf16 v[152:155], a[76:79], a[56:59], v[152:155]
s_add_u32 m0, s54, 122880
v_mfma_f32_16x16x32_bf16 v[156:159], a[76:79], a[60:63], v[156:159]
s_add_u32 s52, s52, 8192
buffer_load_dwordx4 v10, s[48:51], s53 offen offset:0 lds
v_mfma_f32_16x16x32_bf16 v[160:163], a[80:83], a[0:3], v[224:227]
ds_read_b128 a[76:79], v243 offset:8192
v_mfma_f32_16x16x32_bf16 v[164:167], a[80:83], a[4:7], v[228:231]
buffer_load_dwordx4 v11, s[48:51], s53 offen offset:1024 lds
v_mfma_f32_16x16x32_bf16 v[168:171], a[80:83], a[8:11], v[232:235]
v_exp_f32 v144, v144
v_mfma_f32_16x16x32_bf16 v[172:175], a[80:83], a[12:15], v[236:239]
s_add_u32 s53, s53, 8192
v_exp_f32 v145, v145
v_mfma_f32_16x16x32_bf16 v[160:163], a[84:87], a[16:19], v[160:163]
ds_read_b128 a[80:83], v240 offset:12288
s_mov_b32 s3, 3145728
v_mfma_f32_16x16x32_bf16 v[164:167], a[84:87], a[20:23], v[164:167]
buffer_load_dword a247, v12, s[16:19], s3 offen
v_mfma_f32_16x16x32_bf16 v[168:171], a[84:87], a[24:27], v[168:171]
v_exp_f32 v146, v146
v_mfma_f32_16x16x32_bf16 v[172:175], a[84:87], a[28:31], v[172:175]
v_exp_f32 v147, v147
v_mfma_f32_16x16x32_bf16 v[160:163], a[88:91], a[32:35], v[160:163]
ds_read_b128 a[84:87], v241 offset:12288
v_mfma_f32_16x16x32_bf16 v[164:167], a[88:91], a[36:39], v[164:167]
v_exp_f32 v148, v148
v_mfma_f32_16x16x32_bf16 v[168:171], a[88:91], a[40:43], v[168:171]
v_exp_f32 v149, v149
v_mfma_f32_16x16x32_bf16 v[172:175], a[88:91], a[44:47], v[172:175]
v_exp_f32 v150, v150
v_mfma_f32_16x16x32_bf16 v[160:163], a[92:95], a[48:51], v[160:163]
ds_read_b128 a[88:91], v242 offset:12288
v_mfma_f32_16x16x32_bf16 v[164:167], a[92:95], a[52:55], v[164:167]
v_exp_f32 v151, v151
v_mfma_f32_16x16x32_bf16 v[168:171], a[92:95], a[56:59], v[168:171]
v_exp_f32 v152, v152
v_mfma_f32_16x16x32_bf16 v[172:175], a[92:95], a[60:63], v[172:175]
v_exp_f32 v153, v153
v_mfma_f32_16x16x32_bf16 v[16:19], a[96:99], v[208:211], v[16:19]
ds_read_b128 a[92:95], v243 offset:12288
v_mfma_f32_16x16x32_bf16 v[20:23], a[96:99], v[212:215], v[20:23]
v_exp_f32 v154, v154
v_mfma_f32_16x16x32_bf16 v[24:27], a[96:99], v[216:219], v[24:27]
v_exp_f32 v155, v155
v_mfma_f32_16x16x32_bf16 v[28:31], a[96:99], v[220:223], v[28:31]
v_exp_f32 v156, v156
v_mfma_f32_16x16x32_bf16 v[32:35], a[100:103], v[208:211], v[32:35]
ds_read_b64_tr_b16 a[96:97], v244 offset:0
ds_read_b64_tr_b16 a[98:99], v244 offset:4096
v_mfma_f32_16x16x32_bf16 v[36:39], a[100:103], v[212:215], v[36:39]
v_exp_f32 v157, v157
v_mfma_f32_16x16x32_bf16 v[40:43], a[100:103], v[216:219], v[40:43]
v_exp_f32 v158, v158
v_mfma_f32_16x16x32_bf16 v[44:47], a[100:103], v[220:223], v[44:47]
v_exp_f32 v159, v159
v_mfma_f32_16x16x32_bf16 v[48:51], a[104:107], v[208:211], v[48:51]
ds_read_b64_tr_b16 a[100:101], v245 offset:0
ds_read_b64_tr_b16 a[102:103], v245 offset:4096
v_mfma_f32_16x16x32_bf16 v[52:55], a[104:107], v[212:215], v[52:55]
v_exp_f32 v160, v160
v_mfma_f32_16x16x32_bf16 v[56:59], a[104:107], v[216:219], v[56:59]
v_exp_f32 v161, v161
v_mfma_f32_16x16x32_bf16 v[60:63], a[104:107], v[220:223], v[60:63]
v_exp_f32 v162, v162
v_mfma_f32_16x16x32_bf16 v[64:67], a[108:111], v[208:211], v[64:67]
ds_read_b64_tr_b16 a[104:105], v246 offset:0
ds_read_b64_tr_b16 a[106:107], v246 offset:4096
v_mfma_f32_16x16x32_bf16 v[68:71], a[108:111], v[212:215], v[68:71]
v_exp_f32 v163, v163
v_mfma_f32_16x16x32_bf16 v[72:75], a[108:111], v[216:219], v[72:75]
v_exp_f32 v164, v164
v_mfma_f32_16x16x32_bf16 v[76:79], a[108:111], v[220:223], v[76:79]
v_exp_f32 v165, v165
v_mfma_f32_16x16x32_bf16 v[80:83], a[112:115], v[208:211], v[80:83]
ds_read_b64_tr_b16 a[108:109], v247 offset:0
ds_read_b64_tr_b16 a[110:111], v247 offset:4096
v_mfma_f32_16x16x32_bf16 v[84:87], a[112:115], v[212:215], v[84:87]
v_exp_f32 v166, v166
v_mfma_f32_16x16x32_bf16 v[88:91], a[112:115], v[216:219], v[88:91]
v_exp_f32 v167, v167
v_mfma_f32_16x16x32_bf16 v[92:95], a[112:115], v[220:223], v[92:95]
v_exp_f32 v168, v168
v_mfma_f32_16x16x32_bf16 v[96:99], a[116:119], v[208:211], v[96:99]
ds_read_b64_tr_b16 a[112:113], v248 offset:0
ds_read_b64_tr_b16 a[114:115], v248 offset:4096
v_mfma_f32_16x16x32_bf16 v[100:103], a[116:119], v[212:215], v[100:103]
v_exp_f32 v169, v169
v_mfma_f32_16x16x32_bf16 v[104:107], a[116:119], v[216:219], v[104:107]
v_exp_f32 v170, v170
v_mfma_f32_16x16x32_bf16 v[108:111], a[116:119], v[220:223], v[108:111]
v_exp_f32 v171, v171
v_mfma_f32_16x16x32_bf16 v[112:115], a[120:123], v[208:211], v[112:115]
ds_read_b64_tr_b16 a[116:117], v249 offset:0
ds_read_b64_tr_b16 a[118:119], v249 offset:4096
v_mfma_f32_16x16x32_bf16 v[116:119], a[120:123], v[212:215], v[116:119]
v_exp_f32 v172, v172
v_mfma_f32_16x16x32_bf16 v[120:123], a[120:123], v[216:219], v[120:123]
v_exp_f32 v173, v173
v_mfma_f32_16x16x32_bf16 v[124:127], a[120:123], v[220:223], v[124:127]
v_exp_f32 v174, v174
v_mfma_f32_16x16x32_bf16 v[128:131], a[124:127], v[208:211], v[128:131]
ds_read_b64_tr_b16 a[120:121], v250 offset:0
ds_read_b64_tr_b16 a[122:123], v250 offset:4096
v_mfma_f32_16x16x32_bf16 v[132:135], a[124:127], v[212:215], v[132:135]
v_exp_f32 v175, v175
v_mfma_f32_16x16x32_bf16 v[136:139], a[124:127], v[216:219], v[136:139]
v_mfma_f32_16x16x32_bf16 v[140:143], a[124:127], v[220:223], v[140:143]
v_mfma_f32_16x16x32_bf16 a[176:179], a[192:195], v[208:211], a[176:179]
ds_read_b64_tr_b16 a[124:125], v251 offset:0
ds_read_b64_tr_b16 a[126:127], v251 offset:4096
v_mfma_f32_16x16x32_bf16 a[180:183], a[192:195], v[212:215], a[180:183]
v_mfma_f32_16x16x32_bf16 a[184:187], a[192:195], v[216:219], a[184:187]
v_mfma_f32_16x16x32_bf16 a[188:191], a[192:195], v[220:223], a[188:191]
s_waitcnt lgkmcnt(15)
v_mfma_f32_16x16x32_bf16 v[176:179], a[64:67], a[0:3], v[224:227]
v_cvt_pk_bf16_f32 v208, v144, v145
v_cvt_pk_bf16_f32 v209, v146, v147
v_mfma_f32_16x16x32_bf16 v[180:183], a[64:67], a[4:7], v[228:231]
v_cvt_pk_bf16_f32 v210, v160, v161
v_cvt_pk_bf16_f32 v211, v162, v163
v_mfma_f32_16x16x32_bf16 v[184:187], a[64:67], a[8:11], v[232:235]
v_cvt_pk_bf16_f32 v212, v148, v149
v_cvt_pk_bf16_f32 v213, v150, v151
v_mfma_f32_16x16x32_bf16 v[188:191], a[64:67], a[12:15], v[236:239]
v_cvt_pk_bf16_f32 v214, v164, v165
v_cvt_pk_bf16_f32 v215, v166, v167
v_mfma_f32_16x16x32_bf16 v[176:179], a[68:71], a[16:19], v[176:179]
v_cvt_pk_bf16_f32 v216, v152, v153
v_cvt_pk_bf16_f32 v217, v154, v155
v_mfma_f32_16x16x32_bf16 v[180:183], a[68:71], a[20:23], v[180:183]
v_cvt_pk_bf16_f32 v218, v168, v169
v_cvt_pk_bf16_f32 v219, v170, v171
v_mfma_f32_16x16x32_bf16 v[184:187], a[68:71], a[24:27], v[184:187]
v_cvt_pk_bf16_f32 v220, v156, v157
v_cvt_pk_bf16_f32 v221, v158, v159
v_mfma_f32_16x16x32_bf16 v[188:191], a[68:71], a[28:31], v[188:191]
v_cvt_pk_bf16_f32 v222, v172, v173
v_cvt_pk_bf16_f32 v223, v174, v175
v_mfma_f32_16x16x32_bf16 v[176:179], a[72:75], a[32:35], v[176:179]
s_waitcnt vmcnt(12) lgkmcnt(0)
s_barrier
v_mfma_f32_16x16x32_bf16 v[180:183], a[72:75], a[36:39], v[180:183]
ds_read_b128 a[64:67], v240 offset:16384
v_mfma_f32_16x16x32_bf16 v[184:187], a[72:75], a[40:43], v[184:187]
ds_read_b128 a[68:71], v241 offset:16384
s_add_u32 m0, s54, 139264
v_mfma_f32_16x16x32_bf16 v[188:191], a[72:75], a[44:47], v[188:191]
buffer_load_dwordx4 v8, s[44:47], s52 offen offset:0 lds
v_mfma_f32_16x16x32_bf16 v[176:179], a[76:79], a[48:51], v[176:179]
ds_read_b128 a[72:75], v242 offset:16384
v_mfma_f32_16x16x32_bf16 v[180:183], a[76:79], a[52:55], v[180:183]
buffer_load_dwordx4 v9, s[44:47], s52 offen offset:1024 lds
v_mfma_f32_16x16x32_bf16 v[184:187], a[76:79], a[56:59], v[184:187]
s_add_u32 m0, s54, 98304
v_mfma_f32_16x16x32_bf16 v[188:191], a[76:79], a[60:63], v[188:191]
s_add_u32 s52, s52, 8192
buffer_load_dwordx4 v10, s[48:51], s53 offen offset:0 lds
v_mfma_f32_16x16x32_bf16 v[192:195], a[80:83], a[0:3], v[224:227]
ds_read_b128 a[76:79], v243 offset:16384
v_mfma_f32_16x16x32_bf16 v[196:199], a[80:83], a[4:7], v[228:231]
buffer_load_dwordx4 v11, s[48:51], s53 offen offset:1024 lds
v_mfma_f32_16x16x32_bf16 v[200:203], a[80:83], a[8:11], v[232:235]
v_exp_f32 v176, v176
v_mfma_f32_16x16x32_bf16 v[204:207], a[80:83], a[12:15], v[236:239]
s_add_u32 s53, s53, 8192
v_exp_f32 v177, v177
v_mfma_f32_16x16x32_bf16 v[192:195], a[84:87], a[16:19], v[192:195]
ds_read_b128 a[80:83], v240 offset:20480
s_mov_b32 s3, 4194304
v_mfma_f32_16x16x32_bf16 v[196:199], a[84:87], a[20:23], v[196:199]
buffer_load_dword a248, v12, s[4:7], s3 offen
v_mfma_f32_16x16x32_bf16 v[200:203], a[84:87], a[24:27], v[200:203]
v_exp_f32 v178, v178
v_mfma_f32_16x16x32_bf16 v[204:207], a[84:87], a[28:31], v[204:207]
v_exp_f32 v179, v179
v_mfma_f32_16x16x32_bf16 v[192:195], a[88:91], a[32:35], v[192:195]
ds_read_b128 a[84:87], v241 offset:20480
v_mfma_f32_16x16x32_bf16 v[196:199], a[88:91], a[36:39], v[196:199]
v_exp_f32 v180, v180
v_mfma_f32_16x16x32_bf16 v[200:203], a[88:91], a[40:43], v[200:203]
v_exp_f32 v181, v181
v_mfma_f32_16x16x32_bf16 v[204:207], a[88:91], a[44:47], v[204:207]
v_exp_f32 v182, v182
v_mfma_f32_16x16x32_bf16 v[192:195], a[92:95], a[48:51], v[192:195]
ds_read_b128 a[88:91], v242 offset:20480
v_mfma_f32_16x16x32_bf16 v[196:199], a[92:95], a[52:55], v[196:199]
v_exp_f32 v183, v183
v_mfma_f32_16x16x32_bf16 v[200:203], a[92:95], a[56:59], v[200:203]
v_exp_f32 v184, v184
v_mfma_f32_16x16x32_bf16 v[204:207], a[92:95], a[60:63], v[204:207]
v_exp_f32 v185, v185
v_mfma_f32_16x16x32_bf16 v[16:19], a[96:99], v[208:211], v[16:19]
ds_read_b128 a[92:95], v243 offset:20480
v_mfma_f32_16x16x32_bf16 v[20:23], a[96:99], v[212:215], v[20:23]
v_exp_f32 v186, v186
v_mfma_f32_16x16x32_bf16 v[24:27], a[96:99], v[216:219], v[24:27]
v_exp_f32 v187, v187
v_mfma_f32_16x16x32_bf16 v[28:31], a[96:99], v[220:223], v[28:31]
v_exp_f32 v188, v188
v_mfma_f32_16x16x32_bf16 v[32:35], a[100:103], v[208:211], v[32:35]
ds_read_b64_tr_b16 a[96:97], v244 offset:8192
ds_read_b64_tr_b16 a[98:99], v244 offset:12288
v_mfma_f32_16x16x32_bf16 v[36:39], a[100:103], v[212:215], v[36:39]
v_exp_f32 v189, v189
v_mfma_f32_16x16x32_bf16 v[40:43], a[100:103], v[216:219], v[40:43]
v_exp_f32 v190, v190
v_mfma_f32_16x16x32_bf16 v[44:47], a[100:103], v[220:223], v[44:47]
v_exp_f32 v191, v191
v_mfma_f32_16x16x32_bf16 v[48:51], a[104:107], v[208:211], v[48:51]
ds_read_b64_tr_b16 a[100:101], v245 offset:8192
ds_read_b64_tr_b16 a[102:103], v245 offset:12288
s_add_u32 s56, s88, 41943040
v_mfma_f32_16x16x32_bf16 v[52:55], a[104:107], v[212:215], v[52:55]
s_addc_u32 s57, s89, 0
v_exp_f32 v192, v192
v_mfma_f32_16x16x32_bf16 v[56:59], a[104:107], v[216:219], v[56:59]
s_and_b32 s57, s57, 0xffff
v_exp_f32 v193, v193
v_mfma_f32_16x16x32_bf16 v[60:63], a[104:107], v[220:223], v[60:63]
s_mov_b32 s58, 0x4000
v_exp_f32 v194, v194
v_mfma_f32_16x16x32_bf16 v[64:67], a[108:111], v[208:211], v[64:67]
ds_read_b64_tr_b16 a[104:105], v246 offset:8192
ds_read_b64_tr_b16 a[106:107], v246 offset:12288
s_mov_b32 s59, 0x00020000
v_mfma_f32_16x16x32_bf16 v[68:71], a[108:111], v[212:215], v[68:71]
s_lshl_b32 s38, s28, 8
v_exp_f32 v195, v195
v_mfma_f32_16x16x32_bf16 v[72:75], a[108:111], v[216:219], v[72:75]
s_add_u32 s38, s38, 0
v_exp_f32 v196, v196
v_mfma_f32_16x16x32_bf16 v[76:79], a[108:111], v[220:223], v[76:79]
v_and_b32 v13, 31, v0
v_exp_f32 v197, v197
v_mfma_f32_16x16x32_bf16 v[80:83], a[112:115], v[208:211], v[80:83]
ds_read_b64_tr_b16 a[108:109], v247 offset:8192
ds_read_b64_tr_b16 a[110:111], v247 offset:12288
v_lshlrev_b32 v13, 2, v13
v_mfma_f32_16x16x32_bf16 v[84:87], a[112:115], v[212:215], v[84:87]
v_add_u32 v13, s38, v13
v_exp_f32 v198, v198
v_mfma_f32_16x16x32_bf16 v[88:91], a[112:115], v[216:219], v[88:91]
buffer_load_dword v14, v13, s[56:59], 0 offen sc0 sc1
v_mfma_f32_16x16x32_bf16 v[92:95], a[112:115], v[220:223], v[92:95]
v_exp_f32 v199, v199
v_mfma_f32_16x16x32_bf16 v[96:99], a[116:119], v[208:211], v[96:99]
ds_read_b64_tr_b16 a[112:113], v248 offset:8192
ds_read_b64_tr_b16 a[114:115], v248 offset:12288
v_mfma_f32_16x16x32_bf16 v[100:103], a[116:119], v[212:215], v[100:103]
v_exp_f32 v200, v200
v_mfma_f32_16x16x32_bf16 v[104:107], a[116:119], v[216:219], v[104:107]
v_exp_f32 v201, v201
v_mfma_f32_16x16x32_bf16 v[108:111], a[116:119], v[220:223], v[108:111]
v_exp_f32 v202, v202
v_mfma_f32_16x16x32_bf16 v[112:115], a[120:123], v[208:211], v[112:115]
ds_read_b64_tr_b16 a[116:117], v249 offset:8192
ds_read_b64_tr_b16 a[118:119], v249 offset:12288
v_mfma_f32_16x16x32_bf16 v[116:119], a[120:123], v[212:215], v[116:119]
v_exp_f32 v203, v203
v_mfma_f32_16x16x32_bf16 v[120:123], a[120:123], v[216:219], v[120:123]
v_exp_f32 v204, v204
v_mfma_f32_16x16x32_bf16 v[124:127], a[120:123], v[220:223], v[124:127]
v_exp_f32 v205, v205
v_mfma_f32_16x16x32_bf16 v[128:131], a[124:127], v[208:211], v[128:131]
ds_read_b64_tr_b16 a[120:121], v250 offset:8192
ds_read_b64_tr_b16 a[122:123], v250 offset:12288
v_mfma_f32_16x16x32_bf16 v[132:135], a[124:127], v[212:215], v[132:135]
v_exp_f32 v206, v206
v_mfma_f32_16x16x32_bf16 v[136:139], a[124:127], v[216:219], v[136:139]
v_exp_f32 v207, v207
v_mfma_f32_16x16x32_bf16 v[140:143], a[124:127], v[220:223], v[140:143]
v_mfma_f32_16x16x32_bf16 a[176:179], a[192:195], v[208:211], a[176:179]
ds_read_b64_tr_b16 a[124:125], v251 offset:8192
ds_read_b64_tr_b16 a[126:127], v251 offset:12288
v_mfma_f32_16x16x32_bf16 a[180:183], a[192:195], v[212:215], a[180:183]
v_mfma_f32_16x16x32_bf16 a[184:187], a[192:195], v[216:219], a[184:187]
v_mfma_f32_16x16x32_bf16 a[188:191], a[192:195], v[220:223], a[188:191]
s_waitcnt lgkmcnt(15)
v_mfma_f32_16x16x32_bf16 v[144:147], a[64:67], a[0:3], v[224:227]
v_cvt_pk_bf16_f32 v208, v176, v177
v_cvt_pk_bf16_f32 v209, v178, v179
v_mfma_f32_16x16x32_bf16 v[148:151], a[64:67], a[4:7], v[228:231]
v_cvt_pk_bf16_f32 v210, v192, v193
v_cvt_pk_bf16_f32 v211, v194, v195
v_mfma_f32_16x16x32_bf16 v[152:155], a[64:67], a[8:11], v[232:235]
v_cvt_pk_bf16_f32 v212, v180, v181
v_cvt_pk_bf16_f32 v213, v182, v183
v_mfma_f32_16x16x32_bf16 v[156:159], a[64:67], a[12:15], v[236:239]
v_cvt_pk_bf16_f32 v214, v196, v197
v_cvt_pk_bf16_f32 v215, v198, v199
v_mfma_f32_16x16x32_bf16 v[144:147], a[68:71], a[16:19], v[144:147]
v_cvt_pk_bf16_f32 v216, v184, v185
v_cvt_pk_bf16_f32 v217, v186, v187
v_mfma_f32_16x16x32_bf16 v[148:151], a[68:71], a[20:23], v[148:151]
v_cvt_pk_bf16_f32 v218, v200, v201
v_cvt_pk_bf16_f32 v219, v202, v203
v_mfma_f32_16x16x32_bf16 v[152:155], a[68:71], a[24:27], v[152:155]
v_cvt_pk_bf16_f32 v220, v188, v189
v_cvt_pk_bf16_f32 v221, v190, v191
v_mfma_f32_16x16x32_bf16 v[156:159], a[68:71], a[28:31], v[156:159]
v_cvt_pk_bf16_f32 v222, v204, v205
v_cvt_pk_bf16_f32 v223, v206, v207
v_mfma_f32_16x16x32_bf16 v[144:147], a[72:75], a[32:35], v[144:147]
s_waitcnt vmcnt(12) lgkmcnt(0)
s_barrier
v_mfma_f32_16x16x32_bf16 v[148:151], a[72:75], a[36:39], v[148:151]
ds_read_b128 a[64:67], v240 offset:24576
v_mfma_f32_16x16x32_bf16 v[152:155], a[72:75], a[40:43], v[152:155]
ds_read_b128 a[68:71], v241 offset:24576
s_add_u32 m0, s54, 147456
v_mfma_f32_16x16x32_bf16 v[156:159], a[72:75], a[44:47], v[156:159]
buffer_load_dwordx4 v8, s[44:47], s52 offen offset:0 lds
v_mfma_f32_16x16x32_bf16 v[144:147], a[76:79], a[48:51], v[144:147]
ds_read_b128 a[72:75], v242 offset:24576
v_mfma_f32_16x16x32_bf16 v[148:151], a[76:79], a[52:55], v[148:151]
buffer_load_dwordx4 v9, s[44:47], s52 offen offset:1024 lds
v_mfma_f32_16x16x32_bf16 v[152:155], a[76:79], a[56:59], v[152:155]
s_add_u32 m0, s54, 106496
v_mfma_f32_16x16x32_bf16 v[156:159], a[76:79], a[60:63], v[156:159]
s_add_u32 s52, s52, 8192
buffer_load_dwordx4 v10, s[48:51], s53 offen offset:0 lds
v_mfma_f32_16x16x32_bf16 v[160:163], a[80:83], a[0:3], v[224:227]
ds_read_b128 a[76:79], v243 offset:24576
v_mfma_f32_16x16x32_bf16 v[164:167], a[80:83], a[4:7], v[228:231]
buffer_load_dwordx4 v11, s[48:51], s53 offen offset:1024 lds
v_mfma_f32_16x16x32_bf16 v[168:171], a[80:83], a[8:11], v[232:235]
v_exp_f32 v144, v144
v_mfma_f32_16x16x32_bf16 v[172:175], a[80:83], a[12:15], v[236:239]
s_add_u32 s53, s53, 8192
v_exp_f32 v145, v145
v_mfma_f32_16x16x32_bf16 v[160:163], a[84:87], a[16:19], v[160:163]
ds_read_b128 a[80:83], v240 offset:28672
s_mov_b32 s3, 4194304
v_mfma_f32_16x16x32_bf16 v[164:167], a[84:87], a[20:23], v[164:167]
buffer_load_dword a249, v12, s[16:19], s3 offen
v_mfma_f32_16x16x32_bf16 v[168:171], a[84:87], a[24:27], v[168:171]
v_exp_f32 v146, v146
v_mfma_f32_16x16x32_bf16 v[172:175], a[84:87], a[28:31], v[172:175]
v_exp_f32 v147, v147
v_mfma_f32_16x16x32_bf16 v[160:163], a[88:91], a[32:35], v[160:163]
ds_read_b128 a[84:87], v241 offset:28672
v_mfma_f32_16x16x32_bf16 v[164:167], a[88:91], a[36:39], v[164:167]
v_exp_f32 v148, v148
v_mfma_f32_16x16x32_bf16 v[168:171], a[88:91], a[40:43], v[168:171]
v_exp_f32 v149, v149
v_mfma_f32_16x16x32_bf16 v[172:175], a[88:91], a[44:47], v[172:175]
v_exp_f32 v150, v150
v_mfma_f32_16x16x32_bf16 v[160:163], a[92:95], a[48:51], v[160:163]
ds_read_b128 a[88:91], v242 offset:28672
v_mfma_f32_16x16x32_bf16 v[164:167], a[92:95], a[52:55], v[164:167]
v_exp_f32 v151, v151
v_mfma_f32_16x16x32_bf16 v[168:171], a[92:95], a[56:59], v[168:171]
v_exp_f32 v152, v152
v_mfma_f32_16x16x32_bf16 v[172:175], a[92:95], a[60:63], v[172:175]
v_exp_f32 v153, v153
v_mfma_f32_16x16x32_bf16 v[16:19], a[96:99], v[208:211], v[16:19]
ds_read_b128 a[92:95], v243 offset:28672
v_mfma_f32_16x16x32_bf16 v[20:23], a[96:99], v[212:215], v[20:23]
v_exp_f32 v154, v154
v_mfma_f32_16x16x32_bf16 v[24:27], a[96:99], v[216:219], v[24:27]
v_exp_f32 v155, v155
v_mfma_f32_16x16x32_bf16 v[28:31], a[96:99], v[220:223], v[28:31]
v_exp_f32 v156, v156
v_mfma_f32_16x16x32_bf16 v[32:35], a[100:103], v[208:211], v[32:35]
ds_read_b64_tr_b16 a[96:97], v244 offset:16384
ds_read_b64_tr_b16 a[98:99], v244 offset:20480
v_mfma_f32_16x16x32_bf16 v[36:39], a[100:103], v[212:215], v[36:39]
v_exp_f32 v157, v157
v_mfma_f32_16x16x32_bf16 v[40:43], a[100:103], v[216:219], v[40:43]
v_exp_f32 v158, v158
v_mfma_f32_16x16x32_bf16 v[44:47], a[100:103], v[220:223], v[44:47]
v_exp_f32 v159, v159
v_mfma_f32_16x16x32_bf16 v[48:51], a[104:107], v[208:211], v[48:51]
ds_read_b64_tr_b16 a[100:101], v245 offset:16384
ds_read_b64_tr_b16 a[102:103], v245 offset:20480
v_mfma_f32_16x16x32_bf16 v[52:55], a[104:107], v[212:215], v[52:55]
v_exp_f32 v160, v160
v_mfma_f32_16x16x32_bf16 v[56:59], a[104:107], v[216:219], v[56:59]
v_exp_f32 v161, v161
v_mfma_f32_16x16x32_bf16 v[60:63], a[104:107], v[220:223], v[60:63]
v_exp_f32 v162, v162
v_mfma_f32_16x16x32_bf16 v[64:67], a[108:111], v[208:211], v[64:67]
ds_read_b64_tr_b16 a[104:105], v246 offset:16384
ds_read_b64_tr_b16 a[106:107], v246 offset:20480
v_mfma_f32_16x16x32_bf16 v[68:71], a[108:111], v[212:215], v[68:71]
v_exp_f32 v163, v163
v_mfma_f32_16x16x32_bf16 v[72:75], a[108:111], v[216:219], v[72:75]
v_exp_f32 v164, v164
v_mfma_f32_16x16x32_bf16 v[76:79], a[108:111], v[220:223], v[76:79]
v_exp_f32 v165, v165
v_mfma_f32_16x16x32_bf16 v[80:83], a[112:115], v[208:211], v[80:83]
ds_read_b64_tr_b16 a[108:109], v247 offset:16384
ds_read_b64_tr_b16 a[110:111], v247 offset:20480
v_mfma_f32_16x16x32_bf16 v[84:87], a[112:115], v[212:215], v[84:87]
v_exp_f32 v166, v166
v_mfma_f32_16x16x32_bf16 v[88:91], a[112:115], v[216:219], v[88:91]
v_exp_f32 v167, v167
v_mfma_f32_16x16x32_bf16 v[92:95], a[112:115], v[220:223], v[92:95]
v_exp_f32 v168, v168
v_mfma_f32_16x16x32_bf16 v[96:99], a[116:119], v[208:211], v[96:99]
ds_read_b64_tr_b16 a[112:113], v248 offset:16384
ds_read_b64_tr_b16 a[114:115], v248 offset:20480
v_mfma_f32_16x16x32_bf16 v[100:103], a[116:119], v[212:215], v[100:103]
v_exp_f32 v169, v169
v_mfma_f32_16x16x32_bf16 v[104:107], a[116:119], v[216:219], v[104:107]
v_exp_f32 v170, v170
v_mfma_f32_16x16x32_bf16 v[108:111], a[116:119], v[220:223], v[108:111]
v_exp_f32 v171, v171
v_mfma_f32_16x16x32_bf16 v[112:115], a[120:123], v[208:211], v[112:115]
ds_read_b64_tr_b16 a[116:117], v249 offset:16384
ds_read_b64_tr_b16 a[118:119], v249 offset:20480
v_mfma_f32_16x16x32_bf16 v[116:119], a[120:123], v[212:215], v[116:119]
v_exp_f32 v172, v172
v_mfma_f32_16x16x32_bf16 v[120:123], a[120:123], v[216:219], v[120:123]
v_exp_f32 v173, v173
v_mfma_f32_16x16x32_bf16 v[124:127], a[120:123], v[220:223], v[124:127]
v_exp_f32 v174, v174
v_mfma_f32_16x16x32_bf16 v[128:131], a[124:127], v[208:211], v[128:131]
ds_read_b64_tr_b16 a[120:121], v250 offset:16384
ds_read_b64_tr_b16 a[122:123], v250 offset:20480
v_mfma_f32_16x16x32_bf16 v[132:135], a[124:127], v[212:215], v[132:135]
v_exp_f32 v175, v175
v_mfma_f32_16x16x32_bf16 v[136:139], a[124:127], v[216:219], v[136:139]
v_mfma_f32_16x16x32_bf16 v[140:143], a[124:127], v[220:223], v[140:143]
v_mfma_f32_16x16x32_bf16 a[176:179], a[192:195], v[208:211], a[176:179]
ds_read_b64_tr_b16 a[124:125], v251 offset:16384
ds_read_b64_tr_b16 a[126:127], v251 offset:20480
v_mfma_f32_16x16x32_bf16 a[180:183], a[192:195], v[212:215], a[180:183]
v_mfma_f32_16x16x32_bf16 a[184:187], a[192:195], v[216:219], a[184:187]
v_mfma_f32_16x16x32_bf16 a[188:191], a[192:195], v[220:223], a[188:191]
s_waitcnt lgkmcnt(15)
v_mfma_f32_16x16x32_bf16 v[176:179], a[64:67], a[0:3], v[224:227]
v_cvt_pk_bf16_f32 v208, v144, v145
v_cvt_pk_bf16_f32 v209, v146, v147
v_mfma_f32_16x16x32_bf16 v[180:183], a[64:67], a[4:7], v[228:231]
v_cvt_pk_bf16_f32 v210, v160, v161
v_cvt_pk_bf16_f32 v211, v162, v163
v_mfma_f32_16x16x32_bf16 v[184:187], a[64:67], a[8:11], v[232:235]
v_cvt_pk_bf16_f32 v212, v148, v149
v_cvt_pk_bf16_f32 v213, v150, v151
v_mfma_f32_16x16x32_bf16 v[188:191], a[64:67], a[12:15], v[236:239]
v_cvt_pk_bf16_f32 v214, v164, v165
v_cvt_pk_bf16_f32 v215, v166, v167
v_mfma_f32_16x16x32_bf16 v[176:179], a[68:71], a[16:19], v[176:179]
v_cvt_pk_bf16_f32 v216, v152, v153
v_cvt_pk_bf16_f32 v217, v154, v155
v_mfma_f32_16x16x32_bf16 v[180:183], a[68:71], a[20:23], v[180:183]
v_cvt_pk_bf16_f32 v218, v168, v169
v_cvt_pk_bf16_f32 v219, v170, v171
v_mfma_f32_16x16x32_bf16 v[184:187], a[68:71], a[24:27], v[184:187]
v_cvt_pk_bf16_f32 v220, v156, v157
v_cvt_pk_bf16_f32 v221, v158, v159
v_mfma_f32_16x16x32_bf16 v[188:191], a[68:71], a[28:31], v[188:191]
v_cvt_pk_bf16_f32 v222, v172, v173
v_cvt_pk_bf16_f32 v223, v174, v175
v_mfma_f32_16x16x32_bf16 v[176:179], a[72:75], a[32:35], v[176:179]
s_waitcnt vmcnt(12) lgkmcnt(0)
s_barrier
v_mfma_f32_16x16x32_bf16 v[180:183], a[72:75], a[36:39], v[180:183]
ds_read_b128 a[64:67], v240 offset:0
v_mfma_f32_16x16x32_bf16 v[184:187], a[72:75], a[40:43], v[184:187]
ds_read_b128 a[68:71], v241 offset:0
s_add_u32 m0, s54, 155648
v_mfma_f32_16x16x32_bf16 v[188:191], a[72:75], a[44:47], v[188:191]
buffer_load_dwordx4 v8, s[44:47], s52 offen offset:0 lds
v_mfma_f32_16x16x32_bf16 v[176:179], a[76:79], a[48:51], v[176:179]
ds_read_b128 a[72:75], v242 offset:0
v_mfma_f32_16x16x32_bf16 v[180:183], a[76:79], a[52:55], v[180:183]
buffer_load_dwordx4 v9, s[44:47], s52 offen offset:1024 lds
v_mfma_f32_16x16x32_bf16 v[184:187], a[76:79], a[56:59], v[184:187]
s_add_u32 m0, s54, 114688
v_mfma_f32_16x16x32_bf16 v[188:191], a[76:79], a[60:63], v[188:191]
s_add_u32 s52, s52, 8192
buffer_load_dwordx4 v10, s[48:51], s53 offen offset:0 lds
v_mfma_f32_16x16x32_bf16 v[192:195], a[80:83], a[0:3], v[224:227]
ds_read_b128 a[76:79], v243 offset:0
v_mfma_f32_16x16x32_bf16 v[196:199], a[80:83], a[4:7], v[228:231]
buffer_load_dwordx4 v11, s[48:51], s53 offen offset:1024 lds
v_mfma_f32_16x16x32_bf16 v[200:203], a[80:83], a[8:11], v[232:235]
v_exp_f32 v176, v176
v_mfma_f32_16x16x32_bf16 v[204:207], a[80:83], a[12:15], v[236:239]
s_add_u32 s53, s53, 8192
v_exp_f32 v177, v177
v_mfma_f32_16x16x32_bf16 v[192:195], a[84:87], a[16:19], v[192:195]
ds_read_b128 a[80:83], v240 offset:4096
s_mov_b32 s3, 5242880
v_mfma_f32_16x16x32_bf16 v[196:199], a[84:87], a[20:23], v[196:199]
buffer_load_dword a250, v12, s[4:7], s3 offen
v_mfma_f32_16x16x32_bf16 v[200:203], a[84:87], a[24:27], v[200:203]
v_exp_f32 v178, v178
v_mfma_f32_16x16x32_bf16 v[204:207], a[84:87], a[28:31], v[204:207]
v_exp_f32 v179, v179
v_mfma_f32_16x16x32_bf16 v[192:195], a[88:91], a[32:35], v[192:195]
ds_read_b128 a[84:87], v241 offset:4096
v_mfma_f32_16x16x32_bf16 v[196:199], a[88:91], a[36:39], v[196:199]
v_exp_f32 v180, v180
v_mfma_f32_16x16x32_bf16 v[200:203], a[88:91], a[40:43], v[200:203]
v_exp_f32 v181, v181
v_mfma_f32_16x16x32_bf16 v[204:207], a[88:91], a[44:47], v[204:207]
v_exp_f32 v182, v182
v_mfma_f32_16x16x32_bf16 v[192:195], a[92:95], a[48:51], v[192:195]
ds_read_b128 a[88:91], v242 offset:4096
v_mfma_f32_16x16x32_bf16 v[196:199], a[92:95], a[52:55], v[196:199]
v_exp_f32 v183, v183
v_mfma_f32_16x16x32_bf16 v[200:203], a[92:95], a[56:59], v[200:203]
v_exp_f32 v184, v184
v_mfma_f32_16x16x32_bf16 v[204:207], a[92:95], a[60:63], v[204:207]
v_exp_f32 v185, v185
v_mfma_f32_16x16x32_bf16 v[16:19], a[96:99], v[208:211], v[16:19]
ds_read_b128 a[92:95], v243 offset:4096
v_mfma_f32_16x16x32_bf16 v[20:23], a[96:99], v[212:215], v[20:23]
v_exp_f32 v186, v186
v_mfma_f32_16x16x32_bf16 v[24:27], a[96:99], v[216:219], v[24:27]
v_exp_f32 v187, v187
v_mfma_f32_16x16x32_bf16 v[28:31], a[96:99], v[220:223], v[28:31]
v_exp_f32 v188, v188
v_mfma_f32_16x16x32_bf16 v[32:35], a[100:103], v[208:211], v[32:35]
ds_read_b64_tr_b16 a[96:97], v244 offset:24576
ds_read_b64_tr_b16 a[98:99], v244 offset:28672
v_mfma_f32_16x16x32_bf16 v[36:39], a[100:103], v[212:215], v[36:39]
v_exp_f32 v189, v189
v_mfma_f32_16x16x32_bf16 v[40:43], a[100:103], v[216:219], v[40:43]
s_cmp_eq_u32 s31, 0
s_cselect_b32 s12, s80, s72
v_exp_f32 v190, v190
v_mfma_f32_16x16x32_bf16 v[44:47], a[100:103], v[220:223], v[44:47]
s_cselect_b32 s13, s81, s73
s_mov_b32 s36, 7340032
v_exp_f32 v191, v191
v_mfma_f32_16x16x32_bf16 v[48:51], a[104:107], v[208:211], v[48:51]
ds_read_b64_tr_b16 a[100:101], v245 offset:24576
ds_read_b64_tr_b16 a[102:103], v245 offset:28672
s_mov_b32 s37, 8388608
s_cselect_b32 s14, s36, s37
v_mfma_f32_16x16x32_bf16 v[52:55], a[104:107], v[212:215], v[52:55]
s_mov_b32 s36, 4194304
s_mov_b32 s37, 18874368
v_exp_f32 v192, v192
v_mfma_f32_16x16x32_bf16 v[56:59], a[104:107], v[216:219], v[56:59]
s_cselect_b32 s38, s36, s37
s_mov_b32 s10, 67108864
v_exp_f32 v193, v193
v_mfma_f32_16x16x32_bf16 v[60:63], a[104:107], v[220:223], v[60:63]
s_cselect_b32 s32, 6, 7
s_and_b32 s13, s13, 0xffff
v_exp_f32 v194, v194
v_mfma_f32_16x16x32_bf16 v[64:67], a[108:111], v[208:211], v[64:67]
ds_read_b64_tr_b16 a[104:105], v246 offset:24576
ds_read_b64_tr_b16 a[106:107], v246 offset:28672
s_mov_b32 s15, 0x00020000
s_add_u32 s8, s88, s38
v_mfma_f32_16x16x32_bf16 v[68:71], a[108:111], v[212:215], v[68:71]
s_addc_u32 s9, s89, 0
s_and_b32 s9, s9, 0xffff
v_exp_f32 v195, v195
v_mfma_f32_16x16x32_bf16 v[72:75], a[108:111], v[216:219], v[72:75]
s_mov_b32 s11, 0x00020000
s_lshr_b32 s36, s2, 6
v_exp_f32 v196, v196
v_mfma_f32_16x16x32_bf16 v[76:79], a[108:111], v[220:223], v[76:79]
s_mul_i32 s36, s36, 1
s_mul_i32 s37, s30, 0
v_exp_f32 v197, v197
v_mfma_f32_16x16x32_bf16 v[80:83], a[112:115], v[208:211], v[80:83]
ds_read_b64_tr_b16 a[108:109], v247 offset:24576
ds_read_b64_tr_b16 a[110:111], v247 offset:28672
s_add_u32 s36, s36, s37
s_and_b32 s35, s36, 3
v_mfma_f32_16x16x32_bf16 v[84:87], a[112:115], v[212:215], v[84:87]
s_cmp_eq_u32 s31, 0
s_cselect_b32 s63, s35, s27
v_exp_f32 v198, v198
v_mfma_f32_16x16x32_bf16 v[88:91], a[112:115], v[216:219], v[88:91]
s_cselect_b32 s25, 0x2000, 0
s_lshl_b32 s23, s26, 13
v_exp_f32 v199, v199
v_mfma_f32_16x16x32_bf16 v[92:95], a[112:115], v[220:223], v[92:95]
v_exp_f32 v200, v200
v_mfma_f32_16x16x32_bf16 v[96:99], a[116:119], v[208:211], v[96:99]
ds_read_b64_tr_b16 a[112:113], v248 offset:24576
ds_read_b64_tr_b16 a[114:115], v248 offset:28672
v_mfma_f32_16x16x32_bf16 v[100:103], a[116:119], v[212:215], v[100:103]
v_exp_f32 v201, v201
v_mfma_f32_16x16x32_bf16 v[104:107], a[116:119], v[216:219], v[104:107]
v_exp_f32 v202, v202
v_mfma_f32_16x16x32_bf16 v[108:111], a[116:119], v[220:223], v[108:111]
v_exp_f32 v203, v203
v_mfma_f32_16x16x32_bf16 v[112:115], a[120:123], v[208:211], v[112:115]
ds_read_b64_tr_b16 a[116:117], v249 offset:24576
ds_read_b64_tr_b16 a[118:119], v249 offset:28672
v_mfma_f32_16x16x32_bf16 v[116:119], a[120:123], v[212:215], v[116:119]
v_exp_f32 v204, v204
v_mfma_f32_16x16x32_bf16 v[120:123], a[120:123], v[216:219], v[120:123]
v_exp_f32 v205, v205
v_mfma_f32_16x16x32_bf16 v[124:127], a[120:123], v[220:223], v[124:127]
v_exp_f32 v206, v206
v_mfma_f32_16x16x32_bf16 v[128:131], a[124:127], v[208:211], v[128:131]
ds_read_b64_tr_b16 a[120:121], v250 offset:24576
ds_read_b64_tr_b16 a[122:123], v250 offset:28672
v_accvgpr_read_b32 v4, a216
v_mfma_f32_16x16x32_bf16 v[132:135], a[124:127], v[212:215], v[132:135]
v_accvgpr_read_b32 v5, a217
v_exp_f32 v207, v207
v_mfma_f32_16x16x32_bf16 v[136:139], a[124:127], v[216:219], v[136:139]
v_accvgpr_read_b32 v6, a218
v_mfma_f32_16x16x32_bf16 v[140:143], a[124:127], v[220:223], v[140:143]
v_accvgpr_read_b32 v7, a219
v_mfma_f32_16x16x32_bf16 a[176:179], a[192:195], v[208:211], a[176:179]
ds_read_b64_tr_b16 a[124:125], v251 offset:24576
ds_read_b64_tr_b16 a[126:127], v251 offset:28672
v_mfma_f32_16x16x32_bf16 a[180:183], a[192:195], v[212:215], a[180:183]
v_mfma_f32_16x16x32_bf16 a[184:187], a[192:195], v[216:219], a[184:187]
v_mfma_f32_16x16x32_bf16 a[188:191], a[192:195], v[220:223], a[188:191]
s_waitcnt lgkmcnt(15)
v_mfma_f32_16x16x32_bf16 v[144:147], a[64:67], a[0:3], v[224:227]
v_cvt_pk_bf16_f32 v208, v176, v177
v_cvt_pk_bf16_f32 v209, v178, v179
v_mfma_f32_16x16x32_bf16 v[148:151], a[64:67], a[4:7], v[228:231]
v_cvt_pk_bf16_f32 v210, v192, v193
v_cvt_pk_bf16_f32 v211, v194, v195
v_mfma_f32_16x16x32_bf16 v[152:155], a[64:67], a[8:11], v[232:235]
v_cvt_pk_bf16_f32 v212, v180, v181
v_cvt_pk_bf16_f32 v213, v182, v183
v_mfma_f32_16x16x32_bf16 v[156:159], a[64:67], a[12:15], v[236:239]
v_cvt_pk_bf16_f32 v214, v196, v197
v_cvt_pk_bf16_f32 v215, v198, v199
v_mfma_f32_16x16x32_bf16 v[144:147], a[68:71], a[16:19], v[144:147]
v_cvt_pk_bf16_f32 v216, v184, v185
v_cvt_pk_bf16_f32 v217, v186, v187
v_mfma_f32_16x16x32_bf16 v[148:151], a[68:71], a[20:23], v[148:151]
v_cvt_pk_bf16_f32 v218, v200, v201
v_cvt_pk_bf16_f32 v219, v202, v203
v_mfma_f32_16x16x32_bf16 v[152:155], a[68:71], a[24:27], v[152:155]
v_cvt_pk_bf16_f32 v220, v188, v189
v_cvt_pk_bf16_f32 v221, v190, v191
v_mfma_f32_16x16x32_bf16 v[156:159], a[68:71], a[28:31], v[156:159]
v_cvt_pk_bf16_f32 v222, v204, v205
v_cvt_pk_bf16_f32 v223, v206, v207
v_mfma_f32_16x16x32_bf16 v[144:147], a[72:75], a[32:35], v[144:147]
s_waitcnt vmcnt(12) lgkmcnt(0)
s_barrier
v_mfma_f32_16x16x32_bf16 v[148:151], a[72:75], a[36:39], v[148:151]
ds_read_b128 a[64:67], v240 offset:8192
v_mfma_f32_16x16x32_bf16 v[152:155], a[72:75], a[40:43], v[152:155]
ds_read_b128 a[68:71], v241 offset:8192
s_add_u32 m0, s54, 122880
v_mfma_f32_16x16x32_bf16 v[156:159], a[72:75], a[44:47], v[156:159]
buffer_load_dwordx4 v10, s[48:51], s53 offen offset:0 lds
v_mfma_f32_16x16x32_bf16 v[144:147], a[76:79], a[48:51], v[144:147]
ds_read_b128 a[72:75], v242 offset:8192
v_mfma_f32_16x16x32_bf16 v[148:151], a[76:79], a[52:55], v[148:151]
buffer_load_dwordx4 v11, s[48:51], s53 offen offset:1024 lds
s_xor_b32 s36, s27, 0
v_mfma_f32_16x16x32_bf16 v[152:155], a[76:79], a[56:59], v[152:155]
s_add_u32 s37, s35, 0
v_mfma_f32_16x16x32_bf16 v[156:159], a[76:79], a[60:63], v[156:159]
s_add_u32 s53, s53, 8192
s_and_b32 s37, s37, 3
v_mfma_f32_16x16x32_bf16 v[160:163], a[80:83], a[0:3], v[224:227]
ds_read_b128 a[76:79], v243 offset:8192
s_cmp_eq_u32 s31, 0
s_cselect_b32 s36, s37, s36
v_mfma_f32_16x16x32_bf16 v[164:167], a[80:83], a[4:7], v[228:231]
v_exp_f32 v144, v144
v_mfma_f32_16x16x32_bf16 v[168:171], a[80:83], a[8:11], v[232:235]
s_lshl_b32 s21, s36, 18
v_exp_f32 v145, v145
v_mfma_f32_16x16x32_bf16 v[172:175], a[80:83], a[12:15], v[236:239]
s_lshl_b32 s37, s36, 2
v_exp_f32 v146, v146
v_mfma_f32_16x16x32_bf16 v[160:163], a[84:87], a[16:19], v[160:163]
ds_read_b128 a[80:83], v240 offset:12288
s_mov_b32 s3, 5242880
s_add_u32 s37, s37, s26
v_mfma_f32_16x16x32_bf16 v[164:167], a[84:87], a[20:23], v[164:167]
buffer_load_dword a251, v12, s[16:19], s3 offen
s_mul_i32 s38, s37, 147
v_mfma_f32_16x16x32_bf16 v[168:171], a[84:87], a[24:27], v[168:171]
s_lshr_b32 s38, s38, 10
v_exp_f32 v147, v147
v_mfma_f32_16x16x32_bf16 v[172:175], a[84:87], a[28:31], v[172:175]
s_mul_i32 s38, s38, 7
v_exp_f32 v148, v148
v_mfma_f32_16x16x32_bf16 v[160:163], a[88:91], a[32:35], v[160:163]
ds_read_b128 a[84:87], v241 offset:12288
s_sub_u32 s37, s37, s38
v_mfma_f32_16x16x32_bf16 v[164:167], a[88:91], a[36:39], v[164:167]
s_cmp_eq_u32 s37, 3
s_cselect_b32 s24, s25, 0
v_exp_f32 v149, v149
v_mfma_f32_16x16x32_bf16 v[168:171], a[88:91], a[40:43], v[168:171]
v_exp_f32 v150, v150
v_mfma_f32_16x16x32_bf16 v[172:175], a[88:91], a[44:47], v[172:175]
s_mul_i32 s37, s24, 3
v_exp_f32 v151, v151
v_mfma_f32_16x16x32_bf16 v[160:163], a[92:95], a[48:51], v[160:163]
ds_read_b128 a[88:91], v242 offset:12288
s_add_u32 s22, s21, 32768
v_mfma_f32_16x16x32_bf16 v[164:167], a[92:95], a[52:55], v[164:167]
s_sub_u32 s22, s22, s37
v_exp_f32 v152, v152
v_mfma_f32_16x16x32_bf16 v[168:171], a[92:95], a[56:59], v[168:171]
v_exp_f32 v153, v153
v_mfma_f32_16x16x32_bf16 v[172:175], a[92:95], a[60:63], v[172:175]
v_exp_f32 v154, v154
v_mfma_f32_16x16x32_bf16 v[16:19], a[96:99], v[208:211], v[16:19]
ds_read_b128 a[92:95], v243 offset:12288
v_mfma_f32_16x16x32_bf16 v[20:23], a[96:99], v[212:215], v[20:23]
s_add_u32 m0, s23, 0
v_exp_f32 v155, v155
v_mfma_f32_16x16x32_bf16 v[24:27], a[96:99], v[216:219], v[24:27]
buffer_load_dwordx4 v4, s[12:15], s21 offen offset:0 lds
v_mfma_f32_16x16x32_bf16 v[28:31], a[96:99], v[220:223], v[28:31]
v_exp_f32 v156, v156
v_mfma_f32_16x16x32_bf16 v[32:35], a[100:103], v[208:211], v[32:35]
ds_read_b64_tr_b16 a[96:97], v244 offset:0
ds_read_b64_tr_b16 a[98:99], v244 offset:4096
v_mfma_f32_16x16x32_bf16 v[36:39], a[100:103], v[212:215], v[36:39]
v_exp_f32 v157, v157
v_mfma_f32_16x16x32_bf16 v[40:43], a[100:103], v[216:219], v[40:43]
s_add_u32 s21, s21, s24
buffer_load_dwordx4 v5, s[12:15], s21 offen offset:1024 lds
v_mfma_f32_16x16x32_bf16 v[44:47], a[100:103], v[220:223], v[44:47]
v_exp_f32 v158, v158
v_mfma_f32_16x16x32_bf16 v[48:51], a[104:107], v[208:211], v[48:51]
ds_read_b64_tr_b16 a[100:101], v245 offset:0
ds_read_b64_tr_b16 a[102:103], v245 offset:4096
v_mfma_f32_16x16x32_bf16 v[52:55], a[104:107], v[212:215], v[52:55]
v_exp_f32 v159, v159
v_mfma_f32_16x16x32_bf16 v[56:59], a[104:107], v[216:219], v[56:59]
s_add_u32 s21, s21, s24
buffer_load_dwordx4 v6, s[12:15], s21 offen offset:2048 lds
v_mfma_f32_16x16x32_bf16 v[60:63], a[104:107], v[220:223], v[60:63]
v_exp_f32 v160, v160
v_mfma_f32_16x16x32_bf16 v[64:67], a[108:111], v[208:211], v[64:67]
ds_read_b64_tr_b16 a[104:105], v246 offset:0
ds_read_b64_tr_b16 a[106:107], v246 offset:4096
v_mfma_f32_16x16x32_bf16 v[68:71], a[108:111], v[212:215], v[68:71]
v_exp_f32 v161, v161
v_mfma_f32_16x16x32_bf16 v[72:75], a[108:111], v[216:219], v[72:75]
s_add_u32 s21, s21, s24
buffer_load_dwordx4 v7, s[12:15], s21 offen offset:3072 lds
v_mfma_f32_16x16x32_bf16 v[76:79], a[108:111], v[220:223], v[76:79]
v_exp_f32 v162, v162
v_mfma_f32_16x16x32_bf16 v[80:83], a[112:115], v[208:211], v[80:83]
ds_read_b64_tr_b16 a[108:109], v247 offset:0
ds_read_b64_tr_b16 a[110:111], v247 offset:4096
v_mfma_f32_16x16x32_bf16 v[84:87], a[112:115], v[212:215], v[84:87]
s_add_u32 m0, s23, 4096
v_exp_f32 v163, v163
v_mfma_f32_16x16x32_bf16 v[88:91], a[112:115], v[216:219], v[88:91]
buffer_load_dwordx4 v4, s[12:15], s22 offen offset:0 lds
v_mfma_f32_16x16x32_bf16 v[92:95], a[112:115], v[220:223], v[92:95]
v_exp_f32 v164, v164
v_mfma_f32_16x16x32_bf16 v[96:99], a[116:119], v[208:211], v[96:99]
ds_read_b64_tr_b16 a[112:113], v248 offset:0
ds_read_b64_tr_b16 a[114:115], v248 offset:4096
v_mfma_f32_16x16x32_bf16 v[100:103], a[116:119], v[212:215], v[100:103]
v_exp_f32 v165, v165
v_mfma_f32_16x16x32_bf16 v[104:107], a[116:119], v[216:219], v[104:107]
s_add_u32 s22, s22, s24
buffer_load_dwordx4 v5, s[12:15], s22 offen offset:1024 lds
v_mfma_f32_16x16x32_bf16 v[108:111], a[116:119], v[220:223], v[108:111]
v_exp_f32 v166, v166
v_mfma_f32_16x16x32_bf16 v[112:115], a[120:123], v[208:211], v[112:115]
ds_read_b64_tr_b16 a[116:117], v249 offset:0
ds_read_b64_tr_b16 a[118:119], v249 offset:4096
v_mfma_f32_16x16x32_bf16 v[116:119], a[120:123], v[212:215], v[116:119]
v_exp_f32 v167, v167
v_mfma_f32_16x16x32_bf16 v[120:123], a[120:123], v[216:219], v[120:123]
s_add_u32 s22, s22, s24
buffer_load_dwordx4 v6, s[12:15], s22 offen offset:2048 lds
v_mfma_f32_16x16x32_bf16 v[124:127], a[120:123], v[220:223], v[124:127]
v_exp_f32 v168, v168
v_mfma_f32_16x16x32_bf16 v[128:131], a[124:127], v[208:211], v[128:131]
ds_read_b64_tr_b16 a[120:121], v250 offset:0
ds_read_b64_tr_b16 a[122:123], v250 offset:4096
v_mfma_f32_16x16x32_bf16 v[132:135], a[124:127], v[212:215], v[132:135]
v_exp_f32 v169, v169
v_mfma_f32_16x16x32_bf16 v[136:139], a[124:127], v[216:219], v[136:139]
s_add_u32 s22, s22, s24
buffer_load_dwordx4 v7, s[12:15], s22 offen offset:3072 lds
v_mfma_f32_16x16x32_bf16 v[140:143], a[124:127], v[220:223], v[140:143]
v_exp_f32 v170, v170
v_mfma_f32_16x16x32_bf16 a[176:179], a[192:195], v[208:211], a[176:179]
ds_read_b64_tr_b16 a[124:125], v251 offset:0
ds_read_b64_tr_b16 a[126:127], v251 offset:4096
v_mfma_f32_16x16x32_bf16 a[180:183], a[192:195], v[212:215], a[180:183]
v_exp_f32 v171, v171
v_mfma_f32_16x16x32_bf16 a[184:187], a[192:195], v[216:219], a[184:187]
v_exp_f32 v172, v172
v_mfma_f32_16x16x32_bf16 a[188:191], a[192:195], v[220:223], a[188:191]
v_exp_f32 v173, v173
v_exp_f32 v174, v174
v_exp_f32 v175, v175
s_waitcnt lgkmcnt(15)
v_mfma_f32_16x16x32_bf16 v[176:179], a[64:67], a[0:3], v[224:227]
v_cvt_pk_bf16_f32 v208, v144, v145
v_cvt_pk_bf16_f32 v209, v146, v147
v_mfma_f32_16x16x32_bf16 v[180:183], a[64:67], a[4:7], v[228:231]
v_cvt_pk_bf16_f32 v210, v160, v161
v_cvt_pk_bf16_f32 v211, v162, v163
v_mfma_f32_16x16x32_bf16 v[184:187], a[64:67], a[8:11], v[232:235]
v_cvt_pk_bf16_f32 v212, v148, v149
v_cvt_pk_bf16_f32 v213, v150, v151
v_mfma_f32_16x16x32_bf16 v[188:191], a[64:67], a[12:15], v[236:239]
v_cvt_pk_bf16_f32 v214, v164, v165
v_cvt_pk_bf16_f32 v215, v166, v167
v_mfma_f32_16x16x32_bf16 v[176:179], a[68:71], a[16:19], v[176:179]
v_cvt_pk_bf16_f32 v216, v152, v153
v_cvt_pk_bf16_f32 v217, v154, v155
v_mfma_f32_16x16x32_bf16 v[180:183], a[68:71], a[20:23], v[180:183]
v_cvt_pk_bf16_f32 v218, v168, v169
v_cvt_pk_bf16_f32 v219, v170, v171
v_mfma_f32_16x16x32_bf16 v[184:187], a[68:71], a[24:27], v[184:187]
v_cvt_pk_bf16_f32 v220, v156, v157
v_cvt_pk_bf16_f32 v221, v158, v159
v_mfma_f32_16x16x32_bf16 v[188:191], a[68:71], a[28:31], v[188:191]
v_cvt_pk_bf16_f32 v222, v172, v173
v_cvt_pk_bf16_f32 v223, v174, v175
v_mfma_f32_16x16x32_bf16 v[176:179], a[72:75], a[32:35], v[176:179]
s_waitcnt vmcnt(17) lgkmcnt(0)
s_barrier
v_mfma_f32_16x16x32_bf16 v[180:183], a[72:75], a[36:39], v[180:183]
ds_read_b128 a[64:67], v240 offset:16384
v_mfma_f32_16x16x32_bf16 v[184:187], a[72:75], a[40:43], v[184:187]
ds_read_b128 a[68:71], v241 offset:16384
v_mfma_f32_16x16x32_bf16 v[188:191], a[72:75], a[44:47], v[188:191]
v_mfma_f32_16x16x32_bf16 v[176:179], a[76:79], a[48:51], v[176:179]
ds_read_b128 a[72:75], v242 offset:16384
v_mfma_f32_16x16x32_bf16 v[180:183], a[76:79], a[52:55], v[180:183]
s_xor_b32 s36, s27, 1
v_mfma_f32_16x16x32_bf16 v[184:187], a[76:79], a[56:59], v[184:187]
s_add_u32 s37, s35, 1
v_mfma_f32_16x16x32_bf16 v[188:191], a[76:79], a[60:63], v[188:191]
s_and_b32 s37, s37, 3
v_mfma_f32_16x16x32_bf16 v[192:195], a[80:83], a[0:3], v[224:227]
ds_read_b128 a[76:79], v243 offset:16384
s_cmp_eq_u32 s31, 0
s_cselect_b32 s36, s37, s36
v_mfma_f32_16x16x32_bf16 v[196:199], a[80:83], a[4:7], v[228:231]
v_exp_f32 v176, v176
v_mfma_f32_16x16x32_bf16 v[200:203], a[80:83], a[8:11], v[232:235]
s_lshl_b32 s21, s36, 18
v_exp_f32 v177, v177
v_mfma_f32_16x16x32_bf16 v[204:207], a[80:83], a[12:15], v[236:239]
s_lshl_b32 s37, s36, 2
v_exp_f32 v178, v178
v_mfma_f32_16x16x32_bf16 v[192:195], a[84:87], a[16:19], v[192:195]
ds_read_b128 a[80:83], v240 offset:20480
s_mov_b32 s3, 6291456
s_add_u32 s37, s37, s26
v_mfma_f32_16x16x32_bf16 v[196:199], a[84:87], a[20:23], v[196:199]
buffer_load_dword a252, v12, s[4:7], s3 offen
s_mul_i32 s38, s37, 147
v_mfma_f32_16x16x32_bf16 v[200:203], a[84:87], a[24:27], v[200:203]
s_lshr_b32 s38, s38, 10
v_exp_f32 v179, v179
v_mfma_f32_16x16x32_bf16 v[204:207], a[84:87], a[28:31], v[204:207]
s_mul_i32 s38, s38, 7
v_exp_f32 v180, v180
v_mfma_f32_16x16x32_bf16 v[192:195], a[88:91], a[32:35], v[192:195]
ds_read_b128 a[84:87], v241 offset:20480
s_sub_u32 s37, s37, s38
v_mfma_f32_16x16x32_bf16 v[196:199], a[88:91], a[36:39], v[196:199]
s_cmp_eq_u32 s37, 3
s_cselect_b32 s24, s25, 0
v_exp_f32 v181, v181
v_mfma_f32_16x16x32_bf16 v[200:203], a[88:91], a[40:43], v[200:203]
v_exp_f32 v182, v182
v_mfma_f32_16x16x32_bf16 v[204:207], a[88:91], a[44:47], v[204:207]
s_mul_i32 s37, s24, 3
v_exp_f32 v183, v183
v_mfma_f32_16x16x32_bf16 v[192:195], a[92:95], a[48:51], v[192:195]
ds_read_b128 a[88:91], v242 offset:20480
s_add_u32 s22, s21, 32768
v_mfma_f32_16x16x32_bf16 v[196:199], a[92:95], a[52:55], v[196:199]
s_sub_u32 s22, s22, s37
v_exp_f32 v184, v184
v_mfma_f32_16x16x32_bf16 v[200:203], a[92:95], a[56:59], v[200:203]
v_exp_f32 v185, v185
v_mfma_f32_16x16x32_bf16 v[204:207], a[92:95], a[60:63], v[204:207]
v_exp_f32 v186, v186
v_mfma_f32_16x16x32_bf16 v[16:19], a[96:99], v[208:211], v[16:19]
ds_read_b128 a[92:95], v243 offset:20480
v_mfma_f32_16x16x32_bf16 v[20:23], a[96:99], v[212:215], v[20:23]
s_add_u32 m0, s23, 32768
v_exp_f32 v187, v187
v_mfma_f32_16x16x32_bf16 v[24:27], a[96:99], v[216:219], v[24:27]
buffer_load_dwordx4 v4, s[12:15], s21 offen offset:0 lds
v_mfma_f32_16x16x32_bf16 v[28:31], a[96:99], v[220:223], v[28:31]
v_exp_f32 v188, v188
v_mfma_f32_16x16x32_bf16 v[32:35], a[100:103], v[208:211], v[32:35]
ds_read_b64_tr_b16 a[96:97], v244 offset:8192
ds_read_b64_tr_b16 a[98:99], v244 offset:12288
v_mfma_f32_16x16x32_bf16 v[36:39], a[100:103], v[212:215], v[36:39]
v_exp_f32 v189, v189
v_mfma_f32_16x16x32_bf16 v[40:43], a[100:103], v[216:219], v[40:43]
s_add_u32 s21, s21, s24
buffer_load_dwordx4 v5, s[12:15], s21 offen offset:1024 lds
v_mfma_f32_16x16x32_bf16 v[44:47], a[100:103], v[220:223], v[44:47]
v_exp_f32 v190, v190
v_mfma_f32_16x16x32_bf16 v[48:51], a[104:107], v[208:211], v[48:51]
ds_read_b64_tr_b16 a[100:101], v245 offset:8192
ds_read_b64_tr_b16 a[102:103], v245 offset:12288
v_mfma_f32_16x16x32_bf16 v[52:55], a[104:107], v[212:215], v[52:55]
v_exp_f32 v191, v191
v_mfma_f32_16x16x32_bf16 v[56:59], a[104:107], v[216:219], v[56:59]
s_add_u32 s21, s21, s24
buffer_load_dwordx4 v6, s[12:15], s21 offen offset:2048 lds
v_mfma_f32_16x16x32_bf16 v[60:63], a[104:107], v[220:223], v[60:63]
v_exp_f32 v192, v192
v_mfma_f32_16x16x32_bf16 v[64:67], a[108:111], v[208:211], v[64:67]
ds_read_b64_tr_b16 a[104:105], v246 offset:8192
ds_read_b64_tr_b16 a[106:107], v246 offset:12288
v_mfma_f32_16x16x32_bf16 v[68:71], a[108:111], v[212:215], v[68:71]
v_exp_f32 v193, v193
v_mfma_f32_16x16x32_bf16 v[72:75], a[108:111], v[216:219], v[72:75]
s_add_u32 s21, s21, s24
buffer_load_dwordx4 v7, s[12:15], s21 offen offset:3072 lds
v_mfma_f32_16x16x32_bf16 v[76:79], a[108:111], v[220:223], v[76:79]
v_exp_f32 v194, v194
v_mfma_f32_16x16x32_bf16 v[80:83], a[112:115], v[208:211], v[80:83]
ds_read_b64_tr_b16 a[108:109], v247 offset:8192
ds_read_b64_tr_b16 a[110:111], v247 offset:12288
v_mfma_f32_16x16x32_bf16 v[84:87], a[112:115], v[212:215], v[84:87]
s_add_u32 m0, s23, 36864
v_exp_f32 v195, v195
v_mfma_f32_16x16x32_bf16 v[88:91], a[112:115], v[216:219], v[88:91]
buffer_load_dwordx4 v4, s[12:15], s22 offen offset:0 lds
v_mfma_f32_16x16x32_bf16 v[92:95], a[112:115], v[220:223], v[92:95]
v_exp_f32 v196, v196
v_mfma_f32_16x16x32_bf16 v[96:99], a[116:119], v[208:211], v[96:99]
ds_read_b64_tr_b16 a[112:113], v248 offset:8192
ds_read_b64_tr_b16 a[114:115], v248 offset:12288
v_mfma_f32_16x16x32_bf16 v[100:103], a[116:119], v[212:215], v[100:103]
v_exp_f32 v197, v197
v_mfma_f32_16x16x32_bf16 v[104:107], a[116:119], v[216:219], v[104:107]
s_add_u32 s22, s22, s24
buffer_load_dwordx4 v5, s[12:15], s22 offen offset:1024 lds
v_mfma_f32_16x16x32_bf16 v[108:111], a[116:119], v[220:223], v[108:111]
v_exp_f32 v198, v198
v_mfma_f32_16x16x32_bf16 v[112:115], a[120:123], v[208:211], v[112:115]
ds_read_b64_tr_b16 a[116:117], v249 offset:8192
ds_read_b64_tr_b16 a[118:119], v249 offset:12288
v_mfma_f32_16x16x32_bf16 v[116:119], a[120:123], v[212:215], v[116:119]
v_exp_f32 v199, v199
v_mfma_f32_16x16x32_bf16 v[120:123], a[120:123], v[216:219], v[120:123]
s_add_u32 s22, s22, s24
buffer_load_dwordx4 v6, s[12:15], s22 offen offset:2048 lds
v_mfma_f32_16x16x32_bf16 v[124:127], a[120:123], v[220:223], v[124:127]
v_exp_f32 v200, v200
v_mfma_f32_16x16x32_bf16 v[128:131], a[124:127], v[208:211], v[128:131]
ds_read_b64_tr_b16 a[120:121], v250 offset:8192
ds_read_b64_tr_b16 a[122:123], v250 offset:12288
v_mfma_f32_16x16x32_bf16 v[132:135], a[124:127], v[212:215], v[132:135]
v_exp_f32 v201, v201
v_mfma_f32_16x16x32_bf16 v[136:139], a[124:127], v[216:219], v[136:139]
s_add_u32 s22, s22, s24
buffer_load_dwordx4 v7, s[12:15], s22 offen offset:3072 lds
v_mfma_f32_16x16x32_bf16 v[140:143], a[124:127], v[220:223], v[140:143]
v_exp_f32 v202, v202
v_mfma_f32_16x16x32_bf16 a[176:179], a[192:195], v[208:211], a[176:179]
ds_read_b64_tr_b16 a[124:125], v251 offset:8192
ds_read_b64_tr_b16 a[126:127], v251 offset:12288
v_mfma_f32_16x16x32_bf16 a[180:183], a[192:195], v[212:215], a[180:183]
v_exp_f32 v203, v203
v_mfma_f32_16x16x32_bf16 a[184:187], a[192:195], v[216:219], a[184:187]
v_exp_f32 v204, v204
v_mfma_f32_16x16x32_bf16 a[188:191], a[192:195], v[220:223], a[188:191]
v_exp_f32 v205, v205
v_exp_f32 v206, v206
v_exp_f32 v207, v207
s_waitcnt lgkmcnt(15)
v_mfma_f32_16x16x32_bf16 v[144:147], a[64:67], a[0:3], v[224:227]
v_cvt_pk_bf16_f32 v208, v176, v177
v_cvt_pk_bf16_f32 v209, v178, v179
v_mfma_f32_16x16x32_bf16 v[148:151], a[64:67], a[4:7], v[228:231]
v_cvt_pk_bf16_f32 v210, v192, v193
v_cvt_pk_bf16_f32 v211, v194, v195
v_mfma_f32_16x16x32_bf16 v[152:155], a[64:67], a[8:11], v[232:235]
v_cvt_pk_bf16_f32 v212, v180, v181
v_cvt_pk_bf16_f32 v213, v182, v183
v_mfma_f32_16x16x32_bf16 v[156:159], a[64:67], a[12:15], v[236:239]
v_cvt_pk_bf16_f32 v214, v196, v197
v_cvt_pk_bf16_f32 v215, v198, v199
v_mfma_f32_16x16x32_bf16 v[144:147], a[68:71], a[16:19], v[144:147]
v_cvt_pk_bf16_f32 v216, v184, v185
v_cvt_pk_bf16_f32 v217, v186, v187
v_mfma_f32_16x16x32_bf16 v[148:151], a[68:71], a[20:23], v[148:151]
v_cvt_pk_bf16_f32 v218, v200, v201
v_cvt_pk_bf16_f32 v219, v202, v203
v_mfma_f32_16x16x32_bf16 v[152:155], a[68:71], a[24:27], v[152:155]
v_cvt_pk_bf16_f32 v220, v188, v189
v_cvt_pk_bf16_f32 v221, v190, v191
v_mfma_f32_16x16x32_bf16 v[156:159], a[68:71], a[28:31], v[156:159]
v_cvt_pk_bf16_f32 v222, v204, v205
v_cvt_pk_bf16_f32 v223, v206, v207
v_mfma_f32_16x16x32_bf16 v[144:147], a[72:75], a[32:35], v[144:147]
s_waitcnt vmcnt(21) lgkmcnt(0)
s_barrier
v_mfma_f32_16x16x32_bf16 v[148:151], a[72:75], a[36:39], v[148:151]
ds_read_b128 a[64:67], v240 offset:24576
v_cmp_ne_u32 vcc, 1, v14
s_nop 4
s_cbranch_vccz L_hp_k_ok
s_add_u32 s56, s88, 41943040
s_addc_u32 s57, s89, 0
s_and_b32 s57, s57, 0xffff
s_mov_b32 s58, 0x4000
s_mov_b32 s59, 0x00020000
s_lshl_b32 s38, s28, 8
s_add_u32 s38, s38, 0
v_and_b32 v13, 31, v0
v_lshlrev_b32 v13, 2, v13
v_add_u32 v13, s38, v13
s_mov_b32 s39, 0
L_hp_k_loop:
buffer_load_dword v14, v13, s[56:59], 0 offen sc0 sc1
s_waitcnt vmcnt(0)
v_cmp_ne_u32 vcc, 1, v14
s_add_u32 s39, s39, 1
s_cmp_gt_u32 s39, 0x40000
s_cbranch_scc1 L_hp_k_done
s_nop 1
s_cbranch_vccz L_hp_k_done
s_branch L_hp_k_loop
L_hp_k_done:
L_hp_k_ok:
v_mfma_f32_16x16x32_bf16 v[152:155], a[72:75], a[40:43], v[152:155]
ds_read_b128 a[68:71], v241 offset:24576
v_mfma_f32_16x16x32_bf16 v[156:159], a[72:75], a[44:47], v[156:159]
v_mfma_f32_16x16x32_bf16 v[144:147], a[76:79], a[48:51], v[144:147]
ds_read_b128 a[72:75], v242 offset:24576
v_mfma_f32_16x16x32_bf16 v[148:151], a[76:79], a[52:55], v[148:151]
s_xor_b32 s36, s27, 2
v_mfma_f32_16x16x32_bf16 v[152:155], a[76:79], a[56:59], v[152:155]
s_add_u32 s37, s35, 2
v_mfma_f32_16x16x32_bf16 v[156:159], a[76:79], a[60:63], v[156:159]
s_and_b32 s37, s37, 3
v_mfma_f32_16x16x32_bf16 v[160:163], a[80:83], a[0:3], v[224:227]
ds_read_b128 a[76:79], v243 offset:24576
s_cmp_eq_u32 s31, 0
s_cselect_b32 s36, s37, s36
v_mfma_f32_16x16x32_bf16 v[164:167], a[80:83], a[4:7], v[228:231]
v_exp_f32 v144, v144
v_mfma_f32_16x16x32_bf16 v[168:171], a[80:83], a[8:11], v[232:235]
s_lshl_b32 s21, s36, 18
v_exp_f32 v145, v145
v_mfma_f32_16x16x32_bf16 v[172:175], a[80:83], a[12:15], v[236:239]
s_lshl_b32 s37, s36, 2
v_exp_f32 v146, v146
v_mfma_f32_16x16x32_bf16 v[160:163], a[84:87], a[16:19], v[160:163]
ds_read_b128 a[80:83], v240 offset:28672
s_mov_b32 s3, 6291456
s_add_u32 s37, s37, s26
v_mfma_f32_16x16x32_bf16 v[164:167], a[84:87], a[20:23], v[164:167]
buffer_load_dword a253, v12, s[16:19], s3 offen
s_mul_i32 s38, s37, 147
v_mfma_f32_16x16x32_bf16 v[168:171], a[84:87], a[24:27], v[168:171]
s_lshr_b32 s38, s38, 10
v_exp_f32 v147, v147
v_mfma_f32_16x16x32_bf16 v[172:175], a[84:87], a[28:31], v[172:175]
s_mul_i32 s38, s38, 7
v_exp_f32 v148, v148
v_mfma_f32_16x16x32_bf16 v[160:163], a[88:91], a[32:35], v[160:163]
ds_read_b128 a[84:87], v241 offset:28672
s_sub_u32 s37, s37, s38
v_mfma_f32_16x16x32_bf16 v[164:167], a[88:91], a[36:39], v[164:167]
s_cmp_eq_u32 s37, 3
s_cselect_b32 s24, s25, 0
v_exp_f32 v149, v149
v_mfma_f32_16x16x32_bf16 v[168:171], a[88:91], a[40:43], v[168:171]
v_exp_f32 v150, v150
v_mfma_f32_16x16x32_bf16 v[172:175], a[88:91], a[44:47], v[172:175]
s_mul_i32 s37, s24, 3
v_exp_f32 v151, v151
v_mfma_f32_16x16x32_bf16 v[160:163], a[92:95], a[48:51], v[160:163]
ds_read_b128 a[88:91], v242 offset:28672
s_add_u32 s22, s21, 32768
v_mfma_f32_16x16x32_bf16 v[164:167], a[92:95], a[52:55], v[164:167]
s_sub_u32 s22, s22, s37
v_exp_f32 v152, v152
v_mfma_f32_16x16x32_bf16 v[168:171], a[92:95], a[56:59], v[168:171]
v_exp_f32 v153, v153
v_mfma_f32_16x16x32_bf16 v[172:175], a[92:95], a[60:63], v[172:175]
v_exp_f32 v154, v154
v_mfma_f32_16x16x32_bf16 v[16:19], a[96:99], v[208:211], v[16:19]
ds_read_b128 a[92:95], v243 offset:28672
v_mfma_f32_16x16x32_bf16 v[20:23], a[96:99], v[212:215], v[20:23]
s_add_u32 m0, s23, 65536
v_exp_f32 v155, v155
v_mfma_f32_16x16x32_bf16 v[24:27], a[96:99], v[216:219], v[24:27]
buffer_load_dwordx4 v4, s[12:15], s21 offen offset:0 lds
v_mfma_f32_16x16x32_bf16 v[28:31], a[96:99], v[220:223], v[28:31]
v_exp_f32 v156, v156
v_mfma_f32_16x16x32_bf16 v[32:35], a[100:103], v[208:211], v[32:35]
ds_read_b64_tr_b16 a[96:97], v244 offset:16384
ds_read_b64_tr_b16 a[98:99], v244 offset:20480
v_mfma_f32_16x16x32_bf16 v[36:39], a[100:103], v[212:215], v[36:39]
v_exp_f32 v157, v157
v_mfma_f32_16x16x32_bf16 v[40:43], a[100:103], v[216:219], v[40:43]
s_add_u32 s21, s21, s24
buffer_load_dwordx4 v5, s[12:15], s21 offen offset:1024 lds
v_mfma_f32_16x16x32_bf16 v[44:47], a[100:103], v[220:223], v[44:47]
v_exp_f32 v158, v158
v_mfma_f32_16x16x32_bf16 v[48:51], a[104:107], v[208:211], v[48:51]
ds_read_b64_tr_b16 a[100:101], v245 offset:16384
ds_read_b64_tr_b16 a[102:103], v245 offset:20480
ds_write_b32 v1, v2
v_mfma_f32_16x16x32_bf16 v[52:55], a[104:107], v[212:215], v[52:55]
v_exp_f32 v159, v159
v_mfma_f32_16x16x32_bf16 v[56:59], a[104:107], v[216:219], v[56:59]
s_add_u32 s21, s21, s24
buffer_load_dwordx4 v6, s[12:15], s21 offen offset:2048 lds
v_mfma_f32_16x16x32_bf16 v[60:63], a[104:107], v[220:223], v[60:63]
v_exp_f32 v160, v160
v_mfma_f32_16x16x32_bf16 v[64:67], a[108:111], v[208:211], v[64:67]
ds_read_b64_tr_b16 a[104:105], v246 offset:16384
ds_read_b64_tr_b16 a[106:107], v246 offset:20480
v_mfma_f32_16x16x32_bf16 v[68:71], a[108:111], v[212:215], v[68:71]
v_exp_f32 v161, v161
v_mfma_f32_16x16x32_bf16 v[72:75], a[108:111], v[216:219], v[72:75]
s_add_u32 s21, s21, s24
buffer_load_dwordx4 v7, s[12:15], s21 offen offset:3072 lds
v_mfma_f32_16x16x32_bf16 v[76:79], a[108:111], v[220:223], v[76:79]
v_exp_f32 v162, v162
v_mfma_f32_16x16x32_bf16 v[80:83], a[112:115], v[208:211], v[80:83]
ds_read_b64_tr_b16 a[108:109], v247 offset:16384
ds_read_b64_tr_b16 a[110:111], v247 offset:20480
v_mfma_f32_16x16x32_bf16 v[84:87], a[112:115], v[212:215], v[84:87]
s_add_u32 m0, s23, 69632
v_exp_f32 v163, v163
v_mfma_f32_16x16x32_bf16 v[88:91], a[112:115], v[216:219], v[88:91]
buffer_load_dwordx4 v4, s[12:15], s22 offen offset:0 lds
v_mfma_f32_16x16x32_bf16 v[92:95], a[112:115], v[220:223], v[92:95]
v_exp_f32 v164, v164
v_mfma_f32_16x16x32_bf16 v[96:99], a[116:119], v[208:211], v[96:99]
ds_read_b64_tr_b16 a[112:113], v248 offset:16384
ds_read_b64_tr_b16 a[114:115], v248 offset:20480
v_mfma_f32_16x16x32_bf16 v[100:103], a[116:119], v[212:215], v[100:103]
v_exp_f32 v165, v165
v_mfma_f32_16x16x32_bf16 v[104:107], a[116:119], v[216:219], v[104:107]
s_add_u32 s22, s22, s24
buffer_load_dwordx4 v5, s[12:15], s22 offen offset:1024 lds
v_mfma_f32_16x16x32_bf16 v[108:111], a[116:119], v[220:223], v[108:111]
v_exp_f32 v166, v166
v_mfma_f32_16x16x32_bf16 v[112:115], a[120:123], v[208:211], v[112:115]
ds_read_b64_tr_b16 a[116:117], v249 offset:16384
ds_read_b64_tr_b16 a[118:119], v249 offset:20480
v_mfma_f32_16x16x32_bf16 v[116:119], a[120:123], v[212:215], v[116:119]
v_exp_f32 v167, v167
v_mfma_f32_16x16x32_bf16 v[120:123], a[120:123], v[216:219], v[120:123]
s_add_u32 s22, s22, s24
buffer_load_dwordx4 v6, s[12:15], s22 offen offset:2048 lds
v_mfma_f32_16x16x32_bf16 v[124:127], a[120:123], v[220:223], v[124:127]
v_exp_f32 v168, v168
v_mfma_f32_16x16x32_bf16 v[128:131], a[124:127], v[208:211], v[128:131]
ds_read_b64_tr_b16 a[120:121], v250 offset:16384
ds_read_b64_tr_b16 a[122:123], v250 offset:20480
v_mfma_f32_16x16x32_bf16 v[132:135], a[124:127], v[212:215], v[132:135]
v_exp_f32 v169, v169
v_mfma_f32_16x16x32_bf16 v[136:139], a[124:127], v[216:219], v[136:139]
s_add_u32 s22, s22, s24
buffer_load_dwordx4 v7, s[12:15], s22 offen offset:3072 lds
v_mfma_f32_16x16x32_bf16 v[140:143], a[124:127], v[220:223], v[140:143]
v_exp_f32 v170, v170
v_mfma_f32_16x16x32_bf16 a[176:179], a[192:195], v[208:211], a[176:179]
ds_read_b64_tr_b16 a[124:125], v251 offset:16384
ds_read_b64_tr_b16 a[126:127], v251 offset:20480
v_mfma_f32_16x16x32_bf16 a[180:183], a[192:195], v[212:215], a[180:183]
v_exp_f32 v171, v171
v_mfma_f32_16x16x32_bf16 a[184:187], a[192:195], v[216:219], a[184:187]
v_exp_f32 v172, v172
v_mfma_f32_16x16x32_bf16 a[188:191], a[192:195], v[220:223], a[188:191]
v_exp_f32 v173, v173
v_exp_f32 v174, v174
v_exp_f32 v175, v175
s_waitcnt lgkmcnt(15)
v_mfma_f32_16x16x32_bf16 v[176:179], a[64:67], a[0:3], v[224:227]
v_cvt_pk_bf16_f32 v208, v144, v145
v_cvt_pk_bf16_f32 v209, v146, v147
v_mfma_f32_16x16x32_bf16 v[180:183], a[64:67], a[4:7], v[228:231]
v_cvt_pk_bf16_f32 v210, v160, v161
v_cvt_pk_bf16_f32 v211, v162, v163
v_mfma_f32_16x16x32_bf16 v[184:187], a[64:67], a[8:11], v[232:235]
v_cvt_pk_bf16_f32 v212, v148, v149
v_cvt_pk_bf16_f32 v213, v150, v151
v_mfma_f32_16x16x32_bf16 v[188:191], a[64:67], a[12:15], v[236:239]
v_cvt_pk_bf16_f32 v214, v164, v165
v_cvt_pk_bf16_f32 v215, v166, v167
v_mfma_f32_16x16x32_bf16 v[176:179], a[68:71], a[16:19], v[176:179]
v_cvt_pk_bf16_f32 v216, v152, v153
v_cvt_pk_bf16_f32 v217, v154, v155
v_mfma_f32_16x16x32_bf16 v[180:183], a[68:71], a[20:23], v[180:183]
v_cvt_pk_bf16_f32 v218, v168, v169
v_cvt_pk_bf16_f32 v219, v170, v171
v_mfma_f32_16x16x32_bf16 v[184:187], a[68:71], a[24:27], v[184:187]
v_cvt_pk_bf16_f32 v220, v156, v157
v_cvt_pk_bf16_f32 v221, v158, v159
v_mfma_f32_16x16x32_bf16 v[188:191], a[68:71], a[28:31], v[188:191]
v_cvt_pk_bf16_f32 v222, v172, v173
v_cvt_pk_bf16_f32 v223, v174, v175
v_mfma_f32_16x16x32_bf16 v[176:179], a[72:75], a[32:35], v[176:179]
s_waitcnt vmcnt(27) lgkmcnt(0)
s_barrier
v_mfma_f32_16x16x32_bf16 v[180:183], a[72:75], a[36:39], v[180:183]
v_mfma_f32_16x16x32_bf16 v[184:187], a[72:75], a[40:43], v[184:187]
v_mfma_f32_16x16x32_bf16 v[188:191], a[72:75], a[44:47], v[188:191]
v_mfma_f32_16x16x32_bf16 v[176:179], a[76:79], a[48:51], v[176:179]
v_mfma_f32_16x16x32_bf16 v[180:183], a[76:79], a[52:55], v[180:183]
v_mfma_f32_16x16x32_bf16 v[184:187], a[76:79], a[56:59], v[184:187]
v_mfma_f32_16x16x32_bf16 v[188:191], a[76:79], a[60:63], v[188:191]
v_mfma_f32_16x16x32_bf16 v[192:195], a[80:83], a[0:3], v[224:227]
v_mfma_f32_16x16x32_bf16 v[196:199], a[80:83], a[4:7], v[228:231]
s_nop 2
v_exp_f32 v176, v176
v_mfma_f32_16x16x32_bf16 v[200:203], a[80:83], a[8:11], v[232:235]
v_exp_f32 v177, v177
v_mfma_f32_16x16x32_bf16 v[204:207], a[80:83], a[12:15], v[236:239]
v_exp_f32 v178, v178
v_mfma_f32_16x16x32_bf16 v[192:195], a[84:87], a[16:19], v[192:195]
s_mov_b32 s3, 7340032
v_exp_f32 v179, v179
v_mfma_f32_16x16x32_bf16 v[196:199], a[84:87], a[20:23], v[196:199]
buffer_load_dword a254, v12, s[4:7], s3 offen
v_mfma_f32_16x16x32_bf16 v[200:203], a[84:87], a[24:27], v[200:203]
v_exp_f32 v180, v180
v_mfma_f32_16x16x32_bf16 v[204:207], a[84:87], a[28:31], v[204:207]
v_exp_f32 v181, v181
v_mfma_f32_16x16x32_bf16 v[192:195], a[88:91], a[32:35], v[192:195]
v_exp_f32 v182, v182
v_mfma_f32_16x16x32_bf16 v[196:199], a[88:91], a[36:39], v[196:199]
v_exp_f32 v183, v183
v_mfma_f32_16x16x32_bf16 v[200:203], a[88:91], a[40:43], v[200:203]
v_exp_f32 v184, v184
v_mfma_f32_16x16x32_bf16 v[204:207], a[88:91], a[44:47], v[204:207]
v_exp_f32 v185, v185
v_mfma_f32_16x16x32_bf16 v[192:195], a[92:95], a[48:51], v[192:195]
v_exp_f32 v186, v186
v_mfma_f32_16x16x32_bf16 v[196:199], a[92:95], a[52:55], v[196:199]
v_exp_f32 v187, v187
v_mfma_f32_16x16x32_bf16 v[200:203], a[92:95], a[56:59], v[200:203]
v_exp_f32 v188, v188
v_mfma_f32_16x16x32_bf16 v[204:207], a[92:95], a[60:63], v[204:207]
v_exp_f32 v189, v189
v_mfma_f32_16x16x32_bf16 v[16:19], a[96:99], v[208:211], v[16:19]
v_exp_f32 v190, v190
v_mfma_f32_16x16x32_bf16 v[20:23], a[96:99], v[212:215], v[20:23]
v_exp_f32 v191, v191
v_mfma_f32_16x16x32_bf16 v[24:27], a[96:99], v[216:219], v[24:27]
v_exp_f32 v192, v192
v_mfma_f32_16x16x32_bf16 v[28:31], a[96:99], v[220:223], v[28:31]
v_exp_f32 v193, v193
v_mfma_f32_16x16x32_bf16 v[32:35], a[100:103], v[208:211], v[32:35]
ds_read_b64_tr_b16 a[96:97], v244 offset:24576
ds_read_b64_tr_b16 a[98:99], v244 offset:28672
v_mfma_f32_16x16x32_bf16 v[36:39], a[100:103], v[212:215], v[36:39]
v_exp_f32 v194, v194
v_mfma_f32_16x16x32_bf16 v[40:43], a[100:103], v[216:219], v[40:43]
v_exp_f32 v195, v195
v_mfma_f32_16x16x32_bf16 v[44:47], a[100:103], v[220:223], v[44:47]
v_exp_f32 v196, v196
v_mfma_f32_16x16x32_bf16 v[48:51], a[104:107], v[208:211], v[48:51]
ds_read_b64_tr_b16 a[100:101], v245 offset:24576
ds_read_b64_tr_b16 a[102:103], v245 offset:28672
v_mfma_f32_16x16x32_bf16 v[52:55], a[104:107], v[212:215], v[52:55]
v_exp_f32 v197, v197
v_mfma_f32_16x16x32_bf16 v[56:59], a[104:107], v[216:219], v[56:59]
v_exp_f32 v198, v198
v_mfma_f32_16x16x32_bf16 v[60:63], a[104:107], v[220:223], v[60:63]
v_exp_f32 v199, v199
v_mfma_f32_16x16x32_bf16 v[64:67], a[108:111], v[208:211], v[64:67]
ds_read_b64_tr_b16 a[104:105], v246 offset:24576
ds_read_b64_tr_b16 a[106:107], v246 offset:28672
v_mfma_f32_16x16x32_bf16 v[68:71], a[108:111], v[212:215], v[68:71]
v_exp_f32 v200, v200
v_mfma_f32_16x16x32_bf16 v[72:75], a[108:111], v[216:219], v[72:75]
v_exp_f32 v201, v201
v_mfma_f32_16x16x32_bf16 v[76:79], a[108:111], v[220:223], v[76:79]
v_exp_f32 v202, v202
v_mfma_f32_16x16x32_bf16 v[80:83], a[112:115], v[208:211], v[80:83]
ds_read_b64_tr_b16 a[108:109], v247 offset:24576
ds_read_b64_tr_b16 a[110:111], v247 offset:28672
v_mfma_f32_16x16x32_bf16 v[84:87], a[112:115], v[212:215], v[84:87]
v_exp_f32 v203, v203
v_mfma_f32_16x16x32_bf16 v[88:91], a[112:115], v[216:219], v[88:91]
v_exp_f32 v204, v204
v_mfma_f32_16x16x32_bf16 v[92:95], a[112:115], v[220:223], v[92:95]
v_exp_f32 v205, v205
v_mfma_f32_16x16x32_bf16 v[96:99], a[116:119], v[208:211], v[96:99]
ds_read_b64_tr_b16 a[112:113], v248 offset:24576
ds_read_b64_tr_b16 a[114:115], v248 offset:28672
v_mfma_f32_16x16x32_bf16 v[100:103], a[116:119], v[212:215], v[100:103]
v_exp_f32 v206, v206
v_mfma_f32_16x16x32_bf16 v[104:107], a[116:119], v[216:219], v[104:107]
v_exp_f32 v207, v207
v_mfma_f32_16x16x32_bf16 v[108:111], a[116:119], v[220:223], v[108:111]
v_mfma_f32_16x16x32_bf16 v[112:115], a[120:123], v[208:211], v[112:115]
ds_read_b64_tr_b16 a[116:117], v249 offset:24576
ds_read_b64_tr_b16 a[118:119], v249 offset:28672
v_mfma_f32_16x16x32_bf16 v[116:119], a[120:123], v[212:215], v[116:119]
v_mfma_f32_16x16x32_bf16 v[120:123], a[120:123], v[216:219], v[120:123]
v_mfma_f32_16x16x32_bf16 v[124:127], a[120:123], v[220:223], v[124:127]
v_mfma_f32_16x16x32_bf16 v[128:131], a[124:127], v[208:211], v[128:131]
ds_read_b64_tr_b16 a[120:121], v250 offset:24576
ds_read_b64_tr_b16 a[122:123], v250 offset:28672
v_mfma_f32_16x16x32_bf16 v[132:135], a[124:127], v[212:215], v[132:135]
v_mfma_f32_16x16x32_bf16 v[136:139], a[124:127], v[216:219], v[136:139]
v_mfma_f32_16x16x32_bf16 v[140:143], a[124:127], v[220:223], v[140:143]
v_mfma_f32_16x16x32_bf16 a[176:179], a[192:195], v[208:211], a[176:179]
ds_read_b64_tr_b16 a[124:125], v251 offset:24576
ds_read_b64_tr_b16 a[126:127], v251 offset:28672
v_mfma_f32_16x16x32_bf16 a[180:183], a[192:195], v[212:215], a[180:183]
v_mfma_f32_16x16x32_bf16 a[184:187], a[192:195], v[216:219], a[184:187]
v_mfma_f32_16x16x32_bf16 a[188:191], a[192:195], v[220:223], a[188:191]
v_cvt_pk_bf16_f32 v208, v176, v177
v_cvt_pk_bf16_f32 v209, v178, v179
v_cvt_pk_bf16_f32 v210, v192, v193
v_cvt_pk_bf16_f32 v211, v194, v195
v_cvt_pk_bf16_f32 v212, v180, v181
v_cvt_pk_bf16_f32 v213, v182, v183
v_cvt_pk_bf16_f32 v214, v196, v197
v_cvt_pk_bf16_f32 v215, v198, v199
v_cvt_pk_bf16_f32 v216, v184, v185
v_cvt_pk_bf16_f32 v217, v186, v187
v_cvt_pk_bf16_f32 v218, v200, v201
v_cvt_pk_bf16_f32 v219, v202, v203
v_cvt_pk_bf16_f32 v220, v188, v189
v_cvt_pk_bf16_f32 v221, v190, v191
v_cvt_pk_bf16_f32 v222, v204, v205
v_cvt_pk_bf16_f32 v223, v206, v207
s_waitcnt lgkmcnt(14)
v_mfma_f32_16x16x32_bf16 v[16:19], a[96:99], v[208:211], v[16:19]
v_mfma_f32_16x16x32_bf16 v[20:23], a[96:99], v[212:215], v[20:23]
v_mfma_f32_16x16x32_bf16 v[24:27], a[96:99], v[216:219], v[24:27]
v_mfma_f32_16x16x32_bf16 v[28:31], a[96:99], v[220:223], v[28:31]
s_waitcnt lgkmcnt(12)
v_mfma_f32_16x16x32_bf16 v[32:35], a[100:103], v[208:211], v[32:35]
v_mfma_f32_16x16x32_bf16 v[36:39], a[100:103], v[212:215], v[36:39]
v_mfma_f32_16x16x32_bf16 v[40:43], a[100:103], v[216:219], v[40:43]
v_mfma_f32_16x16x32_bf16 v[44:47], a[100:103], v[220:223], v[44:47]
s_waitcnt lgkmcnt(10)
v_mfma_f32_16x16x32_bf16 v[48:51], a[104:107], v[208:211], v[48:51]
v_mfma_f32_16x16x32_bf16 v[52:55], a[104:107], v[212:215], v[52:55]
v_mfma_f32_16x16x32_bf16 v[56:59], a[104:107], v[216:219], v[56:59]
v_mfma_f32_16x16x32_bf16 v[60:63], a[104:107], v[220:223], v[60:63]
s_waitcnt lgkmcnt(8)
v_mfma_f32_16x16x32_bf16 v[64:67], a[108:111], v[208:211], v[64:67]
v_mfma_f32_16x16x32_bf16 v[68:71], a[108:111], v[212:215], v[68:71]
v_mfma_f32_16x16x32_bf16 v[72:75], a[108:111], v[216:219], v[72:75]
v_mfma_f32_16x16x32_bf16 v[76:79], a[108:111], v[220:223], v[76:79]
s_waitcnt lgkmcnt(6)
v_mfma_f32_16x16x32_bf16 v[80:83], a[112:115], v[208:211], v[80:83]
v_mfma_f32_16x16x32_bf16 v[84:87], a[112:115], v[212:215], v[84:87]
v_mfma_f32_16x16x32_bf16 v[88:91], a[112:115], v[216:219], v[88:91]
v_mfma_f32_16x16x32_bf16 v[92:95], a[112:115], v[220:223], v[92:95]
s_waitcnt lgkmcnt(4)
v_mfma_f32_16x16x32_bf16 v[96:99], a[116:119], v[208:211], v[96:99]
v_mfma_f32_16x16x32_bf16 v[100:103], a[116:119], v[212:215], v[100:103]
v_mfma_f32_16x16x32_bf16 v[104:107], a[116:119], v[216:219], v[104:107]
v_mfma_f32_16x16x32_bf16 v[108:111], a[116:119], v[220:223], v[108:111]
s_waitcnt lgkmcnt(2)
v_mfma_f32_16x16x32_bf16 v[112:115], a[120:123], v[208:211], v[112:115]
v_mfma_f32_16x16x32_bf16 v[116:119], a[120:123], v[212:215], v[116:119]
v_mfma_f32_16x16x32_bf16 v[120:123], a[120:123], v[216:219], v[120:123]
v_mfma_f32_16x16x32_bf16 v[124:127], a[120:123], v[220:223], v[124:127]
s_waitcnt lgkmcnt(0)
v_mfma_f32_16x16x32_bf16 v[128:131], a[124:127], v[208:211], v[128:131]
v_mfma_f32_16x16x32_bf16 v[132:135], a[124:127], v[212:215], v[132:135]
v_mfma_f32_16x16x32_bf16 v[136:139], a[124:127], v[216:219], v[136:139]
v_mfma_f32_16x16x32_bf16 v[140:143], a[124:127], v[220:223], v[140:143]
v_mfma_f32_16x16x32_bf16 a[176:179], a[192:195], v[208:211], a[176:179]
v_mfma_f32_16x16x32_bf16 a[180:183], a[192:195], v[212:215], a[180:183]
v_mfma_f32_16x16x32_bf16 a[184:187], a[192:195], v[216:219], a[184:187]
v_mfma_f32_16x16x32_bf16 a[188:191], a[192:195], v[220:223], a[188:191]
L_oepi_k:
s_nop 4
v_accvgpr_read_b32 v144, a176
v_accvgpr_read_b32 v145, a180
v_accvgpr_read_b32 v146, a184
v_accvgpr_read_b32 v147, a188
v_max3_f32 v148, v144, v145, v146
v_min3_f32 v149, v144, v145, v146
v_max_f32 v148, v148, v147
v_min_f32 v149, v149, v147
s_mov_b32 s38, 0x21800000
v_cmp_lt_f32 vcc, 0x5d800000, v148
v_cmp_gt_f32 s[36:37], s38, v149
s_nop 0
s_or_b64 vcc, vcc, s[36:37]
s_cbranch_scc1 L_fbw
L_fbw_ret:
s_barrier
ds_read_b32 v149, v1
s_mov_b32 s56, s82
s_and_b32 s57, s83, 0xffff
s_mov_b32 s58, 0x800
s_mov_b32 s59, 0x00020000
s_lshl_b32 s37, s30, 8
s_add_u32 s39, s37, 128
v_bfe_u32 v13, v0, 4, 2
v_lshlrev_b32 v13, 3, v13
v_add_u32 v14, s39, v13
v_add_u32 v13, s37, v13
buffer_load_dwordx2 v[208:209], v13, s[56:59], 0 offen offset:0
buffer_load_dwordx2 v[210:211], v13, s[56:59], 0 offen offset:32
buffer_load_dwordx2 v[212:213], v13, s[56:59], 0 offen offset:64
buffer_load_dwordx2 v[214:215], v13, s[56:59], 0 offen offset:96
buffer_load_dwordx2 v[216:217], v14, s[56:59], 0 offen offset:0
buffer_load_dwordx2 v[218:219], v14, s[56:59], 0 offen offset:32
buffer_load_dwordx2 v[220:221], v14, s[56:59], 0 offen offset:64
buffer_load_dwordx2 v[222:223], v14, s[56:59], 0 offen offset:96
v_mov_b32 v15, v3
s_add_u32 s40, s88, 18874368
s_addc_u32 s41, s89, 0
s_and_b32 s41, s41, 0xffff
s_mov_b32 s42, 0x4000000
s_mov_b32 s43, 0x00020000
s_lshl_b32 s36, s27, 19
v_rcp_f32 v144, v144
v_rcp_f32 v145, v145
v_rcp_f32 v146, v146
v_rcp_f32 v147, v147
v_mul_f32 v144, 0x3f317218, v144
v_mul_f32 v145, 0x3f317218, v145
v_mul_f32 v146, 0x3f317218, v146
v_mul_f32 v147, 0x3f317218, v147
s_add_u32 s37, s36, 0
v_mul_f32 v16, v16, v144
v_mul_f32 v17, v17, v144
v_mul_f32 v18, v18, v144
v_mul_f32 v19, v19, v144
v_mul_f32 v32, v32, v144
v_mul_f32 v33, v33, v144
v_mul_f32 v34, v34, v144
v_mul_f32 v35, v35, v144
v_cvt_pk_bf16_f32 v152, v16, v17
v_cvt_pk_bf16_f32 v153, v18, v19
v_cvt_pk_bf16_f32 v154, v32, v33
v_cvt_pk_bf16_f32 v155, v34, v35
buffer_store_dwordx4 v[152:155], v3, s[40:43], s37 offen offset:0 sc0 sc1
s_waitcnt lgkmcnt(0)
v_readfirstlane_b32 s36, v149
s_nop 0
s_andn2_b32 s36, s36, s55
s_cbranch_scc1 L_fb
s_lshl_b32 s36, s27, 19
v_mul_f32 v20, v20, v145
v_mul_f32 v21, v21, v145
v_mul_f32 v22, v22, v145
v_mul_f32 v23, v23, v145
v_mul_f32 v36, v36, v145
v_mul_f32 v37, v37, v145
v_mul_f32 v38, v38, v145
v_mul_f32 v39, v39, v145
v_cvt_pk_bf16_f32 v156, v20, v21
v_cvt_pk_bf16_f32 v157, v22, v23
v_cvt_pk_bf16_f32 v158, v36, v37
v_cvt_pk_bf16_f32 v159, v38, v39
buffer_store_dwordx4 v[156:159], v15, s[40:43], s37 offen offset:256 sc0 sc1
v_mul_f32 v24, v24, v146
v_mul_f32 v25, v25, v146
v_mul_f32 v26, v26, v146
v_mul_f32 v27, v27, v146
v_mul_f32 v40, v40, v146
v_mul_f32 v41, v41, v146
v_mul_f32 v42, v42, v146
v_mul_f32 v43, v43, v146
v_cvt_pk_bf16_f32 v160, v24, v25
v_cvt_pk_bf16_f32 v161, v26, v27
v_cvt_pk_bf16_f32 v162, v40, v41
v_cvt_pk_bf16_f32 v163, v42, v43
buffer_store_dwordx4 v[160:163], v3, s[40:43], s37 offen offset:512 sc0 sc1
v_mul_f32 v28, v28, v147
v_mul_f32 v29, v29, v147
v_mul_f32 v30, v30, v147
v_mul_f32 v31, v31, v147
v_mul_f32 v44, v44, v147
v_mul_f32 v45, v45, v147
v_mul_f32 v46, v46, v147
v_mul_f32 v47, v47, v147
v_cvt_pk_bf16_f32 v164, v28, v29
v_cvt_pk_bf16_f32 v165, v30, v31
v_cvt_pk_bf16_f32 v166, v44, v45
v_cvt_pk_bf16_f32 v167, v46, v47
buffer_store_dwordx4 v[164:167], v3, s[40:43], s37 offen offset:768 sc0 sc1
s_add_u32 s37, s36, 131072
v_mul_f32 v48, v48, v144
v_mul_f32 v49, v49, v144
v_mul_f32 v50, v50, v144
v_mul_f32 v51, v51, v144
v_mul_f32 v64, v64, v144
v_mul_f32 v65, v65, v144
v_mul_f32 v66, v66, v144
v_mul_f32 v67, v67, v144
v_cvt_pk_bf16_f32 v168, v48, v49
v_cvt_pk_bf16_f32 v169, v50, v51
v_cvt_pk_bf16_f32 v170, v64, v65
v_cvt_pk_bf16_f32 v171, v66, v67
buffer_store_dwordx4 v[168:171], v3, s[40:43], s37 offen offset:0 sc0 sc1
v_mul_f32 v52, v52, v145
v_mul_f32 v53, v53, v145
v_mul_f32 v54, v54, v145
v_mul_f32 v55, v55, v145
v_mul_f32 v68, v68, v145
v_mul_f32 v69, v69, v145
v_mul_f32 v70, v70, v145
v_mul_f32 v71, v71, v145
v_cvt_pk_bf16_f32 v172, v52, v53
v_cvt_pk_bf16_f32 v173, v54, v55
v_cvt_pk_bf16_f32 v174, v68, v69
v_cvt_pk_bf16_f32 v175, v70, v71
buffer_store_dwordx4 v[172:175], v15, s[40:43], s37 offen offset:256 sc0 sc1
v_mul_f32 v56, v56, v146
v_mul_f32 v57, v57, v146
v_mul_f32 v58, v58, v146
v_mul_f32 v59, v59, v146
v_mul_f32 v72, v72, v146
v_mul_f32 v73, v73, v146
v_mul_f32 v74, v74, v146
v_mul_f32 v75, v75, v146
v_cvt_pk_bf16_f32 v176, v56, v57
v_cvt_pk_bf16_f32 v177, v58, v59
v_cvt_pk_bf16_f32 v178, v72, v73
v_cvt_pk_bf16_f32 v179, v74, v75
buffer_store_dwordx4 v[176:179], v3, s[40:43], s37 offen offset:512 sc0 sc1
v_mul_f32 v60, v60, v147
v_mul_f32 v61, v61, v147
v_mul_f32 v62, v62, v147
v_mul_f32 v63, v63, v147
v_mul_f32 v76, v76, v147
v_mul_f32 v77, v77, v147
v_mul_f32 v78, v78, v147
v_mul_f32 v79, v79, v147
v_cvt_pk_bf16_f32 v180, v60, v61
v_cvt_pk_bf16_f32 v181, v62, v63
v_cvt_pk_bf16_f32 v182, v76, v77
v_cvt_pk_bf16_f32 v183, v78, v79
buffer_store_dwordx4 v[180:183], v3, s[40:43], s37 offen offset:768 sc0 sc1
s_add_u32 s37, s36, 262144
v_mul_f32 v80, v80, v144
v_mul_f32 v81, v81, v144
v_mul_f32 v82, v82, v144
v_mul_f32 v83, v83, v144
v_mul_f32 v96, v96, v144
v_mul_f32 v97, v97, v144
v_mul_f32 v98, v98, v144
v_mul_f32 v99, v99, v144
v_cvt_pk_bf16_f32 v152, v80, v81
v_cvt_pk_bf16_f32 v153, v82, v83
v_cvt_pk_bf16_f32 v154, v96, v97
v_cvt_pk_bf16_f32 v155, v98, v99
buffer_store_dwordx4 v[152:155], v3, s[40:43], s37 offen offset:0 sc0 sc1
v_mul_f32 v84, v84, v145
v_mul_f32 v85, v85, v145
v_mul_f32 v86, v86, v145
v_mul_f32 v87, v87, v145
v_mul_f32 v100, v100, v145
v_mul_f32 v101, v101, v145
v_mul_f32 v102, v102, v145
v_mul_f32 v103, v103, v145
v_cvt_pk_bf16_f32 v156, v84, v85
v_cvt_pk_bf16_f32 v157, v86, v87
v_cvt_pk_bf16_f32 v158, v100, v101
v_cvt_pk_bf16_f32 v159, v102, v103
buffer_store_dwordx4 v[156:159], v15, s[40:43], s37 offen offset:256 sc0 sc1
v_mul_f32 v88, v88, v146
v_mul_f32 v89, v89, v146
v_mul_f32 v90, v90, v146
v_mul_f32 v91, v91, v146
v_mul_f32 v104, v104, v146
v_mul_f32 v105, v105, v146
v_mul_f32 v106, v106, v146
v_mul_f32 v107, v107, v146
v_cvt_pk_bf16_f32 v160, v88, v89
v_cvt_pk_bf16_f32 v161, v90, v91
v_cvt_pk_bf16_f32 v162, v104, v105
v_cvt_pk_bf16_f32 v163, v106, v107
buffer_store_dwordx4 v[160:163], v3, s[40:43], s37 offen offset:512 sc0 sc1
v_mul_f32 v92, v92, v147
v_mul_f32 v93, v93, v147
v_mul_f32 v94, v94, v147
v_mul_f32 v95, v95, v147
v_mul_f32 v108, v108, v147
v_mul_f32 v109, v109, v147
v_mul_f32 v110, v110, v147
v_mul_f32 v111, v111, v147
v_cvt_pk_bf16_f32 v164, v92, v93
v_cvt_pk_bf16_f32 v165, v94, v95
v_cvt_pk_bf16_f32 v166, v108, v109
v_cvt_pk_bf16_f32 v167, v110, v111
buffer_store_dwordx4 v[164:167], v3, s[40:43], s37 offen offset:768 sc0 sc1
s_add_u32 s37, s36, 393216
v_mul_f32 v112, v112, v144
v_mul_f32 v113, v113, v144
v_mul_f32 v114, v114, v144
v_mul_f32 v115, v115, v144
v_mul_f32 v128, v128, v144
v_mul_f32 v129, v129, v144
v_mul_f32 v130, v130, v144
v_mul_f32 v131, v131, v144
v_cvt_pk_bf16_f32 v168, v112, v113
v_cvt_pk_bf16_f32 v169, v114, v115
v_cvt_pk_bf16_f32 v170, v128, v129
v_cvt_pk_bf16_f32 v171, v130, v131
buffer_store_dwordx4 v[168:171], v3, s[40:43], s37 offen offset:0 sc0 sc1
v_mul_f32 v116, v116, v145
v_mul_f32 v117, v117, v145
v_mul_f32 v118, v118, v145
v_mul_f32 v119, v119, v145
v_mul_f32 v132, v132, v145
v_mul_f32 v133, v133, v145
v_mul_f32 v134, v134, v145
v_mul_f32 v135, v135, v145
v_cvt_pk_bf16_f32 v172, v116, v117
v_cvt_pk_bf16_f32 v173, v118, v119
v_cvt_pk_bf16_f32 v174, v132, v133
v_cvt_pk_bf16_f32 v175, v134, v135
buffer_store_dwordx4 v[172:175], v15, s[40:43], s37 offen offset:256 sc0 sc1
v_mul_f32 v120, v120, v146
v_mul_f32 v121, v121, v146
v_mul_f32 v122, v122, v146
v_mul_f32 v123, v123, v146
v_mul_f32 v136, v136, v146
v_mul_f32 v137, v137, v146
v_mul_f32 v138, v138, v146
v_mul_f32 v139, v139, v146
v_cvt_pk_bf16_f32 v176, v120, v121
v_cvt_pk_bf16_f32 v177, v122, v123
v_cvt_pk_bf16_f32 v178, v136, v137
v_cvt_pk_bf16_f32 v179, v138, v139
buffer_store_dwordx4 v[176:179], v3, s[40:43], s37 offen offset:512 sc0 sc1
v_mul_f32 v124, v124, v147
v_mul_f32 v125, v125, v147
v_mul_f32 v126, v126, v147
v_mul_f32 v127, v127, v147
v_mul_f32 v140, v140, v147
v_mul_f32 v141, v141, v147
v_mul_f32 v142, v142, v147
v_mul_f32 v143, v143, v147
v_cvt_pk_bf16_f32 v180, v124, v125
v_cvt_pk_bf16_f32 v181, v126, v127
v_cvt_pk_bf16_f32 v182, v140, v141
v_cvt_pk_bf16_f32 v183, v142, v143
buffer_store_dwordx4 v[180:183], v3, s[40:43], s37 offen offset:768 sc0 sc1
v_accvgpr_read_b32 v144, a220
v_accvgpr_read_b32 v145, a221
v_accvgpr_read_b32 v146, a222
v_accvgpr_read_b32 v147, a223
v_accvgpr_read_b32 v148, a224
v_accvgpr_read_b32 v149, a225
v_accvgpr_read_b32 v150, a226
v_accvgpr_read_b32 v151, a227
v_accvgpr_read_b32 v8, a228
v_mov_b32 v9, v8
v_add_u32 v152, 0x10000, v144
v_add_u32 v153, 0x10000, v145
v_add_u32 v154, 0x10000, v146
v_add_u32 v155, 0x10000, v147
v_add_u32 v156, 0x10000, v148
v_add_u32 v157, 0x10000, v149
v_add_u32 v158, 0x10000, v150
v_add_u32 v159, 0x10000, v151
v_and_b32 v165, 63, v0
v_lshlrev_b32 v165, 4, v165
s_lshl_b32 s36, s26, 14
v_add_u32 v166, s36, v165
s_xor_b32 s36, s26, 2
s_lshl_b32 s36, s36, 14
v_add_u32 v167, s36, v165
s_add_u32 s40, s88, 35651584
s_addc_u32 s41, s89, 0
s_and_b32 s41, s41, 0xffff
s_mov_b32 s42, 0x400000
s_mov_b32 s43, 0x00020000
s_lshl_b32 s36, s29, 3
s_add_u32 s36, s36, s30
s_lshl_b32 s37, s36, 15
s_lshl_b32 s38, s26, 13
s_add_u32 s37, s37, s38
v_and_b32 v13, 63, v0
v_lshlrev_b32 v1, 4, v13
v_add_u32 v1, s37, v1
s_and_b32 s36, s26, 1
s_lshl_b32 s36, s36, 6
s_lshr_b32 s37, s26, 1
s_lshl_b32 s37, s37, 5
s_add_u32 s36, s36, s37
s_lshl_b32 s37, s29, 7
s_add_u32 s36, s36, s37
s_lshl_b32 s36, s36, 11
s_lshl_b32 s37, s30, 8
s_add_u32 s39, s37, 128
v_and_b32 v14, 15, v13
v_lshrrev_b32 v15, 4, v13
v_lshlrev_b32 v11, 11, v15
v_add_u32 v11, s36, v11
v_xor_b32 v161, v14, v15
v_mov_b32 v12, s37
v_xor_b32 v162, 0, v161
v_cmp_gt_u32 vcc, 8, v162
v_mov_b32 v240, s39
s_nop 0
v_cndmask_b32 v240, v240, v12, vcc
v_and_b32 v162, 7, v162
v_lshl_add_u32 v240, v162, 4, v240
v_add_u32 v240, v11, v240
v_xor_b32 v162, 4, v161
v_cmp_gt_u32 vcc, 8, v162
v_mov_b32 v241, s39
s_nop 0
v_cndmask_b32 v241, v241, v12, vcc
v_and_b32 v162, 7, v162
v_lshl_add_u32 v241, v162, 4, v241
v_add_u32 v241, v11, v241
v_xor_b32 v162, 8, v161
v_cmp_gt_u32 vcc, 8, v162
v_mov_b32 v242, s39
s_nop 0
v_cndmask_b32 v242, v242, v12, vcc
v_and_b32 v162, 7, v162
v_lshl_add_u32 v242, v162, 4, v242
v_add_u32 v242, v11, v242
v_xor_b32 v162, 12, v161
v_cmp_gt_u32 vcc, 8, v162
v_mov_b32 v243, s39
s_nop 0
v_cndmask_b32 v243, v243, v12, vcc
v_and_b32 v162, 7, v162
v_lshl_add_u32 v243, v162, 4, v243
v_add_u32 v243, v11, v243
s_add_u32 s38, s23, 131072
v_lshl_add_u32 v252, v13, 4, s38
v_lshrrev_b32 v161, 1, v15
v_xor_b32 v161, v161, v14
v_lshlrev_b32 v161, 4, v161
v_lshl_add_u32 v161, v14, 8, v161
v_and_b32 v162, 1, v15
v_lshl_add_u32 v161, v162, 3, v161
v_add_u32 v244, s38, v161
v_xor_b32 v245, 32, v244
v_xor_b32 v246, 64, v244
v_xor_b32 v247, 96, v244
v_xor_b32 v248, 128, v244
v_xor_b32 v249, 160, v244
v_xor_b32 v250, 192, v244
v_xor_b32 v251, 224, v244
s_lshl_b32 s20, s63, 19
s_cmp_eq_u32 s31, 0
s_cbranch_scc1 L_gP3_k
s_lshr_b32 s36, s26, 1
s_or_b32 s36, s36, s31
s_cmp_eq_u32 s36, 0
s_cselect_b32 s36, 0x3fb8aa3b, 0
s_waitcnt vmcnt(23)
v_lshlrev_b32 v176, 16, v208
v_and_b32 v177, 0xffff0000, v208
v_lshlrev_b32 v178, 16, v209
v_and_b32 v179, 0xffff0000, v209
v_mul_f32 v176, s36, v176
v_mul_f32 v177, s36, v177
v_mul_f32 v178, s36, v178
v_mul_f32 v179, s36, v179
s_waitcnt vmcnt(22)
v_lshlrev_b32 v180, 16, v210
v_and_b32 v181, 0xffff0000, v210
v_lshlrev_b32 v182, 16, v211
v_and_b32 v183, 0xffff0000, v211
v_mul_f32 v180, s36, v180
v_mul_f32 v181, s36, v181
v_mul_f32 v182, s36, v182
v_mul_f32 v183, s36, v183
s_waitcnt vmcnt(21)
v_lshlrev_b32 v184, 16, v212
v_and_b32 v185, 0xffff0000, v212
v_lshlrev_b32 v186, 16, v213
v_and_b32 v187, 0xffff0000, v213
v_mul_f32 v184, s36, v184
v_mul_f32 v185, s36, v185
v_mul_f32 v186, s36, v186
v_mul_f32 v187, s36, v187
s_waitcnt vmcnt(20)
v_lshlrev_b32 v188, 16, v214
v_and_b32 v189, 0xffff0000, v214
v_lshlrev_b32 v190, 16, v215
v_and_b32 v191, 0xffff0000, v215
v_mul_f32 v188, s36, v188
v_mul_f32 v189, s36, v189
v_mul_f32 v190, s36, v190
v_mul_f32 v191, s36, v191
s_waitcnt vmcnt(19)
v_lshlrev_b32 v192, 16, v216
v_and_b32 v193, 0xffff0000, v216
v_lshlrev_b32 v194, 16, v217
v_and_b32 v195, 0xffff0000, v217
v_mul_f32 v192, s36, v192
v_mul_f32 v193, s36, v193
v_mul_f32 v194, s36, v194
v_mul_f32 v195, s36, v195
s_waitcnt vmcnt(18)
v_lshlrev_b32 v196, 16, v218
v_and_b32 v197, 0xffff0000, v218
v_lshlrev_b32 v198, 16, v219
v_and_b32 v199, 0xffff0000, v219
v_mul_f32 v196, s36, v196
v_mul_f32 v197, s36, v197
v_mul_f32 v198, s36, v198
v_mul_f32 v199, s36, v199
s_waitcnt vmcnt(17)
v_lshlrev_b32 v200, 16, v220
v_and_b32 v201, 0xffff0000, v220
v_lshlrev_b32 v202, 16, v221
v_and_b32 v203, 0xffff0000, v221
v_mul_f32 v200, s36, v200
v_mul_f32 v201, s36, v201
v_mul_f32 v202, s36, v202
v_mul_f32 v203, s36, v203
s_waitcnt vmcnt(16)
v_lshlrev_b32 v204, 16, v222
v_and_b32 v205, 0xffff0000, v222
v_lshlrev_b32 v206, 16, v223
v_and_b32 v207, 0xffff0000, v223
v_mul_f32 v204, s36, v204
v_mul_f32 v205, s36, v205
v_mul_f32 v206, s36, v206
v_mul_f32 v207, s36, v207
s_waitcnt vmcnt(0)
s_barrier
s_cmp_eq_u32 s26, 0
s_cbranch_scc0 L_f3_k
s_add_u32 s56, s88, 41943040
s_addc_u32 s57, s89, 0
s_and_b32 s57, s57, 0xffff
s_mov_b32 s58, 0x4000
s_mov_b32 s59, 0x00020000
s_lshl_b32 s38, s28, 8
s_lshl_b32 s39, s27, 2
s_add_u32 s38, s38, s39
s_add_u32 s38, s38, 2048
v_mov_b32 v14, 1
v_mov_b32 v15, s38
v_and_b32 v13, 63, v0
v_cmp_eq_u32 vcc, 0, v13
s_nop 0
s_and_saveexec_b64 s[36:37], vcc
buffer_store_dword v14, v15, s[56:59], 0 offen sc0 sc1
s_mov_b64 exec, s[36:37]
L_f3_k:
s_lshl_b32 s33, 1, s27
s_xor_b32 s36, s27, 1
s_lshl_b32 s36, 1, s36
s_or_b32 s33, s33, s36
s_xor_b32 s36, s27, 2
s_lshl_b32 s36, 1, s36
s_or_b32 s33, s33, s36
s_lshl_b32 s3, 1, s27
v_and_b32 v12, 63, v0
v_lshlrev_b32 v12, 2, v12
v_add_u32 v12, 131072, v12
s_cmp_eq_u32 s26, 1
s_cbranch_scc0 L_p3w_k
s_add_u32 s56, s88, 41943040
s_addc_u32 s57, s89, 0
s_and_b32 s57, s57, 0xffff
s_mov_b32 s58, 0x4000
s_mov_b32 s59, 0x00020000
s_lshl_b32 s38, s28, 8
s_add_u32 s38, s38, 2048
v_and_b32 v13, 31, v0
v_lshlrev_b32 v13, 2, v13
v_add_u32 v13, s38, v13
s_mov_b32 s39, 0
L_os_loop:
buffer_load_dword v14, v13, s[56:59], 0 offen sc0 sc1
s_waitcnt vmcnt(0)
v_cmp_eq_u32 vcc, 1, v14
s_add_u32 s39, s39, 1
s_cmp_gt_u32 s39, 0x40000
s_cbranch_scc1 L_os_done
s_or_b32 s36, vcc_lo, s3
s_bcnt1_i32_b32 s37, s36
s_and_b32 s36, s36, s33
s_cmp_eq_u32 s36, s33
s_cselect_b32 s37, s37, 0
s_cmp_ge_u32 s37, 12
s_cbranch_scc1 L_os_done
s_branch L_os_loop
L_os_done:
v_mov_b32 v14, vcc_lo
ds_write_b32 v12, v14
s_waitcnt lgkmcnt(0)
L_p3w_k:
buffer_load_dwordx4 a[64:67], v8, s[8:11], s20 offen offset:0 sc1
buffer_load_dwordx4 a[68:71], v9, s[8:11], s20 offen offset:256 sc1
buffer_load_dwordx4 a[72:75], v8, s[8:11], s20 offen offset:512 sc1
buffer_load_dwordx4 a[76:79], v8, s[8:11], s20 offen offset:768 sc1
s_add_u32 s20, s20, 262144
buffer_load_dwordx4 a[80:83], v8, s[8:11], s20 offen offset:0 sc1
buffer_load_dwordx4 a[84:87], v9, s[8:11], s20 offen offset:256 sc1
buffer_load_dwordx4 a[88:91], v8, s[8:11], s20 offen offset:512 sc1
buffer_load_dwordx4 a[92:95], v8, s[8:11], s20 offen offset:768 sc1
s_barrier
ds_read_b32 v14, v12
s_waitcnt lgkmcnt(0)
v_readfirstlane_b32 s36, v14
s_nop 0
s_or_b32 s36, s36, s33
s_lshr_b32 s37, 16, s35
s_sub_u32 s37, s37, 1
s_mul_i32 s37, s37, 0x11111111
s_sub_u32 s38, 4, s35
s_lshr_b32 s39, s36, s35
s_and_b32 s39, s39, s37
s_lshl_b32 s36, s36, s38
s_andn2_b32 s36, s36, s37
s_or_b32 s36, s36, s39
s_lshr_b32 s39, s33, s35
s_and_b32 s39, s39, s37
s_lshl_b32 s33, s33, s38
s_andn2_b32 s33, s33, s37
s_or_b32 s33, s33, s39
s_andn2_b32 s60, s36, s33
s_not_b32 s61, s36
s_branch L_goP3_k
L_gP3_k:
buffer_load_dwordx4 a[64:67], v8, s[8:11], s20 offen offset:0 sc1
buffer_load_dwordx4 a[68:71], v9, s[8:11], s20 offen offset:256 sc1
buffer_load_dwordx4 a[72:75], v8, s[8:11], s20 offen offset:512 sc1
buffer_load_dwordx4 a[76:79], v8, s[8:11], s20 offen offset:768 sc1
s_add_u32 s20, s20, 262144
buffer_load_dwordx4 a[80:83], v8, s[8:11], s20 offen offset:0 sc1
buffer_load_dwordx4 a[84:87], v9, s[8:11], s20 offen offset:256 sc1
buffer_load_dwordx4 a[88:91], v8, s[8:11], s20 offen offset:512 sc1
buffer_load_dwordx4 a[92:95], v8, s[8:11], s20 offen offset:768 sc1
s_lshr_b32 s36, s26, 1
s_or_b32 s36, s36, s31
s_cmp_eq_u32 s36, 0
s_cselect_b32 s36, 0x3fb8aa3b, 0
s_waitcnt vmcnt(31)
v_lshlrev_b32 v176, 16, v208
v_and_b32 v177, 0xffff0000, v208
v_lshlrev_b32 v178, 16, v209
v_and_b32 v179, 0xffff0000, v209
v_mul_f32 v176, s36, v176
v_mul_f32 v177, s36, v177
v_mul_f32 v178, s36, v178
v_mul_f32 v179, s36, v179
s_waitcnt vmcnt(30)
v_lshlrev_b32 v180, 16, v210
v_and_b32 v181, 0xffff0000, v210
v_lshlrev_b32 v182, 16, v211
v_and_b32 v183, 0xffff0000, v211
v_mul_f32 v180, s36, v180
v_mul_f32 v181, s36, v181
v_mul_f32 v182, s36, v182
v_mul_f32 v183, s36, v183
s_waitcnt vmcnt(29)
v_lshlrev_b32 v184, 16, v212
v_and_b32 v185, 0xffff0000, v212
v_lshlrev_b32 v186, 16, v213
v_and_b32 v187, 0xffff0000, v213
v_mul_f32 v184, s36, v184
v_mul_f32 v185, s36, v185
v_mul_f32 v186, s36, v186
v_mul_f32 v187, s36, v187
s_waitcnt vmcnt(28)
v_lshlrev_b32 v188, 16, v214
v_and_b32 v189, 0xffff0000, v214
v_lshlrev_b32 v190, 16, v215
v_and_b32 v191, 0xffff0000, v215
v_mul_f32 v188, s36, v188
v_mul_f32 v189, s36, v189
v_mul_f32 v190, s36, v190
v_mul_f32 v191, s36, v191
s_waitcnt vmcnt(27)
v_lshlrev_b32 v192, 16, v216
v_and_b32 v193, 0xffff0000, v216
v_lshlrev_b32 v194, 16, v217
v_and_b32 v195, 0xffff0000, v217
v_mul_f32 v192, s36, v192
v_mul_f32 v193, s36, v193
v_mul_f32 v194, s36, v194
v_mul_f32 v195, s36, v195
s_waitcnt vmcnt(26)
v_lshlrev_b32 v196, 16, v218
v_and_b32 v197, 0xffff0000, v218
v_lshlrev_b32 v198, 16, v219
v_and_b32 v199, 0xffff0000, v219
v_mul_f32 v196, s36, v196
v_mul_f32 v197, s36, v197
v_mul_f32 v198, s36, v198
v_mul_f32 v199, s36, v199
s_waitcnt vmcnt(25)
v_lshlrev_b32 v200, 16, v220
v_and_b32 v201, 0xffff0000, v220
v_lshlrev_b32 v202, 16, v221
v_and_b32 v203, 0xffff0000, v221
v_mul_f32 v200, s36, v200
v_mul_f32 v201, s36, v201
v_mul_f32 v202, s36, v202
v_mul_f32 v203, s36, v203
s_waitcnt vmcnt(24)
v_lshlrev_b32 v204, 16, v222
v_and_b32 v205, 0xffff0000, v222
v_lshlrev_b32 v206, 16, v223
v_and_b32 v207, 0xffff0000, v223
v_mul_f32 v204, s36, v204
v_mul_f32 v205, s36, v205
v_mul_f32 v206, s36, v206
v_mul_f32 v207, s36, v207
s_mov_b32 s60, 0x0ffffff8
s_mov_b32 s61, 0
L_goP3_k:
s_xor_b32 s36, s27, 1
s_add_u32 s37, s35, 1
s_and_b32 s37, s37, 3
s_cmp_eq_u32 s31, 0
s_cselect_b32 s62, s37, s36
s_ff1_i32_b64 s33, s[60:61]
s_bitset0_b64 s[60:61], s33
s_add_u32 s36, s33, s35
s_and_b32 s36, s36, 3
s_and_b32 s33, s33, 28
s_or_b32 s33, s33, s36
s_lshl_b32 s37, s33, 2
s_add_u32 s37, s37, s26
s_mul_i32 s38, s37, 147
s_lshr_b32 s38, s38, 10
s_mul_i32 s38, s38, 7
s_sub_u32 s37, s37, s38
s_cmp_eq_u32 s37, 3
s_cselect_b32 s16, s25, 0
s_mul_i32 s37, s16, 3
s_sub_u32 s17, 0x8000, s37
s_barrier
s_lshl_b32 s20, s62, 19
s_xor_b32 s36, s27, 2
ds_read_b64_tr_b16 a[128:129], v144 offset:0
s_add_u32 s37, s35, 2
s_and_b32 s37, s37, 3
ds_read_b64_tr_b16 a[130:131], v144 offset:4096
s_cmp_eq_u32 s31, 0
s_cselect_b32 s62, s37, s36
buffer_load_dwordx4 a[96:99], v8, s[8:11], s20 offen offset:0 sc1
ds_read_b64_tr_b16 a[132:133], v145 offset:0
ds_read_b64_tr_b16 a[134:135], v145 offset:4096
buffer_load_dwordx4 a[100:103], v9, s[8:11], s20 offen offset:256 sc1
ds_read_b64_tr_b16 a[136:137], v146 offset:0
ds_read_b64_tr_b16 a[138:139], v146 offset:4096
ds_read_b64_tr_b16 a[140:141], v147 offset:0
buffer_load_dwordx4 a[104:107], v8, s[8:11], s20 offen offset:512 sc1
ds_read_b64_tr_b16 a[142:143], v147 offset:4096
ds_read_b64_tr_b16 a[144:145], v148 offset:0
buffer_load_dwordx4 a[108:111], v8, s[8:11], s20 offen offset:768 sc1
ds_read_b64_tr_b16 a[146:147], v148 offset:4096
ds_read_b64_tr_b16 a[148:149], v149 offset:0
s_add_u32 s20, s20, 262144
buffer_load_dwordx4 a[112:115], v8, s[8:11], s20 offen offset:0 sc1
ds_read_b64_tr_b16 a[150:151], v149 offset:4096
ds_read_b64_tr_b16 a[152:153], v150 offset:0
ds_read_b64_tr_b16 a[154:155], v150 offset:4096
buffer_load_dwordx4 a[116:119], v9, s[8:11], s20 offen offset:256 sc1
ds_read_b64_tr_b16 a[156:157], v151 offset:0
s_mov_b32 s34, 0
L_b0_s:
s_waitcnt vmcnt(10) lgkmcnt(7)
v_mfma_f32_16x16x32_bf16 v[16:19], a[128:131], a[64:67], v[176:179]
ds_read_b64_tr_b16 a[158:159], v151 offset:4096
v_mfma_f32_16x16x32_bf16 v[20:23], a[128:131], a[68:71], v[176:179]
buffer_load_dwordx4 a[120:123], v8, s[8:11], s20 offen offset:512 sc1
v_mfma_f32_16x16x32_bf16 v[24:27], a[128:131], a[72:75], v[176:179]
ds_read_b64_tr_b16 a[160:161], v144 offset:16384
v_mfma_f32_16x16x32_bf16 v[28:31], a[128:131], a[76:79], v[176:179]
ds_read_b64_tr_b16 a[162:163], v144 offset:20480
v_mfma_f32_16x16x32_bf16 v[32:35], a[132:135], a[64:67], v[180:183]
v_mfma_f32_16x16x32_bf16 v[36:39], a[132:135], a[68:71], v[180:183]
buffer_load_dwordx4 a[124:127], v8, s[8:11], s20 offen offset:768 sc1
v_mfma_f32_16x16x32_bf16 v[40:43], a[132:135], a[72:75], v[180:183]
ds_read_b64_tr_b16 a[164:165], v145 offset:16384
v_mfma_f32_16x16x32_bf16 v[44:47], a[132:135], a[76:79], v[180:183]
ds_read_b64_tr_b16 a[166:167], v145 offset:20480
v_mfma_f32_16x16x32_bf16 v[48:51], a[136:139], a[64:67], v[184:187]
ds_read_b64_tr_b16 a[168:169], v146 offset:16384
v_mfma_f32_16x16x32_bf16 v[52:55], a[136:139], a[68:71], v[184:187]
v_mfma_f32_16x16x32_bf16 v[56:59], a[136:139], a[72:75], v[184:187]
ds_read_b64_tr_b16 a[170:171], v146 offset:20480
v_mfma_f32_16x16x32_bf16 v[60:63], a[136:139], a[76:79], v[184:187]
v_mfma_f32_16x16x32_bf16 v[64:67], a[140:143], a[64:67], v[188:191]
ds_read_b64_tr_b16 a[172:173], v147 offset:16384
v_mfma_f32_16x16x32_bf16 v[68:71], a[140:143], a[68:71], v[188:191]
v_mfma_f32_16x16x32_bf16 v[72:75], a[140:143], a[72:75], v[188:191]
ds_read_b64_tr_b16 a[174:175], v147 offset:20480
v_mfma_f32_16x16x32_bf16 v[76:79], a[140:143], a[76:79], v[188:191]
ds_read_b64_tr_b16 a[176:177], v148 offset:16384
s_waitcnt lgkmcnt(9)
v_mfma_f32_16x16x32_bf16 v[80:83], a[144:147], a[64:67], v[192:195]
v_mfma_f32_16x16x32_bf16 v[84:87], a[144:147], a[68:71], v[192:195]
v_mfma_f32_16x16x32_bf16 v[88:91], a[144:147], a[72:75], v[192:195]
ds_read_b64_tr_b16 a[178:179], v148 offset:20480
v_mfma_f32_16x16x32_bf16 v[92:95], a[144:147], a[76:79], v[192:195]
ds_read_b64_tr_b16 a[180:181], v149 offset:16384
v_mfma_f32_16x16x32_bf16 v[96:99], a[148:151], a[64:67], v[196:199]
ds_read_b64_tr_b16 a[182:183], v149 offset:20480
v_mfma_f32_16x16x32_bf16 v[100:103], a[148:151], a[68:71], v[196:199]
v_mfma_f32_16x16x32_bf16 v[104:107], a[148:151], a[72:75], v[196:199]
ds_read_b64_tr_b16 a[184:185], v150 offset:16384
v_mfma_f32_16x16x32_bf16 v[108:111], a[148:151], a[76:79], v[196:199]
v_mfma_f32_16x16x32_bf16 v[112:115], a[152:155], a[64:67], v[200:203]
ds_read_b64_tr_b16 a[186:187], v150 offset:20480
v_mfma_f32_16x16x32_bf16 v[116:119], a[152:155], a[68:71], v[200:203]
v_mfma_f32_16x16x32_bf16 v[120:123], a[152:155], a[72:75], v[200:203]
ds_read_b64_tr_b16 a[188:189], v151 offset:16384
v_mfma_f32_16x16x32_bf16 v[124:127], a[152:155], a[76:79], v[200:203]
ds_read_b64_tr_b16 a[190:191], v151 offset:20480
v_mfma_f32_16x16x32_bf16 v[128:131], a[156:159], a[64:67], v[204:207]
v_mfma_f32_16x16x32_bf16 v[132:135], a[156:159], a[68:71], v[204:207]
v_mfma_f32_16x16x32_bf16 v[136:139], a[156:159], a[72:75], v[204:207]
v_mfma_f32_16x16x32_bf16 v[140:143], a[156:159], a[76:79], v[204:207]
s_waitcnt vmcnt(8) lgkmcnt(8)
v_mfma_f32_16x16x32_bf16 v[16:19], a[160:163], a[80:83], v[16:19]
v_mfma_f32_16x16x32_bf16 v[20:23], a[160:163], a[84:87], v[20:23]
v_mfma_f32_16x16x32_bf16 v[24:27], a[160:163], a[88:91], v[24:27]
v_mfma_f32_16x16x32_bf16 v[28:31], a[160:163], a[92:95], v[28:31]
v_mfma_f32_16x16x32_bf16 v[32:35], a[164:167], a[80:83], v[32:35]
v_mfma_f32_16x16x32_bf16 v[36:39], a[164:167], a[84:87], v[36:39]
v_mfma_f32_16x16x32_bf16 v[40:43], a[164:167], a[88:91], v[40:43]
s_waitcnt lgkmcnt(0)
s_barrier
s_lshl_b32 s20, s62, 19
s_mov_b32 s62, s33
v_mfma_f32_16x16x32_bf16 v[44:47], a[164:167], a[92:95], v[44:47]
ds_read_b64_tr_b16 a[128:129], v144 offset:32768
s_lshl_b32 s21, s33, 18
s_mov_b32 s24, s16
s_cmp_eq_u32 s31, 0
s_cbranch_scc0 L_c1
s_cmp_eq_u32 s26, 0
s_cbranch_scc0 L_f3h
s_add_u32 s56, s88, 41943040
s_addc_u32 s57, s89, 0
s_and_b32 s57, s57, 0xffff
s_mov_b32 s58, 0x4000
s_mov_b32 s59, 0x00020000
s_lshl_b32 s38, s28, 8
s_lshl_b32 s39, s27, 2
s_add_u32 s38, s38, s39
s_add_u32 s38, s38, 2048
v_mov_b32 v14, 1
v_mov_b32 v15, s38
v_and_b32 v13, 63, v0
v_cmp_eq_u32 vcc, 0, v13
s_nop 0
s_and_saveexec_b64 s[36:37], vcc
buffer_store_dword v14, v15, s[56:59], 0 offen sc0 sc1
s_mov_b64 exec, s[36:37]
L_f3h:
L_c1:
v_mfma_f32_16x16x32_bf16 v[48:51], a[168:171], a[80:83], v[48:51]
ds_read_b64_tr_b16 a[130:131], v144 offset:36864
s_add_u32 s22, s21, s17
s_add_u32 m0, s23, 98304
v_mfma_f32_16x16x32_bf16 v[52:55], a[168:171], a[84:87], v[52:55]
buffer_load_dwordx4 v4, s[12:15], s21 offen offset:0 lds
v_mfma_f32_16x16x32_bf16 v[56:59], a[168:171], a[88:91], v[56:59]
ds_read_b64_tr_b16 a[132:133], v145 offset:32768
s_ff1_i32_b64 s33, s[60:61]
v_mfma_f32_16x16x32_bf16 v[60:63], a[168:171], a[92:95], v[60:63]
ds_read_b64_tr_b16 a[134:135], v145 offset:36864
s_bitset0_b64 s[60:61], s33
v_mfma_f32_16x16x32_bf16 v[64:67], a[172:175], a[80:83], v[64:67]
s_add_u32 s36, s33, s35
v_mfma_f32_16x16x32_bf16 v[68:71], a[172:175], a[84:87], v[68:71]
s_and_b32 s36, s36, 3
buffer_load_dwordx4 a[0:3], v8, s[8:11], s20 offen offset:0 sc1
v_mfma_f32_16x16x32_bf16 v[72:75], a[172:175], a[88:91], v[72:75]
ds_read_b64_tr_b16 a[136:137], v146 offset:32768
s_and_b32 s33, s33, 28
v_mfma_f32_16x16x32_bf16 v[76:79], a[172:175], a[92:95], v[76:79]
ds_read_b64_tr_b16 a[138:139], v146 offset:36864
s_or_b32 s33, s33, s36
v_mfma_f32_16x16x32_bf16 v[80:83], a[176:179], a[80:83], v[80:83]
ds_read_b64_tr_b16 a[140:141], v147 offset:32768
s_lshl_b32 s37, s33, 2
v_mfma_f32_16x16x32_bf16 v[84:87], a[176:179], a[84:87], v[84:87]
s_add_u32 s37, s37, s26
s_add_u32 s21, s21, s24
buffer_load_dwordx4 v5, s[12:15], s21 offen offset:1024 lds
v_mfma_f32_16x16x32_bf16 v[88:91], a[176:179], a[88:91], v[88:91]
ds_read_b64_tr_b16 a[142:143], v147 offset:36864
s_mul_i32 s38, s37, 147
v_mfma_f32_16x16x32_bf16 v[92:95], a[176:179], a[92:95], v[92:95]
s_lshr_b32 s38, s38, 10
v_mfma_f32_16x16x32_bf16 v[96:99], a[180:183], a[80:83], v[96:99]
ds_read_b64_tr_b16 a[144:145], v148 offset:32768
s_mul_i32 s38, s38, 7
v_mfma_f32_16x16x32_bf16 v[100:103], a[180:183], a[84:87], v[100:103]
s_sub_u32 s37, s37, s38
buffer_load_dwordx4 a[4:7], v9, s[8:11], s20 offen offset:256 sc1
v_mfma_f32_16x16x32_bf16 v[104:107], a[180:183], a[88:91], v[104:107]
ds_read_b64_tr_b16 a[146:147], v148 offset:36864
s_cmp_eq_u32 s37, 3
s_cselect_b32 s16, s25, 0
v_mfma_f32_16x16x32_bf16 v[108:111], a[180:183], a[92:95], v[108:111]
ds_read_b64_tr_b16 a[148:149], v149 offset:32768
v_mfma_f32_16x16x32_bf16 v[112:115], a[184:187], a[80:83], v[112:115]
s_mul_i32 s37, s16, 3
v_mfma_f32_16x16x32_bf16 v[116:119], a[184:187], a[84:87], v[116:119]
s_sub_u32 s17, 0x8000, s37
s_add_u32 s21, s21, s24
buffer_load_dwordx4 v6, s[12:15], s21 offen offset:2048 lds
v_mfma_f32_16x16x32_bf16 v[120:123], a[184:187], a[88:91], v[120:123]
ds_read_b64_tr_b16 a[150:151], v149 offset:36864
v_mfma_f32_16x16x32_bf16 v[124:127], a[184:187], a[92:95], v[124:127]
ds_read_b64_tr_b16 a[152:153], v150 offset:32768
v_mfma_f32_16x16x32_bf16 v[128:131], a[188:191], a[80:83], v[128:131]
ds_read_b64_tr_b16 a[154:155], v150 offset:36864
v_mfma_f32_16x16x32_bf16 v[132:135], a[188:191], a[84:87], v[132:135]
buffer_load_dwordx4 a[8:11], v8, s[8:11], s20 offen offset:512 sc1
v_mfma_f32_16x16x32_bf16 v[136:139], a[188:191], a[88:91], v[136:139]
ds_read_b64_tr_b16 a[156:157], v151 offset:32768
v_mfma_f32_16x16x32_bf16 v[140:143], a[188:191], a[92:95], v[140:143]
s_waitcnt vmcnt(10) lgkmcnt(7)
v_mfma_f32_16x16x32_bf16 v[16:19], a[128:131], a[96:99], v[16:19]
ds_read_b64_tr_b16 a[158:159], v151 offset:36864
v_mfma_f32_16x16x32_bf16 v[20:23], a[128:131], a[100:103], v[20:23]
s_add_u32 s21, s21, s24
buffer_load_dwordx4 v7, s[12:15], s21 offen offset:3072 lds
v_mfma_f32_16x16x32_bf16 v[24:27], a[128:131], a[104:107], v[24:27]
ds_read_b64_tr_b16 a[160:161], v144 offset:49152
v_mfma_f32_16x16x32_bf16 v[28:31], a[128:131], a[108:111], v[28:31]
ds_read_b64_tr_b16 a[162:163], v144 offset:53248
v_mfma_f32_16x16x32_bf16 v[32:35], a[132:135], a[96:99], v[32:35]
v_mfma_f32_16x16x32_bf16 v[36:39], a[132:135], a[100:103], v[36:39]
buffer_load_dwordx4 a[12:15], v8, s[8:11], s20 offen offset:768 sc1
v_mfma_f32_16x16x32_bf16 v[40:43], a[132:135], a[104:107], v[40:43]
ds_read_b64_tr_b16 a[164:165], v145 offset:49152
v_mfma_f32_16x16x32_bf16 v[44:47], a[132:135], a[108:111], v[44:47]
ds_read_b64_tr_b16 a[166:167], v145 offset:53248
v_mfma_f32_16x16x32_bf16 v[48:51], a[136:139], a[96:99], v[48:51]
ds_read_b64_tr_b16 a[168:169], v146 offset:49152
s_add_u32 m0, s23, 102400
v_mfma_f32_16x16x32_bf16 v[52:55], a[136:139], a[100:103], v[52:55]
buffer_load_dwordx4 v4, s[12:15], s22 offen offset:0 lds
v_mfma_f32_16x16x32_bf16 v[56:59], a[136:139], a[104:107], v[56:59]
ds_read_b64_tr_b16 a[170:171], v146 offset:53248
v_mfma_f32_16x16x32_bf16 v[60:63], a[136:139], a[108:111], v[60:63]
v_mfma_f32_16x16x32_bf16 v[64:67], a[140:143], a[96:99], v[64:67]
ds_read_b64_tr_b16 a[172:173], v147 offset:49152
v_mfma_f32_16x16x32_bf16 v[68:71], a[140:143], a[100:103], v[68:71]
s_add_u32 s20, s20, 262144
buffer_load_dwordx4 a[16:19], v8, s[8:11], s20 offen offset:0 sc1
v_mfma_f32_16x16x32_bf16 v[72:75], a[140:143], a[104:107], v[72:75]
ds_read_b64_tr_b16 a[174:175], v147 offset:53248
v_mfma_f32_16x16x32_bf16 v[76:79], a[140:143], a[108:111], v[76:79]
ds_read_b64_tr_b16 a[176:177], v148 offset:49152
s_waitcnt lgkmcnt(9)
v_mfma_f32_16x16x32_bf16 v[80:83], a[144:147], a[96:99], v[80:83]
v_mfma_f32_16x16x32_bf16 v[84:87], a[144:147], a[100:103], v[84:87]
s_add_u32 s22, s22, s24
buffer_load_dwordx4 v5, s[12:15], s22 offen offset:1024 lds
v_mfma_f32_16x16x32_bf16 v[88:91], a[144:147], a[104:107], v[88:91]
ds_read_b64_tr_b16 a[178:179], v148 offset:53248
v_mfma_f32_16x16x32_bf16 v[92:95], a[144:147], a[108:111], v[92:95]
ds_read_b64_tr_b16 a[180:181], v149 offset:49152
v_mfma_f32_16x16x32_bf16 v[96:99], a[148:151], a[96:99], v[96:99]
ds_read_b64_tr_b16 a[182:183], v149 offset:53248
v_mfma_f32_16x16x32_bf16 v[100:103], a[148:151], a[100:103], v[100:103]
buffer_load_dwordx4 a[20:23], v9, s[8:11], s20 offen offset:256 sc1
v_mfma_f32_16x16x32_bf16 v[104:107], a[148:151], a[104:107], v[104:107]
ds_read_b64_tr_b16 a[184:185], v150 offset:49152
v_mfma_f32_16x16x32_bf16 v[108:111], a[148:151], a[108:111], v[108:111]
v_mfma_f32_16x16x32_bf16 v[112:115], a[152:155], a[96:99], v[112:115]
ds_read_b64_tr_b16 a[186:187], v150 offset:53248
v_mfma_f32_16x16x32_bf16 v[116:119], a[152:155], a[100:103], v[116:119]
s_add_u32 s22, s22, s24
buffer_load_dwordx4 v6, s[12:15], s22 offen offset:2048 lds
v_mfma_f32_16x16x32_bf16 v[120:123], a[152:155], a[104:107], v[120:123]
ds_read_b64_tr_b16 a[188:189], v151 offset:49152
v_mfma_f32_16x16x32_bf16 v[124:127], a[152:155], a[108:111], v[124:127]
ds_read_b64_tr_b16 a[190:191], v151 offset:53248
v_mfma_f32_16x16x32_bf16 v[128:131], a[156:159], a[96:99], v[128:131]
v_mfma_f32_16x16x32_bf16 v[132:135], a[156:159], a[100:103], v[132:135]
buffer_load_dwordx4 a[24:27], v8, s[8:11], s20 offen offset:512 sc1
v_mfma_f32_16x16x32_bf16 v[136:139], a[156:159], a[104:107], v[136:139]
v_mfma_f32_16x16x32_bf16 v[140:143], a[156:159], a[108:111], v[140:143]
s_waitcnt vmcnt(14) lgkmcnt(8)
v_mfma_f32_16x16x32_bf16 v[16:19], a[160:163], a[112:115], v[16:19]
v_mfma_f32_16x16x32_bf16 v[20:23], a[160:163], a[116:119], v[20:23]
s_add_u32 s22, s22, s24
buffer_load_dwordx4 v7, s[12:15], s22 offen offset:3072 lds
v_mfma_f32_16x16x32_bf16 v[24:27], a[160:163], a[120:123], v[24:27]
v_mfma_f32_16x16x32_bf16 v[28:31], a[160:163], a[124:127], v[28:31]
v_mfma_f32_16x16x32_bf16 v[32:35], a[164:167], a[112:115], v[32:35]
v_mfma_f32_16x16x32_bf16 v[36:39], a[164:167], a[116:119], v[36:39]
buffer_load_dwordx4 a[28:31], v8, s[8:11], s20 offen offset:768 sc1
v_mfma_f32_16x16x32_bf16 v[40:43], a[164:167], a[120:123], v[40:43]
s_waitcnt lgkmcnt(0)
s_barrier
s_lshl_b32 s20, s62, 19
s_mov_b32 s62, s33
v_mfma_f32_16x16x32_bf16 v[44:47], a[164:167], a[124:127], v[44:47]
ds_read_b64_tr_b16 a[128:129], v152 offset:0
s_lshl_b32 s21, s33, 18
s_mov_b32 s24, s16
v_mfma_f32_16x16x32_bf16 v[48:51], a[168:171], a[112:115], v[48:51]
ds_read_b64_tr_b16 a[130:131], v152 offset:4096
s_add_u32 s22, s21, s17
s_add_u32 m0, s23, 0
v_mfma_f32_16x16x32_bf16 v[52:55], a[168:171], a[116:119], v[52:55]
buffer_load_dwordx4 v4, s[12:15], s21 offen offset:0 lds
v_mfma_f32_16x16x32_bf16 v[56:59], a[168:171], a[120:123], v[56:59]
ds_read_b64_tr_b16 a[132:133], v153 offset:0
s_ff1_i32_b64 s33, s[60:61]
v_mfma_f32_16x16x32_bf16 v[60:63], a[168:171], a[124:127], v[60:63]
ds_read_b64_tr_b16 a[134:135], v153 offset:4096
s_bitset0_b64 s[60:61], s33
v_mfma_f32_16x16x32_bf16 v[64:67], a[172:175], a[112:115], v[64:67]
s_add_u32 s36, s33, s35
v_mfma_f32_16x16x32_bf16 v[68:71], a[172:175], a[116:119], v[68:71]
s_and_b32 s36, s36, 3
buffer_load_dwordx4 a[32:35], v8, s[8:11], s20 offen offset:0 sc1
v_mfma_f32_16x16x32_bf16 v[72:75], a[172:175], a[120:123], v[72:75]
ds_read_b64_tr_b16 a[136:137], v154 offset:0
s_and_b32 s33, s33, 28
v_mfma_f32_16x16x32_bf16 v[76:79], a[172:175], a[124:127], v[76:79]
ds_read_b64_tr_b16 a[138:139], v154 offset:4096
s_or_b32 s33, s33, s36
v_mfma_f32_16x16x32_bf16 v[80:83], a[176:179], a[112:115], v[80:83]
ds_read_b64_tr_b16 a[140:141], v155 offset:0
s_lshl_b32 s37, s33, 2
v_mfma_f32_16x16x32_bf16 v[84:87], a[176:179], a[116:119], v[84:87]
s_add_u32 s37, s37, s26
s_add_u32 s21, s21, s24
buffer_load_dwordx4 v5, s[12:15], s21 offen offset:1024 lds
v_mfma_f32_16x16x32_bf16 v[88:91], a[176:179], a[120:123], v[88:91]
ds_read_b64_tr_b16 a[142:143], v155 offset:4096
s_mul_i32 s38, s37, 147
v_mfma_f32_16x16x32_bf16 v[92:95], a[176:179], a[124:127], v[92:95]
s_lshr_b32 s38, s38, 10
v_mfma_f32_16x16x32_bf16 v[96:99], a[180:183], a[112:115], v[96:99]
ds_read_b64_tr_b16 a[144:145], v156 offset:0
s_mul_i32 s38, s38, 7
v_mfma_f32_16x16x32_bf16 v[100:103], a[180:183], a[116:119], v[100:103]
s_sub_u32 s37, s37, s38
buffer_load_dwordx4 a[36:39], v9, s[8:11], s20 offen offset:256 sc1
v_mfma_f32_16x16x32_bf16 v[104:107], a[180:183], a[120:123], v[104:107]
ds_read_b64_tr_b16 a[146:147], v156 offset:4096
s_cmp_eq_u32 s37, 3
s_cselect_b32 s16, s25, 0
v_mfma_f32_16x16x32_bf16 v[108:111], a[180:183], a[124:127], v[108:111]
ds_read_b64_tr_b16 a[148:149], v157 offset:0
v_mfma_f32_16x16x32_bf16 v[112:115], a[184:187], a[112:115], v[112:115]
s_mul_i32 s37, s16, 3
v_mfma_f32_16x16x32_bf16 v[116:119], a[184:187], a[116:119], v[116:119]
s_sub_u32 s17, 0x8000, s37
s_add_u32 s21, s21, s24
buffer_load_dwordx4 v6, s[12:15], s21 offen offset:2048 lds
v_mfma_f32_16x16x32_bf16 v[120:123], a[184:187], a[120:123], v[120:123]
ds_read_b64_tr_b16 a[150:151], v157 offset:4096
v_mfma_f32_16x16x32_bf16 v[124:127], a[184:187], a[124:127], v[124:127]
ds_read_b64_tr_b16 a[152:153], v158 offset:0
v_mfma_f32_16x16x32_bf16 v[128:131], a[188:191], a[112:115], v[128:131]
ds_read_b64_tr_b16 a[154:155], v158 offset:4096
v_mfma_f32_16x16x32_bf16 v[132:135], a[188:191], a[116:119], v[132:135]
buffer_load_dwordx4 a[40:43], v8, s[8:11], s20 offen offset:512 sc1
v_mfma_f32_16x16x32_bf16 v[136:139], a[188:191], a[120:123], v[136:139]
ds_read_b64_tr_b16 a[156:157], v159 offset:0
v_mfma_f32_16x16x32_bf16 v[140:143], a[188:191], a[124:127], v[140:143]
s_waitcnt vmcnt(14) lgkmcnt(7)
v_mfma_f32_16x16x32_bf16 v[16:19], a[128:131], a[0:3], v[16:19]
ds_read_b64_tr_b16 a[158:159], v159 offset:4096
v_mfma_f32_16x16x32_bf16 v[20:23], a[128:131], a[4:7], v[20:23]
s_add_u32 s21, s21, s24
buffer_load_dwordx4 v7, s[12:15], s21 offen offset:3072 lds
v_mfma_f32_16x16x32_bf16 v[24:27], a[128:131], a[8:11], v[24:27]
ds_read_b64_tr_b16 a[160:161], v152 offset:16384
v_mfma_f32_16x16x32_bf16 v[28:31], a[128:131], a[12:15], v[28:31]
ds_read_b64_tr_b16 a[162:163], v152 offset:20480
v_mfma_f32_16x16x32_bf16 v[32:35], a[132:135], a[0:3], v[32:35]
v_mfma_f32_16x16x32_bf16 v[36:39], a[132:135], a[4:7], v[36:39]
buffer_load_dwordx4 a[44:47], v8, s[8:11], s20 offen offset:768 sc1
v_mfma_f32_16x16x32_bf16 v[40:43], a[132:135], a[8:11], v[40:43]
ds_read_b64_tr_b16 a[164:165], v153 offset:16384
v_mfma_f32_16x16x32_bf16 v[44:47], a[132:135], a[12:15], v[44:47]
ds_read_b64_tr_b16 a[166:167], v153 offset:20480
v_mfma_f32_16x16x32_bf16 v[48:51], a[136:139], a[0:3], v[48:51]
ds_read_b64_tr_b16 a[168:169], v154 offset:16384
s_add_u32 m0, s23, 4096
v_mfma_f32_16x16x32_bf16 v[52:55], a[136:139], a[4:7], v[52:55]
buffer_load_dwordx4 v4, s[12:15], s22 offen offset:0 lds
v_mfma_f32_16x16x32_bf16 v[56:59], a[136:139], a[8:11], v[56:59]
ds_read_b64_tr_b16 a[170:171], v154 offset:20480
v_mfma_f32_16x16x32_bf16 v[60:63], a[136:139], a[12:15], v[60:63]
v_mfma_f32_16x16x32_bf16 v[64:67], a[140:143], a[0:3], v[64:67]
ds_read_b64_tr_b16 a[172:173], v155 offset:16384
v_mfma_f32_16x16x32_bf16 v[68:71], a[140:143], a[4:7], v[68:71]
s_add_u32 s20, s20, 262144
buffer_load_dwordx4 a[48:51], v8, s[8:11], s20 offen offset:0 sc1
v_mfma_f32_16x16x32_bf16 v[72:75], a[140:143], a[8:11], v[72:75]
ds_read_b64_tr_b16 a[174:175], v155 offset:20480
v_mfma_f32_16x16x32_bf16 v[76:79], a[140:143], a[12:15], v[76:79]
ds_read_b64_tr_b16 a[176:177], v156 offset:16384
s_waitcnt lgkmcnt(9)
v_mfma_f32_16x16x32_bf16 v[80:83], a[144:147], a[0:3], v[80:83]
v_mfma_f32_16x16x32_bf16 v[84:87], a[144:147], a[4:7], v[84:87]
s_add_u32 s22, s22, s24
buffer_load_dwordx4 v5, s[12:15], s22 offen offset:1024 lds
v_mfma_f32_16x16x32_bf16 v[88:91], a[144:147], a[8:11], v[88:91]
ds_read_b64_tr_b16 a[178:179], v156 offset:20480
v_mfma_f32_16x16x32_bf16 v[92:95], a[144:147], a[12:15], v[92:95]
ds_read_b64_tr_b16 a[180:181], v157 offset:16384
v_mfma_f32_16x16x32_bf16 v[96:99], a[148:151], a[0:3], v[96:99]
ds_read_b64_tr_b16 a[182:183], v157 offset:20480
v_mfma_f32_16x16x32_bf16 v[100:103], a[148:151], a[4:7], v[100:103]
buffer_load_dwordx4 a[52:55], v9, s[8:11], s20 offen offset:256 sc1
v_mfma_f32_16x16x32_bf16 v[104:107], a[148:151], a[8:11], v[104:107]
ds_read_b64_tr_b16 a[184:185], v158 offset:16384
v_mfma_f32_16x16x32_bf16 v[108:111], a[148:151], a[12:15], v[108:111]
v_mfma_f32_16x16x32_bf16 v[112:115], a[152:155], a[0:3], v[112:115]
ds_read_b64_tr_b16 a[186:187], v158 offset:20480
v_mfma_f32_16x16x32_bf16 v[116:119], a[152:155], a[4:7], v[116:119]
s_add_u32 s22, s22, s24
buffer_load_dwordx4 v6, s[12:15], s22 offen offset:2048 lds
v_mfma_f32_16x16x32_bf16 v[120:123], a[152:155], a[8:11], v[120:123]
ds_read_b64_tr_b16 a[188:189], v159 offset:16384
v_mfma_f32_16x16x32_bf16 v[124:127], a[152:155], a[12:15], v[124:127]
ds_read_b64_tr_b16 a[190:191], v159 offset:20480
v_mfma_f32_16x16x32_bf16 v[128:131], a[156:159], a[0:3], v[128:131]
v_mfma_f32_16x16x32_bf16 v[132:135], a[156:159], a[4:7], v[132:135]
buffer_load_dwordx4 a[56:59], v8, s[8:11], s20 offen offset:512 sc1
v_mfma_f32_16x16x32_bf16 v[136:139], a[156:159], a[8:11], v[136:139]
v_mfma_f32_16x16x32_bf16 v[140:143], a[156:159], a[12:15], v[140:143]
s_waitcnt vmcnt(14) lgkmcnt(8)
v_mfma_f32_16x16x32_bf16 v[16:19], a[160:163], a[16:19], v[16:19]
v_mfma_f32_16x16x32_bf16 v[20:23], a[160:163], a[20:23], v[20:23]
s_add_u32 s22, s22, s24
buffer_load_dwordx4 v7, s[12:15], s22 offen offset:3072 lds
v_mfma_f32_16x16x32_bf16 v[24:27], a[160:163], a[24:27], v[24:27]
v_mfma_f32_16x16x32_bf16 v[28:31], a[160:163], a[28:31], v[28:31]
v_mfma_f32_16x16x32_bf16 v[32:35], a[164:167], a[16:19], v[32:35]
v_mfma_f32_16x16x32_bf16 v[36:39], a[164:167], a[20:23], v[36:39]
buffer_load_dwordx4 a[60:63], v8, s[8:11], s20 offen offset:768 sc1
v_mfma_f32_16x16x32_bf16 v[40:43], a[164:167], a[24:27], v[40:43]
s_waitcnt lgkmcnt(0)
s_barrier
s_lshl_b32 s20, s62, 19
s_mov_b32 s62, s33
v_mfma_f32_16x16x32_bf16 v[44:47], a[164:167], a[28:31], v[44:47]
ds_read_b64_tr_b16 a[128:129], v152 offset:32768
s_lshl_b32 s21, s33, 18
s_mov_b32 s24, s16
v_mfma_f32_16x16x32_bf16 v[48:51], a[168:171], a[16:19], v[48:51]
ds_read_b64_tr_b16 a[130:131], v152 offset:36864
s_add_u32 s22, s21, s17
s_add_u32 m0, s23, 32768
v_mfma_f32_16x16x32_bf16 v[52:55], a[168:171], a[20:23], v[52:55]
buffer_load_dwordx4 v4, s[12:15], s21 offen offset:0 lds
v_mfma_f32_16x16x32_bf16 v[56:59], a[168:171], a[24:27], v[56:59]
ds_read_b64_tr_b16 a[132:133], v153 offset:32768
s_ff1_i32_b64 s33, s[60:61]
v_mfma_f32_16x16x32_bf16 v[60:63], a[168:171], a[28:31], v[60:63]
ds_read_b64_tr_b16 a[134:135], v153 offset:36864
s_bitset0_b64 s[60:61], s33
v_mfma_f32_16x16x32_bf16 v[64:67], a[172:175], a[16:19], v[64:67]
s_add_u32 s36, s33, s35
v_mfma_f32_16x16x32_bf16 v[68:71], a[172:175], a[20:23], v[68:71]
s_and_b32 s36, s36, 3
buffer_load_dwordx4 a[64:67], v8, s[8:11], s20 offen offset:0 sc1
v_mfma_f32_16x16x32_bf16 v[72:75], a[172:175], a[24:27], v[72:75]
ds_read_b64_tr_b16 a[136:137], v154 offset:32768
s_and_b32 s33, s33, 28
v_mfma_f32_16x16x32_bf16 v[76:79], a[172:175], a[28:31], v[76:79]
ds_read_b64_tr_b16 a[138:139], v154 offset:36864
s_or_b32 s33, s33, s36
v_mfma_f32_16x16x32_bf16 v[80:83], a[176:179], a[16:19], v[80:83]
ds_read_b64_tr_b16 a[140:141], v155 offset:32768
s_lshl_b32 s37, s33, 2
v_mfma_f32_16x16x32_bf16 v[84:87], a[176:179], a[20:23], v[84:87]
s_add_u32 s37, s37, s26
s_add_u32 s21, s21, s24
buffer_load_dwordx4 v5, s[12:15], s21 offen offset:1024 lds
v_mfma_f32_16x16x32_bf16 v[88:91], a[176:179], a[24:27], v[88:91]
ds_read_b64_tr_b16 a[142:143], v155 offset:36864
s_mul_i32 s38, s37, 147
v_mfma_f32_16x16x32_bf16 v[92:95], a[176:179], a[28:31], v[92:95]
s_lshr_b32 s38, s38, 10
v_mfma_f32_16x16x32_bf16 v[96:99], a[180:183], a[16:19], v[96:99]
ds_read_b64_tr_b16 a[144:145], v156 offset:32768
s_mul_i32 s38, s38, 7
v_mfma_f32_16x16x32_bf16 v[100:103], a[180:183], a[20:23], v[100:103]
s_sub_u32 s37, s37, s38
buffer_load_dwordx4 a[68:71], v9, s[8:11], s20 offen offset:256 sc1
v_mfma_f32_16x16x32_bf16 v[104:107], a[180:183], a[24:27], v[104:107]
ds_read_b64_tr_b16 a[146:147], v156 offset:36864
s_cmp_eq_u32 s37, 3
s_cselect_b32 s16, s25, 0
v_mfma_f32_16x16x32_bf16 v[108:111], a[180:183], a[28:31], v[108:111]
ds_read_b64_tr_b16 a[148:149], v157 offset:32768
v_mfma_f32_16x16x32_bf16 v[112:115], a[184:187], a[16:19], v[112:115]
s_mul_i32 s37, s16, 3
v_mfma_f32_16x16x32_bf16 v[116:119], a[184:187], a[20:23], v[116:119]
s_sub_u32 s17, 0x8000, s37
s_add_u32 s21, s21, s24
buffer_load_dwordx4 v6, s[12:15], s21 offen offset:2048 lds
v_mfma_f32_16x16x32_bf16 v[120:123], a[184:187], a[24:27], v[120:123]
ds_read_b64_tr_b16 a[150:151], v157 offset:36864
v_mfma_f32_16x16x32_bf16 v[124:127], a[184:187], a[28:31], v[124:127]
ds_read_b64_tr_b16 a[152:153], v158 offset:32768
v_mfma_f32_16x16x32_bf16 v[128:131], a[188:191], a[16:19], v[128:131]
ds_read_b64_tr_b16 a[154:155], v158 offset:36864
v_mfma_f32_16x16x32_bf16 v[132:135], a[188:191], a[20:23], v[132:135]
buffer_load_dwordx4 a[72:75], v8, s[8:11], s20 offen offset:512 sc1
v_mfma_f32_16x16x32_bf16 v[136:139], a[188:191], a[24:27], v[136:139]
ds_read_b64_tr_b16 a[156:157], v159 offset:32768
v_mfma_f32_16x16x32_bf16 v[140:143], a[188:191], a[28:31], v[140:143]
s_waitcnt vmcnt(14) lgkmcnt(7)
v_mfma_f32_16x16x32_bf16 v[16:19], a[128:131], a[32:35], v[16:19]
ds_read_b64_tr_b16 a[158:159], v159 offset:36864
v_mfma_f32_16x16x32_bf16 v[20:23], a[128:131], a[36:39], v[20:23]
s_add_u32 s21, s21, s24
buffer_load_dwordx4 v7, s[12:15], s21 offen offset:3072 lds
v_mfma_f32_16x16x32_bf16 v[24:27], a[128:131], a[40:43], v[24:27]
ds_read_b64_tr_b16 a[160:161], v152 offset:49152
v_mfma_f32_16x16x32_bf16 v[28:31], a[128:131], a[44:47], v[28:31]
ds_read_b64_tr_b16 a[162:163], v152 offset:53248
v_mfma_f32_16x16x32_bf16 v[32:35], a[132:135], a[32:35], v[32:35]
v_mfma_f32_16x16x32_bf16 v[36:39], a[132:135], a[36:39], v[36:39]
buffer_load_dwordx4 a[76:79], v8, s[8:11], s20 offen offset:768 sc1
v_mfma_f32_16x16x32_bf16 v[40:43], a[132:135], a[40:43], v[40:43]
ds_read_b64_tr_b16 a[164:165], v153 offset:49152
v_mfma_f32_16x16x32_bf16 v[44:47], a[132:135], a[44:47], v[44:47]
ds_read_b64_tr_b16 a[166:167], v153 offset:53248
v_mfma_f32_16x16x32_bf16 v[48:51], a[136:139], a[32:35], v[48:51]
ds_read_b64_tr_b16 a[168:169], v154 offset:49152
s_add_u32 m0, s23, 36864
v_mfma_f32_16x16x32_bf16 v[52:55], a[136:139], a[36:39], v[52:55]
buffer_load_dwordx4 v4, s[12:15], s22 offen offset:0 lds
v_mfma_f32_16x16x32_bf16 v[56:59], a[136:139], a[40:43], v[56:59]
ds_read_b64_tr_b16 a[170:171], v154 offset:53248
v_mfma_f32_16x16x32_bf16 v[60:63], a[136:139], a[44:47], v[60:63]
v_mfma_f32_16x16x32_bf16 v[64:67], a[140:143], a[32:35], v[64:67]
ds_read_b64_tr_b16 a[172:173], v155 offset:49152
v_mfma_f32_16x16x32_bf16 v[68:71], a[140:143], a[36:39], v[68:71]
s_add_u32 s20, s20, 262144
buffer_load_dwordx4 a[80:83], v8, s[8:11], s20 offen offset:0 sc1
v_mfma_f32_16x16x32_bf16 v[72:75], a[140:143], a[40:43], v[72:75]
ds_read_b64_tr_b16 a[174:175], v155 offset:53248
v_mfma_f32_16x16x32_bf16 v[76:79], a[140:143], a[44:47], v[76:79]
ds_read_b64_tr_b16 a[176:177], v156 offset:49152
s_waitcnt lgkmcnt(9)
v_mfma_f32_16x16x32_bf16 v[80:83], a[144:147], a[32:35], v[80:83]
v_mfma_f32_16x16x32_bf16 v[84:87], a[144:147], a[36:39], v[84:87]
s_add_u32 s22, s22, s24
buffer_load_dwordx4 v5, s[12:15], s22 offen offset:1024 lds
v_mfma_f32_16x16x32_bf16 v[88:91], a[144:147], a[40:43], v[88:91]
ds_read_b64_tr_b16 a[178:179], v156 offset:53248
v_mfma_f32_16x16x32_bf16 v[92:95], a[144:147], a[44:47], v[92:95]
ds_read_b64_tr_b16 a[180:181], v157 offset:49152
v_mfma_f32_16x16x32_bf16 v[96:99], a[148:151], a[32:35], v[96:99]
ds_read_b64_tr_b16 a[182:183], v157 offset:53248
v_mfma_f32_16x16x32_bf16 v[100:103], a[148:151], a[36:39], v[100:103]
buffer_load_dwordx4 a[84:87], v9, s[8:11], s20 offen offset:256 sc1
v_mfma_f32_16x16x32_bf16 v[104:107], a[148:151], a[40:43], v[104:107]
ds_read_b64_tr_b16 a[184:185], v158 offset:49152
v_mfma_f32_16x16x32_bf16 v[108:111], a[148:151], a[44:47], v[108:111]
v_mfma_f32_16x16x32_bf16 v[112:115], a[152:155], a[32:35], v[112:115]
ds_read_b64_tr_b16 a[186:187], v158 offset:53248
v_mfma_f32_16x16x32_bf16 v[116:119], a[152:155], a[36:39], v[116:119]
s_add_u32 s22, s22, s24
buffer_load_dwordx4 v6, s[12:15], s22 offen offset:2048 lds
v_mfma_f32_16x16x32_bf16 v[120:123], a[152:155], a[40:43], v[120:123]
ds_read_b64_tr_b16 a[188:189], v159 offset:49152
v_mfma_f32_16x16x32_bf16 v[124:127], a[152:155], a[44:47], v[124:127]
ds_read_b64_tr_b16 a[190:191], v159 offset:53248
v_mfma_f32_16x16x32_bf16 v[128:131], a[156:159], a[32:35], v[128:131]
v_mfma_f32_16x16x32_bf16 v[132:135], a[156:159], a[36:39], v[132:135]
buffer_load_dwordx4 a[88:91], v8, s[8:11], s20 offen offset:512 sc1
v_mfma_f32_16x16x32_bf16 v[136:139], a[156:159], a[40:43], v[136:139]
v_mfma_f32_16x16x32_bf16 v[140:143], a[156:159], a[44:47], v[140:143]
s_waitcnt vmcnt(14) lgkmcnt(8)
v_mfma_f32_16x16x32_bf16 v[16:19], a[160:163], a[48:51], v[16:19]
v_mfma_f32_16x16x32_bf16 v[20:23], a[160:163], a[52:55], v[20:23]
s_add_u32 s22, s22, s24
buffer_load_dwordx4 v7, s[12:15], s22 offen offset:3072 lds
v_mfma_f32_16x16x32_bf16 v[24:27], a[160:163], a[56:59], v[24:27]
v_mfma_f32_16x16x32_bf16 v[28:31], a[160:163], a[60:63], v[28:31]
v_mfma_f32_16x16x32_bf16 v[32:35], a[164:167], a[48:51], v[32:35]
v_mfma_f32_16x16x32_bf16 v[36:39], a[164:167], a[52:55], v[36:39]
buffer_load_dwordx4 a[92:95], v8, s[8:11], s20 offen offset:768 sc1
v_mfma_f32_16x16x32_bf16 v[40:43], a[164:167], a[56:59], v[40:43]
s_waitcnt lgkmcnt(0)
s_barrier
s_lshl_b32 s20, s62, 19
s_mov_b32 s62, s33
v_mfma_f32_16x16x32_bf16 v[44:47], a[164:167], a[60:63], v[44:47]
ds_read_b64_tr_b16 a[128:129], v144 offset:0
s_lshl_b32 s21, s33, 18
s_mov_b32 s24, s16
v_mfma_f32_16x16x32_bf16 v[48:51], a[168:171], a[48:51], v[48:51]
ds_read_b64_tr_b16 a[130:131], v144 offset:4096
s_add_u32 s22, s21, s17
s_add_u32 m0, s23, 65536
v_mfma_f32_16x16x32_bf16 v[52:55], a[168:171], a[52:55], v[52:55]
buffer_load_dwordx4 v4, s[12:15], s21 offen offset:0 lds
v_mfma_f32_16x16x32_bf16 v[56:59], a[168:171], a[56:59], v[56:59]
ds_read_b64_tr_b16 a[132:133], v145 offset:0
s_ff1_i32_b64 s33, s[60:61]
v_mfma_f32_16x16x32_bf16 v[60:63], a[168:171], a[60:63], v[60:63]
ds_read_b64_tr_b16 a[134:135], v145 offset:4096
s_bitset0_b64 s[60:61], s33
v_mfma_f32_16x16x32_bf16 v[64:67], a[172:175], a[48:51], v[64:67]
s_add_u32 s36, s33, s35
v_mfma_f32_16x16x32_bf16 v[68:71], a[172:175], a[52:55], v[68:71]
s_and_b32 s36, s36, 3
buffer_load_dwordx4 a[96:99], v8, s[8:11], s20 offen offset:0 sc1
v_mfma_f32_16x16x32_bf16 v[72:75], a[172:175], a[56:59], v[72:75]
ds_read_b64_tr_b16 a[136:137], v146 offset:0
s_and_b32 s33, s33, 28
v_mfma_f32_16x16x32_bf16 v[76:79], a[172:175], a[60:63], v[76:79]
ds_read_b64_tr_b16 a[138:139], v146 offset:4096
s_or_b32 s33, s33, s36
v_mfma_f32_16x16x32_bf16 v[80:83], a[176:179], a[48:51], v[80:83]
ds_read_b64_tr_b16 a[140:141], v147 offset:0
s_lshl_b32 s37, s33, 2
v_mfma_f32_16x16x32_bf16 v[84:87], a[176:179], a[52:55], v[84:87]
s_add_u32 s37, s37, s26
s_add_u32 s21, s21, s24
buffer_load_dwordx4 v5, s[12:15], s21 offen offset:1024 lds
v_mfma_f32_16x16x32_bf16 v[88:91], a[176:179], a[56:59], v[88:91]
ds_read_b64_tr_b16 a[142:143], v147 offset:4096
s_mul_i32 s38, s37, 147
v_mfma_f32_16x16x32_bf16 v[92:95], a[176:179], a[60:63], v[92:95]
s_lshr_b32 s38, s38, 10
v_mfma_f32_16x16x32_bf16 v[96:99], a[180:183], a[48:51], v[96:99]
ds_read_b64_tr_b16 a[144:145], v148 offset:0
s_mul_i32 s38, s38, 7
v_mfma_f32_16x16x32_bf16 v[100:103], a[180:183], a[52:55], v[100:103]
s_sub_u32 s37, s37, s38
buffer_load_dwordx4 a[100:103], v9, s[8:11], s20 offen offset:256 sc1
v_mfma_f32_16x16x32_bf16 v[104:107], a[180:183], a[56:59], v[104:107]
ds_read_b64_tr_b16 a[146:147], v148 offset:4096
s_cmp_eq_u32 s37, 3
s_cselect_b32 s16, s25, 0
v_mfma_f32_16x16x32_bf16 v[108:111], a[180:183], a[60:63], v[108:111]
ds_read_b64_tr_b16 a[148:149], v149 offset:0
v_mfma_f32_16x16x32_bf16 v[112:115], a[184:187], a[48:51], v[112:115]
s_mul_i32 s37, s16, 3
v_mfma_f32_16x16x32_bf16 v[116:119], a[184:187], a[52:55], v[116:119]
s_sub_u32 s17, 0x8000, s37
s_add_u32 s21, s21, s24
buffer_load_dwordx4 v6, s[12:15], s21 offen offset:2048 lds
v_mfma_f32_16x16x32_bf16 v[120:123], a[184:187], a[56:59], v[120:123]
ds_read_b64_tr_b16 a[150:151], v149 offset:4096
v_mfma_f32_16x16x32_bf16 v[124:127], a[184:187], a[60:63], v[124:127]
ds_read_b64_tr_b16 a[152:153], v150 offset:0
v_mfma_f32_16x16x32_bf16 v[128:131], a[188:191], a[48:51], v[128:131]
ds_read_b64_tr_b16 a[154:155], v150 offset:4096
v_mfma_f32_16x16x32_bf16 v[132:135], a[188:191], a[52:55], v[132:135]
buffer_load_dwordx4 a[104:107], v8, s[8:11], s20 offen offset:512 sc1
v_mfma_f32_16x16x32_bf16 v[136:139], a[188:191], a[56:59], v[136:139]
ds_read_b64_tr_b16 a[156:157], v151 offset:0
v_mfma_f32_16x16x32_bf16 v[140:143], a[188:191], a[60:63], v[140:143]
L_b0_e:
s_mov_b32 s34, 1
L_p3loop:
s_waitcnt vmcnt(14) lgkmcnt(7)
v_mfma_f32_16x16x32_bf16 v[16:19], a[128:131], a[64:67], v[16:19]
ds_read_b64_tr_b16 a[158:159], v151 offset:4096
v_mfma_f32_16x16x32_bf16 v[20:23], a[128:131], a[68:71], v[20:23]
s_add_u32 s21, s21, s24
buffer_load_dwordx4 v7, s[12:15], s21 offen offset:3072 lds
s_cmp_eq_u32 s34, 2
s_cbranch_scc1 L_o2
L_o2_ret:
v_mfma_f32_16x16x32_bf16 v[24:27], a[128:131], a[72:75], v[24:27]
ds_read_b64_tr_b16 a[160:161], v144 offset:16384
v_mfma_f32_16x16x32_bf16 v[28:31], a[128:131], a[76:79], v[28:31]
ds_read_b64_tr_b16 a[162:163], v144 offset:20480
v_mfma_f32_16x16x32_bf16 v[32:35], a[132:135], a[64:67], v[32:35]
v_mfma_f32_16x16x32_bf16 v[36:39], a[132:135], a[68:71], v[36:39]
buffer_load_dwordx4 a[108:111], v8, s[8:11], s20 offen offset:768 sc1
v_mfma_f32_16x16x32_bf16 v[40:43], a[132:135], a[72:75], v[40:43]
ds_read_b64_tr_b16 a[164:165], v145 offset:16384
v_mfma_f32_16x16x32_bf16 v[44:47], a[132:135], a[76:79], v[44:47]
ds_read_b64_tr_b16 a[166:167], v145 offset:20480
v_mfma_f32_16x16x32_bf16 v[48:51], a[136:139], a[64:67], v[48:51]
ds_read_b64_tr_b16 a[168:169], v146 offset:16384
s_add_u32 m0, s23, 69632
v_mfma_f32_16x16x32_bf16 v[52:55], a[136:139], a[68:71], v[52:55]
buffer_load_dwordx4 v4, s[12:15], s22 offen offset:0 lds
v_mfma_f32_16x16x32_bf16 v[56:59], a[136:139], a[72:75], v[56:59]
ds_read_b64_tr_b16 a[170:171], v146 offset:20480
v_mfma_f32_16x16x32_bf16 v[60:63], a[136:139], a[76:79], v[60:63]
v_mfma_f32_16x16x32_bf16 v[64:67], a[140:143], a[64:67], v[64:67]
ds_read_b64_tr_b16 a[172:173], v147 offset:16384
v_mfma_f32_16x16x32_bf16 v[68:71], a[140:143], a[68:71], v[68:71]
s_add_u32 s20, s20, 262144
buffer_load_dwordx4 a[112:115], v8, s[8:11], s20 offen offset:0 sc1
v_mfma_f32_16x16x32_bf16 v[72:75], a[140:143], a[72:75], v[72:75]
ds_read_b64_tr_b16 a[174:175], v147 offset:20480
v_mfma_f32_16x16x32_bf16 v[76:79], a[140:143], a[76:79], v[76:79]
ds_read_b64_tr_b16 a[176:177], v148 offset:16384
s_waitcnt lgkmcnt(9)
v_mfma_f32_16x16x32_bf16 v[80:83], a[144:147], a[64:67], v[80:83]
v_mfma_f32_16x16x32_bf16 v[84:87], a[144:147], a[68:71], v[84:87]
s_add_u32 s22, s22, s24
buffer_load_dwordx4 v5, s[12:15], s22 offen offset:1024 lds
v_mfma_f32_16x16x32_bf16 v[88:91], a[144:147], a[72:75], v[88:91]
ds_read_b64_tr_b16 a[178:179], v148 offset:20480
v_mfma_f32_16x16x32_bf16 v[92:95], a[144:147], a[76:79], v[92:95]
ds_read_b64_tr_b16 a[180:181], v149 offset:16384
v_mfma_f32_16x16x32_bf16 v[96:99], a[148:151], a[64:67], v[96:99]
ds_read_b64_tr_b16 a[182:183], v149 offset:20480
v_mfma_f32_16x16x32_bf16 v[100:103], a[148:151], a[68:71], v[100:103]
buffer_load_dwordx4 a[116:119], v9, s[8:11], s20 offen offset:256 sc1
v_mfma_f32_16x16x32_bf16 v[104:107], a[148:151], a[72:75], v[104:107]
ds_read_b64_tr_b16 a[184:185], v150 offset:16384
v_mfma_f32_16x16x32_bf16 v[108:111], a[148:151], a[76:79], v[108:111]
v_mfma_f32_16x16x32_bf16 v[112:115], a[152:155], a[64:67], v[112:115]
ds_read_b64_tr_b16 a[186:187], v150 offset:20480
v_mfma_f32_16x16x32_bf16 v[116:119], a[152:155], a[68:71], v[116:119]
s_add_u32 s22, s22, s24
buffer_load_dwordx4 v6, s[12:15], s22 offen offset:2048 lds
v_mfma_f32_16x16x32_bf16 v[120:123], a[152:155], a[72:75], v[120:123]
ds_read_b64_tr_b16 a[188:189], v151 offset:16384
v_mfma_f32_16x16x32_bf16 v[124:127], a[152:155], a[76:79], v[124:127]
ds_read_b64_tr_b16 a[190:191], v151 offset:20480
v_mfma_f32_16x16x32_bf16 v[128:131], a[156:159], a[64:67], v[128:131]
v_mfma_f32_16x16x32_bf16 v[132:135], a[156:159], a[68:71], v[132:135]
buffer_load_dwordx4 a[120:123], v8, s[8:11], s20 offen offset:512 sc1
v_mfma_f32_16x16x32_bf16 v[136:139], a[156:159], a[72:75], v[136:139]
v_mfma_f32_16x16x32_bf16 v[140:143], a[156:159], a[76:79], v[140:143]
s_waitcnt vmcnt(14) lgkmcnt(8)
v_mfma_f32_16x16x32_bf16 v[16:19], a[160:163], a[80:83], v[16:19]
v_mfma_f32_16x16x32_bf16 v[20:23], a[160:163], a[84:87], v[20:23]
s_add_u32 s22, s22, s24
buffer_load_dwordx4 v7, s[12:15], s22 offen offset:3072 lds
v_mfma_f32_16x16x32_bf16 v[24:27], a[160:163], a[88:91], v[24:27]
v_mfma_f32_16x16x32_bf16 v[28:31], a[160:163], a[92:95], v[28:31]
v_mfma_f32_16x16x32_bf16 v[32:35], a[164:167], a[80:83], v[32:35]
v_mfma_f32_16x16x32_bf16 v[36:39], a[164:167], a[84:87], v[36:39]
buffer_load_dwordx4 a[124:127], v8, s[8:11], s20 offen offset:768 sc1
v_mfma_f32_16x16x32_bf16 v[40:43], a[164:167], a[88:91], v[40:43]
s_waitcnt lgkmcnt(0)
s_barrier
s_lshl_b32 s20, s62, 19
s_mov_b32 s62, s33
v_mfma_f32_16x16x32_bf16 v[44:47], a[164:167], a[92:95], v[44:47]
ds_read_b64_tr_b16 a[128:129], v144 offset:32768
s_lshl_b32 s21, s33, 18
s_mov_b32 s24, s16
v_mfma_f32_16x16x32_bf16 v[48:51], a[168:171], a[80:83], v[48:51]
ds_read_b64_tr_b16 a[130:131], v144 offset:36864
s_add_u32 s22, s21, s17
s_add_u32 m0, s23, 98304
v_mfma_f32_16x16x32_bf16 v[52:55], a[168:171], a[84:87], v[52:55]
buffer_load_dwordx4 v4, s[12:15], s21 offen offset:0 lds
v_mfma_f32_16x16x32_bf16 v[56:59], a[168:171], a[88:91], v[56:59]
ds_read_b64_tr_b16 a[132:133], v145 offset:32768
s_ff1_i32_b64 s33, s[60:61]
v_mfma_f32_16x16x32_bf16 v[60:63], a[168:171], a[92:95], v[60:63]
ds_read_b64_tr_b16 a[134:135], v145 offset:36864
s_bitset0_b64 s[60:61], s33
v_mfma_f32_16x16x32_bf16 v[64:67], a[172:175], a[80:83], v[64:67]
s_add_u32 s36, s33, s35
v_mfma_f32_16x16x32_bf16 v[68:71], a[172:175], a[84:87], v[68:71]
s_and_b32 s36, s36, 3
buffer_load_dwordx4 a[0:3], v8, s[8:11], s20 offen offset:0 sc1
v_mfma_f32_16x16x32_bf16 v[72:75], a[172:175], a[88:91], v[72:75]
ds_read_b64_tr_b16 a[136:137], v146 offset:32768
s_and_b32 s33, s33, 28
v_mfma_f32_16x16x32_bf16 v[76:79], a[172:175], a[92:95], v[76:79]
ds_read_b64_tr_b16 a[138:139], v146 offset:36864
s_or_b32 s33, s33, s36
v_mfma_f32_16x16x32_bf16 v[80:83], a[176:179], a[80:83], v[80:83]
ds_read_b64_tr_b16 a[140:141], v147 offset:32768
s_lshl_b32 s37, s33, 2
v_mfma_f32_16x16x32_bf16 v[84:87], a[176:179], a[84:87], v[84:87]
s_add_u32 s37, s37, s26
s_add_u32 s21, s21, s24
buffer_load_dwordx4 v5, s[12:15], s21 offen offset:1024 lds
v_mfma_f32_16x16x32_bf16 v[88:91], a[176:179], a[88:91], v[88:91]
ds_read_b64_tr_b16 a[142:143], v147 offset:36864
s_mul_i32 s38, s37, 147
v_mfma_f32_16x16x32_bf16 v[92:95], a[176:179], a[92:95], v[92:95]
s_lshr_b32 s38, s38, 10
v_mfma_f32_16x16x32_bf16 v[96:99], a[180:183], a[80:83], v[96:99]
ds_read_b64_tr_b16 a[144:145], v148 offset:32768
s_mul_i32 s38, s38, 7
v_mfma_f32_16x16x32_bf16 v[100:103], a[180:183], a[84:87], v[100:103]
s_sub_u32 s37, s37, s38
buffer_load_dwordx4 a[4:7], v9, s[8:11], s20 offen offset:256 sc1
v_mfma_f32_16x16x32_bf16 v[104:107], a[180:183], a[88:91], v[104:107]
ds_read_b64_tr_b16 a[146:147], v148 offset:36864
s_cmp_eq_u32 s37, 3
s_cselect_b32 s16, s25, 0
v_mfma_f32_16x16x32_bf16 v[108:111], a[180:183], a[92:95], v[108:111]
ds_read_b64_tr_b16 a[148:149], v149 offset:32768
v_mfma_f32_16x16x32_bf16 v[112:115], a[184:187], a[80:83], v[112:115]
s_mul_i32 s37, s16, 3
v_mfma_f32_16x16x32_bf16 v[116:119], a[184:187], a[84:87], v[116:119]
s_sub_u32 s17, 0x8000, s37
s_add_u32 s21, s21, s24
buffer_load_dwordx4 v6, s[12:15], s21 offen offset:2048 lds
v_mfma_f32_16x16x32_bf16 v[120:123], a[184:187], a[88:91], v[120:123]
ds_read_b64_tr_b16 a[150:151], v149 offset:36864
v_mfma_f32_16x16x32_bf16 v[124:127], a[184:187], a[92:95], v[124:127]
ds_read_b64_tr_b16 a[152:153], v150 offset:32768
v_mfma_f32_16x16x32_bf16 v[128:131], a[188:191], a[80:83], v[128:131]
ds_read_b64_tr_b16 a[154:155], v150 offset:36864
v_mfma_f32_16x16x32_bf16 v[132:135], a[188:191], a[84:87], v[132:135]
buffer_load_dwordx4 a[8:11], v8, s[8:11], s20 offen offset:512 sc1
v_mfma_f32_16x16x32_bf16 v[136:139], a[188:191], a[88:91], v[136:139]
ds_read_b64_tr_b16 a[156:157], v151 offset:32768
v_mfma_f32_16x16x32_bf16 v[140:143], a[188:191], a[92:95], v[140:143]
s_waitcnt vmcnt(14) lgkmcnt(7)
v_mfma_f32_16x16x32_bf16 v[16:19], a[128:131], a[96:99], v[16:19]
ds_read_b64_tr_b16 a[158:159], v151 offset:36864
v_mfma_f32_16x16x32_bf16 v[20:23], a[128:131], a[100:103], v[20:23]
s_add_u32 s21, s21, s24
buffer_load_dwordx4 v7, s[12:15], s21 offen offset:3072 lds
v_mfma_f32_16x16x32_bf16 v[24:27], a[128:131], a[104:107], v[24:27]
ds_read_b64_tr_b16 a[160:161], v144 offset:49152
v_mfma_f32_16x16x32_bf16 v[28:31], a[128:131], a[108:111], v[28:31]
ds_read_b64_tr_b16 a[162:163], v144 offset:53248
v_mfma_f32_16x16x32_bf16 v[32:35], a[132:135], a[96:99], v[32:35]
v_mfma_f32_16x16x32_bf16 v[36:39], a[132:135], a[100:103], v[36:39]
buffer_load_dwordx4 a[12:15], v8, s[8:11], s20 offen offset:768 sc1
v_mfma_f32_16x16x32_bf16 v[40:43], a[132:135], a[104:107], v[40:43]
ds_read_b64_tr_b16 a[164:165], v145 offset:49152
v_mfma_f32_16x16x32_bf16 v[44:47], a[132:135], a[108:111], v[44:47]
ds_read_b64_tr_b16 a[166:167], v145 offset:53248
v_mfma_f32_16x16x32_bf16 v[48:51], a[136:139], a[96:99], v[48:51]
ds_read_b64_tr_b16 a[168:169], v146 offset:49152
s_add_u32 m0, s23, 102400
v_mfma_f32_16x16x32_bf16 v[52:55], a[136:139], a[100:103], v[52:55]
buffer_load_dwordx4 v4, s[12:15], s22 offen offset:0 lds
v_mfma_f32_16x16x32_bf16 v[56:59], a[136:139], a[104:107], v[56:59]
ds_read_b64_tr_b16 a[170:171], v146 offset:53248
v_mfma_f32_16x16x32_bf16 v[60:63], a[136:139], a[108:111], v[60:63]
v_mfma_f32_16x16x32_bf16 v[64:67], a[140:143], a[96:99], v[64:67]
ds_read_b64_tr_b16 a[172:173], v147 offset:49152
v_mfma_f32_16x16x32_bf16 v[68:71], a[140:143], a[100:103], v[68:71]
s_add_u32 s20, s20, 262144
buffer_load_dwordx4 a[16:19], v8, s[8:11], s20 offen offset:0 sc1
v_mfma_f32_16x16x32_bf16 v[72:75], a[140:143], a[104:107], v[72:75]
ds_read_b64_tr_b16 a[174:175], v147 offset:53248
v_mfma_f32_16x16x32_bf16 v[76:79], a[140:143], a[108:111], v[76:79]
ds_read_b64_tr_b16 a[176:177], v148 offset:49152
s_waitcnt lgkmcnt(9)
v_mfma_f32_16x16x32_bf16 v[80:83], a[144:147], a[96:99], v[80:83]
v_mfma_f32_16x16x32_bf16 v[84:87], a[144:147], a[100:103], v[84:87]
s_add_u32 s22, s22, s24
buffer_load_dwordx4 v5, s[12:15], s22 offen offset:1024 lds
v_mfma_f32_16x16x32_bf16 v[88:91], a[144:147], a[104:107], v[88:91]
ds_read_b64_tr_b16 a[178:179], v148 offset:53248
v_mfma_f32_16x16x32_bf16 v[92:95], a[144:147], a[108:111], v[92:95]
ds_read_b64_tr_b16 a[180:181], v149 offset:49152
v_mfma_f32_16x16x32_bf16 v[96:99], a[148:151], a[96:99], v[96:99]
ds_read_b64_tr_b16 a[182:183], v149 offset:53248
v_mfma_f32_16x16x32_bf16 v[100:103], a[148:151], a[100:103], v[100:103]
buffer_load_dwordx4 a[20:23], v9, s[8:11], s20 offen offset:256 sc1
v_mfma_f32_16x16x32_bf16 v[104:107], a[148:151], a[104:107], v[104:107]
ds_read_b64_tr_b16 a[184:185], v150 offset:49152
v_mfma_f32_16x16x32_bf16 v[108:111], a[148:151], a[108:111], v[108:111]
v_mfma_f32_16x16x32_bf16 v[112:115], a[152:155], a[96:99], v[112:115]
ds_read_b64_tr_b16 a[186:187], v150 offset:53248
v_mfma_f32_16x16x32_bf16 v[116:119], a[152:155], a[100:103], v[116:119]
s_add_u32 s22, s22, s24
buffer_load_dwordx4 v6, s[12:15], s22 offen offset:2048 lds
v_mfma_f32_16x16x32_bf16 v[120:123], a[152:155], a[104:107], v[120:123]
ds_read_b64_tr_b16 a[188:189], v151 offset:49152
v_mfma_f32_16x16x32_bf16 v[124:127], a[152:155], a[108:111], v[124:127]
ds_read_b64_tr_b16 a[190:191], v151 offset:53248
v_mfma_f32_16x16x32_bf16 v[128:131], a[156:159], a[96:99], v[128:131]
v_mfma_f32_16x16x32_bf16 v[132:135], a[156:159], a[100:103], v[132:135]
buffer_load_dwordx4 a[24:27], v8, s[8:11], s20 offen offset:512 sc1
v_mfma_f32_16x16x32_bf16 v[136:139], a[156:159], a[104:107], v[136:139]
v_mfma_f32_16x16x32_bf16 v[140:143], a[156:159], a[108:111], v[140:143]
s_waitcnt vmcnt(14) lgkmcnt(8)
v_mfma_f32_16x16x32_bf16 v[16:19], a[160:163], a[112:115], v[16:19]
v_mfma_f32_16x16x32_bf16 v[20:23], a[160:163], a[116:119], v[20:23]
s_add_u32 s22, s22, s24
buffer_load_dwordx4 v7, s[12:15], s22 offen offset:3072 lds
v_mfma_f32_16x16x32_bf16 v[24:27], a[160:163], a[120:123], v[24:27]
v_mfma_f32_16x16x32_bf16 v[28:31], a[160:163], a[124:127], v[28:31]
v_mfma_f32_16x16x32_bf16 v[32:35], a[164:167], a[112:115], v[32:35]
v_mfma_f32_16x16x32_bf16 v[36:39], a[164:167], a[116:119], v[36:39]
buffer_load_dwordx4 a[28:31], v8, s[8:11], s20 offen offset:768 sc1
v_mfma_f32_16x16x32_bf16 v[40:43], a[164:167], a[120:123], v[40:43]
s_waitcnt lgkmcnt(0)
s_barrier
s_lshl_b32 s20, s62, 19
s_mov_b32 s62, s33
v_mfma_f32_16x16x32_bf16 v[44:47], a[164:167], a[124:127], v[44:47]
ds_read_b64_tr_b16 a[128:129], v152 offset:0
s_lshl_b32 s21, s33, 18
s_mov_b32 s24, s16
v_mfma_f32_16x16x32_bf16 v[48:51], a[168:171], a[112:115], v[48:51]
ds_read_b64_tr_b16 a[130:131], v152 offset:4096
s_add_u32 s22, s21, s17
s_add_u32 m0, s23, 0
v_mfma_f32_16x16x32_bf16 v[52:55], a[168:171], a[116:119], v[52:55]
buffer_load_dwordx4 v4, s[12:15], s21 offen offset:0 lds
v_mfma_f32_16x16x32_bf16 v[56:59], a[168:171], a[120:123], v[56:59]
ds_read_b64_tr_b16 a[132:133], v153 offset:0
s_ff1_i32_b64 s33, s[60:61]
v_mfma_f32_16x16x32_bf16 v[60:63], a[168:171], a[124:127], v[60:63]
ds_read_b64_tr_b16 a[134:135], v153 offset:4096
s_bitset0_b64 s[60:61], s33
v_mfma_f32_16x16x32_bf16 v[64:67], a[172:175], a[112:115], v[64:67]
s_add_u32 s36, s33, s35
v_mfma_f32_16x16x32_bf16 v[68:71], a[172:175], a[116:119], v[68:71]
s_and_b32 s36, s36, 3
buffer_load_dwordx4 a[32:35], v8, s[8:11], s20 offen offset:0 sc1
v_mfma_f32_16x16x32_bf16 v[72:75], a[172:175], a[120:123], v[72:75]
ds_read_b64_tr_b16 a[136:137], v154 offset:0
s_and_b32 s33, s33, 28
v_mfma_f32_16x16x32_bf16 v[76:79], a[172:175], a[124:127], v[76:79]
ds_read_b64_tr_b16 a[138:139], v154 offset:4096
s_or_b32 s33, s33, s36
v_mfma_f32_16x16x32_bf16 v[80:83], a[176:179], a[112:115], v[80:83]
ds_read_b64_tr_b16 a[140:141], v155 offset:0
s_lshl_b32 s37, s33, 2
v_mfma_f32_16x16x32_bf16 v[84:87], a[176:179], a[116:119], v[84:87]
s_add_u32 s37, s37, s26
s_add_u32 s21, s21, s24
buffer_load_dwordx4 v5, s[12:15], s21 offen offset:1024 lds
v_mfma_f32_16x16x32_bf16 v[88:91], a[176:179], a[120:123], v[88:91]
ds_read_b64_tr_b16 a[142:143], v155 offset:4096
s_mul_i32 s38, s37, 147
v_mfma_f32_16x16x32_bf16 v[92:95], a[176:179], a[124:127], v[92:95]
s_lshr_b32 s38, s38, 10
v_mfma_f32_16x16x32_bf16 v[96:99], a[180:183], a[112:115], v[96:99]
ds_read_b64_tr_b16 a[144:145], v156 offset:0
s_mul_i32 s38, s38, 7
v_mfma_f32_16x16x32_bf16 v[100:103], a[180:183], a[116:119], v[100:103]
s_sub_u32 s37, s37, s38
buffer_load_dwordx4 a[36:39], v9, s[8:11], s20 offen offset:256 sc1
v_mfma_f32_16x16x32_bf16 v[104:107], a[180:183], a[120:123], v[104:107]
ds_read_b64_tr_b16 a[146:147], v156 offset:4096
s_cmp_eq_u32 s37, 3
s_cselect_b32 s16, s25, 0
v_mfma_f32_16x16x32_bf16 v[108:111], a[180:183], a[124:127], v[108:111]
ds_read_b64_tr_b16 a[148:149], v157 offset:0
v_mfma_f32_16x16x32_bf16 v[112:115], a[184:187], a[112:115], v[112:115]
s_mul_i32 s37, s16, 3
v_mfma_f32_16x16x32_bf16 v[116:119], a[184:187], a[116:119], v[116:119]
s_sub_u32 s17, 0x8000, s37
s_add_u32 s21, s21, s24
buffer_load_dwordx4 v6, s[12:15], s21 offen offset:2048 lds
v_mfma_f32_16x16x32_bf16 v[120:123], a[184:187], a[120:123], v[120:123]
ds_read_b64_tr_b16 a[150:151], v157 offset:4096
v_mfma_f32_16x16x32_bf16 v[124:127], a[184:187], a[124:127], v[124:127]
ds_read_b64_tr_b16 a[152:153], v158 offset:0
v_mfma_f32_16x16x32_bf16 v[128:131], a[188:191], a[112:115], v[128:131]
ds_read_b64_tr_b16 a[154:155], v158 offset:4096
v_mfma_f32_16x16x32_bf16 v[132:135], a[188:191], a[116:119], v[132:135]
buffer_load_dwordx4 a[40:43], v8, s[8:11], s20 offen offset:512 sc1
v_mfma_f32_16x16x32_bf16 v[136:139], a[188:191], a[120:123], v[136:139]
ds_read_b64_tr_b16 a[156:157], v159 offset:0
v_mfma_f32_16x16x32_bf16 v[140:143], a[188:191], a[124:127], v[140:143]
s_waitcnt vmcnt(14) lgkmcnt(7)
v_mfma_f32_16x16x32_bf16 v[16:19], a[128:131], a[0:3], v[16:19]
ds_read_b64_tr_b16 a[158:159], v159 offset:4096
v_mfma_f32_16x16x32_bf16 v[20:23], a[128:131], a[4:7], v[20:23]
s_add_u32 s21, s21, s24
buffer_load_dwordx4 v7, s[12:15], s21 offen offset:3072 lds
v_mfma_f32_16x16x32_bf16 v[24:27], a[128:131], a[8:11], v[24:27]
ds_read_b64_tr_b16 a[160:161], v152 offset:16384
s_cmp_eq_u32 s34, 1
s_cbranch_scc1 L_o1
L_o1_ret:
v_mfma_f32_16x16x32_bf16 v[28:31], a[128:131], a[12:15], v[28:31]
ds_read_b64_tr_b16 a[162:163], v152 offset:20480
v_mfma_f32_16x16x32_bf16 v[32:35], a[132:135], a[0:3], v[32:35]
v_mfma_f32_16x16x32_bf16 v[36:39], a[132:135], a[4:7], v[36:39]
buffer_load_dwordx4 a[44:47], v8, s[8:11], s20 offen offset:768 sc1
v_mfma_f32_16x16x32_bf16 v[40:43], a[132:135], a[8:11], v[40:43]
ds_read_b64_tr_b16 a[164:165], v153 offset:16384
v_mfma_f32_16x16x32_bf16 v[44:47], a[132:135], a[12:15], v[44:47]
ds_read_b64_tr_b16 a[166:167], v153 offset:20480
v_mfma_f32_16x16x32_bf16 v[48:51], a[136:139], a[0:3], v[48:51]
ds_read_b64_tr_b16 a[168:169], v154 offset:16384
s_add_u32 m0, s23, 4096
v_mfma_f32_16x16x32_bf16 v[52:55], a[136:139], a[4:7], v[52:55]
buffer_load_dwordx4 v4, s[12:15], s22 offen offset:0 lds
v_mfma_f32_16x16x32_bf16 v[56:59], a[136:139], a[8:11], v[56:59]
ds_read_b64_tr_b16 a[170:171], v154 offset:20480
v_mfma_f32_16x16x32_bf16 v[60:63], a[136:139], a[12:15], v[60:63]
v_mfma_f32_16x16x32_bf16 v[64:67], a[140:143], a[0:3], v[64:67]
ds_read_b64_tr_b16 a[172:173], v155 offset:16384
v_mfma_f32_16x16x32_bf16 v[68:71], a[140:143], a[4:7], v[68:71]
s_add_u32 s20, s20, 262144
buffer_load_dwordx4 a[48:51], v8, s[8:11], s20 offen offset:0 sc1
v_mfma_f32_16x16x32_bf16 v[72:75], a[140:143], a[8:11], v[72:75]
ds_read_b64_tr_b16 a[174:175], v155 offset:20480
v_mfma_f32_16x16x32_bf16 v[76:79], a[140:143], a[12:15], v[76:79]
ds_read_b64_tr_b16 a[176:177], v156 offset:16384
s_waitcnt lgkmcnt(9)
v_mfma_f32_16x16x32_bf16 v[80:83], a[144:147], a[0:3], v[80:83]
v_mfma_f32_16x16x32_bf16 v[84:87], a[144:147], a[4:7], v[84:87]
s_add_u32 s22, s22, s24
buffer_load_dwordx4 v5, s[12:15], s22 offen offset:1024 lds
v_mfma_f32_16x16x32_bf16 v[88:91], a[144:147], a[8:11], v[88:91]
ds_read_b64_tr_b16 a[178:179], v156 offset:20480
v_mfma_f32_16x16x32_bf16 v[92:95], a[144:147], a[12:15], v[92:95]
ds_read_b64_tr_b16 a[180:181], v157 offset:16384
v_mfma_f32_16x16x32_bf16 v[96:99], a[148:151], a[0:3], v[96:99]
ds_read_b64_tr_b16 a[182:183], v157 offset:20480
v_mfma_f32_16x16x32_bf16 v[100:103], a[148:151], a[4:7], v[100:103]
buffer_load_dwordx4 a[52:55], v9, s[8:11], s20 offen offset:256 sc1
v_mfma_f32_16x16x32_bf16 v[104:107], a[148:151], a[8:11], v[104:107]
ds_read_b64_tr_b16 a[184:185], v158 offset:16384
v_mfma_f32_16x16x32_bf16 v[108:111], a[148:151], a[12:15], v[108:111]
v_mfma_f32_16x16x32_bf16 v[112:115], a[152:155], a[0:3], v[112:115]
ds_read_b64_tr_b16 a[186:187], v158 offset:20480
v_mfma_f32_16x16x32_bf16 v[116:119], a[152:155], a[4:7], v[116:119]
s_add_u32 s22, s22, s24
buffer_load_dwordx4 v6, s[12:15], s22 offen offset:2048 lds
v_mfma_f32_16x16x32_bf16 v[120:123], a[152:155], a[8:11], v[120:123]
ds_read_b64_tr_b16 a[188:189], v159 offset:16384
v_mfma_f32_16x16x32_bf16 v[124:127], a[152:155], a[12:15], v[124:127]
ds_read_b64_tr_b16 a[190:191], v159 offset:20480
v_mfma_f32_16x16x32_bf16 v[128:131], a[156:159], a[0:3], v[128:131]
v_mfma_f32_16x16x32_bf16 v[132:135], a[156:159], a[4:7], v[132:135]
buffer_load_dwordx4 a[56:59], v8, s[8:11], s20 offen offset:512 sc1
v_mfma_f32_16x16x32_bf16 v[136:139], a[156:159], a[8:11], v[136:139]
v_mfma_f32_16x16x32_bf16 v[140:143], a[156:159], a[12:15], v[140:143]
s_waitcnt vmcnt(14) lgkmcnt(8)
v_mfma_f32_16x16x32_bf16 v[16:19], a[160:163], a[16:19], v[16:19]
v_mfma_f32_16x16x32_bf16 v[20:23], a[160:163], a[20:23], v[20:23]
s_add_u32 s22, s22, s24
buffer_load_dwordx4 v7, s[12:15], s22 offen offset:3072 lds
v_mfma_f32_16x16x32_bf16 v[24:27], a[160:163], a[24:27], v[24:27]
v_mfma_f32_16x16x32_bf16 v[28:31], a[160:163], a[28:31], v[28:31]
v_mfma_f32_16x16x32_bf16 v[32:35], a[164:167], a[16:19], v[32:35]
v_mfma_f32_16x16x32_bf16 v[36:39], a[164:167], a[20:23], v[36:39]
buffer_load_dwordx4 a[60:63], v8, s[8:11], s20 offen offset:768 sc1
v_mfma_f32_16x16x32_bf16 v[40:43], a[164:167], a[24:27], v[40:43]
s_waitcnt lgkmcnt(0)
s_barrier
s_lshl_b32 s20, s62, 19
s_mov_b32 s62, s33
v_mfma_f32_16x16x32_bf16 v[44:47], a[164:167], a[28:31], v[44:47]
ds_read_b64_tr_b16 a[128:129], v152 offset:32768
s_lshl_b32 s21, s33, 18
s_mov_b32 s24, s16
v_mfma_f32_16x16x32_bf16 v[48:51], a[168:171], a[16:19], v[48:51]
ds_read_b64_tr_b16 a[130:131], v152 offset:36864
s_add_u32 s22, s21, s17
s_add_u32 m0, s23, 32768
v_mfma_f32_16x16x32_bf16 v[52:55], a[168:171], a[20:23], v[52:55]
buffer_load_dwordx4 v4, s[12:15], s21 offen offset:0 lds
v_mfma_f32_16x16x32_bf16 v[56:59], a[168:171], a[24:27], v[56:59]
ds_read_b64_tr_b16 a[132:133], v153 offset:32768
s_ff1_i32_b64 s33, s[60:61]
v_mfma_f32_16x16x32_bf16 v[60:63], a[168:171], a[28:31], v[60:63]
ds_read_b64_tr_b16 a[134:135], v153 offset:36864
s_bitset0_b64 s[60:61], s33
v_mfma_f32_16x16x32_bf16 v[64:67], a[172:175], a[16:19], v[64:67]
s_add_u32 s36, s33, s35
v_mfma_f32_16x16x32_bf16 v[68:71], a[172:175], a[20:23], v[68:71]
s_and_b32 s36, s36, 3
buffer_load_dwordx4 a[64:67], v8, s[8:11], s20 offen offset:0 sc1
v_mfma_f32_16x16x32_bf16 v[72:75], a[172:175], a[24:27], v[72:75]
ds_read_b64_tr_b16 a[136:137], v154 offset:32768
s_and_b32 s33, s33, 28
v_mfma_f32_16x16x32_bf16 v[76:79], a[172:175], a[28:31], v[76:79]
ds_read_b64_tr_b16 a[138:139], v154 offset:36864
s_or_b32 s33, s33, s36
v_mfma_f32_16x16x32_bf16 v[80:83], a[176:179], a[16:19], v[80:83]
ds_read_b64_tr_b16 a[140:141], v155 offset:32768
s_lshl_b32 s37, s33, 2
v_mfma_f32_16x16x32_bf16 v[84:87], a[176:179], a[20:23], v[84:87]
s_add_u32 s37, s37, s26
s_add_u32 s21, s21, s24
buffer_load_dwordx4 v5, s[12:15], s21 offen offset:1024 lds
v_mfma_f32_16x16x32_bf16 v[88:91], a[176:179], a[24:27], v[88:91]
ds_read_b64_tr_b16 a[142:143], v155 offset:36864
s_mul_i32 s38, s37, 147
v_mfma_f32_16x16x32_bf16 v[92:95], a[176:179], a[28:31], v[92:95]
s_lshr_b32 s38, s38, 10
v_mfma_f32_16x16x32_bf16 v[96:99], a[180:183], a[16:19], v[96:99]
ds_read_b64_tr_b16 a[144:145], v156 offset:32768
s_mul_i32 s38, s38, 7
v_mfma_f32_16x16x32_bf16 v[100:103], a[180:183], a[20:23], v[100:103]
s_sub_u32 s37, s37, s38
buffer_load_dwordx4 a[68:71], v9, s[8:11], s20 offen offset:256 sc1
v_mfma_f32_16x16x32_bf16 v[104:107], a[180:183], a[24:27], v[104:107]
ds_read_b64_tr_b16 a[146:147], v156 offset:36864
s_cmp_eq_u32 s37, 3
s_cselect_b32 s16, s25, 0
v_mfma_f32_16x16x32_bf16 v[108:111], a[180:183], a[28:31], v[108:111]
ds_read_b64_tr_b16 a[148:149], v157 offset:32768
v_mfma_f32_16x16x32_bf16 v[112:115], a[184:187], a[16:19], v[112:115]
s_mul_i32 s37, s16, 3
v_mfma_f32_16x16x32_bf16 v[116:119], a[184:187], a[20:23], v[116:119]
s_sub_u32 s17, 0x8000, s37
s_add_u32 s21, s21, s24
buffer_load_dwordx4 v6, s[12:15], s21 offen offset:2048 lds
v_mfma_f32_16x16x32_bf16 v[120:123], a[184:187], a[24:27], v[120:123]
ds_read_b64_tr_b16 a[150:151], v157 offset:36864
v_mfma_f32_16x16x32_bf16 v[124:127], a[184:187], a[28:31], v[124:127]
ds_read_b64_tr_b16 a[152:153], v158 offset:32768
v_mfma_f32_16x16x32_bf16 v[128:131], a[188:191], a[16:19], v[128:131]
ds_read_b64_tr_b16 a[154:155], v158 offset:36864
v_mfma_f32_16x16x32_bf16 v[132:135], a[188:191], a[20:23], v[132:135]
buffer_load_dwordx4 a[72:75], v8, s[8:11], s20 offen offset:512 sc1
v_mfma_f32_16x16x32_bf16 v[136:139], a[188:191], a[24:27], v[136:139]
ds_read_b64_tr_b16 a[156:157], v159 offset:32768
v_mfma_f32_16x16x32_bf16 v[140:143], a[188:191], a[28:31], v[140:143]
s_waitcnt vmcnt(14) lgkmcnt(7)
v_mfma_f32_16x16x32_bf16 v[16:19], a[128:131], a[32:35], v[16:19]
ds_read_b64_tr_b16 a[158:159], v159 offset:36864
v_mfma_f32_16x16x32_bf16 v[20:23], a[128:131], a[36:39], v[20:23]
s_add_u32 s21, s21, s24
buffer_load_dwordx4 v7, s[12:15], s21 offen offset:3072 lds
v_mfma_f32_16x16x32_bf16 v[24:27], a[128:131], a[40:43], v[24:27]
ds_read_b64_tr_b16 a[160:161], v152 offset:49152
v_mfma_f32_16x16x32_bf16 v[28:31], a[128:131], a[44:47], v[28:31]
ds_read_b64_tr_b16 a[162:163], v152 offset:53248
v_mfma_f32_16x16x32_bf16 v[32:35], a[132:135], a[32:35], v[32:35]
v_mfma_f32_16x16x32_bf16 v[36:39], a[132:135], a[36:39], v[36:39]
buffer_load_dwordx4 a[76:79], v8, s[8:11], s20 offen offset:768 sc1
v_mfma_f32_16x16x32_bf16 v[40:43], a[132:135], a[40:43], v[40:43]
ds_read_b64_tr_b16 a[164:165], v153 offset:49152
v_mfma_f32_16x16x32_bf16 v[44:47], a[132:135], a[44:47], v[44:47]
ds_read_b64_tr_b16 a[166:167], v153 offset:53248
v_mfma_f32_16x16x32_bf16 v[48:51], a[136:139], a[32:35], v[48:51]
ds_read_b64_tr_b16 a[168:169], v154 offset:49152
s_add_u32 m0, s23, 36864
v_mfma_f32_16x16x32_bf16 v[52:55], a[136:139], a[36:39], v[52:55]
buffer_load_dwordx4 v4, s[12:15], s22 offen offset:0 lds
v_mfma_f32_16x16x32_bf16 v[56:59], a[136:139], a[40:43], v[56:59]
ds_read_b64_tr_b16 a[170:171], v154 offset:53248
v_mfma_f32_16x16x32_bf16 v[60:63], a[136:139], a[44:47], v[60:63]
v_mfma_f32_16x16x32_bf16 v[64:67], a[140:143], a[32:35], v[64:67]
ds_read_b64_tr_b16 a[172:173], v155 offset:49152
v_mfma_f32_16x16x32_bf16 v[68:71], a[140:143], a[36:39], v[68:71]
s_add_u32 s20, s20, 262144
buffer_load_dwordx4 a[80:83], v8, s[8:11], s20 offen offset:0 sc1
v_mfma_f32_16x16x32_bf16 v[72:75], a[140:143], a[40:43], v[72:75]
ds_read_b64_tr_b16 a[174:175], v155 offset:53248
v_mfma_f32_16x16x32_bf16 v[76:79], a[140:143], a[44:47], v[76:79]
ds_read_b64_tr_b16 a[176:177], v156 offset:49152
s_waitcnt lgkmcnt(9)
v_mfma_f32_16x16x32_bf16 v[80:83], a[144:147], a[32:35], v[80:83]
v_mfma_f32_16x16x32_bf16 v[84:87], a[144:147], a[36:39], v[84:87]
s_add_u32 s22, s22, s24
buffer_load_dwordx4 v5, s[12:15], s22 offen offset:1024 lds
v_mfma_f32_16x16x32_bf16 v[88:91], a[144:147], a[40:43], v[88:91]
ds_read_b64_tr_b16 a[178:179], v156 offset:53248
v_mfma_f32_16x16x32_bf16 v[92:95], a[144:147], a[44:47], v[92:95]
ds_read_b64_tr_b16 a[180:181], v157 offset:49152
v_mfma_f32_16x16x32_bf16 v[96:99], a[148:151], a[32:35], v[96:99]
ds_read_b64_tr_b16 a[182:183], v157 offset:53248
v_mfma_f32_16x16x32_bf16 v[100:103], a[148:151], a[36:39], v[100:103]
buffer_load_dwordx4 a[84:87], v9, s[8:11], s20 offen offset:256 sc1
v_mfma_f32_16x16x32_bf16 v[104:107], a[148:151], a[40:43], v[104:107]
ds_read_b64_tr_b16 a[184:185], v158 offset:49152
v_mfma_f32_16x16x32_bf16 v[108:111], a[148:151], a[44:47], v[108:111]
v_mfma_f32_16x16x32_bf16 v[112:115], a[152:155], a[32:35], v[112:115]
ds_read_b64_tr_b16 a[186:187], v158 offset:53248
v_mfma_f32_16x16x32_bf16 v[116:119], a[152:155], a[36:39], v[116:119]
s_add_u32 s22, s22, s24
buffer_load_dwordx4 v6, s[12:15], s22 offen offset:2048 lds
v_mfma_f32_16x16x32_bf16 v[120:123], a[152:155], a[40:43], v[120:123]
ds_read_b64_tr_b16 a[188:189], v159 offset:49152
v_mfma_f32_16x16x32_bf16 v[124:127], a[152:155], a[44:47], v[124:127]
ds_read_b64_tr_b16 a[190:191], v159 offset:53248
v_mfma_f32_16x16x32_bf16 v[128:131], a[156:159], a[32:35], v[128:131]
v_mfma_f32_16x16x32_bf16 v[132:135], a[156:159], a[36:39], v[132:135]
buffer_load_dwordx4 a[88:91], v8, s[8:11], s20 offen offset:512 sc1
v_mfma_f32_16x16x32_bf16 v[136:139], a[156:159], a[40:43], v[136:139]
v_mfma_f32_16x16x32_bf16 v[140:143], a[156:159], a[44:47], v[140:143]
s_waitcnt vmcnt(14) lgkmcnt(8)
v_mfma_f32_16x16x32_bf16 v[16:19], a[160:163], a[48:51], v[16:19]
v_mfma_f32_16x16x32_bf16 v[20:23], a[160:163], a[52:55], v[20:23]
s_add_u32 s22, s22, s24
buffer_load_dwordx4 v7, s[12:15], s22 offen offset:3072 lds
v_mfma_f32_16x16x32_bf16 v[24:27], a[160:163], a[56:59], v[24:27]
v_mfma_f32_16x16x32_bf16 v[28:31], a[160:163], a[60:63], v[28:31]
v_mfma_f32_16x16x32_bf16 v[32:35], a[164:167], a[48:51], v[32:35]
v_mfma_f32_16x16x32_bf16 v[36:39], a[164:167], a[52:55], v[36:39]
buffer_load_dwordx4 a[92:95], v8, s[8:11], s20 offen offset:768 sc1
v_mfma_f32_16x16x32_bf16 v[40:43], a[164:167], a[56:59], v[40:43]
s_waitcnt lgkmcnt(0)
s_barrier
s_lshl_b32 s20, s62, 19
s_mov_b32 s62, s33
v_mfma_f32_16x16x32_bf16 v[44:47], a[164:167], a[60:63], v[44:47]
ds_read_b64_tr_b16 a[128:129], v144 offset:0
s_lshl_b32 s21, s33, 18
s_mov_b32 s24, s16
v_mfma_f32_16x16x32_bf16 v[48:51], a[168:171], a[48:51], v[48:51]
ds_read_b64_tr_b16 a[130:131], v144 offset:4096
s_add_u32 s22, s21, s17
s_add_u32 m0, s23, 65536
v_mfma_f32_16x16x32_bf16 v[52:55], a[168:171], a[52:55], v[52:55]
buffer_load_dwordx4 v4, s[12:15], s21 offen offset:0 lds
v_mfma_f32_16x16x32_bf16 v[56:59], a[168:171], a[56:59], v[56:59]
ds_read_b64_tr_b16 a[132:133], v145 offset:0
s_ff1_i32_b64 s33, s[60:61]
v_mfma_f32_16x16x32_bf16 v[60:63], a[168:171], a[60:63], v[60:63]
ds_read_b64_tr_b16 a[134:135], v145 offset:4096
s_bitset0_b64 s[60:61], s33
v_mfma_f32_16x16x32_bf16 v[64:67], a[172:175], a[48:51], v[64:67]
s_add_u32 s36, s33, s35
v_mfma_f32_16x16x32_bf16 v[68:71], a[172:175], a[52:55], v[68:71]
s_and_b32 s36, s36, 3
buffer_load_dwordx4 a[96:99], v8, s[8:11], s20 offen offset:0 sc1
v_mfma_f32_16x16x32_bf16 v[72:75], a[172:175], a[56:59], v[72:75]
ds_read_b64_tr_b16 a[136:137], v146 offset:0
s_and_b32 s33, s33, 28
v_mfma_f32_16x16x32_bf16 v[76:79], a[172:175], a[60:63], v[76:79]
ds_read_b64_tr_b16 a[138:139], v146 offset:4096
s_or_b32 s33, s33, s36
v_mfma_f32_16x16x32_bf16 v[80:83], a[176:179], a[48:51], v[80:83]
ds_read_b64_tr_b16 a[140:141], v147 offset:0
s_lshl_b32 s37, s33, 2
v_mfma_f32_16x16x32_bf16 v[84:87], a[176:179], a[52:55], v[84:87]
s_add_u32 s37, s37, s26
s_add_u32 s21, s21, s24
buffer_load_dwordx4 v5, s[12:15], s21 offen offset:1024 lds
v_mfma_f32_16x16x32_bf16 v[88:91], a[176:179], a[56:59], v[88:91]
ds_read_b64_tr_b16 a[142:143], v147 offset:4096
s_mul_i32 s38, s37, 147
v_mfma_f32_16x16x32_bf16 v[92:95], a[176:179], a[60:63], v[92:95]
s_lshr_b32 s38, s38, 10
v_mfma_f32_16x16x32_bf16 v[96:99], a[180:183], a[48:51], v[96:99]
ds_read_b64_tr_b16 a[144:145], v148 offset:0
s_mul_i32 s38, s38, 7
v_mfma_f32_16x16x32_bf16 v[100:103], a[180:183], a[52:55], v[100:103]
s_sub_u32 s37, s37, s38
buffer_load_dwordx4 a[100:103], v9, s[8:11], s20 offen offset:256 sc1
v_mfma_f32_16x16x32_bf16 v[104:107], a[180:183], a[56:59], v[104:107]
ds_read_b64_tr_b16 a[146:147], v148 offset:4096
s_cmp_eq_u32 s37, 3
s_cselect_b32 s16, s25, 0
v_mfma_f32_16x16x32_bf16 v[108:111], a[180:183], a[60:63], v[108:111]
ds_read_b64_tr_b16 a[148:149], v149 offset:0
v_mfma_f32_16x16x32_bf16 v[112:115], a[184:187], a[48:51], v[112:115]
s_mul_i32 s37, s16, 3
v_mfma_f32_16x16x32_bf16 v[116:119], a[184:187], a[52:55], v[116:119]
s_sub_u32 s17, 0x8000, s37
s_add_u32 s21, s21, s24
buffer_load_dwordx4 v6, s[12:15], s21 offen offset:2048 lds
v_mfma_f32_16x16x32_bf16 v[120:123], a[184:187], a[56:59], v[120:123]
ds_read_b64_tr_b16 a[150:151], v149 offset:4096
v_mfma_f32_16x16x32_bf16 v[124:127], a[184:187], a[60:63], v[124:127]
ds_read_b64_tr_b16 a[152:153], v150 offset:0
v_mfma_f32_16x16x32_bf16 v[128:131], a[188:191], a[48:51], v[128:131]
ds_read_b64_tr_b16 a[154:155], v150 offset:4096
v_mfma_f32_16x16x32_bf16 v[132:135], a[188:191], a[52:55], v[132:135]
buffer_load_dwordx4 a[104:107], v8, s[8:11], s20 offen offset:512 sc1
v_mfma_f32_16x16x32_bf16 v[136:139], a[188:191], a[56:59], v[136:139]
ds_read_b64_tr_b16 a[156:157], v151 offset:0
v_mfma_f32_16x16x32_bf16 v[140:143], a[188:191], a[60:63], v[140:143]
s_add_u32 s34, s34, 1
s_cmp_lg_u32 s34, s32
s_cbranch_scc1 L_p3loop
s_waitcnt vmcnt(14) lgkmcnt(7)
v_mfma_f32_16x16x32_bf16 v[16:19], a[128:131], a[64:67], v[16:19]
ds_read_b64_tr_b16 a[158:159], v151 offset:4096
v_mfma_f32_16x16x32_bf16 v[20:23], a[128:131], a[68:71], v[20:23]
s_add_u32 s21, s21, s24
buffer_load_dwordx4 v7, s[12:15], s21 offen offset:3072 lds
v_mfma_f32_16x16x32_bf16 v[24:27], a[128:131], a[72:75], v[24:27]
ds_read_b64_tr_b16 a[160:161], v144 offset:16384
v_mfma_f32_16x16x32_bf16 v[28:31], a[128:131], a[76:79], v[28:31]
ds_read_b64_tr_b16 a[162:163], v144 offset:20480
v_mfma_f32_16x16x32_bf16 v[32:35], a[132:135], a[64:67], v[32:35]
v_mfma_f32_16x16x32_bf16 v[36:39], a[132:135], a[68:71], v[36:39]
buffer_load_dwordx4 a[108:111], v8, s[8:11], s20 offen offset:768 sc1
v_mfma_f32_16x16x32_bf16 v[40:43], a[132:135], a[72:75], v[40:43]
ds_read_b64_tr_b16 a[164:165], v145 offset:16384
v_mfma_f32_16x16x32_bf16 v[44:47], a[132:135], a[76:79], v[44:47]
ds_read_b64_tr_b16 a[166:167], v145 offset:20480
v_mfma_f32_16x16x32_bf16 v[48:51], a[136:139], a[64:67], v[48:51]
ds_read_b64_tr_b16 a[168:169], v146 offset:16384
s_add_u32 m0, s23, 69632
v_mfma_f32_16x16x32_bf16 v[52:55], a[136:139], a[68:71], v[52:55]
buffer_load_dwordx4 v4, s[12:15], s22 offen offset:0 lds
v_mfma_f32_16x16x32_bf16 v[56:59], a[136:139], a[72:75], v[56:59]
ds_read_b64_tr_b16 a[170:171], v146 offset:20480
v_mfma_f32_16x16x32_bf16 v[60:63], a[136:139], a[76:79], v[60:63]
v_mfma_f32_16x16x32_bf16 v[64:67], a[140:143], a[64:67], v[64:67]
ds_read_b64_tr_b16 a[172:173], v147 offset:16384
v_mfma_f32_16x16x32_bf16 v[68:71], a[140:143], a[68:71], v[68:71]
s_add_u32 s20, s20, 262144
buffer_load_dwordx4 a[112:115], v8, s[8:11], s20 offen offset:0 sc1
v_mfma_f32_16x16x32_bf16 v[72:75], a[140:143], a[72:75], v[72:75]
ds_read_b64_tr_b16 a[174:175], v147 offset:20480
v_mfma_f32_16x16x32_bf16 v[76:79], a[140:143], a[76:79], v[76:79]
ds_read_b64_tr_b16 a[176:177], v148 offset:16384
s_waitcnt lgkmcnt(9)
v_mfma_f32_16x16x32_bf16 v[80:83], a[144:147], a[64:67], v[80:83]
v_mfma_f32_16x16x32_bf16 v[84:87], a[144:147], a[68:71], v[84:87]
s_add_u32 s22, s22, s24
buffer_load_dwordx4 v5, s[12:15], s22 offen offset:1024 lds
v_mfma_f32_16x16x32_bf16 v[88:91], a[144:147], a[72:75], v[88:91]
ds_read_b64_tr_b16 a[178:179], v148 offset:20480
v_mfma_f32_16x16x32_bf16 v[92:95], a[144:147], a[76:79], v[92:95]
ds_read_b64_tr_b16 a[180:181], v149 offset:16384
v_mfma_f32_16x16x32_bf16 v[96:99], a[148:151], a[64:67], v[96:99]
ds_read_b64_tr_b16 a[182:183], v149 offset:20480
v_mfma_f32_16x16x32_bf16 v[100:103], a[148:151], a[68:71], v[100:103]
buffer_load_dwordx4 a[116:119], v9, s[8:11], s20 offen offset:256 sc1
v_mfma_f32_16x16x32_bf16 v[104:107], a[148:151], a[72:75], v[104:107]
ds_read_b64_tr_b16 a[184:185], v150 offset:16384
v_mfma_f32_16x16x32_bf16 v[108:111], a[148:151], a[76:79], v[108:111]
v_mfma_f32_16x16x32_bf16 v[112:115], a[152:155], a[64:67], v[112:115]
ds_read_b64_tr_b16 a[186:187], v150 offset:20480
v_mfma_f32_16x16x32_bf16 v[116:119], a[152:155], a[68:71], v[116:119]
s_add_u32 s22, s22, s24
buffer_load_dwordx4 v6, s[12:15], s22 offen offset:2048 lds
v_mfma_f32_16x16x32_bf16 v[120:123], a[152:155], a[72:75], v[120:123]
ds_read_b64_tr_b16 a[188:189], v151 offset:16384
v_mfma_f32_16x16x32_bf16 v[124:127], a[152:155], a[76:79], v[124:127]
ds_read_b64_tr_b16 a[190:191], v151 offset:20480
v_mfma_f32_16x16x32_bf16 v[128:131], a[156:159], a[64:67], v[128:131]
v_mfma_f32_16x16x32_bf16 v[132:135], a[156:159], a[68:71], v[132:135]
buffer_load_dwordx4 a[120:123], v8, s[8:11], s20 offen offset:512 sc1
v_mfma_f32_16x16x32_bf16 v[136:139], a[156:159], a[72:75], v[136:139]
v_mfma_f32_16x16x32_bf16 v[140:143], a[156:159], a[76:79], v[140:143]
s_waitcnt vmcnt(14) lgkmcnt(8)
v_mfma_f32_16x16x32_bf16 v[16:19], a[160:163], a[80:83], v[16:19]
v_mfma_f32_16x16x32_bf16 v[20:23], a[160:163], a[84:87], v[20:23]
s_add_u32 s22, s22, s24
buffer_load_dwordx4 v7, s[12:15], s22 offen offset:3072 lds
v_mfma_f32_16x16x32_bf16 v[24:27], a[160:163], a[88:91], v[24:27]
v_mfma_f32_16x16x32_bf16 v[28:31], a[160:163], a[92:95], v[28:31]
v_mfma_f32_16x16x32_bf16 v[32:35], a[164:167], a[80:83], v[32:35]
v_mfma_f32_16x16x32_bf16 v[36:39], a[164:167], a[84:87], v[36:39]
buffer_load_dwordx4 a[124:127], v8, s[8:11], s20 offen offset:768 sc1
v_mfma_f32_16x16x32_bf16 v[40:43], a[164:167], a[88:91], v[40:43]
s_waitcnt lgkmcnt(0)
s_barrier
s_lshl_b32 s20, s62, 19
s_mov_b32 s62, s33
v_mfma_f32_16x16x32_bf16 v[44:47], a[164:167], a[92:95], v[44:47]
ds_read_b64_tr_b16 a[128:129], v144 offset:32768
s_lshl_b32 s21, s33, 18
s_mov_b32 s24, s16
v_mfma_f32_16x16x32_bf16 v[48:51], a[168:171], a[80:83], v[48:51]
ds_read_b64_tr_b16 a[130:131], v144 offset:36864
s_add_u32 s22, s21, s17
s_add_u32 m0, s23, 98304
v_mfma_f32_16x16x32_bf16 v[52:55], a[168:171], a[84:87], v[52:55]
buffer_load_dwordx4 v4, s[12:15], s21 offen offset:0 lds
v_mfma_f32_16x16x32_bf16 v[56:59], a[168:171], a[88:91], v[56:59]
ds_read_b64_tr_b16 a[132:133], v145 offset:32768
s_ff1_i32_b64 s33, s[60:61]
v_mfma_f32_16x16x32_bf16 v[60:63], a[168:171], a[92:95], v[60:63]
ds_read_b64_tr_b16 a[134:135], v145 offset:36864
s_bitset0_b64 s[60:61], s33
v_mfma_f32_16x16x32_bf16 v[64:67], a[172:175], a[80:83], v[64:67]
s_add_u32 s36, s33, s35
v_mfma_f32_16x16x32_bf16 v[68:71], a[172:175], a[84:87], v[68:71]
s_and_b32 s36, s36, 3
buffer_load_dwordx4 a[0:3], v8, s[8:11], s20 offen offset:0 sc1
v_mfma_f32_16x16x32_bf16 v[72:75], a[172:175], a[88:91], v[72:75]
ds_read_b64_tr_b16 a[136:137], v146 offset:32768
s_and_b32 s33, s33, 28
v_mfma_f32_16x16x32_bf16 v[76:79], a[172:175], a[92:95], v[76:79]
ds_read_b64_tr_b16 a[138:139], v146 offset:36864
s_or_b32 s33, s33, s36
v_mfma_f32_16x16x32_bf16 v[80:83], a[176:179], a[80:83], v[80:83]
ds_read_b64_tr_b16 a[140:141], v147 offset:32768
s_lshl_b32 s37, s33, 2
v_mfma_f32_16x16x32_bf16 v[84:87], a[176:179], a[84:87], v[84:87]
s_add_u32 s37, s37, s26
s_add_u32 s21, s21, s24
buffer_load_dwordx4 v5, s[12:15], s21 offen offset:1024 lds
v_mfma_f32_16x16x32_bf16 v[88:91], a[176:179], a[88:91], v[88:91]
ds_read_b64_tr_b16 a[142:143], v147 offset:36864
s_mul_i32 s38, s37, 147
v_mfma_f32_16x16x32_bf16 v[92:95], a[176:179], a[92:95], v[92:95]
s_lshr_b32 s38, s38, 10
v_mfma_f32_16x16x32_bf16 v[96:99], a[180:183], a[80:83], v[96:99]
ds_read_b64_tr_b16 a[144:145], v148 offset:32768
s_mul_i32 s38, s38, 7
v_mfma_f32_16x16x32_bf16 v[100:103], a[180:183], a[84:87], v[100:103]
s_sub_u32 s37, s37, s38
buffer_load_dwordx4 a[4:7], v9, s[8:11], s20 offen offset:256 sc1
v_mfma_f32_16x16x32_bf16 v[104:107], a[180:183], a[88:91], v[104:107]
ds_read_b64_tr_b16 a[146:147], v148 offset:36864
s_cmp_eq_u32 s37, 3
s_cselect_b32 s16, s25, 0
v_mfma_f32_16x16x32_bf16 v[108:111], a[180:183], a[92:95], v[108:111]
ds_read_b64_tr_b16 a[148:149], v149 offset:32768
v_mfma_f32_16x16x32_bf16 v[112:115], a[184:187], a[80:83], v[112:115]
s_mul_i32 s37, s16, 3
v_mfma_f32_16x16x32_bf16 v[116:119], a[184:187], a[84:87], v[116:119]
s_sub_u32 s17, 0x8000, s37
s_add_u32 s21, s21, s24
buffer_load_dwordx4 v6, s[12:15], s21 offen offset:2048 lds
v_mfma_f32_16x16x32_bf16 v[120:123], a[184:187], a[88:91], v[120:123]
ds_read_b64_tr_b16 a[150:151], v149 offset:36864
v_mfma_f32_16x16x32_bf16 v[124:127], a[184:187], a[92:95], v[124:127]
ds_read_b64_tr_b16 a[152:153], v150 offset:32768
v_mfma_f32_16x16x32_bf16 v[128:131], a[188:191], a[80:83], v[128:131]
ds_read_b64_tr_b16 a[154:155], v150 offset:36864
v_mfma_f32_16x16x32_bf16 v[132:135], a[188:191], a[84:87], v[132:135]
buffer_load_dwordx4 a[8:11], v8, s[8:11], s20 offen offset:512 sc1
v_mfma_f32_16x16x32_bf16 v[136:139], a[188:191], a[88:91], v[136:139]
ds_read_b64_tr_b16 a[156:157], v151 offset:32768
v_mfma_f32_16x16x32_bf16 v[140:143], a[188:191], a[92:95], v[140:143]
s_waitcnt vmcnt(14) lgkmcnt(7)
v_mfma_f32_16x16x32_bf16 v[16:19], a[128:131], a[96:99], v[16:19]
ds_read_b64_tr_b16 a[158:159], v151 offset:36864
v_mfma_f32_16x16x32_bf16 v[20:23], a[128:131], a[100:103], v[20:23]
s_add_u32 s21, s21, s24
buffer_load_dwordx4 v7, s[12:15], s21 offen offset:3072 lds
v_mfma_f32_16x16x32_bf16 v[24:27], a[128:131], a[104:107], v[24:27]
ds_read_b64_tr_b16 a[160:161], v144 offset:49152
v_mfma_f32_16x16x32_bf16 v[28:31], a[128:131], a[108:111], v[28:31]
ds_read_b64_tr_b16 a[162:163], v144 offset:53248
v_mfma_f32_16x16x32_bf16 v[32:35], a[132:135], a[96:99], v[32:35]
s_cmp_eq_u32 s31, 1
s_cbranch_scc0 L_cx_k
s_mov_b32 s56, s64
s_and_b32 s57, s65, 0xffff
s_mov_b32 s58, 0x400000
s_mov_b32 s59, 0x00020000
s_add_u32 m0, s23, 131072
s_mov_b32 s38, 0
buffer_load_dwordx4 v240, s[56:59], s38 offen offset:0 lds
s_mov_b32 s38, 7168
buffer_load_dwordx4 v241, s[56:59], s38 offen offset:1024 lds
s_mov_b32 s38, 14336
buffer_load_dwordx4 v242, s[56:59], s38 offen offset:2048 lds
s_mov_b32 s38, 21504
buffer_load_dwordx4 v243, s[56:59], s38 offen offset:3072 lds
s_add_u32 m0, s23, 135168
s_mov_b32 s38, 32768
buffer_load_dwordx4 v240, s[56:59], s38 offen offset:0 lds
s_mov_b32 s38, 39936
buffer_load_dwordx4 v241, s[56:59], s38 offen offset:1024 lds
s_mov_b32 s38, 47104
buffer_load_dwordx4 v242, s[56:59], s38 offen offset:2048 lds
s_mov_b32 s38, 54272
buffer_load_dwordx4 v243, s[56:59], s38 offen offset:3072 lds
L_cx_k:
v_mfma_f32_16x16x32_bf16 v[36:39], a[132:135], a[100:103], v[36:39]
buffer_load_dwordx4 a[12:15], v8, s[8:11], s20 offen offset:768 sc1
v_mfma_f32_16x16x32_bf16 v[40:43], a[132:135], a[104:107], v[40:43]
ds_read_b64_tr_b16 a[164:165], v145 offset:49152
v_mfma_f32_16x16x32_bf16 v[44:47], a[132:135], a[108:111], v[44:47]
ds_read_b64_tr_b16 a[166:167], v145 offset:53248
v_mfma_f32_16x16x32_bf16 v[48:51], a[136:139], a[96:99], v[48:51]
ds_read_b64_tr_b16 a[168:169], v146 offset:49152
s_add_u32 m0, s23, 102400
v_mfma_f32_16x16x32_bf16 v[52:55], a[136:139], a[100:103], v[52:55]
buffer_load_dwordx4 v4, s[12:15], s22 offen offset:0 lds
v_mfma_f32_16x16x32_bf16 v[56:59], a[136:139], a[104:107], v[56:59]
ds_read_b64_tr_b16 a[170:171], v146 offset:53248
v_mfma_f32_16x16x32_bf16 v[60:63], a[136:139], a[108:111], v[60:63]
v_mfma_f32_16x16x32_bf16 v[64:67], a[140:143], a[96:99], v[64:67]
ds_read_b64_tr_b16 a[172:173], v147 offset:49152
v_mfma_f32_16x16x32_bf16 v[68:71], a[140:143], a[100:103], v[68:71]
s_add_u32 s20, s20, 262144
buffer_load_dwordx4 a[16:19], v8, s[8:11], s20 offen offset:0 sc1
v_mfma_f32_16x16x32_bf16 v[72:75], a[140:143], a[104:107], v[72:75]
ds_read_b64_tr_b16 a[174:175], v147 offset:53248
v_mfma_f32_16x16x32_bf16 v[76:79], a[140:143], a[108:111], v[76:79]
ds_read_b64_tr_b16 a[176:177], v148 offset:49152
s_waitcnt lgkmcnt(9)
v_mfma_f32_16x16x32_bf16 v[80:83], a[144:147], a[96:99], v[80:83]
v_mfma_f32_16x16x32_bf16 v[84:87], a[144:147], a[100:103], v[84:87]
s_add_u32 s22, s22, s24
buffer_load_dwordx4 v5, s[12:15], s22 offen offset:1024 lds
v_mfma_f32_16x16x32_bf16 v[88:91], a[144:147], a[104:107], v[88:91]
ds_read_b64_tr_b16 a[178:179], v148 offset:53248
v_mfma_f32_16x16x32_bf16 v[92:95], a[144:147], a[108:111], v[92:95]
ds_read_b64_tr_b16 a[180:181], v149 offset:49152
v_mfma_f32_16x16x32_bf16 v[96:99], a[148:151], a[96:99], v[96:99]
ds_read_b64_tr_b16 a[182:183], v149 offset:53248
v_mfma_f32_16x16x32_bf16 v[100:103], a[148:151], a[100:103], v[100:103]
buffer_load_dwordx4 a[20:23], v9, s[8:11], s20 offen offset:256 sc1
v_mfma_f32_16x16x32_bf16 v[104:107], a[148:151], a[104:107], v[104:107]
ds_read_b64_tr_b16 a[184:185], v150 offset:49152
v_mfma_f32_16x16x32_bf16 v[108:111], a[148:151], a[108:111], v[108:111]
v_mfma_f32_16x16x32_bf16 v[112:115], a[152:155], a[96:99], v[112:115]
ds_read_b64_tr_b16 a[186:187], v150 offset:53248
v_mfma_f32_16x16x32_bf16 v[116:119], a[152:155], a[100:103], v[116:119]
s_add_u32 s22, s22, s24
buffer_load_dwordx4 v6, s[12:15], s22 offen offset:2048 lds
v_mfma_f32_16x16x32_bf16 v[120:123], a[152:155], a[104:107], v[120:123]
ds_read_b64_tr_b16 a[188:189], v151 offset:49152
v_mfma_f32_16x16x32_bf16 v[124:127], a[152:155], a[108:111], v[124:127]
ds_read_b64_tr_b16 a[190:191], v151 offset:53248
v_mfma_f32_16x16x32_bf16 v[128:131], a[156:159], a[96:99], v[128:131]
v_mfma_f32_16x16x32_bf16 v[132:135], a[156:159], a[100:103], v[132:135]
buffer_load_dwordx4 a[24:27], v8, s[8:11], s20 offen offset:512 sc1
v_mfma_f32_16x16x32_bf16 v[136:139], a[156:159], a[104:107], v[136:139]
v_mfma_f32_16x16x32_bf16 v[140:143], a[156:159], a[108:111], v[140:143]
s_waitcnt vmcnt(14) lgkmcnt(8)
v_mfma_f32_16x16x32_bf16 v[16:19], a[160:163], a[112:115], v[16:19]
v_mfma_f32_16x16x32_bf16 v[20:23], a[160:163], a[116:119], v[20:23]
s_add_u32 s22, s22, s24
buffer_load_dwordx4 v7, s[12:15], s22 offen offset:3072 lds
v_mfma_f32_16x16x32_bf16 v[24:27], a[160:163], a[120:123], v[24:27]
v_mfma_f32_16x16x32_bf16 v[28:31], a[160:163], a[124:127], v[28:31]
v_mfma_f32_16x16x32_bf16 v[32:35], a[164:167], a[112:115], v[32:35]
v_mfma_f32_16x16x32_bf16 v[36:39], a[164:167], a[116:119], v[36:39]
buffer_load_dwordx4 a[28:31], v8, s[8:11], s20 offen offset:768 sc1
v_mfma_f32_16x16x32_bf16 v[40:43], a[164:167], a[120:123], v[40:43]
s_waitcnt lgkmcnt(0)
s_barrier
s_lshl_b32 s20, s62, 19
v_mfma_f32_16x16x32_bf16 v[44:47], a[164:167], a[124:127], v[44:47]
ds_read_b64_tr_b16 a[128:129], v152 offset:0
v_mfma_f32_16x16x32_bf16 v[48:51], a[168:171], a[112:115], v[48:51]
ds_read_b64_tr_b16 a[130:131], v152 offset:4096
v_mfma_f32_16x16x32_bf16 v[52:55], a[168:171], a[116:119], v[52:55]
buffer_load_dwordx4 a[32:35], v8, s[8:11], s20 offen offset:0 sc1
v_mfma_f32_16x16x32_bf16 v[56:59], a[168:171], a[120:123], v[56:59]
ds_read_b64_tr_b16 a[132:133], v153 offset:0
v_mfma_f32_16x16x32_bf16 v[60:63], a[168:171], a[124:127], v[60:63]
ds_read_b64_tr_b16 a[134:135], v153 offset:4096
v_mfma_f32_16x16x32_bf16 v[64:67], a[172:175], a[112:115], v[64:67]
v_mfma_f32_16x16x32_bf16 v[68:71], a[172:175], a[116:119], v[68:71]
buffer_load_dwordx4 a[36:39], v9, s[8:11], s20 offen offset:256 sc1
v_mfma_f32_16x16x32_bf16 v[72:75], a[172:175], a[120:123], v[72:75]
ds_read_b64_tr_b16 a[136:137], v154 offset:0
v_mfma_f32_16x16x32_bf16 v[76:79], a[172:175], a[124:127], v[76:79]
ds_read_b64_tr_b16 a[138:139], v154 offset:4096
v_mfma_f32_16x16x32_bf16 v[80:83], a[176:179], a[112:115], v[80:83]
ds_read_b64_tr_b16 a[140:141], v155 offset:0
v_mfma_f32_16x16x32_bf16 v[84:87], a[176:179], a[116:119], v[84:87]
buffer_load_dwordx4 a[40:43], v8, s[8:11], s20 offen offset:512 sc1
v_mfma_f32_16x16x32_bf16 v[88:91], a[176:179], a[120:123], v[88:91]
ds_read_b64_tr_b16 a[142:143], v155 offset:4096
v_mfma_f32_16x16x32_bf16 v[92:95], a[176:179], a[124:127], v[92:95]
v_mfma_f32_16x16x32_bf16 v[96:99], a[180:183], a[112:115], v[96:99]
ds_read_b64_tr_b16 a[144:145], v156 offset:0
v_mfma_f32_16x16x32_bf16 v[100:103], a[180:183], a[116:119], v[100:103]
buffer_load_dwordx4 a[44:47], v8, s[8:11], s20 offen offset:768 sc1
v_mfma_f32_16x16x32_bf16 v[104:107], a[180:183], a[120:123], v[104:107]
ds_read_b64_tr_b16 a[146:147], v156 offset:4096
v_mfma_f32_16x16x32_bf16 v[108:111], a[180:183], a[124:127], v[108:111]
ds_read_b64_tr_b16 a[148:149], v157 offset:0
v_mfma_f32_16x16x32_bf16 v[112:115], a[184:187], a[112:115], v[112:115]
v_mfma_f32_16x16x32_bf16 v[116:119], a[184:187], a[116:119], v[116:119]
s_add_u32 s20, s20, 262144
buffer_load_dwordx4 a[48:51], v8, s[8:11], s20 offen offset:0 sc1
v_mfma_f32_16x16x32_bf16 v[120:123], a[184:187], a[120:123], v[120:123]
ds_read_b64_tr_b16 a[150:151], v157 offset:4096
v_mfma_f32_16x16x32_bf16 v[124:127], a[184:187], a[124:127], v[124:127]
ds_read_b64_tr_b16 a[152:153], v158 offset:0
v_mfma_f32_16x16x32_bf16 v[128:131], a[188:191], a[112:115], v[128:131]
ds_read_b64_tr_b16 a[154:155], v158 offset:4096
v_mfma_f32_16x16x32_bf16 v[132:135], a[188:191], a[116:119], v[132:135]
buffer_load_dwordx4 a[52:55], v9, s[8:11], s20 offen offset:256 sc1
v_mfma_f32_16x16x32_bf16 v[136:139], a[188:191], a[120:123], v[136:139]
ds_read_b64_tr_b16 a[156:157], v159 offset:0
v_mfma_f32_16x16x32_bf16 v[140:143], a[188:191], a[124:127], v[140:143]
s_waitcnt vmcnt(14) lgkmcnt(7)
v_mfma_f32_16x16x32_bf16 v[16:19], a[128:131], a[0:3], v[16:19]
ds_read_b64_tr_b16 a[158:159], v159 offset:4096
v_mfma_f32_16x16x32_bf16 v[20:23], a[128:131], a[4:7], v[20:23]
buffer_load_dwordx4 a[56:59], v8, s[8:11], s20 offen offset:512 sc1
v_mfma_f32_16x16x32_bf16 v[24:27], a[128:131], a[8:11], v[24:27]
ds_read_b64_tr_b16 a[160:161], v152 offset:16384
v_mfma_f32_16x16x32_bf16 v[28:31], a[128:131], a[12:15], v[28:31]
ds_read_b64_tr_b16 a[162:163], v152 offset:20480
v_mfma_f32_16x16x32_bf16 v[32:35], a[132:135], a[0:3], v[32:35]
v_mfma_f32_16x16x32_bf16 v[36:39], a[132:135], a[4:7], v[36:39]
buffer_load_dwordx4 a[60:63], v8, s[8:11], s20 offen offset:768 sc1
v_mfma_f32_16x16x32_bf16 v[40:43], a[132:135], a[8:11], v[40:43]
ds_read_b64_tr_b16 a[164:165], v153 offset:16384
v_mfma_f32_16x16x32_bf16 v[44:47], a[132:135], a[12:15], v[44:47]
ds_read_b64_tr_b16 a[166:167], v153 offset:20480
v_mfma_f32_16x16x32_bf16 v[48:51], a[136:139], a[0:3], v[48:51]
ds_read_b64_tr_b16 a[168:169], v154 offset:16384
v_mfma_f32_16x16x32_bf16 v[52:55], a[136:139], a[4:7], v[52:55]
v_mfma_f32_16x16x32_bf16 v[56:59], a[136:139], a[8:11], v[56:59]
ds_read_b64_tr_b16 a[170:171], v154 offset:20480
v_mfma_f32_16x16x32_bf16 v[60:63], a[136:139], a[12:15], v[60:63]
v_mfma_f32_16x16x32_bf16 v[64:67], a[140:143], a[0:3], v[64:67]
ds_read_b64_tr_b16 a[172:173], v155 offset:16384
v_mfma_f32_16x16x32_bf16 v[68:71], a[140:143], a[4:7], v[68:71]
v_mfma_f32_16x16x32_bf16 v[72:75], a[140:143], a[8:11], v[72:75]
ds_read_b64_tr_b16 a[174:175], v155 offset:20480
v_mfma_f32_16x16x32_bf16 v[76:79], a[140:143], a[12:15], v[76:79]
ds_read_b64_tr_b16 a[176:177], v156 offset:16384
s_waitcnt lgkmcnt(9)
v_mfma_f32_16x16x32_bf16 v[80:83], a[144:147], a[0:3], v[80:83]
v_mfma_f32_16x16x32_bf16 v[84:87], a[144:147], a[4:7], v[84:87]
v_mfma_f32_16x16x32_bf16 v[88:91], a[144:147], a[8:11], v[88:91]
ds_read_b64_tr_b16 a[178:179], v156 offset:20480
v_mfma_f32_16x16x32_bf16 v[92:95], a[144:147], a[12:15], v[92:95]
ds_read_b64_tr_b16 a[180:181], v157 offset:16384
v_mfma_f32_16x16x32_bf16 v[96:99], a[148:151], a[0:3], v[96:99]
ds_read_b64_tr_b16 a[182:183], v157 offset:20480
v_mfma_f32_16x16x32_bf16 v[100:103], a[148:151], a[4:7], v[100:103]
v_mfma_f32_16x16x32_bf16 v[104:107], a[148:151], a[8:11], v[104:107]
ds_read_b64_tr_b16 a[184:185], v158 offset:16384
v_mfma_f32_16x16x32_bf16 v[108:111], a[148:151], a[12:15], v[108:111]
v_mfma_f32_16x16x32_bf16 v[112:115], a[152:155], a[0:3], v[112:115]
ds_read_b64_tr_b16 a[186:187], v158 offset:20480
v_mfma_f32_16x16x32_bf16 v[116:119], a[152:155], a[4:7], v[116:119]
v_mfma_f32_16x16x32_bf16 v[120:123], a[152:155], a[8:11], v[120:123]
ds_read_b64_tr_b16 a[188:189], v159 offset:16384
v_mfma_f32_16x16x32_bf16 v[124:127], a[152:155], a[12:15], v[124:127]
ds_read_b64_tr_b16 a[190:191], v159 offset:20480
v_mfma_f32_16x16x32_bf16 v[128:131], a[156:159], a[0:3], v[128:131]
v_mfma_f32_16x16x32_bf16 v[132:135], a[156:159], a[4:7], v[132:135]
v_mfma_f32_16x16x32_bf16 v[136:139], a[156:159], a[8:11], v[136:139]
v_mfma_f32_16x16x32_bf16 v[140:143], a[156:159], a[12:15], v[140:143]
s_waitcnt vmcnt(8) lgkmcnt(8)
v_mfma_f32_16x16x32_bf16 v[16:19], a[160:163], a[16:19], v[16:19]
v_mfma_f32_16x16x32_bf16 v[20:23], a[160:163], a[20:23], v[20:23]
v_mfma_f32_16x16x32_bf16 v[24:27], a[160:163], a[24:27], v[24:27]
v_mfma_f32_16x16x32_bf16 v[28:31], a[160:163], a[28:31], v[28:31]
v_mfma_f32_16x16x32_bf16 v[32:35], a[164:167], a[16:19], v[32:35]
v_mfma_f32_16x16x32_bf16 v[36:39], a[164:167], a[20:23], v[36:39]
v_mfma_f32_16x16x32_bf16 v[40:43], a[164:167], a[24:27], v[40:43]
s_waitcnt lgkmcnt(0)
s_barrier
v_mfma_f32_16x16x32_bf16 v[44:47], a[164:167], a[28:31], v[44:47]
ds_read_b64_tr_b16 a[128:129], v152 offset:32768
v_mfma_f32_16x16x32_bf16 v[48:51], a[168:171], a[16:19], v[48:51]
ds_read_b64_tr_b16 a[130:131], v152 offset:36864
v_mfma_f32_16x16x32_bf16 v[52:55], a[168:171], a[20:23], v[52:55]
v_mfma_f32_16x16x32_bf16 v[56:59], a[168:171], a[24:27], v[56:59]
ds_read_b64_tr_b16 a[132:133], v153 offset:32768
v_mfma_f32_16x16x32_bf16 v[60:63], a[168:171], a[28:31], v[60:63]
ds_read_b64_tr_b16 a[134:135], v153 offset:36864
v_mfma_f32_16x16x32_bf16 v[64:67], a[172:175], a[16:19], v[64:67]
v_mfma_f32_16x16x32_bf16 v[68:71], a[172:175], a[20:23], v[68:71]
v_mfma_f32_16x16x32_bf16 v[72:75], a[172:175], a[24:27], v[72:75]
ds_read_b64_tr_b16 a[136:137], v154 offset:32768
v_mfma_f32_16x16x32_bf16 v[76:79], a[172:175], a[28:31], v[76:79]
ds_read_b64_tr_b16 a[138:139], v154 offset:36864
v_mfma_f32_16x16x32_bf16 v[80:83], a[176:179], a[16:19], v[80:83]
ds_read_b64_tr_b16 a[140:141], v155 offset:32768
v_mfma_f32_16x16x32_bf16 v[84:87], a[176:179], a[20:23], v[84:87]
v_mfma_f32_16x16x32_bf16 v[88:91], a[176:179], a[24:27], v[88:91]
ds_read_b64_tr_b16 a[142:143], v155 offset:36864
v_mfma_f32_16x16x32_bf16 v[92:95], a[176:179], a[28:31], v[92:95]
v_mfma_f32_16x16x32_bf16 v[96:99], a[180:183], a[16:19], v[96:99]
ds_read_b64_tr_b16 a[144:145], v156 offset:32768
v_mfma_f32_16x16x32_bf16 v[100:103], a[180:183], a[20:23], v[100:103]
v_mfma_f32_16x16x32_bf16 v[104:107], a[180:183], a[24:27], v[104:107]
ds_read_b64_tr_b16 a[146:147], v156 offset:36864
v_mfma_f32_16x16x32_bf16 v[108:111], a[180:183], a[28:31], v[108:111]
ds_read_b64_tr_b16 a[148:149], v157 offset:32768
v_mfma_f32_16x16x32_bf16 v[112:115], a[184:187], a[16:19], v[112:115]
v_mfma_f32_16x16x32_bf16 v[116:119], a[184:187], a[20:23], v[116:119]
v_mfma_f32_16x16x32_bf16 v[120:123], a[184:187], a[24:27], v[120:123]
ds_read_b64_tr_b16 a[150:151], v157 offset:36864
v_mfma_f32_16x16x32_bf16 v[124:127], a[184:187], a[28:31], v[124:127]
ds_read_b64_tr_b16 a[152:153], v158 offset:32768
v_mfma_f32_16x16x32_bf16 v[128:131], a[188:191], a[16:19], v[128:131]
ds_read_b64_tr_b16 a[154:155], v158 offset:36864
v_mfma_f32_16x16x32_bf16 v[132:135], a[188:191], a[20:23], v[132:135]
v_mfma_f32_16x16x32_bf16 v[136:139], a[188:191], a[24:27], v[136:139]
ds_read_b64_tr_b16 a[156:157], v159 offset:32768
v_mfma_f32_16x16x32_bf16 v[140:143], a[188:191], a[28:31], v[140:143]
s_waitcnt vmcnt(4) lgkmcnt(7)
v_mfma_f32_16x16x32_bf16 v[16:19], a[128:131], a[32:35], v[16:19]
ds_read_b64_tr_b16 a[158:159], v159 offset:36864
v_mfma_f32_16x16x32_bf16 v[20:23], a[128:131], a[36:39], v[20:23]
v_mfma_f32_16x16x32_bf16 v[24:27], a[128:131], a[40:43], v[24:27]
ds_read_b64_tr_b16 a[160:161], v152 offset:49152
v_mfma_f32_16x16x32_bf16 v[28:31], a[128:131], a[44:47], v[28:31]
ds_read_b64_tr_b16 a[162:163], v152 offset:53248
v_mfma_f32_16x16x32_bf16 v[32:35], a[132:135], a[32:35], v[32:35]
v_mfma_f32_16x16x32_bf16 v[36:39], a[132:135], a[36:39], v[36:39]
v_mfma_f32_16x16x32_bf16 v[40:43], a[132:135], a[40:43], v[40:43]
ds_read_b64_tr_b16 a[164:165], v153 offset:49152
v_mfma_f32_16x16x32_bf16 v[44:47], a[132:135], a[44:47], v[44:47]
ds_read_b64_tr_b16 a[166:167], v153 offset:53248
v_mfma_f32_16x16x32_bf16 v[48:51], a[136:139], a[32:35], v[48:51]
ds_read_b64_tr_b16 a[168:169], v154 offset:49152
v_mfma_f32_16x16x32_bf16 v[52:55], a[136:139], a[36:39], v[52:55]
v_mfma_f32_16x16x32_bf16 v[56:59], a[136:139], a[40:43], v[56:59]
ds_read_b64_tr_b16 a[170:171], v154 offset:53248
v_mfma_f32_16x16x32_bf16 v[60:63], a[136:139], a[44:47], v[60:63]
v_mfma_f32_16x16x32_bf16 v[64:67], a[140:143], a[32:35], v[64:67]
ds_read_b64_tr_b16 a[172:173], v155 offset:49152
v_mfma_f32_16x16x32_bf16 v[68:71], a[140:143], a[36:39], v[68:71]
v_mfma_f32_16x16x32_bf16 v[72:75], a[140:143], a[40:43], v[72:75]
ds_read_b64_tr_b16 a[174:175], v155 offset:53248
v_mfma_f32_16x16x32_bf16 v[76:79], a[140:143], a[44:47], v[76:79]
ds_read_b64_tr_b16 a[176:177], v156 offset:49152
s_waitcnt lgkmcnt(9)
v_mfma_f32_16x16x32_bf16 v[80:83], a[144:147], a[32:35], v[80:83]
v_mfma_f32_16x16x32_bf16 v[84:87], a[144:147], a[36:39], v[84:87]
v_mfma_f32_16x16x32_bf16 v[88:91], a[144:147], a[40:43], v[88:91]
ds_read_b64_tr_b16 a[178:179], v156 offset:53248
v_mfma_f32_16x16x32_bf16 v[92:95], a[144:147], a[44:47], v[92:95]
ds_read_b64_tr_b16 a[180:181], v157 offset:49152
v_mfma_f32_16x16x32_bf16 v[96:99], a[148:151], a[32:35], v[96:99]
ds_read_b64_tr_b16 a[182:183], v157 offset:53248
v_mfma_f32_16x16x32_bf16 v[100:103], a[148:151], a[36:39], v[100:103]
v_mfma_f32_16x16x32_bf16 v[104:107], a[148:151], a[40:43], v[104:107]
ds_read_b64_tr_b16 a[184:185], v158 offset:49152
v_mfma_f32_16x16x32_bf16 v[108:111], a[148:151], a[44:47], v[108:111]
v_mfma_f32_16x16x32_bf16 v[112:115], a[152:155], a[32:35], v[112:115]
ds_read_b64_tr_b16 a[186:187], v158 offset:53248
v_mfma_f32_16x16x32_bf16 v[116:119], a[152:155], a[36:39], v[116:119]
v_mfma_f32_16x16x32_bf16 v[120:123], a[152:155], a[40:43], v[120:123]
ds_read_b64_tr_b16 a[188:189], v159 offset:49152
v_mfma_f32_16x16x32_bf16 v[124:127], a[152:155], a[44:47], v[124:127]
ds_read_b64_tr_b16 a[190:191], v159 offset:53248
v_mfma_f32_16x16x32_bf16 v[128:131], a[156:159], a[32:35], v[128:131]
s_cmp_eq_u32 s31, 1
s_cbranch_scc0 L_cg_k
s_add_u32 s56, s88, 41943040
s_addc_u32 s57, s89, 0
s_and_b32 s57, s57, 0xffff
s_mov_b32 s58, 0x4000
s_mov_b32 s59, 0x00020000
s_lshl_b32 s38, s28, 8
s_add_u32 s38, s38, 4096
s_lshl_b32 s39, s26, 11
s_add_u32 s38, s38, s39
s_xor_b32 s39, s27, 8
s_lshl_b32 s39, s39, 2
s_add_u32 s38, s38, s39
v_mov_b32 v13, s38
s_mov_b32 s39, 0
L_pg_k_loop:
buffer_load_dword v14, v13, s[56:59], 0 offen sc0 sc1
s_waitcnt vmcnt(0)
v_cmp_ne_u32 vcc, 1, v14
s_add_u32 s39, s39, 1
s_cmp_gt_u32 s39, 0x40000
s_cbranch_scc1 L_pg_k_done
s_nop 1
s_cbranch_vccz L_pg_k_done
s_branch L_pg_k_loop
L_pg_k_done:
s_mov_b32 s38, 0
buffer_load_dwordx4 v[208:211], v1, s[40:43], s38 offen sc1
s_mov_b32 s38, 1024
buffer_load_dwordx4 v[212:215], v1, s[40:43], s38 offen sc1
s_mov_b32 s38, 2048
buffer_load_dwordx4 v[216:219], v1, s[40:43], s38 offen sc1
s_mov_b32 s38, 3072
buffer_load_dwordx4 v[220:223], v1, s[40:43], s38 offen sc1
s_mov_b32 s38, 4096
buffer_load_dwordx4 v[224:227], v1, s[40:43], s38 offen sc1
s_mov_b32 s38, 5120
buffer_load_dwordx4 v[228:231], v1, s[40:43], s38 offen sc1
s_mov_b32 s38, 6144
buffer_load_dwordx4 v[232:235], v1, s[40:43], s38 offen sc1
s_mov_b32 s38, 7168
buffer_load_dwordx4 v[236:239], v1, s[40:43], s38 offen sc1
L_cg_k:
v_mfma_f32_16x16x32_bf16 v[132:135], a[156:159], a[36:39], v[132:135]
v_mfma_f32_16x16x32_bf16 v[136:139], a[156:159], a[40:43], v[136:139]
v_mfma_f32_16x16x32_bf16 v[140:143], a[156:159], a[44:47], v[140:143]
s_cmp_lt_u32 s26, 2
s_cbranch_scc1 L_lh_even_k
s_waitcnt vmcnt(0) lgkmcnt(8)
v_mfma_f32_16x16x32_bf16 v[16:19], a[160:163], a[48:51], v[16:19]
v_mfma_f32_16x16x32_bf16 v[20:23], a[160:163], a[52:55], v[20:23]
v_mfma_f32_16x16x32_bf16 v[24:27], a[160:163], a[56:59], v[24:27]
v_mfma_f32_16x16x32_bf16 v[28:31], a[160:163], a[60:63], v[28:31]
v_mfma_f32_16x16x32_bf16 v[32:35], a[164:167], a[48:51], v[32:35]
v_mfma_f32_16x16x32_bf16 v[36:39], a[164:167], a[52:55], v[36:39]
v_mfma_f32_16x16x32_bf16 v[40:43], a[164:167], a[56:59], v[40:43]
v_mfma_f32_16x16x32_bf16 v[44:47], a[164:167], a[60:63], v[44:47]
v_mfma_f32_16x16x32_bf16 v[48:51], a[168:171], a[48:51], v[48:51]
v_mfma_f32_16x16x32_bf16 v[52:55], a[168:171], a[52:55], v[52:55]
ds_write_b128 v166, v[16:19] offset:0
v_mfma_f32_16x16x32_bf16 v[56:59], a[168:171], a[56:59], v[56:59]
ds_write_b128 v166, v[20:23] offset:1024
v_mfma_f32_16x16x32_bf16 v[60:63], a[168:171], a[60:63], v[60:63]
v_mfma_f32_16x16x32_bf16 v[64:67], a[172:175], a[48:51], v[64:67]
v_mfma_f32_16x16x32_bf16 v[68:71], a[172:175], a[52:55], v[68:71]
ds_write_b128 v166, v[32:35] offset:2048
v_mfma_f32_16x16x32_bf16 v[72:75], a[172:175], a[56:59], v[72:75]
ds_write_b128 v166, v[36:39] offset:3072
v_mfma_f32_16x16x32_bf16 v[76:79], a[172:175], a[60:63], v[76:79]
s_waitcnt lgkmcnt(4)
v_mfma_f32_16x16x32_bf16 v[80:83], a[176:179], a[48:51], v[80:83]
v_mfma_f32_16x16x32_bf16 v[84:87], a[176:179], a[52:55], v[84:87]
ds_write_b128 v166, v[48:51] offset:4096
v_mfma_f32_16x16x32_bf16 v[88:91], a[176:179], a[56:59], v[88:91]
ds_write_b128 v166, v[52:55] offset:5120
v_mfma_f32_16x16x32_bf16 v[92:95], a[176:179], a[60:63], v[92:95]
v_mfma_f32_16x16x32_bf16 v[96:99], a[180:183], a[48:51], v[96:99]
v_mfma_f32_16x16x32_bf16 v[100:103], a[180:183], a[52:55], v[100:103]
ds_write_b128 v166, v[64:67] offset:6144
v_mfma_f32_16x16x32_bf16 v[104:107], a[180:183], a[56:59], v[104:107]
ds_write_b128 v166, v[68:71] offset:7168
v_mfma_f32_16x16x32_bf16 v[108:111], a[180:183], a[60:63], v[108:111]
v_mfma_f32_16x16x32_bf16 v[112:115], a[184:187], a[48:51], v[112:115]
v_mfma_f32_16x16x32_bf16 v[116:119], a[184:187], a[52:55], v[116:119]
ds_write_b128 v166, v[80:83] offset:8192
v_mfma_f32_16x16x32_bf16 v[120:123], a[184:187], a[56:59], v[120:123]
ds_write_b128 v166, v[84:87] offset:9216
v_mfma_f32_16x16x32_bf16 v[124:127], a[184:187], a[60:63], v[124:127]
v_mfma_f32_16x16x32_bf16 v[128:131], a[188:191], a[48:51], v[128:131]
v_mfma_f32_16x16x32_bf16 v[132:135], a[188:191], a[52:55], v[132:135]
ds_write_b128 v166, v[96:99] offset:10240
v_mfma_f32_16x16x32_bf16 v[136:139], a[188:191], a[56:59], v[136:139]
ds_write_b128 v166, v[100:103] offset:11264
v_mfma_f32_16x16x32_bf16 v[140:143], a[188:191], a[60:63], v[140:143]
ds_write_b128 v166, v[112:115] offset:12288
ds_write_b128 v166, v[116:119] offset:13312
s_nop 0
ds_write_b128 v166, v[128:131] offset:14336
ds_write_b128 v166, v[132:135] offset:15360
s_waitcnt lgkmcnt(0)
s_barrier
ds_read_b128 v[16:19], v167 offset:0
ds_read_b128 v[20:23], v167 offset:1024
ds_read_b128 v[32:35], v167 offset:2048
ds_read_b128 v[36:39], v167 offset:3072
ds_read_b128 v[48:51], v167 offset:4096
ds_read_b128 v[52:55], v167 offset:5120
ds_read_b128 v[64:67], v167 offset:6144
ds_read_b128 v[68:71], v167 offset:7168
ds_read_b128 v[80:83], v167 offset:8192
ds_read_b128 v[84:87], v167 offset:9216
ds_read_b128 v[96:99], v167 offset:10240
ds_read_b128 v[100:103], v167 offset:11264
ds_read_b128 v[112:115], v167 offset:12288
ds_read_b128 v[116:119], v167 offset:13312
ds_read_b128 v[128:131], v167 offset:14336
ds_read_b128 v[132:135], v167 offset:15360
s_branch L_lh_join_k
L_lh_even_k:
s_waitcnt vmcnt(0) lgkmcnt(8)
v_mfma_f32_16x16x32_bf16 v[16:19], a[160:163], a[48:51], v[16:19]
v_mfma_f32_16x16x32_bf16 v[20:23], a[160:163], a[52:55], v[20:23]
v_mfma_f32_16x16x32_bf16 v[24:27], a[160:163], a[56:59], v[24:27]
v_mfma_f32_16x16x32_bf16 v[28:31], a[160:163], a[60:63], v[28:31]
v_mfma_f32_16x16x32_bf16 v[32:35], a[164:167], a[48:51], v[32:35]
v_mfma_f32_16x16x32_bf16 v[36:39], a[164:167], a[52:55], v[36:39]
v_mfma_f32_16x16x32_bf16 v[40:43], a[164:167], a[56:59], v[40:43]
v_mfma_f32_16x16x32_bf16 v[44:47], a[164:167], a[60:63], v[44:47]
v_mfma_f32_16x16x32_bf16 v[48:51], a[168:171], a[48:51], v[48:51]
v_mfma_f32_16x16x32_bf16 v[52:55], a[168:171], a[52:55], v[52:55]
s_nop 0
ds_write_b128 v166, v[24:27] offset:0
v_mfma_f32_16x16x32_bf16 v[56:59], a[168:171], a[56:59], v[56:59]
ds_write_b128 v166, v[28:31] offset:1024
v_mfma_f32_16x16x32_bf16 v[60:63], a[168:171], a[60:63], v[60:63]
v_mfma_f32_16x16x32_bf16 v[64:67], a[172:175], a[48:51], v[64:67]
v_mfma_f32_16x16x32_bf16 v[68:71], a[172:175], a[52:55], v[68:71]
ds_write_b128 v166, v[40:43] offset:2048
v_mfma_f32_16x16x32_bf16 v[72:75], a[172:175], a[56:59], v[72:75]
ds_write_b128 v166, v[44:47] offset:3072
v_mfma_f32_16x16x32_bf16 v[76:79], a[172:175], a[60:63], v[76:79]
s_waitcnt lgkmcnt(4)
v_mfma_f32_16x16x32_bf16 v[80:83], a[176:179], a[48:51], v[80:83]
v_mfma_f32_16x16x32_bf16 v[84:87], a[176:179], a[52:55], v[84:87]
ds_write_b128 v166, v[56:59] offset:4096
v_mfma_f32_16x16x32_bf16 v[88:91], a[176:179], a[56:59], v[88:91]
ds_write_b128 v166, v[60:63] offset:5120
v_mfma_f32_16x16x32_bf16 v[92:95], a[176:179], a[60:63], v[92:95]
v_mfma_f32_16x16x32_bf16 v[96:99], a[180:183], a[48:51], v[96:99]
v_mfma_f32_16x16x32_bf16 v[100:103], a[180:183], a[52:55], v[100:103]
ds_write_b128 v166, v[72:75] offset:6144
v_mfma_f32_16x16x32_bf16 v[104:107], a[180:183], a[56:59], v[104:107]
ds_write_b128 v166, v[76:79] offset:7168
v_mfma_f32_16x16x32_bf16 v[108:111], a[180:183], a[60:63], v[108:111]
v_mfma_f32_16x16x32_bf16 v[112:115], a[184:187], a[48:51], v[112:115]
v_mfma_f32_16x16x32_bf16 v[116:119], a[184:187], a[52:55], v[116:119]
ds_write_b128 v166, v[88:91] offset:8192
v_mfma_f32_16x16x32_bf16 v[120:123], a[184:187], a[56:59], v[120:123]
ds_write_b128 v166, v[92:95] offset:9216
v_mfma_f32_16x16x32_bf16 v[124:127], a[184:187], a[60:63], v[124:127]
v_mfma_f32_16x16x32_bf16 v[128:131], a[188:191], a[48:51], v[128:131]
v_mfma_f32_16x16x32_bf16 v[132:135], a[188:191], a[52:55], v[132:135]
ds_write_b128 v166, v[104:107] offset:10240
v_mfma_f32_16x16x32_bf16 v[136:139], a[188:191], a[56:59], v[136:139]
ds_write_b128 v166, v[108:111] offset:11264
v_mfma_f32_16x16x32_bf16 v[140:143], a[188:191], a[60:63], v[140:143]
ds_write_b128 v166, v[120:123] offset:12288
s_nop 0
ds_write_b128 v166, v[124:127] offset:13312
s_nop 2
ds_write_b128 v166, v[136:139] offset:14336
s_nop 0
ds_write_b128 v166, v[140:143] offset:15360
s_waitcnt lgkmcnt(0)
s_barrier
ds_read_b128 v[24:27], v167 offset:0
ds_read_b128 v[28:31], v167 offset:1024
ds_read_b128 v[40:43], v167 offset:2048
ds_read_b128 v[44:47], v167 offset:3072
ds_read_b128 v[56:59], v167 offset:4096
ds_read_b128 v[60:63], v167 offset:5120
ds_read_b128 v[72:75], v167 offset:6144
ds_read_b128 v[76:79], v167 offset:7168
ds_read_b128 v[88:91], v167 offset:8192
ds_read_b128 v[92:95], v167 offset:9216
ds_read_b128 v[104:107], v167 offset:10240
ds_read_b128 v[108:111], v167 offset:11264
ds_read_b128 v[120:123], v167 offset:12288
ds_read_b128 v[124:127], v167 offset:13312
ds_read_b128 v[136:139], v167 offset:14336
ds_read_b128 v[140:143], v167 offset:15360
L_lh_join_k:
L_tail_k:
s_waitcnt lgkmcnt(15)
v_add_f32 v16, v16, v24
v_add_f32 v17, v17, v25
v_add_f32 v18, v18, v26
v_add_f32 v19, v19, v27
s_waitcnt lgkmcnt(14)
v_add_f32 v20, v20, v28
v_add_f32 v21, v21, v29
v_add_f32 v22, v22, v30
v_add_f32 v23, v23, v31
s_waitcnt lgkmcnt(13)
v_add_f32 v32, v32, v40
v_add_f32 v33, v33, v41
v_add_f32 v34, v34, v42
v_add_f32 v35, v35, v43
s_waitcnt lgkmcnt(12)
v_add_f32 v36, v36, v44
v_add_f32 v37, v37, v45
v_add_f32 v38, v38, v46
v_add_f32 v39, v39, v47
s_waitcnt lgkmcnt(11)
v_add_f32 v48, v48, v56
v_add_f32 v49, v49, v57
v_add_f32 v50, v50, v58
v_add_f32 v51, v51, v59
s_waitcnt lgkmcnt(10)
v_add_f32 v52, v52, v60
v_add_f32 v53, v53, v61
v_add_f32 v54, v54, v62
v_add_f32 v55, v55, v63
s_waitcnt lgkmcnt(9)
v_add_f32 v64, v64, v72
v_add_f32 v65, v65, v73
v_add_f32 v66, v66, v74
v_add_f32 v67, v67, v75
s_waitcnt lgkmcnt(8)
v_add_f32 v68, v68, v76
v_add_f32 v69, v69, v77
v_add_f32 v70, v70, v78
v_add_f32 v71, v71, v79
s_waitcnt lgkmcnt(7)
v_add_f32 v80, v80, v88
v_add_f32 v81, v81, v89
v_add_f32 v82, v82, v90
v_add_f32 v83, v83, v91
s_waitcnt lgkmcnt(6)
v_add_f32 v84, v84, v92
v_add_f32 v85, v85, v93
v_add_f32 v86, v86, v94
v_add_f32 v87, v87, v95
s_waitcnt lgkmcnt(5)
v_add_f32 v96, v96, v104
v_add_f32 v97, v97, v105
v_add_f32 v98, v98, v106
v_add_f32 v99, v99, v107
s_waitcnt lgkmcnt(4)
v_add_f32 v100, v100, v108
v_add_f32 v101, v101, v109
v_add_f32 v102, v102, v110
v_add_f32 v103, v103, v111
s_waitcnt lgkmcnt(3)
v_add_f32 v112, v112, v120
v_add_f32 v113, v113, v121
v_add_f32 v114, v114, v122
v_add_f32 v115, v115, v123
s_waitcnt lgkmcnt(2)
v_add_f32 v116, v116, v124
v_add_f32 v117, v117, v125
v_add_f32 v118, v118, v126
v_add_f32 v119, v119, v127
s_waitcnt lgkmcnt(1)
v_add_f32 v128, v128, v136
v_add_f32 v129, v129, v137
v_add_f32 v130, v130, v138
v_add_f32 v131, v131, v139
s_waitcnt lgkmcnt(0)
v_add_f32 v132, v132, v140
v_add_f32 v133, v133, v141
v_add_f32 v134, v134, v142
v_add_f32 v135, v135, v143
s_cmp_eq_u32 s31, 0
s_cbranch_scc0 L_epi_s_k
v_exp_f32 v24, -v16
v_exp_f32 v25, -v17
v_exp_f32 v26, -v18
v_exp_f32 v27, -v19
v_add_f32 v24, 1.0, v24
v_add_f32 v25, 1.0, v25
v_add_f32 v26, 1.0, v26
v_add_f32 v27, 1.0, v27
v_rcp_f32 v24, v24
v_rcp_f32 v25, v25
v_rcp_f32 v26, v26
v_rcp_f32 v27, v27
v_mul_f32 v16, v16, v24
v_mul_f32 v17, v17, v25
v_mul_f32 v18, v18, v26
v_mul_f32 v19, v19, v27
v_exp_f32 v40, -v32
v_exp_f32 v41, -v33
v_exp_f32 v42, -v34
v_exp_f32 v43, -v35
v_add_f32 v40, 1.0, v40
v_add_f32 v41, 1.0, v41
v_add_f32 v42, 1.0, v42
v_add_f32 v43, 1.0, v43
v_rcp_f32 v40, v40
v_rcp_f32 v41, v41
v_rcp_f32 v42, v42
v_rcp_f32 v43, v43
v_mul_f32 v32, v32, v40
v_mul_f32 v33, v33, v41
v_mul_f32 v34, v34, v42
v_mul_f32 v35, v35, v43
v_cvt_pk_bf16_f32 v24, v16, v17
v_cvt_pk_bf16_f32 v25, v18, v19
v_cvt_pk_bf16_f32 v26, v32, v33
v_cvt_pk_bf16_f32 v27, v34, v35
s_mov_b32 s38, 0
buffer_store_dwordx4 v[24:27], v1, s[40:43], s38 offen sc0 sc1
v_exp_f32 v28, -v20
v_exp_f32 v29, -v21
v_exp_f32 v30, -v22
v_exp_f32 v31, -v23
v_add_f32 v28, 1.0, v28
v_add_f32 v29, 1.0, v29
v_add_f32 v30, 1.0, v30
v_add_f32 v31, 1.0, v31
v_rcp_f32 v28, v28
v_rcp_f32 v29, v29
v_rcp_f32 v30, v30
v_rcp_f32 v31, v31
v_mul_f32 v20, v20, v28
v_mul_f32 v21, v21, v29
v_mul_f32 v22, v22, v30
v_mul_f32 v23, v23, v31
v_exp_f32 v44, -v36
v_exp_f32 v45, -v37
v_exp_f32 v46, -v38
v_exp_f32 v47, -v39
v_add_f32 v44, 1.0, v44
v_add_f32 v45, 1.0, v45
v_add_f32 v46, 1.0, v46
v_add_f32 v47, 1.0, v47
v_rcp_f32 v44, v44
v_rcp_f32 v45, v45
v_rcp_f32 v46, v46
v_rcp_f32 v47, v47
v_mul_f32 v36, v36, v44
v_mul_f32 v37, v37, v45
v_mul_f32 v38, v38, v46
v_mul_f32 v39, v39, v47
v_cvt_pk_bf16_f32 v28, v20, v21
v_cvt_pk_bf16_f32 v29, v22, v23
v_cvt_pk_bf16_f32 v30, v36, v37
v_cvt_pk_bf16_f32 v31, v38, v39
s_mov_b32 s38, 1024
buffer_store_dwordx4 v[28:31], v1, s[40:43], s38 offen sc0 sc1
v_exp_f32 v56, -v48
v_exp_f32 v57, -v49
v_exp_f32 v58, -v50
v_exp_f32 v59, -v51
v_add_f32 v56, 1.0, v56
v_add_f32 v57, 1.0, v57
v_add_f32 v58, 1.0, v58
v_add_f32 v59, 1.0, v59
v_rcp_f32 v56, v56
v_rcp_f32 v57, v57
v_rcp_f32 v58, v58
v_rcp_f32 v59, v59
v_mul_f32 v48, v48, v56
v_mul_f32 v49, v49, v57
v_mul_f32 v50, v50, v58
v_mul_f32 v51, v51, v59
v_exp_f32 v72, -v64
v_exp_f32 v73, -v65
v_exp_f32 v74, -v66
v_exp_f32 v75, -v67
v_add_f32 v72, 1.0, v72
v_add_f32 v73, 1.0, v73
v_add_f32 v74, 1.0, v74
v_add_f32 v75, 1.0, v75
v_rcp_f32 v72, v72
v_rcp_f32 v73, v73
v_rcp_f32 v74, v74
v_rcp_f32 v75, v75
v_mul_f32 v64, v64, v72
v_mul_f32 v65, v65, v73
v_mul_f32 v66, v66, v74
v_mul_f32 v67, v67, v75
v_cvt_pk_bf16_f32 v56, v48, v49
v_cvt_pk_bf16_f32 v57, v50, v51
v_cvt_pk_bf16_f32 v58, v64, v65
v_cvt_pk_bf16_f32 v59, v66, v67
s_mov_b32 s38, 2048
buffer_store_dwordx4 v[56:59], v1, s[40:43], s38 offen sc0 sc1
v_exp_f32 v60, -v52
v_exp_f32 v61, -v53
v_exp_f32 v62, -v54
v_exp_f32 v63, -v55
v_add_f32 v60, 1.0, v60
v_add_f32 v61, 1.0, v61
v_add_f32 v62, 1.0, v62
v_add_f32 v63, 1.0, v63
v_rcp_f32 v60, v60
v_rcp_f32 v61, v61
v_rcp_f32 v62, v62
v_rcp_f32 v63, v63
v_mul_f32 v52, v52, v60
v_mul_f32 v53, v53, v61
v_mul_f32 v54, v54, v62
v_mul_f32 v55, v55, v63
v_exp_f32 v76, -v68
v_exp_f32 v77, -v69
v_exp_f32 v78, -v70
v_exp_f32 v79, -v71
v_add_f32 v76, 1.0, v76
v_add_f32 v77, 1.0, v77
v_add_f32 v78, 1.0, v78
v_add_f32 v79, 1.0, v79
v_rcp_f32 v76, v76
v_rcp_f32 v77, v77
v_rcp_f32 v78, v78
v_rcp_f32 v79, v79
v_mul_f32 v68, v68, v76
v_mul_f32 v69, v69, v77
v_mul_f32 v70, v70, v78
v_mul_f32 v71, v71, v79
v_cvt_pk_bf16_f32 v60, v52, v53
v_cvt_pk_bf16_f32 v61, v54, v55
v_cvt_pk_bf16_f32 v62, v68, v69
v_cvt_pk_bf16_f32 v63, v70, v71
s_mov_b32 s38, 3072
buffer_store_dwordx4 v[60:63], v1, s[40:43], s38 offen sc0 sc1
v_exp_f32 v88, -v80
v_exp_f32 v89, -v81
v_exp_f32 v90, -v82
v_exp_f32 v91, -v83
v_add_f32 v88, 1.0, v88
v_add_f32 v89, 1.0, v89
v_add_f32 v90, 1.0, v90
v_add_f32 v91, 1.0, v91
v_rcp_f32 v88, v88
v_rcp_f32 v89, v89
v_rcp_f32 v90, v90
v_rcp_f32 v91, v91
v_mul_f32 v80, v80, v88
v_mul_f32 v81, v81, v89
v_mul_f32 v82, v82, v90
v_mul_f32 v83, v83, v91
v_exp_f32 v104, -v96
v_exp_f32 v105, -v97
v_exp_f32 v106, -v98
v_exp_f32 v107, -v99
v_add_f32 v104, 1.0, v104
v_add_f32 v105, 1.0, v105
v_add_f32 v106, 1.0, v106
v_add_f32 v107, 1.0, v107
v_rcp_f32 v104, v104
v_rcp_f32 v105, v105
v_rcp_f32 v106, v106
v_rcp_f32 v107, v107
v_mul_f32 v96, v96, v104
v_mul_f32 v97, v97, v105
v_mul_f32 v98, v98, v106
v_mul_f32 v99, v99, v107
v_cvt_pk_bf16_f32 v88, v80, v81
v_cvt_pk_bf16_f32 v89, v82, v83
v_cvt_pk_bf16_f32 v90, v96, v97
v_cvt_pk_bf16_f32 v91, v98, v99
s_mov_b32 s38, 4096
buffer_store_dwordx4 v[88:91], v1, s[40:43], s38 offen sc0 sc1
v_exp_f32 v92, -v84
v_exp_f32 v93, -v85
v_exp_f32 v94, -v86
v_exp_f32 v95, -v87
v_add_f32 v92, 1.0, v92
v_add_f32 v93, 1.0, v93
v_add_f32 v94, 1.0, v94
v_add_f32 v95, 1.0, v95
v_rcp_f32 v92, v92
v_rcp_f32 v93, v93
v_rcp_f32 v94, v94
v_rcp_f32 v95, v95
v_mul_f32 v84, v84, v92
v_mul_f32 v85, v85, v93
v_mul_f32 v86, v86, v94
v_mul_f32 v87, v87, v95
v_exp_f32 v108, -v100
v_exp_f32 v109, -v101
v_exp_f32 v110, -v102
v_exp_f32 v111, -v103
v_add_f32 v108, 1.0, v108
v_add_f32 v109, 1.0, v109
v_add_f32 v110, 1.0, v110
v_add_f32 v111, 1.0, v111
v_rcp_f32 v108, v108
v_rcp_f32 v109, v109
v_rcp_f32 v110, v110
v_rcp_f32 v111, v111
v_mul_f32 v100, v100, v108
v_mul_f32 v101, v101, v109
v_mul_f32 v102, v102, v110
v_mul_f32 v103, v103, v111
v_cvt_pk_bf16_f32 v92, v84, v85
v_cvt_pk_bf16_f32 v93, v86, v87
v_cvt_pk_bf16_f32 v94, v100, v101
v_cvt_pk_bf16_f32 v95, v102, v103
s_mov_b32 s38, 5120
buffer_store_dwordx4 v[92:95], v1, s[40:43], s38 offen sc0 sc1
v_exp_f32 v120, -v112
v_exp_f32 v121, -v113
v_exp_f32 v122, -v114
v_exp_f32 v123, -v115
v_add_f32 v120, 1.0, v120
v_add_f32 v121, 1.0, v121
v_add_f32 v122, 1.0, v122
v_add_f32 v123, 1.0, v123
v_rcp_f32 v120, v120
v_rcp_f32 v121, v121
v_rcp_f32 v122, v122
v_rcp_f32 v123, v123
v_mul_f32 v112, v112, v120
v_mul_f32 v113, v113, v121
v_mul_f32 v114, v114, v122
v_mul_f32 v115, v115, v123
v_exp_f32 v136, -v128
v_exp_f32 v137, -v129
v_exp_f32 v138, -v130
v_exp_f32 v139, -v131
v_add_f32 v136, 1.0, v136
v_add_f32 v137, 1.0, v137
v_add_f32 v138, 1.0, v138
v_add_f32 v139, 1.0, v139
v_rcp_f32 v136, v136
v_rcp_f32 v137, v137
v_rcp_f32 v138, v138
v_rcp_f32 v139, v139
v_mul_f32 v128, v128, v136
v_mul_f32 v129, v129, v137
v_mul_f32 v130, v130, v138
v_mul_f32 v131, v131, v139
v_cvt_pk_bf16_f32 v120, v112, v113
v_cvt_pk_bf16_f32 v121, v114, v115
v_cvt_pk_bf16_f32 v122, v128, v129
v_cvt_pk_bf16_f32 v123, v130, v131
s_mov_b32 s38, 6144
buffer_store_dwordx4 v[120:123], v1, s[40:43], s38 offen sc0 sc1
v_exp_f32 v124, -v116
v_exp_f32 v125, -v117
v_exp_f32 v126, -v118
v_exp_f32 v127, -v119
v_add_f32 v124, 1.0, v124
v_add_f32 v125, 1.0, v125
v_add_f32 v126, 1.0, v126
v_add_f32 v127, 1.0, v127
v_rcp_f32 v124, v124
v_rcp_f32 v125, v125
v_rcp_f32 v126, v126
v_rcp_f32 v127, v127
v_mul_f32 v116, v116, v124
v_mul_f32 v117, v117, v125
v_mul_f32 v118, v118, v126
v_mul_f32 v119, v119, v127
v_exp_f32 v140, -v132
v_exp_f32 v141, -v133
v_exp_f32 v142, -v134
v_exp_f32 v143, -v135
v_add_f32 v140, 1.0, v140
v_add_f32 v141, 1.0, v141
v_add_f32 v142, 1.0, v142
v_add_f32 v143, 1.0, v143
v_rcp_f32 v140, v140
v_rcp_f32 v141, v141
v_rcp_f32 v142, v142
v_rcp_f32 v143, v143
v_mul_f32 v132, v132, v140
v_mul_f32 v133, v133, v141
v_mul_f32 v134, v134, v142
v_mul_f32 v135, v135, v143
v_cvt_pk_bf16_f32 v124, v116, v117
v_cvt_pk_bf16_f32 v125, v118, v119
v_cvt_pk_bf16_f32 v126, v132, v133
v_cvt_pk_bf16_f32 v127, v134, v135
s_mov_b32 s38, 7168
buffer_store_dwordx4 v[124:127], v1, s[40:43], s38 offen sc0 sc1
s_add_u32 s56, s88, 41943040
s_addc_u32 s57, s89, 0
s_and_b32 s57, s57, 0xffff
s_mov_b32 s58, 0x4000
s_mov_b32 s59, 0x00020000
s_lshl_b32 s38, s28, 8
s_lshl_b32 s39, s27, 2
s_add_u32 s38, s38, s39
s_lshl_b32 s39, s26, 11
s_add_u32 s38, s38, s39
s_add_u32 s38, s38, 4096
v_and_b32 v13, 63, v0
v_mov_b32 v14, 0x40000000
v_mov_b32 v15, s38
v_cmp_eq_u32 vcc, 0, v13
s_nop 1
v_cndmask_b32 v15, v14, v15, vcc
v_mov_b32 v14, 1
s_waitcnt vmcnt(0)
buffer_store_dword v14, v15, s[56:59], 0 offen sc0 sc1
s_branch L_fin_k
L_epi_s_k:
s_mov_b32 s52, s84
s_and_b32 s53, s85, 0xffff
s_mov_b32 s54, 0x400000
s_mov_b32 s55, 0x00020000
s_waitcnt vmcnt(0)
ds_read_b64 v[176:177], v244 offset:0
ds_read_b64 v[180:181], v245 offset:0
ds_read_b64 v[184:185], v246 offset:0
ds_read_b64 v[188:189], v247 offset:0
ds_read_b64 v[192:193], v248 offset:0
ds_read_b64 v[196:197], v249 offset:0
ds_read_b64 v[200:201], v250 offset:0
ds_read_b64 v[204:205], v251 offset:0
ds_read_b64 v[178:179], v244 offset:4096
ds_read_b64 v[182:183], v245 offset:4096
ds_read_b64 v[186:187], v246 offset:4096
ds_read_b64 v[190:191], v247 offset:4096
ds_read_b64 v[194:195], v248 offset:4096
ds_read_b64 v[198:199], v249 offset:4096
ds_read_b64 v[202:203], v250 offset:4096
ds_read_b64 v[206:207], v251 offset:4096
v_lshlrev_b32 v24, 16, v208
v_and_b32 v25, 0xffff0000, v208
v_lshlrev_b32 v26, 16, v209
v_and_b32 v27, 0xffff0000, v209
s_waitcnt lgkmcnt(15)
v_lshlrev_b32 v160, 16, v176
v_and_b32 v161, 0xffff0000, v176
v_lshlrev_b32 v162, 16, v177
v_and_b32 v163, 0xffff0000, v177
v_fma_f32 v16, v16, v24, v160
v_fma_f32 v17, v17, v25, v161
v_fma_f32 v18, v18, v26, v162
v_fma_f32 v19, v19, v27, v163
v_cvt_pk_bf16_f32 v176, v16, v17
v_cvt_pk_bf16_f32 v177, v18, v19
ds_write_b64 v244, v[176:177] offset:0
v_lshlrev_b32 v40, 16, v210
v_and_b32 v41, 0xffff0000, v210
v_lshlrev_b32 v42, 16, v211
v_and_b32 v43, 0xffff0000, v211
s_waitcnt lgkmcnt(15)
v_lshlrev_b32 v164, 16, v180
v_and_b32 v165, 0xffff0000, v180
v_lshlrev_b32 v166, 16, v181
v_and_b32 v167, 0xffff0000, v181
v_fma_f32 v32, v32, v40, v164
v_fma_f32 v33, v33, v41, v165
v_fma_f32 v34, v34, v42, v166
v_fma_f32 v35, v35, v43, v167
v_cvt_pk_bf16_f32 v180, v32, v33
v_cvt_pk_bf16_f32 v181, v34, v35
ds_write_b64 v245, v[180:181] offset:0
v_lshlrev_b32 v56, 16, v216
v_and_b32 v57, 0xffff0000, v216
v_lshlrev_b32 v58, 16, v217
v_and_b32 v59, 0xffff0000, v217
s_waitcnt lgkmcnt(15)
v_lshlrev_b32 v160, 16, v184
v_and_b32 v161, 0xffff0000, v184
v_lshlrev_b32 v162, 16, v185
v_and_b32 v163, 0xffff0000, v185
v_fma_f32 v48, v48, v56, v160
v_fma_f32 v49, v49, v57, v161
v_fma_f32 v50, v50, v58, v162
v_fma_f32 v51, v51, v59, v163
v_cvt_pk_bf16_f32 v184, v48, v49
v_cvt_pk_bf16_f32 v185, v50, v51
ds_write_b64 v246, v[184:185] offset:0
v_lshlrev_b32 v72, 16, v218
v_and_b32 v73, 0xffff0000, v218
v_lshlrev_b32 v74, 16, v219
v_and_b32 v75, 0xffff0000, v219
s_waitcnt lgkmcnt(15)
v_lshlrev_b32 v164, 16, v188
v_and_b32 v165, 0xffff0000, v188
v_lshlrev_b32 v166, 16, v189
v_and_b32 v167, 0xffff0000, v189
v_fma_f32 v64, v64, v72, v164
v_fma_f32 v65, v65, v73, v165
v_fma_f32 v66, v66, v74, v166
v_fma_f32 v67, v67, v75, v167
v_cvt_pk_bf16_f32 v188, v64, v65
v_cvt_pk_bf16_f32 v189, v66, v67
ds_write_b64 v247, v[188:189] offset:0
v_lshlrev_b32 v88, 16, v224
v_and_b32 v89, 0xffff0000, v224
v_lshlrev_b32 v90, 16, v225
v_and_b32 v91, 0xffff0000, v225
s_waitcnt lgkmcnt(15)
v_lshlrev_b32 v160, 16, v192
v_and_b32 v161, 0xffff0000, v192
v_lshlrev_b32 v162, 16, v193
v_and_b32 v163, 0xffff0000, v193
v_fma_f32 v80, v80, v88, v160
v_fma_f32 v81, v81, v89, v161
v_fma_f32 v82, v82, v90, v162
v_fma_f32 v83, v83, v91, v163
v_cvt_pk_bf16_f32 v192, v80, v81
v_cvt_pk_bf16_f32 v193, v82, v83
ds_write_b64 v248, v[192:193] offset:0
v_lshlrev_b32 v104, 16, v226
v_and_b32 v105, 0xffff0000, v226
v_lshlrev_b32 v106, 16, v227
v_and_b32 v107, 0xffff0000, v227
s_waitcnt lgkmcnt(15)
v_lshlrev_b32 v164, 16, v196
v_and_b32 v165, 0xffff0000, v196
v_lshlrev_b32 v166, 16, v197
v_and_b32 v167, 0xffff0000, v197
v_fma_f32 v96, v96, v104, v164
v_fma_f32 v97, v97, v105, v165
v_fma_f32 v98, v98, v106, v166
v_fma_f32 v99, v99, v107, v167
v_cvt_pk_bf16_f32 v196, v96, v97
v_cvt_pk_bf16_f32 v197, v98, v99
ds_write_b64 v249, v[196:197] offset:0
v_lshlrev_b32 v120, 16, v232
v_and_b32 v121, 0xffff0000, v232
v_lshlrev_b32 v122, 16, v233
v_and_b32 v123, 0xffff0000, v233
s_waitcnt lgkmcnt(15)
v_lshlrev_b32 v160, 16, v200
v_and_b32 v161, 0xffff0000, v200
v_lshlrev_b32 v162, 16, v201
v_and_b32 v163, 0xffff0000, v201
v_fma_f32 v112, v112, v120, v160
v_fma_f32 v113, v113, v121, v161
v_fma_f32 v114, v114, v122, v162
v_fma_f32 v115, v115, v123, v163
v_cvt_pk_bf16_f32 v200, v112, v113
v_cvt_pk_bf16_f32 v201, v114, v115
ds_write_b64 v250, v[200:201] offset:0
v_lshlrev_b32 v136, 16, v234
v_and_b32 v137, 0xffff0000, v234
v_lshlrev_b32 v138, 16, v235
v_and_b32 v139, 0xffff0000, v235
s_waitcnt lgkmcnt(15)
v_lshlrev_b32 v164, 16, v204
v_and_b32 v165, 0xffff0000, v204
v_lshlrev_b32 v166, 16, v205
v_and_b32 v167, 0xffff0000, v205
v_fma_f32 v128, v128, v136, v164
v_fma_f32 v129, v129, v137, v165
v_fma_f32 v130, v130, v138, v166
v_fma_f32 v131, v131, v139, v167
v_cvt_pk_bf16_f32 v204, v128, v129
v_cvt_pk_bf16_f32 v205, v130, v131
ds_write_b64 v251, v[204:205] offset:0
ds_read_b128 v[24:27], v252 offset:0
ds_read_b128 v[40:43], v252 offset:1024
ds_read_b128 v[56:59], v252 offset:2048
ds_read_b128 v[72:75], v252 offset:3072
s_mov_b32 s38, 0
s_waitcnt lgkmcnt(3)
buffer_store_dwordx4 v[24:27], v240, s[52:55], s38 offen sc0 sc1
s_mov_b32 s38, 8192
s_waitcnt lgkmcnt(2)
buffer_store_dwordx4 v[40:43], v241, s[52:55], s38 offen sc0 sc1
s_mov_b32 s38, 16384
s_waitcnt lgkmcnt(1)
buffer_store_dwordx4 v[56:59], v242, s[52:55], s38 offen sc0 sc1
s_mov_b32 s38, 24576
s_waitcnt lgkmcnt(0)
buffer_store_dwordx4 v[72:75], v243, s[52:55], s38 offen sc0 sc1
v_lshlrev_b32 v28, 16, v212
v_and_b32 v29, 0xffff0000, v212
v_lshlrev_b32 v30, 16, v213
v_and_b32 v31, 0xffff0000, v213
v_lshlrev_b32 v160, 16, v178
v_and_b32 v161, 0xffff0000, v178
v_lshlrev_b32 v162, 16, v179
v_and_b32 v163, 0xffff0000, v179
v_fma_f32 v20, v20, v28, v160
v_fma_f32 v21, v21, v29, v161
v_fma_f32 v22, v22, v30, v162
v_fma_f32 v23, v23, v31, v163
v_cvt_pk_bf16_f32 v178, v20, v21
v_cvt_pk_bf16_f32 v179, v22, v23
ds_write_b64 v244, v[178:179] offset:4096
v_lshlrev_b32 v44, 16, v214
v_and_b32 v45, 0xffff0000, v214
v_lshlrev_b32 v46, 16, v215
v_and_b32 v47, 0xffff0000, v215
v_lshlrev_b32 v164, 16, v182
v_and_b32 v165, 0xffff0000, v182
v_lshlrev_b32 v166, 16, v183
v_and_b32 v167, 0xffff0000, v183
v_fma_f32 v36, v36, v44, v164
v_fma_f32 v37, v37, v45, v165
v_fma_f32 v38, v38, v46, v166
v_fma_f32 v39, v39, v47, v167
v_cvt_pk_bf16_f32 v182, v36, v37
v_cvt_pk_bf16_f32 v183, v38, v39
ds_write_b64 v245, v[182:183] offset:4096
v_lshlrev_b32 v60, 16, v220
v_and_b32 v61, 0xffff0000, v220
v_lshlrev_b32 v62, 16, v221
v_and_b32 v63, 0xffff0000, v221
v_lshlrev_b32 v160, 16, v186
v_and_b32 v161, 0xffff0000, v186
v_lshlrev_b32 v162, 16, v187
v_and_b32 v163, 0xffff0000, v187
v_fma_f32 v52, v52, v60, v160
v_fma_f32 v53, v53, v61, v161
v_fma_f32 v54, v54, v62, v162
v_fma_f32 v55, v55, v63, v163
v_cvt_pk_bf16_f32 v186, v52, v53
v_cvt_pk_bf16_f32 v187, v54, v55
ds_write_b64 v246, v[186:187] offset:4096
v_lshlrev_b32 v76, 16, v222
v_and_b32 v77, 0xffff0000, v222
v_lshlrev_b32 v78, 16, v223
v_and_b32 v79, 0xffff0000, v223
v_lshlrev_b32 v164, 16, v190
v_and_b32 v165, 0xffff0000, v190
v_lshlrev_b32 v166, 16, v191
v_and_b32 v167, 0xffff0000, v191
v_fma_f32 v68, v68, v76, v164
v_fma_f32 v69, v69, v77, v165
v_fma_f32 v70, v70, v78, v166
v_fma_f32 v71, v71, v79, v167
v_cvt_pk_bf16_f32 v190, v68, v69
v_cvt_pk_bf16_f32 v191, v70, v71
ds_write_b64 v247, v[190:191] offset:4096
v_lshlrev_b32 v92, 16, v228
v_and_b32 v93, 0xffff0000, v228
v_lshlrev_b32 v94, 16, v229
v_and_b32 v95, 0xffff0000, v229
v_lshlrev_b32 v160, 16, v194
v_and_b32 v161, 0xffff0000, v194
v_lshlrev_b32 v162, 16, v195
v_and_b32 v163, 0xffff0000, v195
v_fma_f32 v84, v84, v92, v160
v_fma_f32 v85, v85, v93, v161
v_fma_f32 v86, v86, v94, v162
v_fma_f32 v87, v87, v95, v163
v_cvt_pk_bf16_f32 v194, v84, v85
v_cvt_pk_bf16_f32 v195, v86, v87
ds_write_b64 v248, v[194:195] offset:4096
v_lshlrev_b32 v108, 16, v230
v_and_b32 v109, 0xffff0000, v230
v_lshlrev_b32 v110, 16, v231
v_and_b32 v111, 0xffff0000, v231
v_lshlrev_b32 v164, 16, v198
v_and_b32 v165, 0xffff0000, v198
v_lshlrev_b32 v166, 16, v199
v_and_b32 v167, 0xffff0000, v199
v_fma_f32 v100, v100, v108, v164
v_fma_f32 v101, v101, v109, v165
v_fma_f32 v102, v102, v110, v166
v_fma_f32 v103, v103, v111, v167
v_cvt_pk_bf16_f32 v198, v100, v101
v_cvt_pk_bf16_f32 v199, v102, v103
ds_write_b64 v249, v[198:199] offset:4096
v_lshlrev_b32 v124, 16, v236
v_and_b32 v125, 0xffff0000, v236
v_lshlrev_b32 v126, 16, v237
v_and_b32 v127, 0xffff0000, v237
v_lshlrev_b32 v160, 16, v202
v_and_b32 v161, 0xffff0000, v202
v_lshlrev_b32 v162, 16, v203
v_and_b32 v163, 0xffff0000, v203
v_fma_f32 v116, v116, v124, v160
v_fma_f32 v117, v117, v125, v161
v_fma_f32 v118, v118, v126, v162
v_fma_f32 v119, v119, v127, v163
v_cvt_pk_bf16_f32 v202, v116, v117
v_cvt_pk_bf16_f32 v203, v118, v119
ds_write_b64 v250, v[202:203] offset:4096
v_lshlrev_b32 v140, 16, v238
v_and_b32 v141, 0xffff0000, v238
v_lshlrev_b32 v142, 16, v239
v_and_b32 v143, 0xffff0000, v239
v_lshlrev_b32 v164, 16, v206
v_and_b32 v165, 0xffff0000, v206
v_lshlrev_b32 v166, 16, v207
v_and_b32 v167, 0xffff0000, v207
v_fma_f32 v132, v132, v140, v164
v_fma_f32 v133, v133, v141, v165
v_fma_f32 v134, v134, v142, v166
v_fma_f32 v135, v135, v143, v167
v_cvt_pk_bf16_f32 v206, v132, v133
v_cvt_pk_bf16_f32 v207, v134, v135
ds_write_b64 v251, v[206:207] offset:4096
ds_read_b128 v[88:91], v252 offset:4096
ds_read_b128 v[104:107], v252 offset:5120
ds_read_b128 v[120:123], v252 offset:6144
ds_read_b128 v[136:139], v252 offset:7168
s_mov_b32 s38, 32768
s_waitcnt lgkmcnt(3)
buffer_store_dwordx4 v[88:91], v240, s[52:55], s38 offen sc0 sc1
s_mov_b32 s38, 40960
s_waitcnt lgkmcnt(2)
buffer_store_dwordx4 v[104:107], v241, s[52:55], s38 offen sc0 sc1
s_mov_b32 s38, 49152
s_waitcnt lgkmcnt(1)
buffer_store_dwordx4 v[120:123], v242, s[52:55], s38 offen sc0 sc1
s_mov_b32 s38, 57344
s_waitcnt lgkmcnt(0)
buffer_store_dwordx4 v[136:139], v243, s[52:55], s38 offen sc0 sc1
L_fin_k:
L_end_k:
s_endpgm
L_fbw:
s_nop 4
v_mov_b32 v149, 1
ds_write_b32 v1, v149
s_waitcnt lgkmcnt(0)
s_branch L_fbw_ret
L_fb:
s_waitcnt vmcnt(0) lgkmcnt(0)
s_barrier
s_mov_b32 s55, 1
v_mov_b32 v224, 0xff800000
v_mov_b32 v225, 0xff800000
v_mov_b32 v226, 0xff800000
v_mov_b32 v227, 0xff800000
v_mov_b32 v228, 0xff800000
v_mov_b32 v229, 0xff800000
v_mov_b32 v230, 0xff800000
v_mov_b32 v231, 0xff800000
v_mov_b32 v232, 0xff800000
v_mov_b32 v233, 0xff800000
v_mov_b32 v234, 0xff800000
v_mov_b32 v235, 0xff800000
v_mov_b32 v236, 0xff800000
v_mov_b32 v237, 0xff800000
v_mov_b32 v238, 0xff800000
v_mov_b32 v239, 0xff800000
v_and_b32 v13, 15, v0
v_bfe_u32 v14, v0, 4, 2
v_lshlrev_b32 v14, 4, v14
v_lshl_add_u32 v13, v13, 8, v14
s_lshr_b32 s36, s27, 3
s_lshl_b32 s36, s36, 19
s_add_u32 s36, s36, 393216
s_mov_b32 s52, s36
s_mov_b32 s53, s36
s_mov_b32 s37, 0
L_fb_loop:
buffer_load_dwordx4 a[64:67], v13, s[44:47], s36 offen offset:0
buffer_load_dwordx4 a[68:71], v13, s[44:47], s36 offen offset:64
buffer_load_dwordx4 a[72:75], v13, s[44:47], s36 offen offset:128
buffer_load_dwordx4 a[76:79], v13, s[44:47], s36 offen offset:192
s_waitcnt vmcnt(0)
v_mfma_f32_16x16x32_bf16 v[144:147], a[64:67], a[0:3], 0
v_mfma_f32_16x16x32_bf16 v[148:151], a[64:67], a[4:7], 0
v_mfma_f32_16x16x32_bf16 v[152:155], a[64:67], a[8:11], 0
v_mfma_f32_16x16x32_bf16 v[156:159], a[64:67], a[12:15], 0
v_mfma_f32_16x16x32_bf16 v[144:147], a[68:71], a[16:19], v[144:147]
v_mfma_f32_16x16x32_bf16 v[148:151], a[68:71], a[20:23], v[148:151]
v_mfma_f32_16x16x32_bf16 v[152:155], a[68:71], a[24:27], v[152:155]
v_mfma_f32_16x16x32_bf16 v[156:159], a[68:71], a[28:31], v[156:159]
v_mfma_f32_16x16x32_bf16 v[144:147], a[72:75], a[32:35], v[144:147]
v_mfma_f32_16x16x32_bf16 v[148:151], a[72:75], a[36:39], v[148:151]
v_mfma_f32_16x16x32_bf16 v[152:155], a[72:75], a[40:43], v[152:155]
v_mfma_f32_16x16x32_bf16 v[156:159], a[72:75], a[44:47], v[156:159]
v_mfma_f32_16x16x32_bf16 v[144:147], a[76:79], a[48:51], v[144:147]
v_mfma_f32_16x16x32_bf16 v[148:151], a[76:79], a[52:55], v[148:151]
v_mfma_f32_16x16x32_bf16 v[152:155], a[76:79], a[56:59], v[152:155]
v_mfma_f32_16x16x32_bf16 v[156:159], a[76:79], a[60:63], v[156:159]
s_nop 15
v_max_f32 v224, v224, v144
v_max_f32 v225, v225, v145
v_max_f32 v226, v226, v146
v_max_f32 v227, v227, v147
v_max_f32 v228, v228, v148
v_max_f32 v229, v229, v149
v_max_f32 v230, v230, v150
v_max_f32 v231, v231, v151
v_max_f32 v232, v232, v152
v_max_f32 v233, v233, v153
v_max_f32 v234, v234, v154
v_max_f32 v235, v235, v155
v_max_f32 v236, v236, v156
v_max_f32 v237, v237, v157
v_max_f32 v238, v238, v158
v_max_f32 v239, v239, v159
s_add_u32 s36, s36, 4096
s_add_u32 s37, s37, 1
s_cmp_lt_u32 s37, 32
s_cbranch_scc1 L_fb_loop
v_max3_f32 v224, v224, v225, v226
v_max_f32 v224, v224, v227
v_mov_b32 v14, v224
s_nop 1
v_permlane16_swap_b32 v224, v14
v_max_f32 v224, v224, v14
v_mov_b32 v14, v224
s_nop 1
v_permlane32_swap_b32 v224, v14
v_max_f32 v224, v224, v14
v_sub_f32 v224, 0, v224
v_mov_b32 v225, v224
v_mov_b32 v226, v224
v_mov_b32 v227, v224
v_max3_f32 v228, v228, v229, v230
v_max_f32 v228, v228, v231
v_mov_b32 v14, v228
s_nop 1
v_permlane16_swap_b32 v228, v14
v_max_f32 v228, v228, v14
v_mov_b32 v14, v228
s_nop 1
v_permlane32_swap_b32 v228, v14
v_max_f32 v228, v228, v14
v_sub_f32 v228, 0, v228
v_mov_b32 v229, v228
v_mov_b32 v230, v228
v_mov_b32 v231, v228
v_max3_f32 v232, v232, v233, v234
v_max_f32 v232, v232, v235
v_mov_b32 v14, v232
s_nop 1
v_permlane16_swap_b32 v232, v14
v_max_f32 v232, v232, v14
v_mov_b32 v14, v232
s_nop 1
v_permlane32_swap_b32 v232, v14
v_max_f32 v232, v232, v14
v_sub_f32 v232, 0, v232
v_mov_b32 v233, v232
v_mov_b32 v234, v232
v_mov_b32 v235, v232
v_max3_f32 v236, v236, v237, v238
v_max_f32 v236, v236, v239
v_mov_b32 v14, v236
s_nop 1
v_permlane16_swap_b32 v236, v14
v_max_f32 v236, v236, v14
v_mov_b32 v14, v236
s_nop 1
v_permlane32_swap_b32 v236, v14
v_max_f32 v236, v236, v14
v_sub_f32 v236, 0, v236
v_mov_b32 v237, v236
v_mov_b32 v238, v236
v_mov_b32 v239, v236
s_add_u32 m0, s54, 131072
s_nop 0
buffer_load_dwordx4 v8, s[44:47], s52 offen offset:0 lds
buffer_load_dwordx4 v9, s[44:47], s52 offen offset:1024 lds
s_add_u32 s52, s52, 8192
s_add_u32 m0, s54, 98304
s_nop 0
buffer_load_dwordx4 v10, s[48:51], s53 offen offset:0 lds
buffer_load_dwordx4 v11, s[48:51], s53 offen offset:1024 lds
s_add_u32 s53, s53, 8192
s_add_u32 m0, s54, 139264
s_nop 0
buffer_load_dwordx4 v8, s[44:47], s52 offen offset:0 lds
buffer_load_dwordx4 v9, s[44:47], s52 offen offset:1024 lds
s_add_u32 s52, s52, 8192
s_add_u32 m0, s54, 106496
s_nop 0
buffer_load_dwordx4 v10, s[48:51], s53 offen offset:0 lds
buffer_load_dwordx4 v11, s[48:51], s53 offen offset:1024 lds
s_add_u32 s53, s53, 8192
s_add_u32 m0, s54, 147456
s_nop 0
buffer_load_dwordx4 v8, s[44:47], s52 offen offset:0 lds
buffer_load_dwordx4 v9, s[44:47], s52 offen offset:1024 lds
s_add_u32 s52, s52, 8192
s_add_u32 m0, s54, 114688
s_nop 0
buffer_load_dwordx4 v10, s[48:51], s53 offen offset:0 lds
buffer_load_dwordx4 v11, s[48:51], s53 offen offset:1024 lds
s_add_u32 s53, s53, 8192
s_add_u32 m0, s54, 155648
s_nop 0
buffer_load_dwordx4 v8, s[44:47], s52 offen offset:0 lds
buffer_load_dwordx4 v9, s[44:47], s52 offen offset:1024 lds
s_add_u32 s52, s52, 8192
s_add_u32 m0, s54, 122880
s_nop 0
buffer_load_dwordx4 v10, s[48:51], s53 offen offset:0 lds
buffer_load_dwordx4 v11, s[48:51], s53 offen offset:1024 lds
s_add_u32 s53, s53, 8192
s_add_u32 s40, s88, 4194304
s_addc_u32 s41, s89, 0
s_and_b32 s41, s41, 0xffff
s_mov_b32 s42, 0x4000000
s_mov_b32 s43, 0x00020000
s_mul_i32 s38, s27, 7
s_and_b32 s39, s27, 1
s_add_u32 s33, s38, s39
s_lshl_b32 s33, s33, 16
s_cmp_eq_u32 s39, 0
s_cselect_b32 s39, 6, 0
s_add_u32 s39, s38, s39
s_lshr_b32 s3, s39, 1
s_lshl_b32 s3, s3, 17
s_and_b32 s39, s39, 1
s_lshl_b32 s39, s39, 16
s_add_u32 s32, s39, s3
s_waitcnt vmcnt(0)
s_barrier
s_branch L_attn_k
L_lnpoll:
s_mov_b32 s39, 0
v_accvgpr_read_b32 v14, a215
L_lnpoll_loop:
buffer_load_dword a197, v14, s[56:59], 0 offen sc0 sc1
s_waitcnt vmcnt(0)
v_accvgpr_read_b32 v15, a197
v_accvgpr_write_b32 a95, v14
v_accvgpr_read_b32 v14, a196
v_and_b32 v15, v15, v14
v_cmp_ne_u32 vcc, v14, v15
v_accvgpr_read_b32 v14, a95
s_add_u32 s39, s39, 1
s_cmp_gt_u32 s39, 0x40000
s_cbranch_scc1 L_lnpoll_ret
s_nop 0
s_cbranch_vccz L_lnpoll_ret
s_branch L_lnpoll_loop
L_o1:
s_cmp_eq_u32 s31, 1
s_cbranch_scc0 L_o1_ret
s_add_u32 s56, s88, 41943040
s_addc_u32 s57, s89, 0
s_and_b32 s57, s57, 0xffff
s_mov_b32 s58, 0x4000
s_mov_b32 s59, 0x00020000
s_lshl_b32 s38, s28, 8
s_add_u32 s38, s38, 2048
v_and_b32 v13, 31, v0
v_lshlrev_b32 v13, 2, v13
v_add_u32 v13, s38, v13
buffer_load_dword v14, v13, s[56:59], 0 offen sc0 sc1
s_branch L_o1_ret
L_o2:
s_cmp_eq_u32 s31, 1
s_cbranch_scc0 L_o2_ret
s_waitcnt vmcnt(0)
v_cmp_ne_u32 vcc, 1, v14
s_nop 4
s_cbranch_vccz L_o2_ret
s_add_u32 s56, s88, 41943040
s_addc_u32 s57, s89, 0
s_and_b32 s57, s57, 0xffff
s_mov_b32 s58, 0x4000
s_mov_b32 s59, 0x00020000
s_lshl_b32 s38, s28, 8
s_add_u32 s38, s38, 2048
v_and_b32 v13, 31, v0
v_lshlrev_b32 v13, 2, v13
v_add_u32 v13, s38, v13
s_mov_b32 s39, 0
L_o2p_loop:
buffer_load_dword v14, v13, s[56:59], 0 offen sc0 sc1
s_waitcnt vmcnt(0)
v_cmp_ne_u32 vcc, 1, v14
s_add_u32 s39, s39, 1
s_cmp_gt_u32 s39, 0x40000
s_cbranch_scc1 L_o2p_done
s_nop 1
s_cbranch_vccz L_o2p_done
s_branch L_o2p_loop
L_o2p_done:
s_branch L_o2_ret
L_end_k2:
.section .rodata,"a"
.p2align 6
.amdhsa_kernel recurrent_scan__sliding_block_cached__dense_activation_squared_relu__prompt_kernel
  .amdhsa_next_free_vgpr 512
  .amdhsa_next_free_sgpr 102
  .amdhsa_accum_offset 256
  .amdhsa_group_segment_fixed_size 0
  .amdhsa_kernarg_size 104
  .amdhsa_user_sgpr_count 2
  .amdhsa_user_sgpr_kernarg_segment_ptr 1
  .amdhsa_system_sgpr_workgroup_id_x 1
  .amdhsa_float_denorm_mode_32 3
  .amdhsa_float_denorm_mode_16_64 3
.end_amdhsa_kernel
.text
```
